```python
import torch

def _softmax(x, axis=-1):
    return torch.softmax(x, dim=axis)
def _gelu(x):
    return torch.nn.functional.gelu(x, approximate="tanh")
def _silu(x):
    return torch.nn.functional.silu(x)
def _sigmoid(x):
    return torch.sigmoid(x)
def _layernorm(x, axis=-1, eps=1e-5):
    m = x.mean(dim=axis, keepdim=True)
    v = x.var(dim=axis, keepdim=True, unbiased=False)
    return (x - m) / torch.sqrt(v + eps)
def _scatter_add(tgt, idx, src, axis=0):
    return tgt.clone().index_add_(axis, idx, src)
def _segment_sum(src, seg, n):
    out = torch.zeros((n,) + src.shape[1:], dtype=src.dtype)
    return out.index_add_(0, seg, src)
def _pad(x, pw):
    flat = tuple(v for pair in reversed(pw) for v in pair)
    return torch.nn.functional.pad(x, flat)

kernel_name = 'recurrent_scan__gqa_block_cached__geglu_ffn__prompt'

def setup_inputs():

    _w = (lambda a: (lambda t: t.to(torch.bfloat16) if t.is_floating_point() else t)(torch.as_tensor(a)))
    def _A_setup():
        B, Sq, D = 1, 2048, 512
        Hq, Hkv, Sk, Dh = 32, 8, 2048, 128
        assert Hq % Hkv == 0, (Hq, Hkv)
        return {
            "x": _w((lambda *s: torch.randn(*s, dtype=torch.bfloat16) * 0.05)(B, Sq, D)),
            "k_cache": _w((lambda *s: torch.randn(*s, dtype=torch.bfloat16) * 0.8)(B, Hkv, Sk, Dh)),
            "v_cache": _w((lambda *s: torch.randn(*s, dtype=torch.bfloat16) * 0.2)(B, Hkv, Sk, Dh)),
            "wq": _w((lambda *s: torch.randn(*s, dtype=torch.bfloat16) * 0.8)(D, Hq * Dh) * (D ** -0.5)),
            "wo": _w((lambda *s: torch.randn(*s, dtype=torch.bfloat16) * 0.2)(Hq * Dh, D) * ((Hq * Dh) ** -0.5)),
        }
    _A_in = _A_setup()

    def _B_setup():
        B, S, D, F = 1, 2048, 512, 1792
        return {
            "x": _w((lambda *s: torch.randn(*s, dtype=torch.bfloat16) * 0.05)(B, S, D)),
            "w_gate": _w((lambda *s: torch.randn(*s, dtype=torch.bfloat16) * 0.1)(D, F)),
            "w_up": _w((lambda *s: torch.randn(*s, dtype=torch.bfloat16) * 0.1)(D, F)),
            "w_down": _w((lambda *s: torch.randn(*s, dtype=torch.bfloat16) * 0.1)(F, D)),
        }
    _B_in = _B_setup()

    return {
        "A_x": _A_in["x"],
        "A_k_cache": _A_in["k_cache"],
        "A_v_cache": _A_in["v_cache"],
        "A_wq": _A_in["wq"],
        "A_wo": _A_in["wo"],
        "B_x": _B_in["x"],
        "B_w_gate": _B_in["w_gate"],
        "B_w_up": _B_in["w_up"],
        "B_w_down": _B_in["w_down"],
    }

def reference(A_x, A_k_cache, A_v_cache, A_wq, A_wo, B_x, B_w_gate, B_w_up, B_w_down):
    def _A_ref(x, k_cache, v_cache, wq, wo):
        B, Sq, D = x.shape
        Hq, Dh = 32, 128
        Hkv = k_cache.shape[1]
        rep = Hq // Hkv
        q = (lambda x, *d: x.permute(*d))((x @ wq).reshape(B, Sq, Hq, Dh), 0, 2, 1, 3)
        k = (lambda x, n, axis: torch.repeat_interleave(x, n, dim=axis))(k_cache, rep, axis=1)
        v = (lambda x, n, axis: torch.repeat_interleave(x, n, dim=axis))(v_cache, rep, axis=1)
        scores = torch.einsum("bhqd,bhkd->bhqk", q, k) * (Dh ** -0.5)
        p = _softmax(scores, axis=-1)
        o = torch.einsum("bhqk,bhkd->bhqd", p, v)
        return (lambda x, *d: x.permute(*d))(o, 0, 2, 1, 3).reshape(B, Sq, Hq * Dh) @ wo

    def _B_ref(x, w_gate, w_up, w_down):
        return (_gelu(x @ w_gate) * (x @ w_up)) @ w_down

    x = A_x
    xn = _layernorm(x, axis=-1)
    s = _A_ref(xn, A_k_cache, A_v_cache, A_wq, A_wo)
    g = _silu(_B_ref(xn, B_w_gate, B_w_up, B_w_down))
    return x + s * g
```

```asm
; @launch grid=(256,1,1) block=(256,1,1) lds=163840
.amdgcn_target "amdgcn-amd-amdhsa--gfx950"
.text
.globl recurrent_scan__gqa_block_cached__geglu_ffn__prompt_kernel
.p2align 8
.type recurrent_scan__gqa_block_cached__geglu_ffn__prompt_kernel,@function
recurrent_scan__gqa_block_cached__geglu_ffn__prompt_kernel:
s_cmp_ge_u32 s2, 256
s_cbranch_scc1 L_main_end
s_load_dwordx16 s[64:79], s[0:1], 0
s_load_dwordx8 s[80:87], s[0:1], 64
v_lshrrev_b32 v2, 6, v0
v_and_b32 v0, 63, v0
v_readfirstlane_b32 s3, v2
v_lshlrev_b32 v1, 4, v0
s_and_b32 s4, s2, 3
s_lshl_b32 s4, s4, 1
s_bfe_u32 s5, s2, 0x10003
s_add_u32 s4, s4, s5
s_bfe_u32 s5, s2, 0x10002
s_lshl_b32 s5, s5, 4
s_lshr_b32 s54, s2, 4
s_add_u32 s5, s5, s54
s_and_b32 s54, s5, 3
s_lshl_b32 s54, s54, 1
v_lshrrev_b32 v6, 4, v0
v_and_b32 v5, 15, v0
v_add_u32 v7, 0, v6
v_xor_b32 v7, v7, v5
v_lshlrev_b32 v7, 4, v7
v_add_u32 v8, 0, v6
v_lshl_add_u32 v32, v8, 10, v7
v_add_u32 v7, 4, v6
v_xor_b32 v7, v7, v5
v_lshlrev_b32 v7, 4, v7
v_add_u32 v8, 3, v6
v_lshl_add_u32 v33, v8, 10, v7
v_add_u32 v7, 8, v6
v_xor_b32 v7, v7, v5
v_lshlrev_b32 v7, 4, v7
v_add_u32 v8, 6, v6
v_lshl_add_u32 v34, v8, 10, v7
v_add_u32 v7, 12, v6
v_xor_b32 v7, v7, v5
v_lshlrev_b32 v7, 4, v7
v_add_u32 v8, 9, v6
v_lshl_add_u32 v35, v8, 10, v7
s_lshl_b32 s62, s5, 16
s_lshl_b32 s63, s3, 14
s_add_u32 s62, s62, s63
s_add_u32 s60, s63, 98304
s_lshl_b32 s63, s54, 7
s_and_b32 s61, s5, 15
s_lshl_b32 s61, s61, 2
s_add_u32 s61, s61, s3
s_lshl_b32 s61, s61, 13
v_lshlrev_b32 v31, 3, v1
v_add_u32 v31, s61, v31
s_getpc_b64 s[46:47]
L_pc0:
v_min_u32 v7, L_code_end-L_pc0-4, v31
global_load_dword v30, v7, s[46:47]
s_waitcnt lgkmcnt(0)
s_mov_b32 s36, s64
s_mov_b32 s37, s65
s_mov_b32 s38, 2097152
s_mov_b32 s39, 0x20000
s_add_u32 s61, s63, 0
s_and_b32 s61, s61, 0x3ff
s_add_u32 m0, s60, 0
s_add_u32 s61, s61, s62
buffer_load_dwordx4 v32, s[36:39], s61 offen offset:0 lds
buffer_load_dwordx4 v33, s[36:39], s61 offen offset:1024 lds
buffer_load_dwordx4 v34, s[36:39], s61 offen offset:2048 lds
buffer_load_dwordx4 v35, s[36:39], s61 offen offset:3072 lds
s_add_u32 s61, s63, 256
s_and_b32 s61, s61, 0x3ff
s_add_u32 m0, s60, 4096
s_add_u32 s61, s61, s62
buffer_load_dwordx4 v32, s[36:39], s61 offen offset:0 lds
buffer_load_dwordx4 v33, s[36:39], s61 offen offset:1024 lds
buffer_load_dwordx4 v34, s[36:39], s61 offen offset:2048 lds
buffer_load_dwordx4 v35, s[36:39], s61 offen offset:3072 lds
s_add_u32 s61, s63, 512
s_and_b32 s61, s61, 0x3ff
s_add_u32 m0, s60, 8192
s_add_u32 s61, s61, s62
buffer_load_dwordx4 v32, s[36:39], s61 offen offset:0 lds
buffer_load_dwordx4 v33, s[36:39], s61 offen offset:1024 lds
buffer_load_dwordx4 v34, s[36:39], s61 offen offset:2048 lds
buffer_load_dwordx4 v35, s[36:39], s61 offen offset:3072 lds
s_add_u32 s61, s63, 768
s_and_b32 s61, s61, 0x3ff
s_add_u32 m0, s60, 12288
s_add_u32 s61, s61, s62
buffer_load_dwordx4 v32, s[36:39], s61 offen offset:0 lds
buffer_load_dwordx4 v33, s[36:39], s61 offen offset:1024 lds
buffer_load_dwordx4 v34, s[36:39], s61 offen offset:2048 lds
buffer_load_dwordx4 v35, s[36:39], s61 offen offset:3072 lds
v_add_u32 v7, 0, v6
v_xor_b32 v7, v7, v5
v_lshlrev_b32 v7, 4, v7
v_lshl_add_u32 v7, v5, 8, v7
v_add_u32 v50, s60, v7
v_add_u32 v7, 4, v6
v_xor_b32 v7, v7, v5
v_lshlrev_b32 v7, 4, v7
v_lshl_add_u32 v7, v5, 8, v7
v_add_u32 v51, s60, v7
v_add_u32 v7, 8, v6
v_xor_b32 v7, v7, v5
v_lshlrev_b32 v7, 4, v7
v_lshl_add_u32 v7, v5, 8, v7
v_add_u32 v52, s60, v7
v_add_u32 v7, 12, v6
v_xor_b32 v7, v7, v5
v_lshlrev_b32 v7, 4, v7
v_lshl_add_u32 v7, v5, 8, v7
v_add_u32 v53, s60, v7
s_add_u32 s62, s4, s5
s_and_b32 s62, s62, 1
s_sub_u32 s6, 4, s62
s_lshr_b32 s62, s4, 1
s_mul_i32 s7, s62, 7
s_sub_u32 s63, 7, s6
s_and_b32 s61, s4, 1
s_mul_i32 s63, s63, s61
s_add_u32 s7, s7, s63
s_add_u32 s62, s7, s3
s_lshl_b32 s55, s62, 7
s_cmp_lt_u32 s3, s6
s_cselect_b32 s55, s55, 0x40000000
s_lshl_b32 s62, s4, 10
s_lshl_b32 s63, s3, 8
s_add_u32 s56, s62, s63
s_lshl_b32 s62, s7, 16
s_add_u32 s57, s62, s63
s_cmp_eq_u32 s6, 4
s_cselect_b32 s58, s57, 0x40000000
s_lshl_b32 s62, s4, 19
s_add_u32 s59, s62, s63
s_mul_i32 s50, s3, 24576
s_lshl_b32 s48, s3, 12
s_add_u32 s48, s48, 98304
s_mov_b32 s16, s76
s_mov_b32 s17, s77
s_mov_b32 s18, 1835008
s_mov_b32 s19, 0x20000
v_lshrrev_b32 v6, 3, v0
v_bfe_u32 v7, v0, 4, 1
v_lshlrev_b32 v7, 1, v7
v_bfe_u32 v8, v0, 5, 1
v_lshl_add_u32 v7, v8, 2, v7
v_and_b32 v8, 7, v0
v_xor_b32 v7, v7, v8
v_lshlrev_b32 v7, 4, v7
v_xor_b32 v8, 64, v7
v_mul_u32_u24 v9, 3584, v6
v_add_u32 v10, v9, v7
v_add_u32 v11, v9, v8
v_add_u32 v11, 27648, v11
v_add_u32 v12, v9, v7
v_add_u32 v12, 55296, v12
v_add_u32 v13, v9, v8
v_add_u32 v13, 82944, v13
v_mul_u32_u24 v9, 8192, v6
v_add_u32 v14, v9, v7
v_add_u32 v15, v9, v8
v_add_u32 v15, 64512, v15
v_add_u32 v16, v9, v7
v_add_u32 v16, 129024, v16
v_add_u32 v17, v9, v8
v_add_u32 v17, 193536, v17
v_mul_u32_u24 v9, 1024, v6
v_add_u32 v18, v9, v7
v_add_u32 v19, v9, v8
v_add_u32 v19, 7168, v19
v_add_u32 v20, v9, v7
v_add_u32 v20, 14336, v20
v_add_u32 v21, v9, v8
v_add_u32 v21, 21504, v21
s_sub_u32 s51, s54, 1
s_mov_b32 s28, s80
s_mov_b32 s29, s81
s_mov_b32 s30, 1835008
s_mov_b32 s31, 0x20000
s_lshr_b32 s62, s4, 1
s_mul_i32 s62, s62, 7
s_and_b32 s61, s4, 1
s_mul_i32 s61, s61, 3
s_add_u32 s62, s62, s61
s_lshl_b32 s62, s62, 16
v_cmp_gt_u32 vcc, 0x40000, v31
v_mov_b32 v9, 0x40000000
s_nop 0
v_cndmask_b32 v9, v9, v31, vcc
v_mov_b32 v54, v9
s_mov_b32 s44, s62
s_mov_b32 s20, s78
s_mov_b32 s21, s79
s_mov_b32 s22, 1835008
s_mov_b32 s23, 0x20000
s_mov_b32 s24, s70
s_mov_b32 s25, s71
s_mov_b32 s26, 4194304
s_mov_b32 s27, 0x20000
s_mov_b32 s32, s72
s_mov_b32 s33, s73
s_mov_b32 s34, 4194304
s_mov_b32 s35, 0x20000
s_lshl_b32 s62, s4, 19
s_mov_b32 s8, s66
s_mov_b32 s9, s67
s_add_u32 s8, s8, s62
s_addc_u32 s9, s9, 0
s_mov_b32 s10, 524288
s_mov_b32 s11, 0x20000
s_mov_b32 s12, s68
s_mov_b32 s13, s69
s_add_u32 s12, s12, s62
s_addc_u32 s13, s13, 0
s_sub_u32 s12, s12, 2048
s_subb_u32 s13, s13, 0
s_mov_b32 s14, 526336
s_mov_b32 s15, 0x20000
s_mov_b32 s40, s86
s_mov_b32 s41, s87
s_mov_b32 s42, 33554432
s_mov_b32 s43, 0x20000
s_mov_b32 s64, s82
s_mov_b32 s65, s83
s_mov_b32 s66, 2097152
s_mov_b32 s67, 0x20000
s_mov_b32 s68, s84
s_mov_b32 s69, s85
s_mov_b32 s70, 256
s_mov_b32 s71, 0x20000
s_lshl_b32 s81, s4, 19
s_lshl_b32 s82, s3, 13
s_lshl_b32 s83, s3, 14
s_lshl_b32 s60, s4, 5
s_add_u32 s60, s60, s5
s_lshl_b32 s60, s60, 2
s_add_u32 s60, s60, s3
s_lshl_b32 s60, s60, 14
s_add_u32 s72, s60, 0
s_add_u32 s73, s60, 4096
s_add_u32 s74, s60, 8192
s_add_u32 s75, s60, 12288
s_add_u32 s76, s60, 16777216
s_add_u32 s77, s60, 16781312
s_add_u32 s78, s60, 16785408
s_add_u32 s79, s60, 16789504
v_bfe_u32 v5, v0, 2, 2
v_lshrrev_b32 v6, 4, v0
v_and_b32 v7, 3, v0
v_lshlrev_b32 v7, 3, v7
v_add_u32 v7, s50, v7
v_lshrrev_b32 v8, 1, v5
v_and_b32 v9, 1, v6
v_lshl_add_u32 v9, v9, 1, v8
v_lshl_add_u32 v26, v6, 3, v5
v_lshl_add_u32 v26, v26, 7, v7
v_lshrrev_b32 v27, 1, v6
v_xor_b32 v27, v27, v6
v_and_b32 v27, 1, v27
v_lshl_add_u32 v27, v27, 1, v8
v_lshl_add_u32 v28, v6, 2, v5
v_lshl_add_u32 v28, v28, 7, v7
s_lshl_b32 s62, s3, 3
v_add_u32 v29, s62, v6
v_and_b32 v5, 15, v0
v_add_u32 v8, 0, v29
v_and_b32 v8, 15, v8
v_xor_b32 v8, v8, v5
v_lshlrev_b32 v8, 4, v8
v_lshl_add_u32 v22, v29, 8, v8
v_add_u32 v8, 0, v6
v_lshlrev_b32 v8, 1, v8
v_xor_b32 v8, v8, v5
v_lshlrev_b32 v8, 4, v8
v_lshl_add_u32 v24, v29, 8, v8
v_add_u32 v8, 4, v29
v_and_b32 v8, 15, v8
v_xor_b32 v8, v8, v5
v_lshlrev_b32 v8, 4, v8
v_lshl_add_u32 v23, v29, 8, v8
v_add_u32 v8, 4, v6
v_lshlrev_b32 v8, 1, v8
v_xor_b32 v8, v8, v5
v_lshlrev_b32 v8, 4, v8
v_lshl_add_u32 v25, v29, 8, v8
v_mov_b32 v29, v9
v_xor_b32 v2, 0, v29
v_lshl_add_u32 v2, v2, 5, v26
v_xor_b32 v6, 0, v27
v_lshl_add_u32 v6, v6, 5, v28
v_xor_b32 v3, 1, v29
v_lshl_add_u32 v3, v3, 5, v26
v_xor_b32 v7, 1, v27
v_lshl_add_u32 v7, v7, 5, v28
v_xor_b32 v4, 2, v29
v_lshl_add_u32 v4, v4, 5, v26
v_xor_b32 v8, 2, v27
v_lshl_add_u32 v8, v8, 5, v28
v_xor_b32 v5, 3, v29
v_lshl_add_u32 v5, v5, 5, v26
v_xor_b32 v9, 3, v27
v_lshl_add_u32 v9, v9, 5, v28
v_add_u32 v0, 98304, v1
v_add_u32 v44, s83, v0
s_mov_b32 s45, 0xffff0000
v_mov_b32 v32, 0x3f803f80
v_mov_b32 v33, 0x3f803f80
v_mov_b32 v34, 0x3f803f80
v_mov_b32 v35, 0x3f803f80
v_bfe_u32 v45, v1, 4, 2
v_bfe_u32 v46, v1, 6, 2
v_lshrrev_b32 v47, 8, v1
s_waitcnt vmcnt(12)
ds_read_b128 v[64:67], v50
ds_read_b128 v[68:71], v51
ds_read_b128 v[72:75], v52
ds_read_b128 v[76:79], v53
s_waitcnt vmcnt(8)
ds_read_b128 v[80:83], v50 offset:4096
ds_read_b128 v[84:87], v51 offset:4096
s_add_u32 s51, s51, 1
s_and_b32 s51, s51, 7
s_mul_i32 s52, s51, 229376
s_add_u32 s52, s52, s55
s_add_u32 m0, s50, 0
s_nop 0
buffer_load_dwordx4 v10, s[16:19], s52 offen lds
ds_read_b128 v[88:91], v52 offset:4096
ds_read_b128 v[92:95], v53 offset:4096
s_waitcnt lgkmcnt(4)
v_mfma_f32_16x16x32_bf16 v[36:39], v[32:35], v[64:67], 0
v_lshlrev_b32 v128, 16, v64
v_and_b32 v129, s45, v64
v_lshlrev_b32 v130, 16, v65
v_and_b32 v131, s45, v65
v_mfma_f32_16x16x32_bf16 v[40:43], v[64:67], v[64:67], 0
v_lshlrev_b32 v132, 16, v66
v_and_b32 v133, s45, v66
v_lshlrev_b32 v134, 16, v67
v_and_b32 v135, s45, v67
v_mfma_f32_16x16x32_bf16 v[36:39], v[32:35], v[68:71], v[36:39]
v_lshlrev_b32 v136, 16, v68
v_and_b32 v137, s45, v68
buffer_load_dwordx4 v11, s[16:19], s52 offen offset:1024 lds
v_lshlrev_b32 v138, 16, v69
v_and_b32 v139, s45, v69
v_mfma_f32_16x16x32_bf16 v[40:43], v[68:71], v[68:71], v[40:43]
v_lshlrev_b32 v140, 16, v70
v_and_b32 v141, s45, v70
v_lshlrev_b32 v142, 16, v71
v_and_b32 v143, s45, v71
v_mfma_f32_16x16x32_bf16 v[36:39], v[32:35], v[72:75], v[36:39]
v_lshlrev_b32 v144, 16, v72
v_and_b32 v145, s45, v72
v_lshlrev_b32 v146, 16, v73
v_and_b32 v147, s45, v73
v_mfma_f32_16x16x32_bf16 v[40:43], v[72:75], v[72:75], v[40:43]
v_lshlrev_b32 v148, 16, v74
v_and_b32 v149, s45, v74
v_lshlrev_b32 v150, 16, v75
buffer_load_dwordx4 v12, s[16:19], s52 offen offset:2048 lds
v_and_b32 v151, s45, v75
v_mfma_f32_16x16x32_bf16 v[36:39], v[32:35], v[76:79], v[36:39]
v_lshlrev_b32 v152, 16, v76
v_and_b32 v153, s45, v76
v_lshlrev_b32 v154, 16, v77
v_and_b32 v155, s45, v77
v_mfma_f32_16x16x32_bf16 v[40:43], v[76:79], v[76:79], v[40:43]
v_lshlrev_b32 v156, 16, v78
v_and_b32 v157, s45, v78
v_lshlrev_b32 v158, 16, v79
v_and_b32 v159, s45, v79
s_waitcnt vmcnt(7)
ds_read_b128 v[96:99], v50 offset:8192
ds_read_b128 v[100:103], v51 offset:8192
ds_read_b128 v[104:107], v52 offset:8192
ds_read_b128 v[108:111], v53 offset:8192
buffer_load_dwordx4 v13, s[16:19], s52 offen offset:3072 lds
s_waitcnt lgkmcnt(4)
v_mfma_f32_16x16x32_bf16 v[36:39], v[32:35], v[80:83], v[36:39]
v_lshlrev_b32 v160, 16, v80
v_and_b32 v161, s45, v80
v_lshlrev_b32 v162, 16, v81
v_and_b32 v163, s45, v81
v_mfma_f32_16x16x32_bf16 v[40:43], v[80:83], v[80:83], v[40:43]
v_lshlrev_b32 v164, 16, v82
v_and_b32 v165, s45, v82
v_lshlrev_b32 v166, 16, v83
v_and_b32 v167, s45, v83
v_mfma_f32_16x16x32_bf16 v[36:39], v[32:35], v[84:87], v[36:39]
v_lshlrev_b32 v168, 16, v84
v_and_b32 v169, s45, v84
v_lshlrev_b32 v170, 16, v85
v_and_b32 v171, s45, v85
s_add_u32 s53, s52, 114688
s_add_u32 m0, s50, 4096
s_nop 0
buffer_load_dwordx4 v10, s[16:19], s53 offen lds
v_mfma_f32_16x16x32_bf16 v[40:43], v[84:87], v[84:87], v[40:43]
v_lshlrev_b32 v172, 16, v86
v_and_b32 v173, s45, v86
v_lshlrev_b32 v174, 16, v87
v_and_b32 v175, s45, v87
v_mfma_f32_16x16x32_bf16 v[36:39], v[32:35], v[88:91], v[36:39]
v_lshlrev_b32 v176, 16, v88
v_and_b32 v177, s45, v88
v_lshlrev_b32 v178, 16, v89
v_and_b32 v179, s45, v89
v_mfma_f32_16x16x32_bf16 v[40:43], v[88:91], v[88:91], v[40:43]
v_lshlrev_b32 v180, 16, v90
v_and_b32 v181, s45, v90
v_lshlrev_b32 v182, 16, v91
v_and_b32 v183, s45, v91
v_mfma_f32_16x16x32_bf16 v[36:39], v[32:35], v[92:95], v[36:39]
buffer_load_dwordx4 v11, s[16:19], s53 offen offset:1024 lds
v_lshlrev_b32 v184, 16, v92
v_and_b32 v185, s45, v92
v_lshlrev_b32 v186, 16, v93
v_and_b32 v187, s45, v93
v_mfma_f32_16x16x32_bf16 v[40:43], v[92:95], v[92:95], v[40:43]
v_lshlrev_b32 v188, 16, v94
v_and_b32 v189, s45, v94
v_lshlrev_b32 v190, 16, v95
v_and_b32 v191, s45, v95
s_waitcnt vmcnt(6)
ds_read_b128 v[112:115], v50 offset:12288
ds_read_b128 v[116:119], v51 offset:12288
ds_read_b128 v[120:123], v52 offset:12288
ds_read_b128 v[124:127], v53 offset:12288
s_waitcnt lgkmcnt(4)
v_mfma_f32_16x16x32_bf16 v[36:39], v[32:35], v[96:99], v[36:39]
buffer_load_dwordx4 v12, s[16:19], s53 offen offset:2048 lds
v_lshlrev_b32 v192, 16, v96
v_and_b32 v193, s45, v96
v_lshlrev_b32 v194, 16, v97
v_and_b32 v195, s45, v97
v_mfma_f32_16x16x32_bf16 v[40:43], v[96:99], v[96:99], v[40:43]
v_lshlrev_b32 v196, 16, v98
v_and_b32 v197, s45, v98
v_lshlrev_b32 v198, 16, v99
v_and_b32 v199, s45, v99
v_mfma_f32_16x16x32_bf16 v[36:39], v[32:35], v[100:103], v[36:39]
v_lshlrev_b32 v200, 16, v100
v_and_b32 v201, s45, v100
v_lshlrev_b32 v202, 16, v101
v_and_b32 v203, s45, v101
v_mfma_f32_16x16x32_bf16 v[40:43], v[100:103], v[100:103], v[40:43]
v_lshlrev_b32 v204, 16, v102
buffer_load_dwordx4 v13, s[16:19], s53 offen offset:3072 lds
v_and_b32 v205, s45, v102
v_lshlrev_b32 v206, 16, v103
v_and_b32 v207, s45, v103
v_mfma_f32_16x16x32_bf16 v[36:39], v[32:35], v[104:107], v[36:39]
v_lshlrev_b32 v208, 16, v104
v_and_b32 v209, s45, v104
v_lshlrev_b32 v210, 16, v105
v_and_b32 v211, s45, v105
v_mfma_f32_16x16x32_bf16 v[40:43], v[104:107], v[104:107], v[40:43]
v_lshlrev_b32 v212, 16, v106
v_and_b32 v213, s45, v106
v_lshlrev_b32 v214, 16, v107
v_and_b32 v215, s45, v107
v_mfma_f32_16x16x32_bf16 v[36:39], v[32:35], v[108:111], v[36:39]
v_lshlrev_b32 v216, 16, v108
v_and_b32 v217, s45, v108
s_add_u32 s51, s51, 1
s_and_b32 s51, s51, 7
s_mul_i32 s52, s51, 229376
s_add_u32 s52, s52, s55
s_add_u32 m0, s50, 8192
s_nop 0
buffer_load_dwordx4 v10, s[16:19], s52 offen lds
v_lshlrev_b32 v218, 16, v109
v_and_b32 v219, s45, v109
v_mfma_f32_16x16x32_bf16 v[40:43], v[108:111], v[108:111], v[40:43]
v_lshlrev_b32 v220, 16, v110
v_and_b32 v221, s45, v110
v_lshlrev_b32 v222, 16, v111
v_and_b32 v223, s45, v111
s_waitcnt lgkmcnt(0)
v_mfma_f32_16x16x32_bf16 v[36:39], v[32:35], v[112:115], v[36:39]
v_mfma_f32_16x16x32_bf16 v[40:43], v[112:115], v[112:115], v[40:43]
v_mfma_f32_16x16x32_bf16 v[36:39], v[32:35], v[116:119], v[36:39]
v_mfma_f32_16x16x32_bf16 v[40:43], v[116:119], v[116:119], v[40:43]
v_mfma_f32_16x16x32_bf16 v[36:39], v[32:35], v[120:123], v[36:39]
v_mfma_f32_16x16x32_bf16 v[40:43], v[120:123], v[120:123], v[40:43]
v_mfma_f32_16x16x32_bf16 v[36:39], v[32:35], v[124:127], v[36:39]
v_mfma_f32_16x16x32_bf16 v[40:43], v[124:127], v[124:127], v[40:43]
buffer_load_dwordx4 v11, s[16:19], s52 offen offset:1024 lds
v_lshlrev_b32 v224, 16, v112
v_and_b32 v225, s45, v112
v_lshlrev_b32 v226, 16, v113
v_and_b32 v227, s45, v113
v_lshlrev_b32 v228, 16, v114
v_and_b32 v229, s45, v114
v_lshlrev_b32 v230, 16, v115
v_and_b32 v231, s45, v115
v_lshlrev_b32 v232, 16, v116
v_and_b32 v233, s45, v116
v_cmp_eq_u32 vcc, 1, v45
v_lshlrev_b32 v234, 16, v117
v_and_b32 v235, s45, v117
v_cndmask_b32 v40, v40, v41, vcc
v_cmp_eq_u32 vcc, 2, v45
v_lshlrev_b32 v236, 16, v118
buffer_load_dwordx4 v12, s[16:19], s52 offen offset:2048 lds
v_and_b32 v237, s45, v118
v_cndmask_b32 v40, v40, v42, vcc
v_cmp_eq_u32 vcc, 3, v45
v_lshlrev_b32 v238, 16, v119
v_and_b32 v239, s45, v119
v_cndmask_b32 v40, v40, v43, vcc
v_cmp_eq_u32 vcc, v46, v47
v_lshlrev_b32 v240, 16, v120
v_and_b32 v241, s45, v120
v_cndmask_b32 v40, 0, v40, vcc
v_mul_f32 v36, 0x3b000000, v36
v_mov_b32 v41, v40
v_cvt_pk_bf16_f32 v37, v36, v36
v_lshlrev_b32 v242, 16, v121
v_permlane16_swap_b32 v40, v41
v_lshlrev_b32 v37, 16, v37
buffer_load_dwordx4 v13, s[16:19], s52 offen offset:3072 lds
v_add_f32 v40, v40, v41
v_mov_b32 v41, v40
v_and_b32 v243, s45, v121
v_lshlrev_b32 v244, 16, v122
v_permlane32_swap_b32 v40, v41
v_and_b32 v245, s45, v122
v_add_f32 v40, v40, v41
v_mul_f32 v40, 0x3b000000, v40
v_fma_f32 v40, -v36, v36, v40
v_max_f32 v40, 0, v40
v_cvt_pk_bf16_f32 v40, v40, v40
v_lshlrev_b32 v40, 16, v40
v_add_f32 v40, 0x3727c5ac, v40
v_cvt_pk_bf16_f32 v40, v40, v40
v_lshlrev_b32 v40, 16, v40
v_sqrt_f32 v40, v40
s_add_u32 s53, s52, 114688
s_add_u32 m0, s50, 12288
s_nop 0
buffer_load_dwordx4 v10, s[16:19], s53 offen lds
v_lshlrev_b32 v246, 16, v123
v_cvt_pk_bf16_f32 v40, v40, v40
v_lshlrev_b32 v40, 16, v40
v_rcp_f32 v42, v40
v_and_b32 v247, s45, v123
v_mul_f32 v43, v37, v42
v_lshlrev_b32 v248, 16, v124
v_and_b32 v249, s45, v124
v_lshlrev_b32 v250, 16, v125
v_and_b32 v251, s45, v125
v_lshlrev_b32 v252, 16, v126
v_and_b32 v253, s45, v126
v_lshlrev_b32 v254, 16, v127
v_and_b32 v255, s45, v127
v_pk_fma_f32 v[128:129], v[128:129], v[42:43], v[42:43] op_sel:[0,0,1] op_sel_hi:[1,0,1] neg_lo:[0,0,1] neg_hi:[0,0,1]
v_pk_fma_f32 v[130:131], v[130:131], v[42:43], v[42:43] op_sel:[0,0,1] op_sel_hi:[1,0,1] neg_lo:[0,0,1] neg_hi:[0,0,1]
buffer_load_dwordx4 v11, s[16:19], s53 offen offset:1024 lds
v_pk_fma_f32 v[132:133], v[132:133], v[42:43], v[42:43] op_sel:[0,0,1] op_sel_hi:[1,0,1] neg_lo:[0,0,1] neg_hi:[0,0,1]
v_pk_fma_f32 v[134:135], v[134:135], v[42:43], v[42:43] op_sel:[0,0,1] op_sel_hi:[1,0,1] neg_lo:[0,0,1] neg_hi:[0,0,1]
v_cvt_pk_bf16_f32 v64, v128, v129
v_cvt_pk_bf16_f32 v65, v130, v131
v_cvt_pk_bf16_f32 v66, v132, v133
v_cvt_pk_bf16_f32 v67, v134, v135
v_pk_fma_f32 v[136:137], v[136:137], v[42:43], v[42:43] op_sel:[0,0,1] op_sel_hi:[1,0,1] neg_lo:[0,0,1] neg_hi:[0,0,1]
v_pk_fma_f32 v[138:139], v[138:139], v[42:43], v[42:43] op_sel:[0,0,1] op_sel_hi:[1,0,1] neg_lo:[0,0,1] neg_hi:[0,0,1]
v_pk_fma_f32 v[140:141], v[140:141], v[42:43], v[42:43] op_sel:[0,0,1] op_sel_hi:[1,0,1] neg_lo:[0,0,1] neg_hi:[0,0,1]
v_pk_fma_f32 v[142:143], v[142:143], v[42:43], v[42:43] op_sel:[0,0,1] op_sel_hi:[1,0,1] neg_lo:[0,0,1] neg_hi:[0,0,1]
ds_write_b128 v44, v[64:67] offset:0
v_cvt_pk_bf16_f32 v68, v136, v137
v_cvt_pk_bf16_f32 v69, v138, v139
v_cvt_pk_bf16_f32 v70, v140, v141
v_cvt_pk_bf16_f32 v71, v142, v143
v_pk_fma_f32 v[144:145], v[144:145], v[42:43], v[42:43] op_sel:[0,0,1] op_sel_hi:[1,0,1] neg_lo:[0,0,1] neg_hi:[0,0,1]
buffer_load_dwordx4 v12, s[16:19], s53 offen offset:2048 lds
v_pk_fma_f32 v[146:147], v[146:147], v[42:43], v[42:43] op_sel:[0,0,1] op_sel_hi:[1,0,1] neg_lo:[0,0,1] neg_hi:[0,0,1]
v_pk_fma_f32 v[148:149], v[148:149], v[42:43], v[42:43] op_sel:[0,0,1] op_sel_hi:[1,0,1] neg_lo:[0,0,1] neg_hi:[0,0,1]
v_pk_fma_f32 v[150:151], v[150:151], v[42:43], v[42:43] op_sel:[0,0,1] op_sel_hi:[1,0,1] neg_lo:[0,0,1] neg_hi:[0,0,1]
ds_write_b128 v44, v[68:71] offset:1024
v_cvt_pk_bf16_f32 v72, v144, v145
v_cvt_pk_bf16_f32 v73, v146, v147
v_cvt_pk_bf16_f32 v74, v148, v149
v_cvt_pk_bf16_f32 v75, v150, v151
v_pk_fma_f32 v[152:153], v[152:153], v[42:43], v[42:43] op_sel:[0,0,1] op_sel_hi:[1,0,1] neg_lo:[0,0,1] neg_hi:[0,0,1]
v_pk_fma_f32 v[154:155], v[154:155], v[42:43], v[42:43] op_sel:[0,0,1] op_sel_hi:[1,0,1] neg_lo:[0,0,1] neg_hi:[0,0,1]
v_pk_fma_f32 v[156:157], v[156:157], v[42:43], v[42:43] op_sel:[0,0,1] op_sel_hi:[1,0,1] neg_lo:[0,0,1] neg_hi:[0,0,1]
v_pk_fma_f32 v[158:159], v[158:159], v[42:43], v[42:43] op_sel:[0,0,1] op_sel_hi:[1,0,1] neg_lo:[0,0,1] neg_hi:[0,0,1]
ds_write_b128 v44, v[72:75] offset:2048
v_cvt_pk_bf16_f32 v76, v152, v153
v_cvt_pk_bf16_f32 v77, v154, v155
v_cvt_pk_bf16_f32 v78, v156, v157
buffer_load_dwordx4 v13, s[16:19], s53 offen offset:3072 lds
v_cvt_pk_bf16_f32 v79, v158, v159
v_pk_fma_f32 v[160:161], v[160:161], v[42:43], v[42:43] op_sel:[0,0,1] op_sel_hi:[1,0,1] neg_lo:[0,0,1] neg_hi:[0,0,1]
v_pk_fma_f32 v[162:163], v[162:163], v[42:43], v[42:43] op_sel:[0,0,1] op_sel_hi:[1,0,1] neg_lo:[0,0,1] neg_hi:[0,0,1]
v_pk_fma_f32 v[164:165], v[164:165], v[42:43], v[42:43] op_sel:[0,0,1] op_sel_hi:[1,0,1] neg_lo:[0,0,1] neg_hi:[0,0,1]
v_pk_fma_f32 v[166:167], v[166:167], v[42:43], v[42:43] op_sel:[0,0,1] op_sel_hi:[1,0,1] neg_lo:[0,0,1] neg_hi:[0,0,1]
ds_write_b128 v44, v[76:79] offset:3072
v_cvt_pk_bf16_f32 v80, v160, v161
v_cvt_pk_bf16_f32 v81, v162, v163
v_cvt_pk_bf16_f32 v82, v164, v165
v_cvt_pk_bf16_f32 v83, v166, v167
v_pk_fma_f32 v[168:169], v[168:169], v[42:43], v[42:43] op_sel:[0,0,1] op_sel_hi:[1,0,1] neg_lo:[0,0,1] neg_hi:[0,0,1]
v_pk_fma_f32 v[170:171], v[170:171], v[42:43], v[42:43] op_sel:[0,0,1] op_sel_hi:[1,0,1] neg_lo:[0,0,1] neg_hi:[0,0,1]
v_pk_fma_f32 v[172:173], v[172:173], v[42:43], v[42:43] op_sel:[0,0,1] op_sel_hi:[1,0,1] neg_lo:[0,0,1] neg_hi:[0,0,1]
v_pk_fma_f32 v[174:175], v[174:175], v[42:43], v[42:43] op_sel:[0,0,1] op_sel_hi:[1,0,1] neg_lo:[0,0,1] neg_hi:[0,0,1]
ds_write_b128 v44, v[80:83] offset:4096
v_cvt_pk_bf16_f32 v84, v168, v169
buffer_load_dword v30, v54, s[28:31], s44 offen
v_cvt_pk_bf16_f32 v85, v170, v171
v_cvt_pk_bf16_f32 v86, v172, v173
v_cvt_pk_bf16_f32 v87, v174, v175
v_pk_fma_f32 v[176:177], v[176:177], v[42:43], v[42:43] op_sel:[0,0,1] op_sel_hi:[1,0,1] neg_lo:[0,0,1] neg_hi:[0,0,1]
v_pk_fma_f32 v[178:179], v[178:179], v[42:43], v[42:43] op_sel:[0,0,1] op_sel_hi:[1,0,1] neg_lo:[0,0,1] neg_hi:[0,0,1]
v_pk_fma_f32 v[180:181], v[180:181], v[42:43], v[42:43] op_sel:[0,0,1] op_sel_hi:[1,0,1] neg_lo:[0,0,1] neg_hi:[0,0,1]
v_pk_fma_f32 v[182:183], v[182:183], v[42:43], v[42:43] op_sel:[0,0,1] op_sel_hi:[1,0,1] neg_lo:[0,0,1] neg_hi:[0,0,1]
ds_write_b128 v44, v[84:87] offset:5120
v_cvt_pk_bf16_f32 v88, v176, v177
v_cvt_pk_bf16_f32 v89, v178, v179
v_cvt_pk_bf16_f32 v90, v180, v181
v_cvt_pk_bf16_f32 v91, v182, v183
v_pk_fma_f32 v[184:185], v[184:185], v[42:43], v[42:43] op_sel:[0,0,1] op_sel_hi:[1,0,1] neg_lo:[0,0,1] neg_hi:[0,0,1]
v_pk_fma_f32 v[186:187], v[186:187], v[42:43], v[42:43] op_sel:[0,0,1] op_sel_hi:[1,0,1] neg_lo:[0,0,1] neg_hi:[0,0,1]
v_pk_fma_f32 v[188:189], v[188:189], v[42:43], v[42:43] op_sel:[0,0,1] op_sel_hi:[1,0,1] neg_lo:[0,0,1] neg_hi:[0,0,1]
v_pk_fma_f32 v[190:191], v[190:191], v[42:43], v[42:43] op_sel:[0,0,1] op_sel_hi:[1,0,1] neg_lo:[0,0,1] neg_hi:[0,0,1]
ds_write_b128 v44, v[88:91] offset:6144
v_cvt_pk_bf16_f32 v92, v184, v185
v_cvt_pk_bf16_f32 v93, v186, v187
v_cvt_pk_bf16_f32 v94, v188, v189
v_cvt_pk_bf16_f32 v95, v190, v191
v_pk_fma_f32 v[192:193], v[192:193], v[42:43], v[42:43] op_sel:[0,0,1] op_sel_hi:[1,0,1] neg_lo:[0,0,1] neg_hi:[0,0,1]
v_pk_fma_f32 v[194:195], v[194:195], v[42:43], v[42:43] op_sel:[0,0,1] op_sel_hi:[1,0,1] neg_lo:[0,0,1] neg_hi:[0,0,1]
v_pk_fma_f32 v[196:197], v[196:197], v[42:43], v[42:43] op_sel:[0,0,1] op_sel_hi:[1,0,1] neg_lo:[0,0,1] neg_hi:[0,0,1]
v_pk_fma_f32 v[198:199], v[198:199], v[42:43], v[42:43] op_sel:[0,0,1] op_sel_hi:[1,0,1] neg_lo:[0,0,1] neg_hi:[0,0,1]
ds_write_b128 v44, v[92:95] offset:7168
v_cvt_pk_bf16_f32 v96, v192, v193
v_cvt_pk_bf16_f32 v97, v194, v195
v_cvt_pk_bf16_f32 v98, v196, v197
v_cvt_pk_bf16_f32 v99, v198, v199
v_pk_fma_f32 v[200:201], v[200:201], v[42:43], v[42:43] op_sel:[0,0,1] op_sel_hi:[1,0,1] neg_lo:[0,0,1] neg_hi:[0,0,1]
v_pk_fma_f32 v[202:203], v[202:203], v[42:43], v[42:43] op_sel:[0,0,1] op_sel_hi:[1,0,1] neg_lo:[0,0,1] neg_hi:[0,0,1]
v_pk_fma_f32 v[204:205], v[204:205], v[42:43], v[42:43] op_sel:[0,0,1] op_sel_hi:[1,0,1] neg_lo:[0,0,1] neg_hi:[0,0,1]
v_pk_fma_f32 v[206:207], v[206:207], v[42:43], v[42:43] op_sel:[0,0,1] op_sel_hi:[1,0,1] neg_lo:[0,0,1] neg_hi:[0,0,1]
ds_write_b128 v44, v[96:99] offset:8192
v_cvt_pk_bf16_f32 v100, v200, v201
v_cvt_pk_bf16_f32 v101, v202, v203
v_cvt_pk_bf16_f32 v102, v204, v205
v_cvt_pk_bf16_f32 v103, v206, v207
v_pk_fma_f32 v[208:209], v[208:209], v[42:43], v[42:43] op_sel:[0,0,1] op_sel_hi:[1,0,1] neg_lo:[0,0,1] neg_hi:[0,0,1]
v_pk_fma_f32 v[210:211], v[210:211], v[42:43], v[42:43] op_sel:[0,0,1] op_sel_hi:[1,0,1] neg_lo:[0,0,1] neg_hi:[0,0,1]
v_pk_fma_f32 v[212:213], v[212:213], v[42:43], v[42:43] op_sel:[0,0,1] op_sel_hi:[1,0,1] neg_lo:[0,0,1] neg_hi:[0,0,1]
v_pk_fma_f32 v[214:215], v[214:215], v[42:43], v[42:43] op_sel:[0,0,1] op_sel_hi:[1,0,1] neg_lo:[0,0,1] neg_hi:[0,0,1]
ds_write_b128 v44, v[100:103] offset:9216
v_cvt_pk_bf16_f32 v104, v208, v209
v_cvt_pk_bf16_f32 v105, v210, v211
v_cvt_pk_bf16_f32 v106, v212, v213
v_cvt_pk_bf16_f32 v107, v214, v215
v_pk_fma_f32 v[216:217], v[216:217], v[42:43], v[42:43] op_sel:[0,0,1] op_sel_hi:[1,0,1] neg_lo:[0,0,1] neg_hi:[0,0,1]
v_pk_fma_f32 v[218:219], v[218:219], v[42:43], v[42:43] op_sel:[0,0,1] op_sel_hi:[1,0,1] neg_lo:[0,0,1] neg_hi:[0,0,1]
v_pk_fma_f32 v[220:221], v[220:221], v[42:43], v[42:43] op_sel:[0,0,1] op_sel_hi:[1,0,1] neg_lo:[0,0,1] neg_hi:[0,0,1]
v_pk_fma_f32 v[222:223], v[222:223], v[42:43], v[42:43] op_sel:[0,0,1] op_sel_hi:[1,0,1] neg_lo:[0,0,1] neg_hi:[0,0,1]
ds_write_b128 v44, v[104:107] offset:10240
v_cvt_pk_bf16_f32 v108, v216, v217
v_cvt_pk_bf16_f32 v109, v218, v219
v_cvt_pk_bf16_f32 v110, v220, v221
v_cvt_pk_bf16_f32 v111, v222, v223
v_pk_fma_f32 v[224:225], v[224:225], v[42:43], v[42:43] op_sel:[0,0,1] op_sel_hi:[1,0,1] neg_lo:[0,0,1] neg_hi:[0,0,1]
v_pk_fma_f32 v[226:227], v[226:227], v[42:43], v[42:43] op_sel:[0,0,1] op_sel_hi:[1,0,1] neg_lo:[0,0,1] neg_hi:[0,0,1]
v_pk_fma_f32 v[228:229], v[228:229], v[42:43], v[42:43] op_sel:[0,0,1] op_sel_hi:[1,0,1] neg_lo:[0,0,1] neg_hi:[0,0,1]
v_pk_fma_f32 v[230:231], v[230:231], v[42:43], v[42:43] op_sel:[0,0,1] op_sel_hi:[1,0,1] neg_lo:[0,0,1] neg_hi:[0,0,1]
ds_write_b128 v44, v[108:111] offset:11264
v_cvt_pk_bf16_f32 v112, v224, v225
v_cvt_pk_bf16_f32 v113, v226, v227
v_cvt_pk_bf16_f32 v114, v228, v229
v_cvt_pk_bf16_f32 v115, v230, v231
v_pk_fma_f32 v[232:233], v[232:233], v[42:43], v[42:43] op_sel:[0,0,1] op_sel_hi:[1,0,1] neg_lo:[0,0,1] neg_hi:[0,0,1]
v_pk_fma_f32 v[234:235], v[234:235], v[42:43], v[42:43] op_sel:[0,0,1] op_sel_hi:[1,0,1] neg_lo:[0,0,1] neg_hi:[0,0,1]
v_pk_fma_f32 v[236:237], v[236:237], v[42:43], v[42:43] op_sel:[0,0,1] op_sel_hi:[1,0,1] neg_lo:[0,0,1] neg_hi:[0,0,1]
v_pk_fma_f32 v[238:239], v[238:239], v[42:43], v[42:43] op_sel:[0,0,1] op_sel_hi:[1,0,1] neg_lo:[0,0,1] neg_hi:[0,0,1]
ds_write_b128 v44, v[112:115] offset:12288
v_cvt_pk_bf16_f32 v116, v232, v233
v_cvt_pk_bf16_f32 v117, v234, v235
v_cvt_pk_bf16_f32 v118, v236, v237
v_cvt_pk_bf16_f32 v119, v238, v239
v_pk_fma_f32 v[240:241], v[240:241], v[42:43], v[42:43] op_sel:[0,0,1] op_sel_hi:[1,0,1] neg_lo:[0,0,1] neg_hi:[0,0,1]
v_pk_fma_f32 v[242:243], v[242:243], v[42:43], v[42:43] op_sel:[0,0,1] op_sel_hi:[1,0,1] neg_lo:[0,0,1] neg_hi:[0,0,1]
v_pk_fma_f32 v[244:245], v[244:245], v[42:43], v[42:43] op_sel:[0,0,1] op_sel_hi:[1,0,1] neg_lo:[0,0,1] neg_hi:[0,0,1]
v_pk_fma_f32 v[246:247], v[246:247], v[42:43], v[42:43] op_sel:[0,0,1] op_sel_hi:[1,0,1] neg_lo:[0,0,1] neg_hi:[0,0,1]
ds_write_b128 v44, v[116:119] offset:13312
v_cvt_pk_bf16_f32 v120, v240, v241
v_cvt_pk_bf16_f32 v121, v242, v243
v_cvt_pk_bf16_f32 v122, v244, v245
v_cvt_pk_bf16_f32 v123, v246, v247
v_pk_fma_f32 v[248:249], v[248:249], v[42:43], v[42:43] op_sel:[0,0,1] op_sel_hi:[1,0,1] neg_lo:[0,0,1] neg_hi:[0,0,1]
v_pk_fma_f32 v[250:251], v[250:251], v[42:43], v[42:43] op_sel:[0,0,1] op_sel_hi:[1,0,1] neg_lo:[0,0,1] neg_hi:[0,0,1]
v_pk_fma_f32 v[252:253], v[252:253], v[42:43], v[42:43] op_sel:[0,0,1] op_sel_hi:[1,0,1] neg_lo:[0,0,1] neg_hi:[0,0,1]
v_pk_fma_f32 v[254:255], v[254:255], v[42:43], v[42:43] op_sel:[0,0,1] op_sel_hi:[1,0,1] neg_lo:[0,0,1] neg_hi:[0,0,1]
ds_write_b128 v44, v[120:123] offset:14336
v_cvt_pk_bf16_f32 v124, v248, v249
v_cvt_pk_bf16_f32 v125, v250, v251
v_cvt_pk_bf16_f32 v126, v252, v253
v_cvt_pk_bf16_f32 v127, v254, v255
ds_write_b128 v44, v[124:127] offset:15360
s_waitcnt vmcnt(9) lgkmcnt(0)
s_barrier
ds_read_b64_tr_b16 v[32:33], v2 offset:0
ds_read_b64_tr_b16 v[34:35], v4 offset:512
ds_read_b64_tr_b16 v[36:37], v2 offset:4096
ds_read_b64_tr_b16 v[38:39], v4 offset:4608
ds_read_b128 a[0:3], v0 offset:0
ds_read_b128 a[4:7], v0 offset:16384
ds_read_b128 a[8:11], v0 offset:32768
ds_read_b128 a[12:15], v0 offset:49152
ds_read_b128 a[16:19], v0 offset:1024
ds_read_b128 a[20:23], v0 offset:17408
ds_read_b128 a[24:27], v0 offset:33792
ds_read_b128 a[28:31], v0 offset:50176
ds_read_b64_tr_b16 v[40:41], v3 offset:0
ds_read_b64_tr_b16 v[42:43], v5 offset:512
ds_read_b64_tr_b16 v[44:45], v3 offset:4096
ds_read_b64_tr_b16 v[46:47], v5 offset:4608
ds_read_b64_tr_b16 v[48:49], v4 offset:0
ds_read_b64_tr_b16 v[50:51], v2 offset:512
ds_read_b64_tr_b16 v[52:53], v4 offset:4096
ds_read_b64_tr_b16 v[54:55], v2 offset:4608
s_add_u32 s51, s51, 1
s_and_b32 s51, s51, 7
s_mul_i32 s52, s51, 229376
s_add_u32 s52, s52, s55
s_add_u32 m0, s50, 16384
s_nop 0
buffer_load_dwordx4 v10, s[16:19], s52 offen lds
buffer_load_dwordx4 v11, s[16:19], s52 offen offset:1024 lds
buffer_load_dwordx4 v12, s[16:19], s52 offen offset:2048 lds
buffer_load_dwordx4 v13, s[16:19], s52 offen offset:3072 lds
s_add_u32 s53, s52, 114688
s_add_u32 m0, s50, 20480
s_nop 0
buffer_load_dwordx4 v10, s[16:19], s53 offen lds
buffer_load_dwordx4 v11, s[16:19], s53 offen offset:1024 lds
buffer_load_dwordx4 v12, s[16:19], s53 offen offset:2048 lds
buffer_load_dwordx4 v13, s[16:19], s53 offen offset:3072 lds
s_waitcnt lgkmcnt(8)
v_mfma_f32_16x16x32_bf16 v[64:67], v[32:35], a[0:3], 0
ds_read_b64_tr_b16 v[56:57], v5 offset:0
ds_read_b64_tr_b16 v[58:59], v3 offset:512
v_mfma_f32_16x16x32_bf16 v[64:67], v[36:39], a[16:19], v[64:67]
ds_read_b64_tr_b16 v[60:61], v5 offset:4096
ds_read_b64_tr_b16 v[62:63], v3 offset:4608
v_mfma_f32_16x16x32_bf16 v[68:71], v[32:35], a[4:7], 0
s_add_u32 s51, s51, 1
ds_read_b128 a[32:35], v0 offset:2048
v_mfma_f32_16x16x32_bf16 v[68:71], v[36:39], a[20:23], v[68:71]
s_and_b32 s51, s51, 7
ds_read_b128 a[48:51], v0 offset:3072
v_mfma_f32_16x16x32_bf16 v[72:75], v[32:35], a[8:11], 0
s_mul_i32 s52, s51, 229376
ds_read_b128 a[36:39], v0 offset:18432
v_mfma_f32_16x16x32_bf16 v[72:75], v[36:39], a[24:27], v[72:75]
s_add_u32 s52, s52, s55
ds_read_b128 a[52:55], v0 offset:19456
v_mfma_f32_16x16x32_bf16 v[76:79], v[32:35], a[12:15], 0
s_add_u32 m0, s50, 0
ds_read_b128 a[40:43], v0 offset:34816
v_mfma_f32_16x16x32_bf16 v[76:79], v[36:39], a[28:31], v[76:79]
s_waitcnt vmcnt(9) lgkmcnt(5)
v_mfma_f32_16x16x32_bf16 v[80:83], v[40:43], a[0:3], 0
ds_read_b64_tr_b16 v[32:33], v2 offset:8192
ds_read_b64_tr_b16 v[34:35], v4 offset:8704
v_mfma_f32_16x16x32_bf16 v[80:83], v[44:47], a[16:19], v[80:83]
buffer_load_dwordx4 v10, s[16:19], s52 offen lds
v_mfma_f32_16x16x32_bf16 v[84:87], v[40:43], a[4:7], 0
ds_read_b64_tr_b16 v[36:37], v2 offset:12288
ds_read_b64_tr_b16 v[38:39], v4 offset:12800
v_mfma_f32_16x16x32_bf16 v[84:87], v[44:47], a[20:23], v[84:87]
buffer_load_dwordx4 v11, s[16:19], s52 offen offset:1024 lds
v_mfma_f32_16x16x32_bf16 v[88:91], v[40:43], a[8:11], 0
ds_read_b128 a[56:59], v0 offset:35840
v_mfma_f32_16x16x32_bf16 v[88:91], v[44:47], a[24:27], v[88:91]
buffer_load_dwordx4 v12, s[16:19], s52 offen offset:2048 lds
v_mfma_f32_16x16x32_bf16 v[92:95], v[40:43], a[12:15], 0
ds_read_b128 a[44:47], v0 offset:51200
v_mfma_f32_16x16x32_bf16 v[92:95], v[44:47], a[28:31], v[92:95]
v_mfma_f32_16x16x32_bf16 v[96:99], v[48:51], a[0:3], 0
s_add_u32 s53, s52, 114688
ds_read_b64_tr_b16 v[40:41], v3 offset:8192
ds_read_b64_tr_b16 v[42:43], v5 offset:8704
v_mfma_f32_16x16x32_bf16 v[96:99], v[52:55], a[16:19], v[96:99]
buffer_load_dwordx4 v13, s[16:19], s52 offen offset:3072 lds
v_mfma_f32_16x16x32_bf16 v[100:103], v[48:51], a[4:7], 0
s_add_u32 m0, s50, 4096
ds_read_b64_tr_b16 v[44:45], v3 offset:12288
ds_read_b64_tr_b16 v[46:47], v5 offset:12800
v_mfma_f32_16x16x32_bf16 v[100:103], v[52:55], a[20:23], v[100:103]
buffer_load_dwordx4 v10, s[16:19], s53 offen lds
v_mfma_f32_16x16x32_bf16 v[104:107], v[48:51], a[8:11], 0
ds_read_b128 a[60:63], v0 offset:52224
v_mfma_f32_16x16x32_bf16 v[104:107], v[52:55], a[24:27], v[104:107]
buffer_load_dwordx4 v11, s[16:19], s53 offen offset:1024 lds
v_mfma_f32_16x16x32_bf16 v[108:111], v[48:51], a[12:15], 0
v_mfma_f32_16x16x32_bf16 v[108:111], v[52:55], a[28:31], v[108:111]
v_mfma_f32_16x16x32_bf16 v[112:115], v[56:59], a[0:3], 0
ds_read_b64_tr_b16 v[48:49], v4 offset:8192
ds_read_b64_tr_b16 v[50:51], v2 offset:8704
v_mfma_f32_16x16x32_bf16 v[112:115], v[60:63], a[16:19], v[112:115]
buffer_load_dwordx4 v12, s[16:19], s53 offen offset:2048 lds
v_mfma_f32_16x16x32_bf16 v[116:119], v[56:59], a[4:7], 0
ds_read_b64_tr_b16 v[52:53], v4 offset:12288
ds_read_b64_tr_b16 v[54:55], v2 offset:12800
v_mfma_f32_16x16x32_bf16 v[116:119], v[60:63], a[20:23], v[116:119]
buffer_load_dwordx4 v13, s[16:19], s53 offen offset:3072 lds
v_mfma_f32_16x16x32_bf16 v[120:123], v[56:59], a[8:11], 0
v_mfma_f32_16x16x32_bf16 v[120:123], v[60:63], a[24:27], v[120:123]
v_mfma_f32_16x16x32_bf16 v[124:127], v[56:59], a[12:15], 0
v_mfma_f32_16x16x32_bf16 v[124:127], v[60:63], a[28:31], v[124:127]
s_waitcnt lgkmcnt(4)
v_mfma_f32_16x16x32_bf16 v[64:67], v[32:35], a[32:35], v[64:67]
ds_read_b64_tr_b16 v[56:57], v5 offset:8192
ds_read_b64_tr_b16 v[58:59], v3 offset:8704
v_mfma_f32_16x16x32_bf16 v[64:67], v[36:39], a[48:51], v[64:67]
ds_read_b64_tr_b16 v[60:61], v5 offset:12288
ds_read_b64_tr_b16 v[62:63], v3 offset:12800
v_mfma_f32_16x16x32_bf16 v[68:71], v[32:35], a[36:39], v[68:71]
s_add_u32 s51, s51, 1
ds_read_b128 a[64:67], v0 offset:4096
v_mfma_f32_16x16x32_bf16 v[68:71], v[36:39], a[52:55], v[68:71]
s_and_b32 s51, s51, 7
ds_read_b128 a[80:83], v0 offset:5120
v_mfma_f32_16x16x32_bf16 v[72:75], v[32:35], a[40:43], v[72:75]
s_mul_i32 s52, s51, 229376
ds_read_b128 a[68:71], v0 offset:20480
v_mfma_f32_16x16x32_bf16 v[72:75], v[36:39], a[56:59], v[72:75]
s_add_u32 s52, s52, s55
ds_read_b128 a[84:87], v0 offset:21504
v_mfma_f32_16x16x32_bf16 v[76:79], v[32:35], a[44:47], v[76:79]
s_add_u32 m0, s50, 8192
ds_read_b128 a[72:75], v0 offset:36864
v_mfma_f32_16x16x32_bf16 v[76:79], v[36:39], a[60:63], v[76:79]
s_waitcnt vmcnt(8) lgkmcnt(5)
v_mfma_f32_16x16x32_bf16 v[80:83], v[40:43], a[32:35], v[80:83]
ds_read_b64_tr_b16 v[32:33], v2 offset:16384
ds_read_b64_tr_b16 v[34:35], v4 offset:16896
v_mfma_f32_16x16x32_bf16 v[80:83], v[44:47], a[48:51], v[80:83]
buffer_load_dwordx4 v10, s[16:19], s52 offen lds
v_mfma_f32_16x16x32_bf16 v[84:87], v[40:43], a[36:39], v[84:87]
ds_read_b64_tr_b16 v[36:37], v2 offset:20480
ds_read_b64_tr_b16 v[38:39], v4 offset:20992
v_mfma_f32_16x16x32_bf16 v[84:87], v[44:47], a[52:55], v[84:87]
buffer_load_dwordx4 v11, s[16:19], s52 offen offset:1024 lds
v_mfma_f32_16x16x32_bf16 v[88:91], v[40:43], a[40:43], v[88:91]
ds_read_b128 a[88:91], v0 offset:37888
v_mfma_f32_16x16x32_bf16 v[88:91], v[44:47], a[56:59], v[88:91]
buffer_load_dwordx4 v12, s[16:19], s52 offen offset:2048 lds
v_mfma_f32_16x16x32_bf16 v[92:95], v[40:43], a[44:47], v[92:95]
ds_read_b128 a[76:79], v0 offset:53248
v_mfma_f32_16x16x32_bf16 v[92:95], v[44:47], a[60:63], v[92:95]
v_mfma_f32_16x16x32_bf16 v[96:99], v[48:51], a[32:35], v[96:99]
s_add_u32 s53, s52, 114688
ds_read_b64_tr_b16 v[40:41], v3 offset:16384
ds_read_b64_tr_b16 v[42:43], v5 offset:16896
v_mfma_f32_16x16x32_bf16 v[96:99], v[52:55], a[48:51], v[96:99]
buffer_load_dwordx4 v13, s[16:19], s52 offen offset:3072 lds
v_mfma_f32_16x16x32_bf16 v[100:103], v[48:51], a[36:39], v[100:103]
s_add_u32 m0, s50, 12288
ds_read_b64_tr_b16 v[44:45], v3 offset:20480
ds_read_b64_tr_b16 v[46:47], v5 offset:20992
v_mfma_f32_16x16x32_bf16 v[100:103], v[52:55], a[52:55], v[100:103]
buffer_load_dwordx4 v10, s[16:19], s53 offen lds
v_mfma_f32_16x16x32_bf16 v[104:107], v[48:51], a[40:43], v[104:107]
ds_read_b128 a[92:95], v0 offset:54272
v_mfma_f32_16x16x32_bf16 v[104:107], v[52:55], a[56:59], v[104:107]
buffer_load_dwordx4 v11, s[16:19], s53 offen offset:1024 lds
v_mfma_f32_16x16x32_bf16 v[108:111], v[48:51], a[44:47], v[108:111]
v_mfma_f32_16x16x32_bf16 v[108:111], v[52:55], a[60:63], v[108:111]
v_mfma_f32_16x16x32_bf16 v[112:115], v[56:59], a[32:35], v[112:115]
ds_read_b64_tr_b16 v[48:49], v4 offset:16384
ds_read_b64_tr_b16 v[50:51], v2 offset:16896
v_mfma_f32_16x16x32_bf16 v[112:115], v[60:63], a[48:51], v[112:115]
buffer_load_dwordx4 v12, s[16:19], s53 offen offset:2048 lds
v_mfma_f32_16x16x32_bf16 v[116:119], v[56:59], a[36:39], v[116:119]
ds_read_b64_tr_b16 v[52:53], v4 offset:20480
ds_read_b64_tr_b16 v[54:55], v2 offset:20992
v_mfma_f32_16x16x32_bf16 v[116:119], v[60:63], a[52:55], v[116:119]
buffer_load_dwordx4 v13, s[16:19], s53 offen offset:3072 lds
v_mfma_f32_16x16x32_bf16 v[120:123], v[56:59], a[40:43], v[120:123]
v_mfma_f32_16x16x32_bf16 v[120:123], v[60:63], a[56:59], v[120:123]
v_mfma_f32_16x16x32_bf16 v[124:127], v[56:59], a[44:47], v[124:127]
v_mfma_f32_16x16x32_bf16 v[124:127], v[60:63], a[60:63], v[124:127]
s_waitcnt lgkmcnt(4)
v_mfma_f32_16x16x32_bf16 v[64:67], v[32:35], a[64:67], v[64:67]
ds_read_b64_tr_b16 v[56:57], v5 offset:16384
ds_read_b64_tr_b16 v[58:59], v3 offset:16896
v_mfma_f32_16x16x32_bf16 v[64:67], v[36:39], a[80:83], v[64:67]
ds_read_b64_tr_b16 v[60:61], v5 offset:20480
ds_read_b64_tr_b16 v[62:63], v3 offset:20992
v_mfma_f32_16x16x32_bf16 v[68:71], v[32:35], a[68:71], v[68:71]
s_add_u32 s51, s51, 1
ds_read_b128 a[96:99], v0 offset:6144
v_mfma_f32_16x16x32_bf16 v[68:71], v[36:39], a[84:87], v[68:71]
s_and_b32 s51, s51, 7
ds_read_b128 a[112:115], v0 offset:7168
v_mfma_f32_16x16x32_bf16 v[72:75], v[32:35], a[72:75], v[72:75]
s_mul_i32 s52, s51, 229376
ds_read_b128 a[100:103], v0 offset:22528
v_mfma_f32_16x16x32_bf16 v[72:75], v[36:39], a[88:91], v[72:75]
s_add_u32 s52, s52, s55
ds_read_b128 a[116:119], v0 offset:23552
v_mfma_f32_16x16x32_bf16 v[76:79], v[32:35], a[76:79], v[76:79]
s_add_u32 m0, s50, 16384
ds_read_b128 a[104:107], v0 offset:38912
v_mfma_f32_16x16x32_bf16 v[76:79], v[36:39], a[92:95], v[76:79]
s_waitcnt vmcnt(8) lgkmcnt(5)
v_mfma_f32_16x16x32_bf16 v[80:83], v[40:43], a[64:67], v[80:83]
ds_read_b64_tr_b16 v[32:33], v2 offset:0
ds_read_b64_tr_b16 v[34:35], v4 offset:512
v_mfma_f32_16x16x32_bf16 v[80:83], v[44:47], a[80:83], v[80:83]
buffer_load_dwordx4 v10, s[16:19], s52 offen lds
v_mfma_f32_16x16x32_bf16 v[84:87], v[40:43], a[68:71], v[84:87]
ds_read_b64_tr_b16 v[36:37], v2 offset:4096
ds_read_b64_tr_b16 v[38:39], v4 offset:4608
v_mfma_f32_16x16x32_bf16 v[84:87], v[44:47], a[84:87], v[84:87]
buffer_load_dwordx4 v11, s[16:19], s52 offen offset:1024 lds
v_mfma_f32_16x16x32_bf16 v[88:91], v[40:43], a[72:75], v[88:91]
ds_read_b128 a[120:123], v0 offset:39936
v_mfma_f32_16x16x32_bf16 v[88:91], v[44:47], a[88:91], v[88:91]
buffer_load_dwordx4 v12, s[16:19], s52 offen offset:2048 lds
v_mfma_f32_16x16x32_bf16 v[92:95], v[40:43], a[76:79], v[92:95]
ds_read_b128 a[108:111], v0 offset:55296
v_mfma_f32_16x16x32_bf16 v[92:95], v[44:47], a[92:95], v[92:95]
v_mfma_f32_16x16x32_bf16 v[96:99], v[48:51], a[64:67], v[96:99]
s_add_u32 s53, s52, 114688
ds_read_b64_tr_b16 v[40:41], v3 offset:0
ds_read_b64_tr_b16 v[42:43], v5 offset:512
v_mfma_f32_16x16x32_bf16 v[96:99], v[52:55], a[80:83], v[96:99]
buffer_load_dwordx4 v13, s[16:19], s52 offen offset:3072 lds
v_mfma_f32_16x16x32_bf16 v[100:103], v[48:51], a[68:71], v[100:103]
s_add_u32 m0, s50, 20480
ds_read_b64_tr_b16 v[44:45], v3 offset:4096
ds_read_b64_tr_b16 v[46:47], v5 offset:4608
v_mfma_f32_16x16x32_bf16 v[100:103], v[52:55], a[84:87], v[100:103]
buffer_load_dwordx4 v10, s[16:19], s53 offen lds
v_mfma_f32_16x16x32_bf16 v[104:107], v[48:51], a[72:75], v[104:107]
ds_read_b128 a[124:127], v0 offset:56320
v_mfma_f32_16x16x32_bf16 v[104:107], v[52:55], a[88:91], v[104:107]
buffer_load_dwordx4 v11, s[16:19], s53 offen offset:1024 lds
v_mfma_f32_16x16x32_bf16 v[108:111], v[48:51], a[76:79], v[108:111]
v_mfma_f32_16x16x32_bf16 v[108:111], v[52:55], a[92:95], v[108:111]
v_mfma_f32_16x16x32_bf16 v[112:115], v[56:59], a[64:67], v[112:115]
ds_read_b64_tr_b16 v[48:49], v4 offset:0
ds_read_b64_tr_b16 v[50:51], v2 offset:512
v_mfma_f32_16x16x32_bf16 v[112:115], v[60:63], a[80:83], v[112:115]
buffer_load_dwordx4 v12, s[16:19], s53 offen offset:2048 lds
v_mfma_f32_16x16x32_bf16 v[116:119], v[56:59], a[68:71], v[116:119]
ds_read_b64_tr_b16 v[52:53], v4 offset:4096
ds_read_b64_tr_b16 v[54:55], v2 offset:4608
v_mfma_f32_16x16x32_bf16 v[116:119], v[60:63], a[84:87], v[116:119]
buffer_load_dwordx4 v13, s[16:19], s53 offen offset:3072 lds
v_mfma_f32_16x16x32_bf16 v[120:123], v[56:59], a[72:75], v[120:123]
v_mfma_f32_16x16x32_bf16 v[120:123], v[60:63], a[88:91], v[120:123]
v_mfma_f32_16x16x32_bf16 v[124:127], v[56:59], a[76:79], v[124:127]
v_mfma_f32_16x16x32_bf16 v[124:127], v[60:63], a[92:95], v[124:127]
s_waitcnt lgkmcnt(4)
v_mfma_f32_16x16x32_bf16 v[64:67], v[32:35], a[96:99], v[64:67]
ds_read_b64_tr_b16 v[56:57], v5 offset:0
ds_read_b64_tr_b16 v[58:59], v3 offset:512
v_mfma_f32_16x16x32_bf16 v[64:67], v[36:39], a[112:115], v[64:67]
ds_read_b64_tr_b16 v[60:61], v5 offset:4096
ds_read_b64_tr_b16 v[62:63], v3 offset:4608
v_mfma_f32_16x16x32_bf16 v[68:71], v[32:35], a[100:103], v[68:71]
s_add_u32 s51, s51, 1
ds_read_b128 a[128:131], v0 offset:8192
v_mfma_f32_16x16x32_bf16 v[68:71], v[36:39], a[116:119], v[68:71]
s_and_b32 s51, s51, 7
ds_read_b128 a[144:147], v0 offset:9216
v_mfma_f32_16x16x32_bf16 v[72:75], v[32:35], a[104:107], v[72:75]
s_mul_i32 s52, s51, 229376
ds_read_b128 a[132:135], v0 offset:24576
v_mfma_f32_16x16x32_bf16 v[72:75], v[36:39], a[120:123], v[72:75]
s_add_u32 s52, s52, s55
ds_read_b128 a[148:151], v0 offset:25600
v_mfma_f32_16x16x32_bf16 v[76:79], v[32:35], a[108:111], v[76:79]
s_add_u32 m0, s50, 0
ds_read_b128 a[136:139], v0 offset:40960
v_mfma_f32_16x16x32_bf16 v[76:79], v[36:39], a[124:127], v[76:79]
s_waitcnt vmcnt(8) lgkmcnt(5)
v_mfma_f32_16x16x32_bf16 v[80:83], v[40:43], a[96:99], v[80:83]
ds_read_b64_tr_b16 v[32:33], v2 offset:8192
ds_read_b64_tr_b16 v[34:35], v4 offset:8704
v_mfma_f32_16x16x32_bf16 v[80:83], v[44:47], a[112:115], v[80:83]
buffer_load_dwordx4 v10, s[16:19], s52 offen lds
v_mfma_f32_16x16x32_bf16 v[84:87], v[40:43], a[100:103], v[84:87]
ds_read_b64_tr_b16 v[36:37], v2 offset:12288
ds_read_b64_tr_b16 v[38:39], v4 offset:12800
v_mfma_f32_16x16x32_bf16 v[84:87], v[44:47], a[116:119], v[84:87]
buffer_load_dwordx4 v11, s[16:19], s52 offen offset:1024 lds
v_mfma_f32_16x16x32_bf16 v[88:91], v[40:43], a[104:107], v[88:91]
ds_read_b128 a[152:155], v0 offset:41984
v_mfma_f32_16x16x32_bf16 v[88:91], v[44:47], a[120:123], v[88:91]
buffer_load_dwordx4 v12, s[16:19], s52 offen offset:2048 lds
v_mfma_f32_16x16x32_bf16 v[92:95], v[40:43], a[108:111], v[92:95]
ds_read_b128 a[140:143], v0 offset:57344
v_mfma_f32_16x16x32_bf16 v[92:95], v[44:47], a[124:127], v[92:95]
v_mfma_f32_16x16x32_bf16 v[96:99], v[48:51], a[96:99], v[96:99]
s_add_u32 s53, s52, 114688
ds_read_b64_tr_b16 v[40:41], v3 offset:8192
ds_read_b64_tr_b16 v[42:43], v5 offset:8704
v_mfma_f32_16x16x32_bf16 v[96:99], v[52:55], a[112:115], v[96:99]
buffer_load_dwordx4 v13, s[16:19], s52 offen offset:3072 lds
v_mfma_f32_16x16x32_bf16 v[100:103], v[48:51], a[100:103], v[100:103]
s_add_u32 m0, s50, 4096
ds_read_b64_tr_b16 v[44:45], v3 offset:12288
ds_read_b64_tr_b16 v[46:47], v5 offset:12800
v_mfma_f32_16x16x32_bf16 v[100:103], v[52:55], a[116:119], v[100:103]
buffer_load_dwordx4 v10, s[16:19], s53 offen lds
v_mfma_f32_16x16x32_bf16 v[104:107], v[48:51], a[104:107], v[104:107]
ds_read_b128 a[156:159], v0 offset:58368
v_mfma_f32_16x16x32_bf16 v[104:107], v[52:55], a[120:123], v[104:107]
buffer_load_dwordx4 v11, s[16:19], s53 offen offset:1024 lds
v_mfma_f32_16x16x32_bf16 v[108:111], v[48:51], a[108:111], v[108:111]
v_mfma_f32_16x16x32_bf16 v[108:111], v[52:55], a[124:127], v[108:111]
v_mfma_f32_16x16x32_bf16 v[112:115], v[56:59], a[96:99], v[112:115]
ds_read_b64_tr_b16 v[48:49], v4 offset:8192
ds_read_b64_tr_b16 v[50:51], v2 offset:8704
v_mfma_f32_16x16x32_bf16 v[112:115], v[60:63], a[112:115], v[112:115]
buffer_load_dwordx4 v12, s[16:19], s53 offen offset:2048 lds
v_mfma_f32_16x16x32_bf16 v[116:119], v[56:59], a[100:103], v[116:119]
ds_read_b64_tr_b16 v[52:53], v4 offset:12288
ds_read_b64_tr_b16 v[54:55], v2 offset:12800
v_mfma_f32_16x16x32_bf16 v[116:119], v[60:63], a[116:119], v[116:119]
buffer_load_dwordx4 v13, s[16:19], s53 offen offset:3072 lds
v_mfma_f32_16x16x32_bf16 v[120:123], v[56:59], a[104:107], v[120:123]
v_mfma_f32_16x16x32_bf16 v[120:123], v[60:63], a[120:123], v[120:123]
v_mfma_f32_16x16x32_bf16 v[124:127], v[56:59], a[108:111], v[124:127]
v_mfma_f32_16x16x32_bf16 v[124:127], v[60:63], a[124:127], v[124:127]
s_waitcnt lgkmcnt(4)
v_mfma_f32_16x16x32_bf16 v[64:67], v[32:35], a[128:131], v[64:67]
ds_read_b64_tr_b16 v[56:57], v5 offset:8192
ds_read_b64_tr_b16 v[58:59], v3 offset:8704
v_mfma_f32_16x16x32_bf16 v[64:67], v[36:39], a[144:147], v[64:67]
ds_read_b64_tr_b16 v[60:61], v5 offset:12288
ds_read_b64_tr_b16 v[62:63], v3 offset:12800
v_mfma_f32_16x16x32_bf16 v[68:71], v[32:35], a[132:135], v[68:71]
s_add_u32 s51, s51, 1
ds_read_b128 a[160:163], v0 offset:10240
v_mfma_f32_16x16x32_bf16 v[68:71], v[36:39], a[148:151], v[68:71]
s_and_b32 s51, s51, 7
ds_read_b128 a[176:179], v0 offset:11264
v_mfma_f32_16x16x32_bf16 v[72:75], v[32:35], a[136:139], v[72:75]
s_mul_i32 s52, s51, 229376
ds_read_b128 a[164:167], v0 offset:26624
v_mfma_f32_16x16x32_bf16 v[72:75], v[36:39], a[152:155], v[72:75]
s_add_u32 s52, s52, s55
ds_read_b128 a[180:183], v0 offset:27648
v_mfma_f32_16x16x32_bf16 v[76:79], v[32:35], a[140:143], v[76:79]
s_add_u32 m0, s50, 8192
ds_read_b128 a[168:171], v0 offset:43008
v_mfma_f32_16x16x32_bf16 v[76:79], v[36:39], a[156:159], v[76:79]
s_waitcnt vmcnt(8) lgkmcnt(5)
v_mfma_f32_16x16x32_bf16 v[80:83], v[40:43], a[128:131], v[80:83]
ds_read_b64_tr_b16 v[32:33], v2 offset:16384
ds_read_b64_tr_b16 v[34:35], v4 offset:16896
v_mfma_f32_16x16x32_bf16 v[80:83], v[44:47], a[144:147], v[80:83]
buffer_load_dwordx4 v10, s[16:19], s52 offen lds
v_mfma_f32_16x16x32_bf16 v[84:87], v[40:43], a[132:135], v[84:87]
ds_read_b64_tr_b16 v[36:37], v2 offset:20480
ds_read_b64_tr_b16 v[38:39], v4 offset:20992
v_mfma_f32_16x16x32_bf16 v[84:87], v[44:47], a[148:151], v[84:87]
buffer_load_dwordx4 v11, s[16:19], s52 offen offset:1024 lds
v_mfma_f32_16x16x32_bf16 v[88:91], v[40:43], a[136:139], v[88:91]
ds_read_b128 a[184:187], v0 offset:44032
v_mfma_f32_16x16x32_bf16 v[88:91], v[44:47], a[152:155], v[88:91]
buffer_load_dwordx4 v12, s[16:19], s52 offen offset:2048 lds
v_mfma_f32_16x16x32_bf16 v[92:95], v[40:43], a[140:143], v[92:95]
ds_read_b128 a[172:175], v0 offset:59392
v_mfma_f32_16x16x32_bf16 v[92:95], v[44:47], a[156:159], v[92:95]
v_mfma_f32_16x16x32_bf16 v[96:99], v[48:51], a[128:131], v[96:99]
s_add_u32 s53, s52, 114688
ds_read_b64_tr_b16 v[40:41], v3 offset:16384
ds_read_b64_tr_b16 v[42:43], v5 offset:16896
v_mfma_f32_16x16x32_bf16 v[96:99], v[52:55], a[144:147], v[96:99]
buffer_load_dwordx4 v13, s[16:19], s52 offen offset:3072 lds
v_mfma_f32_16x16x32_bf16 v[100:103], v[48:51], a[132:135], v[100:103]
s_add_u32 m0, s50, 12288
ds_read_b64_tr_b16 v[44:45], v3 offset:20480
ds_read_b64_tr_b16 v[46:47], v5 offset:20992
v_mfma_f32_16x16x32_bf16 v[100:103], v[52:55], a[148:151], v[100:103]
buffer_load_dwordx4 v10, s[16:19], s53 offen lds
v_mfma_f32_16x16x32_bf16 v[104:107], v[48:51], a[136:139], v[104:107]
ds_read_b128 a[188:191], v0 offset:60416
v_mfma_f32_16x16x32_bf16 v[104:107], v[52:55], a[152:155], v[104:107]
buffer_load_dwordx4 v11, s[16:19], s53 offen offset:1024 lds
v_mfma_f32_16x16x32_bf16 v[108:111], v[48:51], a[140:143], v[108:111]
v_mfma_f32_16x16x32_bf16 v[108:111], v[52:55], a[156:159], v[108:111]
v_mfma_f32_16x16x32_bf16 v[112:115], v[56:59], a[128:131], v[112:115]
ds_read_b64_tr_b16 v[48:49], v4 offset:16384
ds_read_b64_tr_b16 v[50:51], v2 offset:16896
v_mfma_f32_16x16x32_bf16 v[112:115], v[60:63], a[144:147], v[112:115]
buffer_load_dwordx4 v12, s[16:19], s53 offen offset:2048 lds
v_mfma_f32_16x16x32_bf16 v[116:119], v[56:59], a[132:135], v[116:119]
ds_read_b64_tr_b16 v[52:53], v4 offset:20480
ds_read_b64_tr_b16 v[54:55], v2 offset:20992
v_mfma_f32_16x16x32_bf16 v[116:119], v[60:63], a[148:151], v[116:119]
buffer_load_dwordx4 v13, s[16:19], s53 offen offset:3072 lds
v_mfma_f32_16x16x32_bf16 v[120:123], v[56:59], a[136:139], v[120:123]
v_mfma_f32_16x16x32_bf16 v[120:123], v[60:63], a[152:155], v[120:123]
v_mfma_f32_16x16x32_bf16 v[124:127], v[56:59], a[140:143], v[124:127]
v_mfma_f32_16x16x32_bf16 v[124:127], v[60:63], a[156:159], v[124:127]
s_waitcnt lgkmcnt(4)
v_mfma_f32_16x16x32_bf16 v[64:67], v[32:35], a[160:163], v[64:67]
ds_read_b64_tr_b16 v[56:57], v5 offset:16384
ds_read_b64_tr_b16 v[58:59], v3 offset:16896
v_mfma_f32_16x16x32_bf16 v[64:67], v[36:39], a[176:179], v[64:67]
ds_read_b64_tr_b16 v[60:61], v5 offset:20480
ds_read_b64_tr_b16 v[62:63], v3 offset:20992
v_mfma_f32_16x16x32_bf16 v[68:71], v[32:35], a[164:167], v[68:71]
s_add_u32 s51, s51, 1
ds_read_b128 a[192:195], v0 offset:12288
v_mfma_f32_16x16x32_bf16 v[68:71], v[36:39], a[180:183], v[68:71]
s_and_b32 s51, s51, 7
ds_read_b128 a[208:211], v0 offset:13312
v_mfma_f32_16x16x32_bf16 v[72:75], v[32:35], a[168:171], v[72:75]
s_mul_i32 s52, s51, 229376
ds_read_b128 a[196:199], v0 offset:28672
v_mfma_f32_16x16x32_bf16 v[72:75], v[36:39], a[184:187], v[72:75]
s_add_u32 s52, s52, s55
ds_read_b128 a[212:215], v0 offset:29696
v_mfma_f32_16x16x32_bf16 v[76:79], v[32:35], a[172:175], v[76:79]
s_add_u32 m0, s50, 16384
ds_read_b128 a[200:203], v0 offset:45056
v_mfma_f32_16x16x32_bf16 v[76:79], v[36:39], a[188:191], v[76:79]
s_waitcnt vmcnt(8) lgkmcnt(5)
v_mfma_f32_16x16x32_bf16 v[80:83], v[40:43], a[160:163], v[80:83]
ds_read_b64_tr_b16 v[32:33], v2 offset:0
ds_read_b64_tr_b16 v[34:35], v4 offset:512
v_mfma_f32_16x16x32_bf16 v[80:83], v[44:47], a[176:179], v[80:83]
buffer_load_dwordx4 v10, s[20:23], s52 offen lds
v_mfma_f32_16x16x32_bf16 v[84:87], v[40:43], a[164:167], v[84:87]
ds_read_b64_tr_b16 v[36:37], v2 offset:4096
ds_read_b64_tr_b16 v[38:39], v4 offset:4608
v_mfma_f32_16x16x32_bf16 v[84:87], v[44:47], a[180:183], v[84:87]
buffer_load_dwordx4 v11, s[20:23], s52 offen offset:1024 lds
v_mfma_f32_16x16x32_bf16 v[88:91], v[40:43], a[168:171], v[88:91]
ds_read_b128 a[216:219], v0 offset:46080
v_mfma_f32_16x16x32_bf16 v[88:91], v[44:47], a[184:187], v[88:91]
buffer_load_dwordx4 v12, s[20:23], s52 offen offset:2048 lds
v_mfma_f32_16x16x32_bf16 v[92:95], v[40:43], a[172:175], v[92:95]
ds_read_b128 a[204:207], v0 offset:61440
v_mfma_f32_16x16x32_bf16 v[92:95], v[44:47], a[188:191], v[92:95]
v_mfma_f32_16x16x32_bf16 v[96:99], v[48:51], a[160:163], v[96:99]
s_add_u32 s53, s52, 114688
ds_read_b64_tr_b16 v[40:41], v3 offset:0
ds_read_b64_tr_b16 v[42:43], v5 offset:512
v_mfma_f32_16x16x32_bf16 v[96:99], v[52:55], a[176:179], v[96:99]
buffer_load_dwordx4 v13, s[20:23], s52 offen offset:3072 lds
v_mfma_f32_16x16x32_bf16 v[100:103], v[48:51], a[164:167], v[100:103]
s_add_u32 m0, s50, 20480
ds_read_b64_tr_b16 v[44:45], v3 offset:4096
ds_read_b64_tr_b16 v[46:47], v5 offset:4608
v_mfma_f32_16x16x32_bf16 v[100:103], v[52:55], a[180:183], v[100:103]
buffer_load_dwordx4 v10, s[20:23], s53 offen lds
v_mfma_f32_16x16x32_bf16 v[104:107], v[48:51], a[168:171], v[104:107]
ds_read_b128 a[220:223], v0 offset:62464
v_mfma_f32_16x16x32_bf16 v[104:107], v[52:55], a[184:187], v[104:107]
buffer_load_dwordx4 v11, s[20:23], s53 offen offset:1024 lds
v_mfma_f32_16x16x32_bf16 v[108:111], v[48:51], a[172:175], v[108:111]
v_mfma_f32_16x16x32_bf16 v[108:111], v[52:55], a[188:191], v[108:111]
v_mfma_f32_16x16x32_bf16 v[112:115], v[56:59], a[160:163], v[112:115]
ds_read_b64_tr_b16 v[48:49], v4 offset:0
ds_read_b64_tr_b16 v[50:51], v2 offset:512
v_mfma_f32_16x16x32_bf16 v[112:115], v[60:63], a[176:179], v[112:115]
buffer_load_dwordx4 v12, s[20:23], s53 offen offset:2048 lds
v_mfma_f32_16x16x32_bf16 v[116:119], v[56:59], a[164:167], v[116:119]
ds_read_b64_tr_b16 v[52:53], v4 offset:4096
ds_read_b64_tr_b16 v[54:55], v2 offset:4608
v_mfma_f32_16x16x32_bf16 v[116:119], v[60:63], a[180:183], v[116:119]
buffer_load_dwordx4 v13, s[20:23], s53 offen offset:3072 lds
v_mfma_f32_16x16x32_bf16 v[120:123], v[56:59], a[168:171], v[120:123]
v_mfma_f32_16x16x32_bf16 v[120:123], v[60:63], a[184:187], v[120:123]
v_mfma_f32_16x16x32_bf16 v[124:127], v[56:59], a[172:175], v[124:127]
v_mfma_f32_16x16x32_bf16 v[124:127], v[60:63], a[188:191], v[124:127]
s_waitcnt lgkmcnt(4)
v_mfma_f32_16x16x32_bf16 v[64:67], v[32:35], a[192:195], v[64:67]
ds_read_b64_tr_b16 v[56:57], v5 offset:0
ds_read_b64_tr_b16 v[58:59], v3 offset:512
v_mfma_f32_16x16x32_bf16 v[64:67], v[36:39], a[208:211], v[64:67]
ds_read_b64_tr_b16 v[60:61], v5 offset:4096
ds_read_b64_tr_b16 v[62:63], v3 offset:4608
v_mfma_f32_16x16x32_bf16 v[68:71], v[32:35], a[196:199], v[68:71]
s_add_u32 s51, s51, 1
ds_read_b128 a[224:227], v0 offset:14336
v_mfma_f32_16x16x32_bf16 v[68:71], v[36:39], a[212:215], v[68:71]
s_and_b32 s51, s51, 7
ds_read_b128 a[240:243], v0 offset:15360
v_mfma_f32_16x16x32_bf16 v[72:75], v[32:35], a[200:203], v[72:75]
s_mul_i32 s52, s51, 229376
ds_read_b128 a[228:231], v0 offset:30720
v_mfma_f32_16x16x32_bf16 v[72:75], v[36:39], a[216:219], v[72:75]
s_add_u32 s52, s52, s55
ds_read_b128 a[244:247], v0 offset:31744
v_mfma_f32_16x16x32_bf16 v[76:79], v[32:35], a[204:207], v[76:79]
s_add_u32 m0, s50, 0
ds_read_b128 a[232:235], v0 offset:47104
v_mfma_f32_16x16x32_bf16 v[76:79], v[36:39], a[220:223], v[76:79]
s_waitcnt vmcnt(8) lgkmcnt(5)
v_mfma_f32_16x16x32_bf16 v[80:83], v[40:43], a[192:195], v[80:83]
ds_read_b64_tr_b16 v[32:33], v2 offset:8192
ds_read_b64_tr_b16 v[34:35], v4 offset:8704
v_mfma_f32_16x16x32_bf16 v[80:83], v[44:47], a[208:211], v[80:83]
buffer_load_dwordx4 v10, s[20:23], s52 offen lds
v_mfma_f32_16x16x32_bf16 v[84:87], v[40:43], a[196:199], v[84:87]
ds_read_b64_tr_b16 v[36:37], v2 offset:12288
ds_read_b64_tr_b16 v[38:39], v4 offset:12800
v_mfma_f32_16x16x32_bf16 v[84:87], v[44:47], a[212:215], v[84:87]
buffer_load_dwordx4 v11, s[20:23], s52 offen offset:1024 lds
v_mfma_f32_16x16x32_bf16 v[88:91], v[40:43], a[200:203], v[88:91]
ds_read_b128 a[248:251], v0 offset:48128
v_mfma_f32_16x16x32_bf16 v[88:91], v[44:47], a[216:219], v[88:91]
buffer_load_dwordx4 v12, s[20:23], s52 offen offset:2048 lds
v_mfma_f32_16x16x32_bf16 v[92:95], v[40:43], a[204:207], v[92:95]
ds_read_b128 a[236:239], v0 offset:63488
v_mfma_f32_16x16x32_bf16 v[92:95], v[44:47], a[220:223], v[92:95]
v_mfma_f32_16x16x32_bf16 v[96:99], v[48:51], a[192:195], v[96:99]
s_add_u32 s53, s52, 114688
ds_read_b64_tr_b16 v[40:41], v3 offset:8192
ds_read_b64_tr_b16 v[42:43], v5 offset:8704
v_mfma_f32_16x16x32_bf16 v[96:99], v[52:55], a[208:211], v[96:99]
buffer_load_dwordx4 v13, s[20:23], s52 offen offset:3072 lds
v_mfma_f32_16x16x32_bf16 v[100:103], v[48:51], a[196:199], v[100:103]
s_add_u32 m0, s50, 4096
ds_read_b64_tr_b16 v[44:45], v3 offset:12288
ds_read_b64_tr_b16 v[46:47], v5 offset:12800
v_mfma_f32_16x16x32_bf16 v[100:103], v[52:55], a[212:215], v[100:103]
buffer_load_dwordx4 v10, s[20:23], s53 offen lds
v_mfma_f32_16x16x32_bf16 v[104:107], v[48:51], a[200:203], v[104:107]
ds_read_b128 a[252:255], v0 offset:64512
v_mfma_f32_16x16x32_bf16 v[104:107], v[52:55], a[216:219], v[104:107]
buffer_load_dwordx4 v11, s[20:23], s53 offen offset:1024 lds
v_mfma_f32_16x16x32_bf16 v[108:111], v[48:51], a[204:207], v[108:111]
v_mfma_f32_16x16x32_bf16 v[108:111], v[52:55], a[220:223], v[108:111]
v_mfma_f32_16x16x32_bf16 v[112:115], v[56:59], a[192:195], v[112:115]
ds_read_b64_tr_b16 v[48:49], v4 offset:8192
ds_read_b64_tr_b16 v[50:51], v2 offset:8704
v_mfma_f32_16x16x32_bf16 v[112:115], v[60:63], a[208:211], v[112:115]
buffer_load_dwordx4 v12, s[20:23], s53 offen offset:2048 lds
v_mfma_f32_16x16x32_bf16 v[116:119], v[56:59], a[196:199], v[116:119]
ds_read_b64_tr_b16 v[52:53], v4 offset:12288
ds_read_b64_tr_b16 v[54:55], v2 offset:12800
v_mfma_f32_16x16x32_bf16 v[116:119], v[60:63], a[212:215], v[116:119]
buffer_load_dwordx4 v13, s[20:23], s53 offen offset:3072 lds
v_mfma_f32_16x16x32_bf16 v[120:123], v[56:59], a[200:203], v[120:123]
v_mfma_f32_16x16x32_bf16 v[120:123], v[60:63], a[216:219], v[120:123]
v_mfma_f32_16x16x32_bf16 v[124:127], v[56:59], a[204:207], v[124:127]
v_mfma_f32_16x16x32_bf16 v[124:127], v[60:63], a[220:223], v[124:127]
s_waitcnt lgkmcnt(4)
v_mfma_f32_16x16x32_bf16 v[64:67], v[32:35], a[224:227], v[64:67]
ds_read_b64_tr_b16 v[56:57], v5 offset:8192
ds_read_b64_tr_b16 v[58:59], v3 offset:8704
v_mfma_f32_16x16x32_bf16 v[64:67], v[36:39], a[240:243], v[64:67]
ds_read_b64_tr_b16 v[60:61], v5 offset:12288
ds_read_b64_tr_b16 v[62:63], v3 offset:12800
v_mfma_f32_16x16x32_bf16 v[68:71], v[32:35], a[228:231], v[68:71]
s_add_u32 s51, s51, 1
v_mfma_f32_16x16x32_bf16 v[68:71], v[36:39], a[244:247], v[68:71]
s_and_b32 s51, s51, 7
v_mfma_f32_16x16x32_bf16 v[72:75], v[32:35], a[232:235], v[72:75]
s_mul_i32 s52, s51, 229376
v_mfma_f32_16x16x32_bf16 v[72:75], v[36:39], a[248:251], v[72:75]
s_add_u32 s52, s52, s55
v_mfma_f32_16x16x32_bf16 v[76:79], v[32:35], a[236:239], v[76:79]
s_add_u32 m0, s50, 8192
v_mfma_f32_16x16x32_bf16 v[76:79], v[36:39], a[252:255], v[76:79]
s_waitcnt vmcnt(8) lgkmcnt(0)
v_mfma_f32_16x16x32_bf16 v[80:83], v[40:43], a[224:227], v[80:83]
ds_read_b64_tr_b16 v[32:33], v2 offset:16384
ds_read_b64_tr_b16 v[34:35], v4 offset:16896
v_mfma_f32_16x16x32_bf16 v[80:83], v[44:47], a[240:243], v[80:83]
buffer_load_dwordx4 v10, s[20:23], s52 offen lds
v_mfma_f32_16x16x32_bf16 v[84:87], v[40:43], a[228:231], v[84:87]
ds_read_b64_tr_b16 v[36:37], v2 offset:20480
ds_read_b64_tr_b16 v[38:39], v4 offset:20992
v_mfma_f32_16x16x32_bf16 v[84:87], v[44:47], a[244:247], v[84:87]
buffer_load_dwordx4 v11, s[20:23], s52 offen offset:1024 lds
v_mfma_f32_16x16x32_bf16 v[88:91], v[40:43], a[232:235], v[88:91]
v_mfma_f32_16x16x32_bf16 v[88:91], v[44:47], a[248:251], v[88:91]
buffer_load_dwordx4 v12, s[20:23], s52 offen offset:2048 lds
v_mfma_f32_16x16x32_bf16 v[92:95], v[40:43], a[236:239], v[92:95]
v_mfma_f32_16x16x32_bf16 v[92:95], v[44:47], a[252:255], v[92:95]
v_mfma_f32_16x16x32_bf16 v[96:99], v[48:51], a[224:227], v[96:99]
s_add_u32 s53, s52, 114688
ds_read_b64_tr_b16 v[40:41], v3 offset:16384
ds_read_b64_tr_b16 v[42:43], v5 offset:16896
v_mfma_f32_16x16x32_bf16 v[96:99], v[52:55], a[240:243], v[96:99]
buffer_load_dwordx4 v13, s[20:23], s52 offen offset:3072 lds
v_mfma_f32_16x16x32_bf16 v[100:103], v[48:51], a[228:231], v[100:103]
s_add_u32 m0, s50, 12288
ds_read_b64_tr_b16 v[44:45], v3 offset:20480
ds_read_b64_tr_b16 v[46:47], v5 offset:20992
v_mfma_f32_16x16x32_bf16 v[100:103], v[52:55], a[244:247], v[100:103]
buffer_load_dwordx4 v10, s[20:23], s53 offen lds
v_mfma_f32_16x16x32_bf16 v[104:107], v[48:51], a[232:235], v[104:107]
v_mfma_f32_16x16x32_bf16 v[104:107], v[52:55], a[248:251], v[104:107]
buffer_load_dwordx4 v11, s[20:23], s53 offen offset:1024 lds
v_mfma_f32_16x16x32_bf16 v[108:111], v[48:51], a[236:239], v[108:111]
v_mfma_f32_16x16x32_bf16 v[108:111], v[52:55], a[252:255], v[108:111]
v_mfma_f32_16x16x32_bf16 v[112:115], v[56:59], a[224:227], v[112:115]
ds_read_b64_tr_b16 v[48:49], v4 offset:16384
ds_read_b64_tr_b16 v[50:51], v2 offset:16896
v_mfma_f32_16x16x32_bf16 v[112:115], v[60:63], a[240:243], v[112:115]
buffer_load_dwordx4 v12, s[20:23], s53 offen offset:2048 lds
v_mfma_f32_16x16x32_bf16 v[116:119], v[56:59], a[228:231], v[116:119]
ds_read_b64_tr_b16 v[52:53], v4 offset:20480
ds_read_b64_tr_b16 v[54:55], v2 offset:20992
v_mfma_f32_16x16x32_bf16 v[116:119], v[60:63], a[244:247], v[116:119]
buffer_load_dwordx4 v13, s[20:23], s53 offen offset:3072 lds
v_mfma_f32_16x16x32_bf16 v[120:123], v[56:59], a[232:235], v[120:123]
v_mfma_f32_16x16x32_bf16 v[120:123], v[60:63], a[248:251], v[120:123]
v_mfma_f32_16x16x32_bf16 v[124:127], v[56:59], a[236:239], v[124:127]
v_mfma_f32_16x16x32_bf16 v[124:127], v[60:63], a[252:255], v[124:127]
s_waitcnt lgkmcnt(8)
v_mfma_f32_16x16x32_bf16 v[128:131], v[32:35], a[0:3], 0
ds_read_b64_tr_b16 v[56:57], v5 offset:16384
ds_read_b64_tr_b16 v[58:59], v3 offset:16896
v_mfma_f32_16x16x32_bf16 v[128:131], v[36:39], a[16:19], v[128:131]
ds_read_b64_tr_b16 v[60:61], v5 offset:20480
ds_read_b64_tr_b16 v[62:63], v3 offset:20992
v_add_u32 v31, s82, v0
v_mfma_f32_16x16x32_bf16 v[132:135], v[32:35], a[4:7], 0
s_add_u32 s51, s51, 1
v_mov_b32 v30, 0xbdd2d3e8
v_mul_f32 v26, v64, v64
v_mfma_f32_16x16x32_bf16 v[132:135], v[36:39], a[20:23], v[132:135]
s_and_b32 s51, s51, 7
v_mul_f32 v27, v65, v65
v_mul_f32 v28, v66, v66
v_mul_f32 v29, v67, v67
v_mfma_f32_16x16x32_bf16 v[136:139], v[32:35], a[8:11], 0
s_mul_i32 s52, s51, 229376
v_fmaak_f32 v26, v30, v26, 0xc0135761
v_fmaak_f32 v27, v30, v27, 0xc0135761
v_mfma_f32_16x16x32_bf16 v[136:139], v[36:39], a[24:27], v[136:139]
s_add_u32 s52, s52, s55
v_fmaak_f32 v28, v30, v28, 0xc0135761
v_fmaak_f32 v29, v30, v29, 0xc0135761
v_mul_f32 v26, v26, v64
v_mfma_f32_16x16x32_bf16 v[140:143], v[32:35], a[12:15], 0
s_add_u32 m0, s50, 16384
v_mul_f32 v27, v27, v65
v_mul_f32 v28, v28, v66
v_mfma_f32_16x16x32_bf16 v[140:143], v[36:39], a[28:31], v[140:143]
s_waitcnt vmcnt(8) lgkmcnt(0)
v_mul_f32 v29, v29, v67
v_exp_f32 v26, v26
v_mfma_f32_16x16x32_bf16 v[144:147], v[40:43], a[0:3], 0
ds_read_b64_tr_b16 v[32:33], v2 offset:0
ds_read_b64_tr_b16 v[34:35], v4 offset:512
v_mfma_f32_16x16x32_bf16 v[144:147], v[44:47], a[16:19], v[144:147]
buffer_load_dwordx4 v10, s[20:23], s52 offen lds
v_mfma_f32_16x16x32_bf16 v[148:151], v[40:43], a[4:7], 0
ds_read_b64_tr_b16 v[36:37], v2 offset:4096
ds_read_b64_tr_b16 v[38:39], v4 offset:4608
v_mfma_f32_16x16x32_bf16 v[148:151], v[44:47], a[20:23], v[148:151]
buffer_load_dwordx4 v11, s[20:23], s52 offen offset:1024 lds
v_mfma_f32_16x16x32_bf16 v[152:155], v[40:43], a[8:11], 0
v_exp_f32 v27, v27
v_mfma_f32_16x16x32_bf16 v[152:155], v[44:47], a[24:27], v[152:155]
buffer_load_dwordx4 v12, s[20:23], s52 offen offset:2048 lds
v_mfma_f32_16x16x32_bf16 v[156:159], v[40:43], a[12:15], 0
v_exp_f32 v28, v28
v_exp_f32 v29, v29
v_mfma_f32_16x16x32_bf16 v[156:159], v[44:47], a[28:31], v[156:159]
v_add_f32 v26, 1.0, v26
v_add_f32 v27, 1.0, v27
v_mfma_f32_16x16x32_bf16 v[160:163], v[48:51], a[0:3], 0
s_add_u32 s53, s52, 114688
ds_read_b64_tr_b16 v[40:41], v3 offset:0
ds_read_b64_tr_b16 v[42:43], v5 offset:512
v_add_f32 v28, 1.0, v28
v_mfma_f32_16x16x32_bf16 v[160:163], v[52:55], a[16:19], v[160:163]
buffer_load_dwordx4 v13, s[20:23], s52 offen offset:3072 lds
v_mfma_f32_16x16x32_bf16 v[164:167], v[48:51], a[4:7], 0
s_add_u32 m0, s50, 20480
ds_read_b64_tr_b16 v[44:45], v3 offset:4096
ds_read_b64_tr_b16 v[46:47], v5 offset:4608
v_mfma_f32_16x16x32_bf16 v[164:167], v[52:55], a[20:23], v[164:167]
buffer_load_dwordx4 v10, s[20:23], s53 offen lds
v_mfma_f32_16x16x32_bf16 v[168:171], v[48:51], a[8:11], 0
v_add_f32 v29, 1.0, v29
v_rcp_f32 v26, v26
v_mfma_f32_16x16x32_bf16 v[168:171], v[52:55], a[24:27], v[168:171]
buffer_load_dwordx4 v11, s[20:23], s53 offen offset:1024 lds
v_mfma_f32_16x16x32_bf16 v[172:175], v[48:51], a[12:15], 0
v_rcp_f32 v27, v27
v_mfma_f32_16x16x32_bf16 v[172:175], v[52:55], a[28:31], v[172:175]
v_rcp_f32 v28, v28
v_mfma_f32_16x16x32_bf16 v[176:179], v[56:59], a[0:3], 0
ds_read_b64_tr_b16 v[48:49], v4 offset:0
ds_read_b64_tr_b16 v[50:51], v2 offset:512
v_mfma_f32_16x16x32_bf16 v[176:179], v[60:63], a[16:19], v[176:179]
buffer_load_dwordx4 v12, s[20:23], s53 offen offset:2048 lds
v_mfma_f32_16x16x32_bf16 v[180:183], v[56:59], a[4:7], 0
ds_read_b64_tr_b16 v[52:53], v4 offset:4096
ds_read_b64_tr_b16 v[54:55], v2 offset:4608
v_rcp_f32 v29, v29
v_mfma_f32_16x16x32_bf16 v[180:183], v[60:63], a[20:23], v[180:183]
buffer_load_dwordx4 v13, s[20:23], s53 offen offset:3072 lds
v_mfma_f32_16x16x32_bf16 v[184:187], v[56:59], a[8:11], 0
v_mul_f32 v64, v64, v26
v_mul_f32 v65, v65, v27
v_mfma_f32_16x16x32_bf16 v[184:187], v[60:63], a[24:27], v[184:187]
v_mul_f32 v66, v66, v28
v_mul_f32 v67, v67, v29
v_mul_f32 v26, v68, v68
v_mfma_f32_16x16x32_bf16 v[188:191], v[56:59], a[12:15], 0
v_mul_f32 v27, v69, v69
v_mul_f32 v28, v70, v70
v_mfma_f32_16x16x32_bf16 v[188:191], v[60:63], a[28:31], v[188:191]
s_waitcnt lgkmcnt(8)
v_mul_f32 v29, v71, v71
v_fmaak_f32 v26, v30, v26, 0xc0135761
v_fmaak_f32 v27, v30, v27, 0xc0135761
v_mfma_f32_16x16x32_bf16 v[128:131], v[32:35], a[32:35], v[128:131]
s_barrier
ds_read_b64_tr_b16 v[56:57], v5 offset:0
ds_read_b64_tr_b16 v[58:59], v3 offset:512
v_mfma_f32_16x16x32_bf16 v[128:131], v[36:39], a[48:51], v[128:131]
ds_read_b64_tr_b16 v[60:61], v5 offset:4096
ds_read_b64_tr_b16 v[62:63], v3 offset:4608
v_fmaak_f32 v28, v30, v28, 0xc0135761
v_mfma_f32_16x16x32_bf16 v[132:135], v[32:35], a[36:39], v[132:135]
s_add_u32 s51, s51, 1
v_fmaak_f32 v29, v30, v29, 0xc0135761
v_mul_f32 v26, v26, v68
v_mfma_f32_16x16x32_bf16 v[132:135], v[36:39], a[52:55], v[132:135]
s_and_b32 s51, s51, 7
v_mul_f32 v27, v27, v69
v_mul_f32 v28, v28, v70
v_mul_f32 v29, v29, v71
v_mfma_f32_16x16x32_bf16 v[136:139], v[32:35], a[40:43], v[136:139]
s_mul_i32 s52, s51, 229376
v_exp_f32 v26, v26
v_mfma_f32_16x16x32_bf16 v[136:139], v[36:39], a[56:59], v[136:139]
s_add_u32 s52, s52, s55
v_exp_f32 v27, v27
v_mfma_f32_16x16x32_bf16 v[140:143], v[32:35], a[44:47], v[140:143]
s_add_u32 m0, s50, 0
v_exp_f32 v28, v28
v_mfma_f32_16x16x32_bf16 v[140:143], v[36:39], a[60:63], v[140:143]
s_waitcnt vmcnt(8) lgkmcnt(0)
v_exp_f32 v29, v29
v_add_f32 v26, 1.0, v26
v_add_f32 v27, 1.0, v27
v_mfma_f32_16x16x32_bf16 v[144:147], v[40:43], a[32:35], v[144:147]
ds_read_b64_tr_b16 v[32:33], v2 offset:8192
ds_read_b64_tr_b16 v[34:35], v4 offset:8704
v_mfma_f32_16x16x32_bf16 v[144:147], v[44:47], a[48:51], v[144:147]
buffer_load_dwordx4 v10, s[20:23], s52 offen lds
v_mfma_f32_16x16x32_bf16 v[148:151], v[40:43], a[36:39], v[148:151]
ds_read_b64_tr_b16 v[36:37], v2 offset:12288
ds_read_b64_tr_b16 v[38:39], v4 offset:12800
v_add_f32 v28, 1.0, v28
v_mfma_f32_16x16x32_bf16 v[148:151], v[44:47], a[52:55], v[148:151]
buffer_load_dwordx4 v11, s[20:23], s52 offen offset:1024 lds
v_mfma_f32_16x16x32_bf16 v[152:155], v[40:43], a[40:43], v[152:155]
v_add_f32 v29, 1.0, v29
v_rcp_f32 v26, v26
v_mfma_f32_16x16x32_bf16 v[152:155], v[44:47], a[56:59], v[152:155]
buffer_load_dwordx4 v12, s[20:23], s52 offen offset:2048 lds
v_mfma_f32_16x16x32_bf16 v[156:159], v[40:43], a[44:47], v[156:159]
v_rcp_f32 v27, v27
v_mfma_f32_16x16x32_bf16 v[156:159], v[44:47], a[60:63], v[156:159]
v_rcp_f32 v28, v28
v_mfma_f32_16x16x32_bf16 v[160:163], v[48:51], a[32:35], v[160:163]
s_add_u32 s53, s52, 114688
ds_read_b64_tr_b16 v[40:41], v3 offset:8192
ds_read_b64_tr_b16 v[42:43], v5 offset:8704
v_mfma_f32_16x16x32_bf16 v[160:163], v[52:55], a[48:51], v[160:163]
buffer_load_dwordx4 v13, s[20:23], s52 offen offset:3072 lds
v_mfma_f32_16x16x32_bf16 v[164:167], v[48:51], a[36:39], v[164:167]
s_add_u32 m0, s50, 4096
ds_read_b64_tr_b16 v[44:45], v3 offset:12288
ds_read_b64_tr_b16 v[46:47], v5 offset:12800
v_mfma_f32_16x16x32_bf16 v[164:167], v[52:55], a[52:55], v[164:167]
buffer_load_dwordx4 v10, s[20:23], s53 offen lds
v_mfma_f32_16x16x32_bf16 v[168:171], v[48:51], a[40:43], v[168:171]
v_rcp_f32 v29, v29
v_mul_f32 v68, v68, v26
v_mul_f32 v69, v69, v27
v_mfma_f32_16x16x32_bf16 v[168:171], v[52:55], a[56:59], v[168:171]
buffer_load_dwordx4 v11, s[20:23], s53 offen offset:1024 lds
v_mfma_f32_16x16x32_bf16 v[172:175], v[48:51], a[44:47], v[172:175]
v_mul_f32 v70, v70, v28
v_mul_f32 v71, v71, v29
v_mfma_f32_16x16x32_bf16 v[172:175], v[52:55], a[60:63], v[172:175]
v_mul_f32 v26, v72, v72
v_mul_f32 v27, v73, v73
v_mul_f32 v28, v74, v74
v_mfma_f32_16x16x32_bf16 v[176:179], v[56:59], a[32:35], v[176:179]
ds_read_b64_tr_b16 v[48:49], v4 offset:8192
ds_read_b64_tr_b16 v[50:51], v2 offset:8704
v_mfma_f32_16x16x32_bf16 v[176:179], v[60:63], a[48:51], v[176:179]
buffer_load_dwordx4 v12, s[20:23], s53 offen offset:2048 lds
v_mfma_f32_16x16x32_bf16 v[180:183], v[56:59], a[36:39], v[180:183]
ds_read_b64_tr_b16 v[52:53], v4 offset:12288
ds_read_b64_tr_b16 v[54:55], v2 offset:12800
v_mul_f32 v29, v75, v75
v_mfma_f32_16x16x32_bf16 v[180:183], v[60:63], a[52:55], v[180:183]
buffer_load_dwordx4 v13, s[20:23], s53 offen offset:3072 lds
v_mfma_f32_16x16x32_bf16 v[184:187], v[56:59], a[40:43], v[184:187]
v_fmaak_f32 v26, v30, v26, 0xc0135761
v_fmaak_f32 v27, v30, v27, 0xc0135761
v_mfma_f32_16x16x32_bf16 v[184:187], v[60:63], a[56:59], v[184:187]
v_fmaak_f32 v28, v30, v28, 0xc0135761
v_fmaak_f32 v29, v30, v29, 0xc0135761
v_mul_f32 v26, v26, v72
v_mfma_f32_16x16x32_bf16 v[188:191], v[56:59], a[44:47], v[188:191]
v_mul_f32 v27, v27, v73
v_mul_f32 v28, v28, v74
v_mfma_f32_16x16x32_bf16 v[188:191], v[60:63], a[60:63], v[188:191]
s_waitcnt lgkmcnt(8)
v_mul_f32 v29, v29, v75
v_exp_f32 v26, v26
v_mfma_f32_16x16x32_bf16 v[128:131], v[32:35], a[64:67], v[128:131]
ds_read_b64_tr_b16 v[56:57], v5 offset:8192
ds_read_b64_tr_b16 v[58:59], v3 offset:8704
v_mfma_f32_16x16x32_bf16 v[128:131], v[36:39], a[80:83], v[128:131]
ds_read_b64_tr_b16 v[60:61], v5 offset:12288
ds_read_b64_tr_b16 v[62:63], v3 offset:12800
v_mfma_f32_16x16x32_bf16 v[132:135], v[32:35], a[68:71], v[132:135]
s_add_u32 s51, s51, 1
v_exp_f32 v27, v27
v_mfma_f32_16x16x32_bf16 v[132:135], v[36:39], a[84:87], v[132:135]
s_and_b32 s51, s51, 7
v_exp_f32 v28, v28
v_exp_f32 v29, v29
v_mfma_f32_16x16x32_bf16 v[136:139], v[32:35], a[72:75], v[136:139]
s_mul_i32 s52, s51, 229376
v_add_f32 v26, 1.0, v26
v_add_f32 v27, 1.0, v27
v_mfma_f32_16x16x32_bf16 v[136:139], v[36:39], a[88:91], v[136:139]
s_add_u32 s52, s52, s55
v_add_f32 v28, 1.0, v28
v_add_f32 v29, 1.0, v29
v_mfma_f32_16x16x32_bf16 v[140:143], v[32:35], a[76:79], v[140:143]
s_add_u32 m0, s50, 8192
v_rcp_f32 v26, v26
v_mfma_f32_16x16x32_bf16 v[140:143], v[36:39], a[92:95], v[140:143]
s_waitcnt vmcnt(8) lgkmcnt(0)
v_rcp_f32 v27, v27
v_rcp_f32 v28, v28
v_mfma_f32_16x16x32_bf16 v[144:147], v[40:43], a[64:67], v[144:147]
ds_read_b64_tr_b16 v[32:33], v2 offset:16384
ds_read_b64_tr_b16 v[34:35], v4 offset:16896
v_mfma_f32_16x16x32_bf16 v[144:147], v[44:47], a[80:83], v[144:147]
buffer_load_dwordx4 v10, s[20:23], s52 offen lds
v_mfma_f32_16x16x32_bf16 v[148:151], v[40:43], a[68:71], v[148:151]
ds_read_b64_tr_b16 v[36:37], v2 offset:20480
ds_read_b64_tr_b16 v[38:39], v4 offset:20992
v_mfma_f32_16x16x32_bf16 v[148:151], v[44:47], a[84:87], v[148:151]
buffer_load_dwordx4 v11, s[20:23], s52 offen offset:1024 lds
v_mfma_f32_16x16x32_bf16 v[152:155], v[40:43], a[72:75], v[152:155]
v_rcp_f32 v29, v29
v_mul_f32 v72, v72, v26
v_mfma_f32_16x16x32_bf16 v[152:155], v[44:47], a[88:91], v[152:155]
buffer_load_dwordx4 v12, s[20:23], s52 offen offset:2048 lds
v_mfma_f32_16x16x32_bf16 v[156:159], v[40:43], a[76:79], v[156:159]
v_mul_f32 v73, v73, v27
v_mul_f32 v74, v74, v28
v_mul_f32 v75, v75, v29
v_mfma_f32_16x16x32_bf16 v[156:159], v[44:47], a[92:95], v[156:159]
v_mul_f32 v26, v76, v76
v_mul_f32 v27, v77, v77
v_mfma_f32_16x16x32_bf16 v[160:163], v[48:51], a[64:67], v[160:163]
s_add_u32 s53, s52, 114688
ds_read_b64_tr_b16 v[40:41], v3 offset:16384
ds_read_b64_tr_b16 v[42:43], v5 offset:16896
v_mul_f32 v28, v78, v78
v_mfma_f32_16x16x32_bf16 v[160:163], v[52:55], a[80:83], v[160:163]
buffer_load_dwordx4 v13, s[20:23], s52 offen offset:3072 lds
v_mfma_f32_16x16x32_bf16 v[164:167], v[48:51], a[68:71], v[164:167]
s_add_u32 m0, s50, 12288
ds_read_b64_tr_b16 v[44:45], v3 offset:20480
ds_read_b64_tr_b16 v[46:47], v5 offset:20992
v_mfma_f32_16x16x32_bf16 v[164:167], v[52:55], a[84:87], v[164:167]
buffer_load_dwordx4 v10, s[20:23], s53 offen lds
v_mfma_f32_16x16x32_bf16 v[168:171], v[48:51], a[72:75], v[168:171]
v_mul_f32 v29, v79, v79
v_fmaak_f32 v26, v30, v26, 0xc0135761
v_fmaak_f32 v27, v30, v27, 0xc0135761
v_mfma_f32_16x16x32_bf16 v[168:171], v[52:55], a[88:91], v[168:171]
buffer_load_dwordx4 v11, s[20:23], s53 offen offset:1024 lds
v_mfma_f32_16x16x32_bf16 v[172:175], v[48:51], a[76:79], v[172:175]
v_fmaak_f32 v28, v30, v28, 0xc0135761
v_fmaak_f32 v29, v30, v29, 0xc0135761
v_mfma_f32_16x16x32_bf16 v[172:175], v[52:55], a[92:95], v[172:175]
v_mul_f32 v26, v26, v76
v_mul_f32 v27, v27, v77
v_mul_f32 v28, v28, v78
v_mfma_f32_16x16x32_bf16 v[176:179], v[56:59], a[64:67], v[176:179]
ds_read_b64_tr_b16 v[48:49], v4 offset:16384
ds_read_b64_tr_b16 v[50:51], v2 offset:16896
v_mfma_f32_16x16x32_bf16 v[176:179], v[60:63], a[80:83], v[176:179]
buffer_load_dwordx4 v12, s[20:23], s53 offen offset:2048 lds
v_mfma_f32_16x16x32_bf16 v[180:183], v[56:59], a[68:71], v[180:183]
ds_read_b64_tr_b16 v[52:53], v4 offset:20480
ds_read_b64_tr_b16 v[54:55], v2 offset:20992
v_mul_f32 v29, v29, v79
v_mfma_f32_16x16x32_bf16 v[180:183], v[60:63], a[84:87], v[180:183]
buffer_load_dwordx4 v13, s[20:23], s53 offen offset:3072 lds
v_mfma_f32_16x16x32_bf16 v[184:187], v[56:59], a[72:75], v[184:187]
v_exp_f32 v26, v26
v_mfma_f32_16x16x32_bf16 v[184:187], v[60:63], a[88:91], v[184:187]
v_exp_f32 v27, v27
v_mfma_f32_16x16x32_bf16 v[188:191], v[56:59], a[76:79], v[188:191]
v_exp_f32 v28, v28
v_mfma_f32_16x16x32_bf16 v[188:191], v[60:63], a[92:95], v[188:191]
s_waitcnt lgkmcnt(8)
v_exp_f32 v29, v29
v_add_f32 v26, 1.0, v26
v_add_f32 v27, 1.0, v27
v_mfma_f32_16x16x32_bf16 v[128:131], v[32:35], a[96:99], v[128:131]
ds_read_b64_tr_b16 v[56:57], v5 offset:16384
ds_read_b64_tr_b16 v[58:59], v3 offset:16896
v_mfma_f32_16x16x32_bf16 v[128:131], v[36:39], a[112:115], v[128:131]
ds_read_b64_tr_b16 v[60:61], v5 offset:20480
ds_read_b64_tr_b16 v[62:63], v3 offset:20992
v_add_f32 v28, 1.0, v28
v_mfma_f32_16x16x32_bf16 v[132:135], v[32:35], a[100:103], v[132:135]
s_add_u32 s51, s51, 1
v_add_f32 v29, 1.0, v29
v_rcp_f32 v26, v26
v_mfma_f32_16x16x32_bf16 v[132:135], v[36:39], a[116:119], v[132:135]
s_and_b32 s51, s51, 7
v_rcp_f32 v27, v27
v_mfma_f32_16x16x32_bf16 v[136:139], v[32:35], a[104:107], v[136:139]
s_mul_i32 s52, s51, 229376
v_rcp_f32 v28, v28
v_mfma_f32_16x16x32_bf16 v[136:139], v[36:39], a[120:123], v[136:139]
s_add_u32 s52, s52, s55
v_rcp_f32 v29, v29
v_mul_f32 v76, v76, v26
v_mfma_f32_16x16x32_bf16 v[140:143], v[32:35], a[108:111], v[140:143]
s_add_u32 m0, s50, 16384
v_mul_f32 v77, v77, v27
v_mul_f32 v78, v78, v28
v_mfma_f32_16x16x32_bf16 v[140:143], v[36:39], a[124:127], v[140:143]
s_waitcnt vmcnt(8) lgkmcnt(0)
v_mul_f32 v79, v79, v29
v_mul_f32 v26, v80, v80
v_mul_f32 v27, v81, v81
v_mfma_f32_16x16x32_bf16 v[144:147], v[40:43], a[96:99], v[144:147]
ds_read_b64_tr_b16 v[32:33], v2 offset:0
ds_read_b64_tr_b16 v[34:35], v4 offset:512
v_mfma_f32_16x16x32_bf16 v[144:147], v[44:47], a[112:115], v[144:147]
buffer_load_dwordx4 v10, s[20:23], s52 offen lds
v_mfma_f32_16x16x32_bf16 v[148:151], v[40:43], a[100:103], v[148:151]
ds_read_b64_tr_b16 v[36:37], v2 offset:4096
ds_read_b64_tr_b16 v[38:39], v4 offset:4608
v_mul_f32 v28, v82, v82
v_mfma_f32_16x16x32_bf16 v[148:151], v[44:47], a[116:119], v[148:151]
buffer_load_dwordx4 v11, s[20:23], s52 offen offset:1024 lds
v_mfma_f32_16x16x32_bf16 v[152:155], v[40:43], a[104:107], v[152:155]
v_mul_f32 v29, v83, v83
v_fmaak_f32 v26, v30, v26, 0xc0135761
v_mfma_f32_16x16x32_bf16 v[152:155], v[44:47], a[120:123], v[152:155]
buffer_load_dwordx4 v12, s[20:23], s52 offen offset:2048 lds
v_mfma_f32_16x16x32_bf16 v[156:159], v[40:43], a[108:111], v[156:159]
v_fmaak_f32 v27, v30, v27, 0xc0135761
v_fmaak_f32 v28, v30, v28, 0xc0135761
v_fmaak_f32 v29, v30, v29, 0xc0135761
v_mfma_f32_16x16x32_bf16 v[156:159], v[44:47], a[124:127], v[156:159]
v_mul_f32 v26, v26, v80
v_mul_f32 v27, v27, v81
v_mfma_f32_16x16x32_bf16 v[160:163], v[48:51], a[96:99], v[160:163]
s_add_u32 s53, s52, 114688
ds_read_b64_tr_b16 v[40:41], v3 offset:0
ds_read_b64_tr_b16 v[42:43], v5 offset:512
v_mul_f32 v28, v28, v82
v_mfma_f32_16x16x32_bf16 v[160:163], v[52:55], a[112:115], v[160:163]
buffer_load_dwordx4 v13, s[20:23], s52 offen offset:3072 lds
v_mfma_f32_16x16x32_bf16 v[164:167], v[48:51], a[100:103], v[164:167]
s_add_u32 m0, s50, 20480
ds_read_b64_tr_b16 v[44:45], v3 offset:4096
ds_read_b64_tr_b16 v[46:47], v5 offset:4608
v_mfma_f32_16x16x32_bf16 v[164:167], v[52:55], a[116:119], v[164:167]
buffer_load_dwordx4 v10, s[20:23], s53 offen lds
v_mfma_f32_16x16x32_bf16 v[168:171], v[48:51], a[104:107], v[168:171]
v_mul_f32 v29, v29, v83
v_exp_f32 v26, v26
v_mfma_f32_16x16x32_bf16 v[168:171], v[52:55], a[120:123], v[168:171]
buffer_load_dwordx4 v11, s[20:23], s53 offen offset:1024 lds
v_mfma_f32_16x16x32_bf16 v[172:175], v[48:51], a[108:111], v[172:175]
v_exp_f32 v27, v27
v_mfma_f32_16x16x32_bf16 v[172:175], v[52:55], a[124:127], v[172:175]
v_exp_f32 v28, v28
v_mfma_f32_16x16x32_bf16 v[176:179], v[56:59], a[96:99], v[176:179]
ds_read_b64_tr_b16 v[48:49], v4 offset:0
ds_read_b64_tr_b16 v[50:51], v2 offset:512
v_mfma_f32_16x16x32_bf16 v[176:179], v[60:63], a[112:115], v[176:179]
buffer_load_dwordx4 v12, s[20:23], s53 offen offset:2048 lds
v_mfma_f32_16x16x32_bf16 v[180:183], v[56:59], a[100:103], v[180:183]
ds_read_b64_tr_b16 v[52:53], v4 offset:4096
ds_read_b64_tr_b16 v[54:55], v2 offset:4608
v_exp_f32 v29, v29
v_mfma_f32_16x16x32_bf16 v[180:183], v[60:63], a[116:119], v[180:183]
buffer_load_dwordx4 v13, s[20:23], s53 offen offset:3072 lds
v_mfma_f32_16x16x32_bf16 v[184:187], v[56:59], a[104:107], v[184:187]
v_add_f32 v26, 1.0, v26
v_add_f32 v27, 1.0, v27
v_mfma_f32_16x16x32_bf16 v[184:187], v[60:63], a[120:123], v[184:187]
v_add_f32 v28, 1.0, v28
v_add_f32 v29, 1.0, v29
v_mfma_f32_16x16x32_bf16 v[188:191], v[56:59], a[108:111], v[188:191]
v_rcp_f32 v26, v26
v_mfma_f32_16x16x32_bf16 v[188:191], v[60:63], a[124:127], v[188:191]
s_waitcnt lgkmcnt(8)
v_rcp_f32 v27, v27
v_rcp_f32 v28, v28
v_mfma_f32_16x16x32_bf16 v[128:131], v[32:35], a[128:131], v[128:131]
ds_read_b64_tr_b16 v[56:57], v5 offset:0
ds_read_b64_tr_b16 v[58:59], v3 offset:512
v_mfma_f32_16x16x32_bf16 v[128:131], v[36:39], a[144:147], v[128:131]
ds_read_b64_tr_b16 v[60:61], v5 offset:4096
ds_read_b64_tr_b16 v[62:63], v3 offset:4608
v_mfma_f32_16x16x32_bf16 v[132:135], v[32:35], a[132:135], v[132:135]
s_add_u32 s51, s51, 1
v_rcp_f32 v29, v29
v_mul_f32 v80, v80, v26
v_mfma_f32_16x16x32_bf16 v[132:135], v[36:39], a[148:151], v[132:135]
s_and_b32 s51, s51, 7
v_mul_f32 v81, v81, v27
v_mul_f32 v82, v82, v28
v_mul_f32 v83, v83, v29
v_mfma_f32_16x16x32_bf16 v[136:139], v[32:35], a[136:139], v[136:139]
s_mul_i32 s52, s51, 229376
v_mul_f32 v26, v84, v84
v_mul_f32 v27, v85, v85
v_mfma_f32_16x16x32_bf16 v[136:139], v[36:39], a[152:155], v[136:139]
s_add_u32 s52, s52, s55
v_mul_f32 v28, v86, v86
v_mul_f32 v29, v87, v87
v_fmaak_f32 v26, v30, v26, 0xc0135761
v_mfma_f32_16x16x32_bf16 v[140:143], v[32:35], a[140:143], v[140:143]
s_add_u32 m0, s50, 0
v_fmaak_f32 v27, v30, v27, 0xc0135761
v_fmaak_f32 v28, v30, v28, 0xc0135761
v_mfma_f32_16x16x32_bf16 v[140:143], v[36:39], a[156:159], v[140:143]
s_waitcnt vmcnt(8) lgkmcnt(0)
v_fmaak_f32 v29, v30, v29, 0xc0135761
v_mul_f32 v26, v26, v84
v_mul_f32 v27, v27, v85
v_mfma_f32_16x16x32_bf16 v[144:147], v[40:43], a[128:131], v[144:147]
ds_read_b64_tr_b16 v[32:33], v2 offset:8192
ds_read_b64_tr_b16 v[34:35], v4 offset:8704
v_mfma_f32_16x16x32_bf16 v[144:147], v[44:47], a[144:147], v[144:147]
buffer_load_dwordx4 v10, s[20:23], s52 offen lds
v_mfma_f32_16x16x32_bf16 v[148:151], v[40:43], a[132:135], v[148:151]
ds_read_b64_tr_b16 v[36:37], v2 offset:12288
ds_read_b64_tr_b16 v[38:39], v4 offset:12800
v_mul_f32 v28, v28, v86
v_mfma_f32_16x16x32_bf16 v[148:151], v[44:47], a[148:151], v[148:151]
buffer_load_dwordx4 v11, s[20:23], s52 offen offset:1024 lds
v_mfma_f32_16x16x32_bf16 v[152:155], v[40:43], a[136:139], v[152:155]
v_mul_f32 v29, v29, v87
v_exp_f32 v26, v26
v_mfma_f32_16x16x32_bf16 v[152:155], v[44:47], a[152:155], v[152:155]
buffer_load_dwordx4 v12, s[20:23], s52 offen offset:2048 lds
v_mfma_f32_16x16x32_bf16 v[156:159], v[40:43], a[140:143], v[156:159]
v_exp_f32 v27, v27
v_mfma_f32_16x16x32_bf16 v[156:159], v[44:47], a[156:159], v[156:159]
v_exp_f32 v28, v28
v_mfma_f32_16x16x32_bf16 v[160:163], v[48:51], a[128:131], v[160:163]
s_add_u32 s53, s52, 114688
ds_read_b64_tr_b16 v[40:41], v3 offset:8192
ds_read_b64_tr_b16 v[42:43], v5 offset:8704
v_mfma_f32_16x16x32_bf16 v[160:163], v[52:55], a[144:147], v[160:163]
buffer_load_dwordx4 v13, s[20:23], s52 offen offset:3072 lds
v_mfma_f32_16x16x32_bf16 v[164:167], v[48:51], a[132:135], v[164:167]
s_add_u32 m0, s50, 4096
ds_read_b64_tr_b16 v[44:45], v3 offset:12288
ds_read_b64_tr_b16 v[46:47], v5 offset:12800
v_mfma_f32_16x16x32_bf16 v[164:167], v[52:55], a[148:151], v[164:167]
buffer_load_dwordx4 v10, s[20:23], s53 offen lds
v_mfma_f32_16x16x32_bf16 v[168:171], v[48:51], a[136:139], v[168:171]
v_exp_f32 v29, v29
v_add_f32 v26, 1.0, v26
v_add_f32 v27, 1.0, v27
v_mfma_f32_16x16x32_bf16 v[168:171], v[52:55], a[152:155], v[168:171]
buffer_load_dwordx4 v11, s[20:23], s53 offen offset:1024 lds
v_mfma_f32_16x16x32_bf16 v[172:175], v[48:51], a[140:143], v[172:175]
v_add_f32 v28, 1.0, v28
v_add_f32 v29, 1.0, v29
v_mfma_f32_16x16x32_bf16 v[172:175], v[52:55], a[156:159], v[172:175]
v_rcp_f32 v26, v26
v_mfma_f32_16x16x32_bf16 v[176:179], v[56:59], a[128:131], v[176:179]
ds_read_b64_tr_b16 v[48:49], v4 offset:8192
ds_read_b64_tr_b16 v[50:51], v2 offset:8704
v_mfma_f32_16x16x32_bf16 v[176:179], v[60:63], a[144:147], v[176:179]
buffer_load_dwordx4 v12, s[20:23], s53 offen offset:2048 lds
v_mfma_f32_16x16x32_bf16 v[180:183], v[56:59], a[132:135], v[180:183]
ds_read_b64_tr_b16 v[52:53], v4 offset:12288
ds_read_b64_tr_b16 v[54:55], v2 offset:12800
v_rcp_f32 v27, v27
v_mfma_f32_16x16x32_bf16 v[180:183], v[60:63], a[148:151], v[180:183]
buffer_load_dwordx4 v13, s[20:23], s53 offen offset:3072 lds
v_mfma_f32_16x16x32_bf16 v[184:187], v[56:59], a[136:139], v[184:187]
v_rcp_f32 v28, v28
v_mfma_f32_16x16x32_bf16 v[184:187], v[60:63], a[152:155], v[184:187]
v_rcp_f32 v29, v29
v_mul_f32 v84, v84, v26
v_mfma_f32_16x16x32_bf16 v[188:191], v[56:59], a[140:143], v[188:191]
v_mul_f32 v85, v85, v27
v_mul_f32 v86, v86, v28
v_mfma_f32_16x16x32_bf16 v[188:191], v[60:63], a[156:159], v[188:191]
s_waitcnt lgkmcnt(8)
v_mul_f32 v87, v87, v29
v_mul_f32 v26, v88, v88
v_mul_f32 v27, v89, v89
v_mfma_f32_16x16x32_bf16 v[128:131], v[32:35], a[160:163], v[128:131]
ds_read_b64_tr_b16 v[56:57], v5 offset:8192
ds_read_b64_tr_b16 v[58:59], v3 offset:8704
v_mfma_f32_16x16x32_bf16 v[128:131], v[36:39], a[176:179], v[128:131]
ds_read_b64_tr_b16 v[60:61], v5 offset:12288
ds_read_b64_tr_b16 v[62:63], v3 offset:12800
v_mul_f32 v28, v90, v90
v_mfma_f32_16x16x32_bf16 v[132:135], v[32:35], a[164:167], v[132:135]
s_add_u32 s51, s51, 1
v_mul_f32 v29, v91, v91
v_fmaak_f32 v26, v30, v26, 0xc0135761
v_mfma_f32_16x16x32_bf16 v[132:135], v[36:39], a[180:183], v[132:135]
s_and_b32 s51, s51, 7
v_fmaak_f32 v27, v30, v27, 0xc0135761
v_fmaak_f32 v28, v30, v28, 0xc0135761
v_fmaak_f32 v29, v30, v29, 0xc0135761
v_mfma_f32_16x16x32_bf16 v[136:139], v[32:35], a[168:171], v[136:139]
s_mul_i32 s52, s51, 524288
v_mul_f32 v26, v26, v88
v_mul_f32 v27, v27, v89
v_mfma_f32_16x16x32_bf16 v[136:139], v[36:39], a[184:187], v[136:139]
s_add_u32 s52, s52, s56
v_mul_f32 v28, v28, v90
v_mul_f32 v29, v29, v91
v_mfma_f32_16x16x32_bf16 v[140:143], v[32:35], a[172:175], v[140:143]
s_add_u32 m0, s50, 8192
v_exp_f32 v26, v26
v_mfma_f32_16x16x32_bf16 v[140:143], v[36:39], a[188:191], v[140:143]
s_waitcnt vmcnt(8) lgkmcnt(0)
v_exp_f32 v27, v27
v_exp_f32 v28, v28
v_mfma_f32_16x16x32_bf16 v[144:147], v[40:43], a[160:163], v[144:147]
ds_read_b64_tr_b16 v[32:33], v2 offset:16384
ds_read_b64_tr_b16 v[34:35], v4 offset:16896
v_mfma_f32_16x16x32_bf16 v[144:147], v[44:47], a[176:179], v[144:147]
buffer_load_dwordx4 v14, s[24:27], s52 offen lds
v_mfma_f32_16x16x32_bf16 v[148:151], v[40:43], a[164:167], v[148:151]
ds_read_b64_tr_b16 v[36:37], v2 offset:20480
ds_read_b64_tr_b16 v[38:39], v4 offset:20992
v_mfma_f32_16x16x32_bf16 v[148:151], v[44:47], a[180:183], v[148:151]
buffer_load_dwordx4 v15, s[24:27], s52 offen offset:1024 lds
v_mfma_f32_16x16x32_bf16 v[152:155], v[40:43], a[168:171], v[152:155]
v_exp_f32 v29, v29
v_add_f32 v26, 1.0, v26
v_mfma_f32_16x16x32_bf16 v[152:155], v[44:47], a[184:187], v[152:155]
buffer_load_dwordx4 v16, s[24:27], s52 offen offset:2048 lds
v_mfma_f32_16x16x32_bf16 v[156:159], v[40:43], a[172:175], v[156:159]
v_add_f32 v27, 1.0, v27
v_add_f32 v28, 1.0, v28
v_add_f32 v29, 1.0, v29
v_mfma_f32_16x16x32_bf16 v[156:159], v[44:47], a[188:191], v[156:159]
v_rcp_f32 v26, v26
v_mfma_f32_16x16x32_bf16 v[160:163], v[48:51], a[160:163], v[160:163]
s_add_u32 s53, s52, 262144
ds_read_b64_tr_b16 v[40:41], v3 offset:16384
ds_read_b64_tr_b16 v[42:43], v5 offset:16896
v_mfma_f32_16x16x32_bf16 v[160:163], v[52:55], a[176:179], v[160:163]
buffer_load_dwordx4 v17, s[24:27], s52 offen offset:3072 lds
v_mfma_f32_16x16x32_bf16 v[164:167], v[48:51], a[164:167], v[164:167]
s_add_u32 m0, s50, 12288
ds_read_b64_tr_b16 v[44:45], v3 offset:20480
ds_read_b64_tr_b16 v[46:47], v5 offset:20992
v_mfma_f32_16x16x32_bf16 v[164:167], v[52:55], a[180:183], v[164:167]
buffer_load_dwordx4 v14, s[24:27], s53 offen lds
v_mfma_f32_16x16x32_bf16 v[168:171], v[48:51], a[168:171], v[168:171]
v_rcp_f32 v27, v27
v_rcp_f32 v28, v28
v_mfma_f32_16x16x32_bf16 v[168:171], v[52:55], a[184:187], v[168:171]
buffer_load_dwordx4 v15, s[24:27], s53 offen offset:1024 lds
v_mfma_f32_16x16x32_bf16 v[172:175], v[48:51], a[172:175], v[172:175]
v_rcp_f32 v29, v29
v_mfma_f32_16x16x32_bf16 v[172:175], v[52:55], a[188:191], v[172:175]
v_mul_f32 v88, v88, v26
v_mul_f32 v89, v89, v27
v_mul_f32 v90, v90, v28
v_mfma_f32_16x16x32_bf16 v[176:179], v[56:59], a[160:163], v[176:179]
ds_read_b64_tr_b16 v[48:49], v4 offset:16384
ds_read_b64_tr_b16 v[50:51], v2 offset:16896
v_mfma_f32_16x16x32_bf16 v[176:179], v[60:63], a[176:179], v[176:179]
buffer_load_dwordx4 v16, s[24:27], s53 offen offset:2048 lds
v_mfma_f32_16x16x32_bf16 v[180:183], v[56:59], a[164:167], v[180:183]
ds_read_b64_tr_b16 v[52:53], v4 offset:20480
ds_read_b64_tr_b16 v[54:55], v2 offset:20992
v_mul_f32 v91, v91, v29
v_mfma_f32_16x16x32_bf16 v[180:183], v[60:63], a[180:183], v[180:183]
buffer_load_dwordx4 v17, s[24:27], s53 offen offset:3072 lds
v_mfma_f32_16x16x32_bf16 v[184:187], v[56:59], a[168:171], v[184:187]
v_mul_f32 v26, v92, v92
v_mul_f32 v27, v93, v93
v_mfma_f32_16x16x32_bf16 v[184:187], v[60:63], a[184:187], v[184:187]
v_mul_f32 v28, v94, v94
v_mul_f32 v29, v95, v95
v_fmaak_f32 v26, v30, v26, 0xc0135761
v_mfma_f32_16x16x32_bf16 v[188:191], v[56:59], a[172:175], v[188:191]
v_fmaak_f32 v27, v30, v27, 0xc0135761
v_fmaak_f32 v28, v30, v28, 0xc0135761
v_mfma_f32_16x16x32_bf16 v[188:191], v[60:63], a[188:191], v[188:191]
s_waitcnt lgkmcnt(8)
v_fmaak_f32 v29, v30, v29, 0xc0135761
v_mul_f32 v26, v26, v92
v_mul_f32 v27, v27, v93
v_mfma_f32_16x16x32_bf16 v[128:131], v[32:35], a[192:195], v[128:131]
ds_read_b64_tr_b16 v[56:57], v5 offset:16384
ds_read_b64_tr_b16 v[58:59], v3 offset:16896
v_mfma_f32_16x16x32_bf16 v[128:131], v[36:39], a[208:211], v[128:131]
ds_read_b64_tr_b16 v[60:61], v5 offset:20480
ds_read_b64_tr_b16 v[62:63], v3 offset:20992
v_mul_f32 v28, v28, v94
v_mfma_f32_16x16x32_bf16 v[132:135], v[32:35], a[196:199], v[132:135]
s_add_u32 s51, s51, 1
v_mul_f32 v29, v29, v95
v_exp_f32 v26, v26
v_mfma_f32_16x16x32_bf16 v[132:135], v[36:39], a[212:215], v[132:135]
s_and_b32 s51, s51, 7
v_exp_f32 v27, v27
v_mfma_f32_16x16x32_bf16 v[136:139], v[32:35], a[200:203], v[136:139]
s_mul_i32 s52, s51, 524288
v_exp_f32 v28, v28
v_mfma_f32_16x16x32_bf16 v[136:139], v[36:39], a[216:219], v[136:139]
s_add_u32 s52, s52, s56
v_exp_f32 v29, v29
v_add_f32 v26, 1.0, v26
v_mfma_f32_16x16x32_bf16 v[140:143], v[32:35], a[204:207], v[140:143]
s_add_u32 m0, s50, 16384
v_add_f32 v27, 1.0, v27
v_add_f32 v28, 1.0, v28
v_mfma_f32_16x16x32_bf16 v[140:143], v[36:39], a[220:223], v[140:143]
s_waitcnt vmcnt(8) lgkmcnt(0)
v_add_f32 v29, 1.0, v29
v_rcp_f32 v26, v26
v_mfma_f32_16x16x32_bf16 v[144:147], v[40:43], a[192:195], v[144:147]
ds_read_b64_tr_b16 v[32:33], v2 offset:0
ds_read_b64_tr_b16 v[34:35], v4 offset:512
v_mfma_f32_16x16x32_bf16 v[144:147], v[44:47], a[208:211], v[144:147]
buffer_load_dwordx4 v14, s[24:27], s52 offen lds
v_mfma_f32_16x16x32_bf16 v[148:151], v[40:43], a[196:199], v[148:151]
ds_read_b64_tr_b16 v[36:37], v2 offset:4096
ds_read_b64_tr_b16 v[38:39], v4 offset:4608
v_mfma_f32_16x16x32_bf16 v[148:151], v[44:47], a[212:215], v[148:151]
buffer_load_dwordx4 v15, s[24:27], s52 offen offset:1024 lds
v_mfma_f32_16x16x32_bf16 v[152:155], v[40:43], a[200:203], v[152:155]
v_rcp_f32 v27, v27
v_mfma_f32_16x16x32_bf16 v[152:155], v[44:47], a[216:219], v[152:155]
buffer_load_dwordx4 v16, s[24:27], s52 offen offset:2048 lds
v_mfma_f32_16x16x32_bf16 v[156:159], v[40:43], a[204:207], v[156:159]
v_rcp_f32 v28, v28
v_rcp_f32 v29, v29
v_mfma_f32_16x16x32_bf16 v[156:159], v[44:47], a[220:223], v[156:159]
v_mul_f32 v92, v92, v26
v_mul_f32 v93, v93, v27
v_mfma_f32_16x16x32_bf16 v[160:163], v[48:51], a[192:195], v[160:163]
s_add_u32 s53, s52, 262144
ds_read_b64_tr_b16 v[40:41], v3 offset:0
ds_read_b64_tr_b16 v[42:43], v5 offset:512
v_mul_f32 v94, v94, v28
v_mfma_f32_16x16x32_bf16 v[160:163], v[52:55], a[208:211], v[160:163]
buffer_load_dwordx4 v17, s[24:27], s52 offen offset:3072 lds
v_mfma_f32_16x16x32_bf16 v[164:167], v[48:51], a[196:199], v[164:167]
s_add_u32 m0, s50, 20480
ds_read_b64_tr_b16 v[44:45], v3 offset:4096
ds_read_b64_tr_b16 v[46:47], v5 offset:4608
v_mfma_f32_16x16x32_bf16 v[164:167], v[52:55], a[212:215], v[164:167]
buffer_load_dwordx4 v14, s[24:27], s53 offen lds
v_mfma_f32_16x16x32_bf16 v[168:171], v[48:51], a[200:203], v[168:171]
v_mul_f32 v95, v95, v29
v_mul_f32 v26, v96, v96
v_mul_f32 v27, v97, v97
v_mfma_f32_16x16x32_bf16 v[168:171], v[52:55], a[216:219], v[168:171]
buffer_load_dwordx4 v15, s[24:27], s53 offen offset:1024 lds
v_mfma_f32_16x16x32_bf16 v[172:175], v[48:51], a[204:207], v[172:175]
v_mul_f32 v28, v98, v98
v_mul_f32 v29, v99, v99
v_mfma_f32_16x16x32_bf16 v[172:175], v[52:55], a[220:223], v[172:175]
v_fmaak_f32 v26, v30, v26, 0xc0135761
v_fmaak_f32 v27, v30, v27, 0xc0135761
v_fmaak_f32 v28, v30, v28, 0xc0135761
v_mfma_f32_16x16x32_bf16 v[176:179], v[56:59], a[192:195], v[176:179]
ds_read_b64_tr_b16 v[48:49], v4 offset:0
ds_read_b64_tr_b16 v[50:51], v2 offset:512
v_mfma_f32_16x16x32_bf16 v[176:179], v[60:63], a[208:211], v[176:179]
buffer_load_dwordx4 v16, s[24:27], s53 offen offset:2048 lds
v_mfma_f32_16x16x32_bf16 v[180:183], v[56:59], a[196:199], v[180:183]
ds_read_b64_tr_b16 v[52:53], v4 offset:4096
ds_read_b64_tr_b16 v[54:55], v2 offset:4608
v_fmaak_f32 v29, v30, v29, 0xc0135761
v_mfma_f32_16x16x32_bf16 v[180:183], v[60:63], a[212:215], v[180:183]
buffer_load_dwordx4 v17, s[24:27], s53 offen offset:3072 lds
v_mfma_f32_16x16x32_bf16 v[184:187], v[56:59], a[200:203], v[184:187]
v_mul_f32 v26, v26, v96
v_mul_f32 v27, v27, v97
v_mfma_f32_16x16x32_bf16 v[184:187], v[60:63], a[216:219], v[184:187]
v_mul_f32 v28, v28, v98
v_mul_f32 v29, v29, v99
v_mfma_f32_16x16x32_bf16 v[188:191], v[56:59], a[204:207], v[188:191]
v_exp_f32 v26, v26
v_mfma_f32_16x16x32_bf16 v[188:191], v[60:63], a[220:223], v[188:191]
s_waitcnt lgkmcnt(8)
v_exp_f32 v27, v27
v_exp_f32 v28, v28
v_mfma_f32_16x16x32_bf16 v[128:131], v[32:35], a[224:227], v[128:131]
ds_read_b64_tr_b16 v[56:57], v5 offset:0
ds_read_b64_tr_b16 v[58:59], v3 offset:512
v_mfma_f32_16x16x32_bf16 v[128:131], v[36:39], a[240:243], v[128:131]
ds_read_b64_tr_b16 v[60:61], v5 offset:4096
ds_read_b64_tr_b16 v[62:63], v3 offset:4608
v_mfma_f32_16x16x32_bf16 v[132:135], v[32:35], a[228:231], v[132:135]
s_add_u32 s51, s51, 1
v_exp_f32 v29, v29
v_add_f32 v26, 1.0, v26
v_mfma_f32_16x16x32_bf16 v[132:135], v[36:39], a[244:247], v[132:135]
s_and_b32 s51, s51, 7
v_add_f32 v27, 1.0, v27
v_add_f32 v28, 1.0, v28
v_add_f32 v29, 1.0, v29
v_mfma_f32_16x16x32_bf16 v[136:139], v[32:35], a[232:235], v[136:139]
s_mul_i32 s52, s51, 524288
v_rcp_f32 v26, v26
v_mfma_f32_16x16x32_bf16 v[136:139], v[36:39], a[248:251], v[136:139]
s_add_u32 s52, s52, s56
v_rcp_f32 v27, v27
v_mfma_f32_16x16x32_bf16 v[140:143], v[32:35], a[236:239], v[140:143]
s_add_u32 m0, s50, 0
v_rcp_f32 v28, v28
v_mfma_f32_16x16x32_bf16 v[140:143], v[36:39], a[252:255], v[140:143]
s_waitcnt vmcnt(8) lgkmcnt(0)
v_rcp_f32 v29, v29
v_mul_f32 v96, v96, v26
v_mul_f32 v97, v97, v27
v_mfma_f32_16x16x32_bf16 v[144:147], v[40:43], a[224:227], v[144:147]
ds_read_b64_tr_b16 v[32:33], v2 offset:8192
ds_read_b64_tr_b16 v[34:35], v4 offset:8704
v_mfma_f32_16x16x32_bf16 v[144:147], v[44:47], a[240:243], v[144:147]
buffer_load_dwordx4 v14, s[24:27], s52 offen lds
v_mfma_f32_16x16x32_bf16 v[148:151], v[40:43], a[228:231], v[148:151]
ds_read_b64_tr_b16 v[36:37], v2 offset:12288
ds_read_b64_tr_b16 v[38:39], v4 offset:12800
v_mul_f32 v98, v98, v28
v_mfma_f32_16x16x32_bf16 v[148:151], v[44:47], a[244:247], v[148:151]
buffer_load_dwordx4 v15, s[24:27], s52 offen offset:1024 lds
v_mfma_f32_16x16x32_bf16 v[152:155], v[40:43], a[232:235], v[152:155]
v_mul_f32 v99, v99, v29
v_mul_f32 v26, v100, v100
v_mfma_f32_16x16x32_bf16 v[152:155], v[44:47], a[248:251], v[152:155]
buffer_load_dwordx4 v16, s[24:27], s52 offen offset:2048 lds
v_mfma_f32_16x16x32_bf16 v[156:159], v[40:43], a[236:239], v[156:159]
v_mul_f32 v27, v101, v101
v_mul_f32 v28, v102, v102
v_mul_f32 v29, v103, v103
v_mfma_f32_16x16x32_bf16 v[156:159], v[44:47], a[252:255], v[156:159]
v_fmaak_f32 v26, v30, v26, 0xc0135761
v_fmaak_f32 v27, v30, v27, 0xc0135761
v_mfma_f32_16x16x32_bf16 v[160:163], v[48:51], a[224:227], v[160:163]
s_add_u32 s53, s52, 262144
ds_read_b64_tr_b16 v[40:41], v3 offset:8192
ds_read_b64_tr_b16 v[42:43], v5 offset:8704
v_fmaak_f32 v28, v30, v28, 0xc0135761
v_mfma_f32_16x16x32_bf16 v[160:163], v[52:55], a[240:243], v[160:163]
buffer_load_dwordx4 v17, s[24:27], s52 offen offset:3072 lds
v_mfma_f32_16x16x32_bf16 v[164:167], v[48:51], a[228:231], v[164:167]
s_add_u32 m0, s50, 4096
ds_read_b64_tr_b16 v[44:45], v3 offset:12288
ds_read_b64_tr_b16 v[46:47], v5 offset:12800
v_mfma_f32_16x16x32_bf16 v[164:167], v[52:55], a[244:247], v[164:167]
buffer_load_dwordx4 v14, s[24:27], s53 offen lds
v_mfma_f32_16x16x32_bf16 v[168:171], v[48:51], a[232:235], v[168:171]
v_fmaak_f32 v29, v30, v29, 0xc0135761
v_mul_f32 v26, v26, v100
v_mul_f32 v27, v27, v101
v_mfma_f32_16x16x32_bf16 v[168:171], v[52:55], a[248:251], v[168:171]
buffer_load_dwordx4 v15, s[24:27], s53 offen offset:1024 lds
v_mfma_f32_16x16x32_bf16 v[172:175], v[48:51], a[236:239], v[172:175]
v_mul_f32 v28, v28, v102
v_mul_f32 v29, v29, v103
v_mfma_f32_16x16x32_bf16 v[172:175], v[52:55], a[252:255], v[172:175]
v_exp_f32 v26, v26
v_mfma_f32_16x16x32_bf16 v[176:179], v[56:59], a[224:227], v[176:179]
ds_read_b64_tr_b16 v[48:49], v4 offset:8192
ds_read_b64_tr_b16 v[50:51], v2 offset:8704
v_mfma_f32_16x16x32_bf16 v[176:179], v[60:63], a[240:243], v[176:179]
buffer_load_dwordx4 v16, s[24:27], s53 offen offset:2048 lds
v_mfma_f32_16x16x32_bf16 v[180:183], v[56:59], a[228:231], v[180:183]
ds_read_b64_tr_b16 v[52:53], v4 offset:12288
ds_read_b64_tr_b16 v[54:55], v2 offset:12800
v_exp_f32 v27, v27
v_mfma_f32_16x16x32_bf16 v[180:183], v[60:63], a[244:247], v[180:183]
buffer_load_dwordx4 v17, s[24:27], s53 offen offset:3072 lds
v_mfma_f32_16x16x32_bf16 v[184:187], v[56:59], a[232:235], v[184:187]
v_exp_f32 v28, v28
v_mfma_f32_16x16x32_bf16 v[184:187], v[60:63], a[248:251], v[184:187]
v_exp_f32 v29, v29
v_add_f32 v26, 1.0, v26
v_mfma_f32_16x16x32_bf16 v[188:191], v[56:59], a[236:239], v[188:191]
v_add_f32 v27, 1.0, v27
v_add_f32 v28, 1.0, v28
v_mfma_f32_16x16x32_bf16 v[188:191], v[60:63], a[252:255], v[188:191]
s_waitcnt lgkmcnt(8)
v_add_f32 v29, 1.0, v29
v_rcp_f32 v26, v26
v_mfma_f32_16x16x32_bf16 v[192:195], v[32:35], a[0:3], 0
ds_read_b64_tr_b16 v[56:57], v5 offset:8192
ds_read_b64_tr_b16 v[58:59], v3 offset:8704
v_mfma_f32_16x16x32_bf16 v[192:195], v[36:39], a[16:19], v[192:195]
ds_read_b64_tr_b16 v[60:61], v5 offset:12288
ds_read_b64_tr_b16 v[62:63], v3 offset:12800
v_mfma_f32_16x16x32_bf16 v[196:199], v[32:35], a[4:7], 0
s_add_u32 s51, s51, 1
v_rcp_f32 v27, v27
v_mfma_f32_16x16x32_bf16 v[196:199], v[36:39], a[20:23], v[196:199]
s_and_b32 s51, s51, 7
v_rcp_f32 v28, v28
v_rcp_f32 v29, v29
v_mfma_f32_16x16x32_bf16 v[200:203], v[32:35], a[8:11], 0
s_mul_i32 s52, s51, 524288
v_mul_f32 v100, v100, v26
v_mul_f32 v101, v101, v27
v_mfma_f32_16x16x32_bf16 v[200:203], v[36:39], a[24:27], v[200:203]
s_add_u32 s52, s52, s56
v_mul_f32 v102, v102, v28
v_mul_f32 v103, v103, v29
v_mul_f32 v26, v104, v104
v_mfma_f32_16x16x32_bf16 v[204:207], v[32:35], a[12:15], 0
s_add_u32 m0, s50, 8192
v_mul_f32 v27, v105, v105
v_mul_f32 v28, v106, v106
v_mfma_f32_16x16x32_bf16 v[204:207], v[36:39], a[28:31], v[204:207]
s_waitcnt vmcnt(8) lgkmcnt(0)
v_mul_f32 v29, v107, v107
v_fmaak_f32 v26, v30, v26, 0xc0135761
v_fmaak_f32 v27, v30, v27, 0xc0135761
v_mfma_f32_16x16x32_bf16 v[208:211], v[40:43], a[0:3], 0
ds_read_b64_tr_b16 v[32:33], v2 offset:16384
ds_read_b64_tr_b16 v[34:35], v4 offset:16896
v_mfma_f32_16x16x32_bf16 v[208:211], v[44:47], a[16:19], v[208:211]
buffer_load_dwordx4 v14, s[24:27], s52 offen lds
v_mfma_f32_16x16x32_bf16 v[212:215], v[40:43], a[4:7], 0
ds_read_b64_tr_b16 v[36:37], v2 offset:20480
ds_read_b64_tr_b16 v[38:39], v4 offset:20992
v_fmaak_f32 v28, v30, v28, 0xc0135761
v_mfma_f32_16x16x32_bf16 v[212:215], v[44:47], a[20:23], v[212:215]
buffer_load_dwordx4 v15, s[24:27], s52 offen offset:1024 lds
v_mfma_f32_16x16x32_bf16 v[216:219], v[40:43], a[8:11], 0
v_fmaak_f32 v29, v30, v29, 0xc0135761
v_mul_f32 v26, v26, v104
v_mfma_f32_16x16x32_bf16 v[216:219], v[44:47], a[24:27], v[216:219]
buffer_load_dwordx4 v16, s[24:27], s52 offen offset:2048 lds
v_mfma_f32_16x16x32_bf16 v[220:223], v[40:43], a[12:15], 0
v_mul_f32 v27, v27, v105
v_mul_f32 v28, v28, v106
v_mul_f32 v29, v29, v107
v_mfma_f32_16x16x32_bf16 v[220:223], v[44:47], a[28:31], v[220:223]
v_exp_f32 v26, v26
v_mfma_f32_16x16x32_bf16 v[224:227], v[48:51], a[0:3], 0
s_add_u32 s53, s52, 262144
ds_read_b64_tr_b16 v[40:41], v3 offset:16384
ds_read_b64_tr_b16 v[42:43], v5 offset:16896
v_mfma_f32_16x16x32_bf16 v[224:227], v[52:55], a[16:19], v[224:227]
buffer_load_dwordx4 v17, s[24:27], s52 offen offset:3072 lds
v_mfma_f32_16x16x32_bf16 v[228:231], v[48:51], a[4:7], 0
s_add_u32 m0, s50, 12288
ds_read_b64_tr_b16 v[44:45], v3 offset:20480
ds_read_b64_tr_b16 v[46:47], v5 offset:20992
v_mfma_f32_16x16x32_bf16 v[228:231], v[52:55], a[20:23], v[228:231]
buffer_load_dwordx4 v14, s[24:27], s53 offen lds
v_mfma_f32_16x16x32_bf16 v[232:235], v[48:51], a[8:11], 0
v_exp_f32 v27, v27
v_exp_f32 v28, v28
v_mfma_f32_16x16x32_bf16 v[232:235], v[52:55], a[24:27], v[232:235]
buffer_load_dwordx4 v15, s[24:27], s53 offen offset:1024 lds
v_mfma_f32_16x16x32_bf16 v[236:239], v[48:51], a[12:15], 0
v_exp_f32 v29, v29
v_mfma_f32_16x16x32_bf16 v[236:239], v[52:55], a[28:31], v[236:239]
v_add_f32 v26, 1.0, v26
v_add_f32 v27, 1.0, v27
v_add_f32 v28, 1.0, v28
v_mfma_f32_16x16x32_bf16 v[240:243], v[56:59], a[0:3], 0
ds_read_b64_tr_b16 v[48:49], v4 offset:16384
ds_read_b64_tr_b16 v[50:51], v2 offset:16896
v_mfma_f32_16x16x32_bf16 v[240:243], v[60:63], a[16:19], v[240:243]
buffer_load_dwordx4 v16, s[24:27], s53 offen offset:2048 lds
v_mfma_f32_16x16x32_bf16 v[244:247], v[56:59], a[4:7], 0
ds_read_b64_tr_b16 v[52:53], v4 offset:20480
ds_read_b64_tr_b16 v[54:55], v2 offset:20992
v_add_f32 v29, 1.0, v29
v_mfma_f32_16x16x32_bf16 v[244:247], v[60:63], a[20:23], v[244:247]
buffer_load_dwordx4 v17, s[24:27], s53 offen offset:3072 lds
v_mfma_f32_16x16x32_bf16 v[248:251], v[56:59], a[8:11], 0
v_rcp_f32 v26, v26
v_mfma_f32_16x16x32_bf16 v[248:251], v[60:63], a[24:27], v[248:251]
v_rcp_f32 v27, v27
v_mfma_f32_16x16x32_bf16 v[252:255], v[56:59], a[12:15], 0
v_rcp_f32 v28, v28
v_mfma_f32_16x16x32_bf16 v[252:255], v[60:63], a[28:31], v[252:255]
s_waitcnt lgkmcnt(8)
v_rcp_f32 v29, v29
v_mul_f32 v104, v104, v26
v_mul_f32 v105, v105, v27
v_mfma_f32_16x16x32_bf16 v[192:195], v[32:35], a[32:35], v[192:195]
ds_read_b64_tr_b16 v[56:57], v5 offset:16384
ds_read_b64_tr_b16 v[58:59], v3 offset:16896
v_mfma_f32_16x16x32_bf16 v[192:195], v[36:39], a[48:51], v[192:195]
ds_read_b64_tr_b16 v[60:61], v5 offset:20480
ds_read_b64_tr_b16 v[62:63], v3 offset:20992
v_mul_f32 v106, v106, v28
v_mfma_f32_16x16x32_bf16 v[196:199], v[32:35], a[36:39], v[196:199]
s_add_u32 s51, s51, 1
v_mul_f32 v107, v107, v29
v_mul_f32 v26, v108, v108
v_mfma_f32_16x16x32_bf16 v[196:199], v[36:39], a[52:55], v[196:199]
s_and_b32 s51, s51, 7
v_mul_f32 v27, v109, v109
v_mul_f32 v28, v110, v110
v_mul_f32 v29, v111, v111
v_mfma_f32_16x16x32_bf16 v[200:203], v[32:35], a[40:43], v[200:203]
s_mul_i32 s52, s51, 524288
v_fmaak_f32 v26, v30, v26, 0xc0135761
v_fmaak_f32 v27, v30, v27, 0xc0135761
v_mfma_f32_16x16x32_bf16 v[200:203], v[36:39], a[56:59], v[200:203]
s_add_u32 s52, s52, s56
v_fmaak_f32 v28, v30, v28, 0xc0135761
v_fmaak_f32 v29, v30, v29, 0xc0135761
v_mul_f32 v26, v26, v108
v_mfma_f32_16x16x32_bf16 v[204:207], v[32:35], a[44:47], v[204:207]
s_add_u32 m0, s50, 16384
v_mul_f32 v27, v27, v109
v_mul_f32 v28, v28, v110
v_mfma_f32_16x16x32_bf16 v[204:207], v[36:39], a[60:63], v[204:207]
s_waitcnt vmcnt(8) lgkmcnt(0)
v_mul_f32 v29, v29, v111
v_exp_f32 v26, v26
v_mfma_f32_16x16x32_bf16 v[208:211], v[40:43], a[32:35], v[208:211]
ds_read_b64_tr_b16 v[32:33], v2 offset:0
ds_read_b64_tr_b16 v[34:35], v4 offset:512
v_mfma_f32_16x16x32_bf16 v[208:211], v[44:47], a[48:51], v[208:211]
buffer_load_dwordx4 v14, s[24:27], s52 offen lds
v_mfma_f32_16x16x32_bf16 v[212:215], v[40:43], a[36:39], v[212:215]
ds_read_b64_tr_b16 v[36:37], v2 offset:4096
ds_read_b64_tr_b16 v[38:39], v4 offset:4608
v_mfma_f32_16x16x32_bf16 v[212:215], v[44:47], a[52:55], v[212:215]
buffer_load_dwordx4 v15, s[24:27], s52 offen offset:1024 lds
v_mfma_f32_16x16x32_bf16 v[216:219], v[40:43], a[40:43], v[216:219]
v_exp_f32 v27, v27
v_mfma_f32_16x16x32_bf16 v[216:219], v[44:47], a[56:59], v[216:219]
buffer_load_dwordx4 v16, s[24:27], s52 offen offset:2048 lds
v_mfma_f32_16x16x32_bf16 v[220:223], v[40:43], a[44:47], v[220:223]
v_exp_f32 v28, v28
v_exp_f32 v29, v29
v_mfma_f32_16x16x32_bf16 v[220:223], v[44:47], a[60:63], v[220:223]
v_add_f32 v26, 1.0, v26
v_add_f32 v27, 1.0, v27
v_mfma_f32_16x16x32_bf16 v[224:227], v[48:51], a[32:35], v[224:227]
s_add_u32 s53, s52, 262144
ds_read_b64_tr_b16 v[40:41], v3 offset:0
ds_read_b64_tr_b16 v[42:43], v5 offset:512
v_add_f32 v28, 1.0, v28
v_mfma_f32_16x16x32_bf16 v[224:227], v[52:55], a[48:51], v[224:227]
buffer_load_dwordx4 v17, s[24:27], s52 offen offset:3072 lds
v_mfma_f32_16x16x32_bf16 v[228:231], v[48:51], a[36:39], v[228:231]
s_add_u32 m0, s50, 20480
ds_read_b64_tr_b16 v[44:45], v3 offset:4096
ds_read_b64_tr_b16 v[46:47], v5 offset:4608
v_mfma_f32_16x16x32_bf16 v[228:231], v[52:55], a[52:55], v[228:231]
buffer_load_dwordx4 v14, s[24:27], s53 offen lds
v_mfma_f32_16x16x32_bf16 v[232:235], v[48:51], a[40:43], v[232:235]
v_add_f32 v29, 1.0, v29
v_rcp_f32 v26, v26
v_mfma_f32_16x16x32_bf16 v[232:235], v[52:55], a[56:59], v[232:235]
buffer_load_dwordx4 v15, s[24:27], s53 offen offset:1024 lds
v_mfma_f32_16x16x32_bf16 v[236:239], v[48:51], a[44:47], v[236:239]
v_rcp_f32 v27, v27
v_mfma_f32_16x16x32_bf16 v[236:239], v[52:55], a[60:63], v[236:239]
v_rcp_f32 v28, v28
v_mfma_f32_16x16x32_bf16 v[240:243], v[56:59], a[32:35], v[240:243]
ds_read_b64_tr_b16 v[48:49], v4 offset:0
ds_read_b64_tr_b16 v[50:51], v2 offset:512
v_mfma_f32_16x16x32_bf16 v[240:243], v[60:63], a[48:51], v[240:243]
buffer_load_dwordx4 v16, s[24:27], s53 offen offset:2048 lds
v_mfma_f32_16x16x32_bf16 v[244:247], v[56:59], a[36:39], v[244:247]
ds_read_b64_tr_b16 v[52:53], v4 offset:4096
ds_read_b64_tr_b16 v[54:55], v2 offset:4608
v_rcp_f32 v29, v29
v_mfma_f32_16x16x32_bf16 v[244:247], v[60:63], a[52:55], v[244:247]
buffer_load_dwordx4 v17, s[24:27], s53 offen offset:3072 lds
v_mfma_f32_16x16x32_bf16 v[248:251], v[56:59], a[40:43], v[248:251]
v_mul_f32 v108, v108, v26
v_mul_f32 v109, v109, v27
v_mfma_f32_16x16x32_bf16 v[248:251], v[60:63], a[56:59], v[248:251]
v_mul_f32 v110, v110, v28
v_mul_f32 v111, v111, v29
v_mul_f32 v26, v112, v112
v_mfma_f32_16x16x32_bf16 v[252:255], v[56:59], a[44:47], v[252:255]
v_mul_f32 v27, v113, v113
v_mul_f32 v28, v114, v114
v_mfma_f32_16x16x32_bf16 v[252:255], v[60:63], a[60:63], v[252:255]
s_waitcnt lgkmcnt(8)
v_mul_f32 v29, v115, v115
v_fmaak_f32 v26, v30, v26, 0xc0135761
v_fmaak_f32 v27, v30, v27, 0xc0135761
v_mfma_f32_16x16x32_bf16 v[192:195], v[32:35], a[64:67], v[192:195]
ds_read_b64_tr_b16 v[56:57], v5 offset:0
ds_read_b64_tr_b16 v[58:59], v3 offset:512
v_mfma_f32_16x16x32_bf16 v[192:195], v[36:39], a[80:83], v[192:195]
ds_read_b64_tr_b16 v[60:61], v5 offset:4096
ds_read_b64_tr_b16 v[62:63], v3 offset:4608
v_fmaak_f32 v28, v30, v28, 0xc0135761
v_mfma_f32_16x16x32_bf16 v[196:199], v[32:35], a[68:71], v[196:199]
s_add_u32 s51, s51, 1
v_fmaak_f32 v29, v30, v29, 0xc0135761
v_mul_f32 v26, v26, v112
v_mfma_f32_16x16x32_bf16 v[196:199], v[36:39], a[84:87], v[196:199]
s_and_b32 s51, s51, 7
v_mul_f32 v27, v27, v113
v_mul_f32 v28, v28, v114
v_mul_f32 v29, v29, v115
v_mfma_f32_16x16x32_bf16 v[200:203], v[32:35], a[72:75], v[200:203]
s_mul_i32 s52, s51, 524288
v_exp_f32 v26, v26
v_mfma_f32_16x16x32_bf16 v[200:203], v[36:39], a[88:91], v[200:203]
s_add_u32 s52, s52, s56
v_exp_f32 v27, v27
v_mfma_f32_16x16x32_bf16 v[204:207], v[32:35], a[76:79], v[204:207]
s_add_u32 m0, s50, 0
v_exp_f32 v28, v28
v_mfma_f32_16x16x32_bf16 v[204:207], v[36:39], a[92:95], v[204:207]
s_waitcnt vmcnt(8) lgkmcnt(0)
v_exp_f32 v29, v29
v_add_f32 v26, 1.0, v26
v_add_f32 v27, 1.0, v27
v_mfma_f32_16x16x32_bf16 v[208:211], v[40:43], a[64:67], v[208:211]
ds_read_b64_tr_b16 v[32:33], v2 offset:8192
ds_read_b64_tr_b16 v[34:35], v4 offset:8704
v_mfma_f32_16x16x32_bf16 v[208:211], v[44:47], a[80:83], v[208:211]
buffer_load_dwordx4 v14, s[24:27], s52 offen lds
v_mfma_f32_16x16x32_bf16 v[212:215], v[40:43], a[68:71], v[212:215]
ds_read_b64_tr_b16 v[36:37], v2 offset:12288
ds_read_b64_tr_b16 v[38:39], v4 offset:12800
v_add_f32 v28, 1.0, v28
v_mfma_f32_16x16x32_bf16 v[212:215], v[44:47], a[84:87], v[212:215]
buffer_load_dwordx4 v15, s[24:27], s52 offen offset:1024 lds
v_mfma_f32_16x16x32_bf16 v[216:219], v[40:43], a[72:75], v[216:219]
v_add_f32 v29, 1.0, v29
v_rcp_f32 v26, v26
v_mfma_f32_16x16x32_bf16 v[216:219], v[44:47], a[88:91], v[216:219]
buffer_load_dwordx4 v16, s[24:27], s52 offen offset:2048 lds
v_mfma_f32_16x16x32_bf16 v[220:223], v[40:43], a[76:79], v[220:223]
v_rcp_f32 v27, v27
v_mfma_f32_16x16x32_bf16 v[220:223], v[44:47], a[92:95], v[220:223]
v_rcp_f32 v28, v28
v_mfma_f32_16x16x32_bf16 v[224:227], v[48:51], a[64:67], v[224:227]
s_add_u32 s53, s52, 262144
ds_read_b64_tr_b16 v[40:41], v3 offset:8192
ds_read_b64_tr_b16 v[42:43], v5 offset:8704
v_mfma_f32_16x16x32_bf16 v[224:227], v[52:55], a[80:83], v[224:227]
buffer_load_dwordx4 v17, s[24:27], s52 offen offset:3072 lds
v_mfma_f32_16x16x32_bf16 v[228:231], v[48:51], a[68:71], v[228:231]
s_add_u32 m0, s50, 4096
ds_read_b64_tr_b16 v[44:45], v3 offset:12288
ds_read_b64_tr_b16 v[46:47], v5 offset:12800
v_mfma_f32_16x16x32_bf16 v[228:231], v[52:55], a[84:87], v[228:231]
buffer_load_dwordx4 v14, s[24:27], s53 offen lds
v_mfma_f32_16x16x32_bf16 v[232:235], v[48:51], a[72:75], v[232:235]
v_rcp_f32 v29, v29
v_mul_f32 v112, v112, v26
v_mul_f32 v113, v113, v27
v_mfma_f32_16x16x32_bf16 v[232:235], v[52:55], a[88:91], v[232:235]
buffer_load_dwordx4 v15, s[24:27], s53 offen offset:1024 lds
v_mfma_f32_16x16x32_bf16 v[236:239], v[48:51], a[76:79], v[236:239]
v_mul_f32 v114, v114, v28
v_mul_f32 v115, v115, v29
v_mfma_f32_16x16x32_bf16 v[236:239], v[52:55], a[92:95], v[236:239]
v_mul_f32 v26, v116, v116
v_mul_f32 v27, v117, v117
v_mul_f32 v28, v118, v118
v_mfma_f32_16x16x32_bf16 v[240:243], v[56:59], a[64:67], v[240:243]
ds_read_b64_tr_b16 v[48:49], v4 offset:8192
ds_read_b64_tr_b16 v[50:51], v2 offset:8704
v_mfma_f32_16x16x32_bf16 v[240:243], v[60:63], a[80:83], v[240:243]
buffer_load_dwordx4 v16, s[24:27], s53 offen offset:2048 lds
v_mfma_f32_16x16x32_bf16 v[244:247], v[56:59], a[68:71], v[244:247]
ds_read_b64_tr_b16 v[52:53], v4 offset:12288
ds_read_b64_tr_b16 v[54:55], v2 offset:12800
v_mul_f32 v29, v119, v119
v_mfma_f32_16x16x32_bf16 v[244:247], v[60:63], a[84:87], v[244:247]
buffer_load_dwordx4 v17, s[24:27], s53 offen offset:3072 lds
v_mfma_f32_16x16x32_bf16 v[248:251], v[56:59], a[72:75], v[248:251]
v_fmaak_f32 v26, v30, v26, 0xc0135761
v_fmaak_f32 v27, v30, v27, 0xc0135761
v_mfma_f32_16x16x32_bf16 v[248:251], v[60:63], a[88:91], v[248:251]
v_fmaak_f32 v28, v30, v28, 0xc0135761
v_fmaak_f32 v29, v30, v29, 0xc0135761
v_mul_f32 v26, v26, v116
v_mfma_f32_16x16x32_bf16 v[252:255], v[56:59], a[76:79], v[252:255]
v_mul_f32 v27, v27, v117
v_mul_f32 v28, v28, v118
v_mfma_f32_16x16x32_bf16 v[252:255], v[60:63], a[92:95], v[252:255]
s_waitcnt lgkmcnt(8)
v_mul_f32 v29, v29, v119
v_exp_f32 v26, v26
v_mfma_f32_16x16x32_bf16 v[192:195], v[32:35], a[96:99], v[192:195]
ds_read_b64_tr_b16 v[56:57], v5 offset:8192
ds_read_b64_tr_b16 v[58:59], v3 offset:8704
v_mfma_f32_16x16x32_bf16 v[192:195], v[36:39], a[112:115], v[192:195]
ds_read_b64_tr_b16 v[60:61], v5 offset:12288
ds_read_b64_tr_b16 v[62:63], v3 offset:12800
v_mfma_f32_16x16x32_bf16 v[196:199], v[32:35], a[100:103], v[196:199]
s_add_u32 s51, s51, 1
v_exp_f32 v27, v27
v_mfma_f32_16x16x32_bf16 v[196:199], v[36:39], a[116:119], v[196:199]
s_and_b32 s51, s51, 7
v_exp_f32 v28, v28
v_exp_f32 v29, v29
v_mfma_f32_16x16x32_bf16 v[200:203], v[32:35], a[104:107], v[200:203]
s_mul_i32 s52, s51, 524288
v_add_f32 v26, 1.0, v26
v_add_f32 v27, 1.0, v27
v_mfma_f32_16x16x32_bf16 v[200:203], v[36:39], a[120:123], v[200:203]
s_add_u32 s52, s52, s56
v_add_f32 v28, 1.0, v28
v_add_f32 v29, 1.0, v29
v_mfma_f32_16x16x32_bf16 v[204:207], v[32:35], a[108:111], v[204:207]
s_add_u32 m0, s50, 8192
v_rcp_f32 v26, v26
v_mfma_f32_16x16x32_bf16 v[204:207], v[36:39], a[124:127], v[204:207]
s_waitcnt vmcnt(8) lgkmcnt(0)
v_rcp_f32 v27, v27
v_rcp_f32 v28, v28
v_mfma_f32_16x16x32_bf16 v[208:211], v[40:43], a[96:99], v[208:211]
ds_read_b64_tr_b16 v[32:33], v2 offset:16384
ds_read_b64_tr_b16 v[34:35], v4 offset:16896
v_mfma_f32_16x16x32_bf16 v[208:211], v[44:47], a[112:115], v[208:211]
buffer_load_dwordx4 v14, s[24:27], s52 offen lds
v_mfma_f32_16x16x32_bf16 v[212:215], v[40:43], a[100:103], v[212:215]
ds_read_b64_tr_b16 v[36:37], v2 offset:20480
ds_read_b64_tr_b16 v[38:39], v4 offset:20992
v_mfma_f32_16x16x32_bf16 v[212:215], v[44:47], a[116:119], v[212:215]
buffer_load_dwordx4 v15, s[24:27], s52 offen offset:1024 lds
v_mfma_f32_16x16x32_bf16 v[216:219], v[40:43], a[104:107], v[216:219]
v_rcp_f32 v29, v29
v_mul_f32 v116, v116, v26
v_mfma_f32_16x16x32_bf16 v[216:219], v[44:47], a[120:123], v[216:219]
buffer_load_dwordx4 v16, s[24:27], s52 offen offset:2048 lds
v_mfma_f32_16x16x32_bf16 v[220:223], v[40:43], a[108:111], v[220:223]
v_mul_f32 v117, v117, v27
v_mul_f32 v118, v118, v28
v_mul_f32 v119, v119, v29
v_mfma_f32_16x16x32_bf16 v[220:223], v[44:47], a[124:127], v[220:223]
v_mul_f32 v26, v120, v120
v_mul_f32 v27, v121, v121
v_mfma_f32_16x16x32_bf16 v[224:227], v[48:51], a[96:99], v[224:227]
s_add_u32 s53, s52, 262144
ds_read_b64_tr_b16 v[40:41], v3 offset:16384
ds_read_b64_tr_b16 v[42:43], v5 offset:16896
v_mul_f32 v28, v122, v122
v_mfma_f32_16x16x32_bf16 v[224:227], v[52:55], a[112:115], v[224:227]
buffer_load_dwordx4 v17, s[24:27], s52 offen offset:3072 lds
v_mfma_f32_16x16x32_bf16 v[228:231], v[48:51], a[100:103], v[228:231]
s_add_u32 m0, s50, 12288
ds_read_b64_tr_b16 v[44:45], v3 offset:20480
ds_read_b64_tr_b16 v[46:47], v5 offset:20992
v_mfma_f32_16x16x32_bf16 v[228:231], v[52:55], a[116:119], v[228:231]
buffer_load_dwordx4 v14, s[24:27], s53 offen lds
v_mfma_f32_16x16x32_bf16 v[232:235], v[48:51], a[104:107], v[232:235]
v_mul_f32 v29, v123, v123
v_fmaak_f32 v26, v30, v26, 0xc0135761
v_fmaak_f32 v27, v30, v27, 0xc0135761
v_mfma_f32_16x16x32_bf16 v[232:235], v[52:55], a[120:123], v[232:235]
buffer_load_dwordx4 v15, s[24:27], s53 offen offset:1024 lds
v_mfma_f32_16x16x32_bf16 v[236:239], v[48:51], a[108:111], v[236:239]
v_fmaak_f32 v28, v30, v28, 0xc0135761
v_fmaak_f32 v29, v30, v29, 0xc0135761
v_mfma_f32_16x16x32_bf16 v[236:239], v[52:55], a[124:127], v[236:239]
v_mul_f32 v26, v26, v120
v_mul_f32 v27, v27, v121
v_mul_f32 v28, v28, v122
v_mfma_f32_16x16x32_bf16 v[240:243], v[56:59], a[96:99], v[240:243]
ds_read_b64_tr_b16 v[48:49], v4 offset:16384
ds_read_b64_tr_b16 v[50:51], v2 offset:16896
v_mfma_f32_16x16x32_bf16 v[240:243], v[60:63], a[112:115], v[240:243]
buffer_load_dwordx4 v16, s[24:27], s53 offen offset:2048 lds
v_mfma_f32_16x16x32_bf16 v[244:247], v[56:59], a[100:103], v[244:247]
ds_read_b64_tr_b16 v[52:53], v4 offset:20480
ds_read_b64_tr_b16 v[54:55], v2 offset:20992
v_mul_f32 v29, v29, v123
v_mfma_f32_16x16x32_bf16 v[244:247], v[60:63], a[116:119], v[244:247]
buffer_load_dwordx4 v17, s[24:27], s53 offen offset:3072 lds
v_mfma_f32_16x16x32_bf16 v[248:251], v[56:59], a[104:107], v[248:251]
v_exp_f32 v26, v26
v_mfma_f32_16x16x32_bf16 v[248:251], v[60:63], a[120:123], v[248:251]
v_exp_f32 v27, v27
v_mfma_f32_16x16x32_bf16 v[252:255], v[56:59], a[108:111], v[252:255]
v_exp_f32 v28, v28
v_mfma_f32_16x16x32_bf16 v[252:255], v[60:63], a[124:127], v[252:255]
s_waitcnt lgkmcnt(8)
v_exp_f32 v29, v29
v_add_f32 v26, 1.0, v26
v_add_f32 v27, 1.0, v27
v_mfma_f32_16x16x32_bf16 v[192:195], v[32:35], a[128:131], v[192:195]
ds_read_b64_tr_b16 v[56:57], v5 offset:16384
ds_read_b64_tr_b16 v[58:59], v3 offset:16896
v_mfma_f32_16x16x32_bf16 v[192:195], v[36:39], a[144:147], v[192:195]
ds_read_b64_tr_b16 v[60:61], v5 offset:20480
ds_read_b64_tr_b16 v[62:63], v3 offset:20992
v_add_f32 v28, 1.0, v28
v_mfma_f32_16x16x32_bf16 v[196:199], v[32:35], a[132:135], v[196:199]
s_add_u32 s51, s51, 1
v_add_f32 v29, 1.0, v29
v_rcp_f32 v26, v26
v_mfma_f32_16x16x32_bf16 v[196:199], v[36:39], a[148:151], v[196:199]
s_and_b32 s51, s51, 7
v_rcp_f32 v27, v27
v_mfma_f32_16x16x32_bf16 v[200:203], v[32:35], a[136:139], v[200:203]
s_mul_i32 s52, s51, 524288
v_rcp_f32 v28, v28
v_mfma_f32_16x16x32_bf16 v[200:203], v[36:39], a[152:155], v[200:203]
s_add_u32 s52, s52, s56
v_rcp_f32 v29, v29
v_mul_f32 v120, v120, v26
v_mfma_f32_16x16x32_bf16 v[204:207], v[32:35], a[140:143], v[204:207]
s_add_u32 m0, s50, 16384
v_mul_f32 v121, v121, v27
v_mul_f32 v122, v122, v28
v_mfma_f32_16x16x32_bf16 v[204:207], v[36:39], a[156:159], v[204:207]
s_waitcnt vmcnt(8) lgkmcnt(0)
v_mul_f32 v123, v123, v29
v_mul_f32 v26, v124, v124
v_mul_f32 v27, v125, v125
v_mfma_f32_16x16x32_bf16 v[208:211], v[40:43], a[128:131], v[208:211]
ds_read_b64_tr_b16 v[32:33], v2 offset:0
ds_read_b64_tr_b16 v[34:35], v4 offset:512
v_mfma_f32_16x16x32_bf16 v[208:211], v[44:47], a[144:147], v[208:211]
buffer_load_dwordx4 v14, s[24:27], s52 offen lds
v_mfma_f32_16x16x32_bf16 v[212:215], v[40:43], a[132:135], v[212:215]
ds_read_b64_tr_b16 v[36:37], v2 offset:4096
ds_read_b64_tr_b16 v[38:39], v4 offset:4608
v_mul_f32 v28, v126, v126
v_mfma_f32_16x16x32_bf16 v[212:215], v[44:47], a[148:151], v[212:215]
buffer_load_dwordx4 v15, s[24:27], s52 offen offset:1024 lds
v_mfma_f32_16x16x32_bf16 v[216:219], v[40:43], a[136:139], v[216:219]
v_mul_f32 v29, v127, v127
v_fmaak_f32 v26, v30, v26, 0xc0135761
v_mfma_f32_16x16x32_bf16 v[216:219], v[44:47], a[152:155], v[216:219]
buffer_load_dwordx4 v16, s[24:27], s52 offen offset:2048 lds
v_mfma_f32_16x16x32_bf16 v[220:223], v[40:43], a[140:143], v[220:223]
v_fmaak_f32 v27, v30, v27, 0xc0135761
v_fmaak_f32 v28, v30, v28, 0xc0135761
v_fmaak_f32 v29, v30, v29, 0xc0135761
v_mfma_f32_16x16x32_bf16 v[220:223], v[44:47], a[156:159], v[220:223]
v_mul_f32 v26, v26, v124
v_mul_f32 v27, v27, v125
v_mfma_f32_16x16x32_bf16 v[224:227], v[48:51], a[128:131], v[224:227]
s_add_u32 s53, s52, 262144
ds_read_b64_tr_b16 v[40:41], v3 offset:0
ds_read_b64_tr_b16 v[42:43], v5 offset:512
v_mul_f32 v28, v28, v126
v_mfma_f32_16x16x32_bf16 v[224:227], v[52:55], a[144:147], v[224:227]
buffer_load_dwordx4 v17, s[24:27], s52 offen offset:3072 lds
v_mfma_f32_16x16x32_bf16 v[228:231], v[48:51], a[132:135], v[228:231]
s_add_u32 m0, s50, 20480
ds_read_b64_tr_b16 v[44:45], v3 offset:4096
ds_read_b64_tr_b16 v[46:47], v5 offset:4608
v_mfma_f32_16x16x32_bf16 v[228:231], v[52:55], a[148:151], v[228:231]
buffer_load_dwordx4 v14, s[24:27], s53 offen lds
v_mfma_f32_16x16x32_bf16 v[232:235], v[48:51], a[136:139], v[232:235]
v_mul_f32 v29, v29, v127
v_exp_f32 v26, v26
v_mfma_f32_16x16x32_bf16 v[232:235], v[52:55], a[152:155], v[232:235]
buffer_load_dwordx4 v15, s[24:27], s53 offen offset:1024 lds
v_mfma_f32_16x16x32_bf16 v[236:239], v[48:51], a[140:143], v[236:239]
v_exp_f32 v27, v27
v_mfma_f32_16x16x32_bf16 v[236:239], v[52:55], a[156:159], v[236:239]
v_exp_f32 v28, v28
v_mfma_f32_16x16x32_bf16 v[240:243], v[56:59], a[128:131], v[240:243]
ds_read_b64_tr_b16 v[48:49], v4 offset:0
ds_read_b64_tr_b16 v[50:51], v2 offset:512
v_mfma_f32_16x16x32_bf16 v[240:243], v[60:63], a[144:147], v[240:243]
buffer_load_dwordx4 v16, s[24:27], s53 offen offset:2048 lds
v_mfma_f32_16x16x32_bf16 v[244:247], v[56:59], a[132:135], v[244:247]
ds_read_b64_tr_b16 v[52:53], v4 offset:4096
ds_read_b64_tr_b16 v[54:55], v2 offset:4608
v_exp_f32 v29, v29
v_mfma_f32_16x16x32_bf16 v[244:247], v[60:63], a[148:151], v[244:247]
buffer_load_dwordx4 v17, s[24:27], s53 offen offset:3072 lds
v_mfma_f32_16x16x32_bf16 v[248:251], v[56:59], a[136:139], v[248:251]
v_add_f32 v26, 1.0, v26
v_add_f32 v27, 1.0, v27
v_mfma_f32_16x16x32_bf16 v[248:251], v[60:63], a[152:155], v[248:251]
v_add_f32 v28, 1.0, v28
v_add_f32 v29, 1.0, v29
v_mfma_f32_16x16x32_bf16 v[252:255], v[56:59], a[140:143], v[252:255]
v_rcp_f32 v26, v26
v_mfma_f32_16x16x32_bf16 v[252:255], v[60:63], a[156:159], v[252:255]
s_waitcnt lgkmcnt(8)
v_rcp_f32 v27, v27
v_rcp_f32 v28, v28
v_mfma_f32_16x16x32_bf16 v[192:195], v[32:35], a[160:163], v[192:195]
ds_read_b64_tr_b16 v[56:57], v5 offset:0
ds_read_b64_tr_b16 v[58:59], v3 offset:512
v_mfma_f32_16x16x32_bf16 v[192:195], v[36:39], a[176:179], v[192:195]
s_add_u32 s51, s51, 1
ds_read_b64_tr_b16 v[60:61], v5 offset:4096
ds_read_b64_tr_b16 v[62:63], v3 offset:4608
v_mfma_f32_16x16x32_bf16 v[196:199], v[32:35], a[164:167], v[196:199]
s_and_b32 s51, s51, 7
v_rcp_f32 v29, v29
v_mul_f32 v124, v124, v26
v_mfma_f32_16x16x32_bf16 v[196:199], v[36:39], a[180:183], v[196:199]
s_mul_i32 s52, s51, 524288
v_mul_f32 v125, v125, v27
v_mul_f32 v126, v126, v28
v_mul_f32 v127, v127, v29
v_mfma_f32_16x16x32_bf16 v[200:203], v[32:35], a[168:171], v[200:203]
s_add_u32 s52, s52, s56
v_mul_f32 v128, v64, v128
v_mul_f32 v129, v65, v129
v_mfma_f32_16x16x32_bf16 v[200:203], v[36:39], a[184:187], v[200:203]
s_add_u32 s52, s52, 128
v_mul_f32 v130, v66, v130
v_mul_f32 v131, v67, v131
v_mul_f32 v132, v68, v132
v_mfma_f32_16x16x32_bf16 v[204:207], v[32:35], a[172:175], v[204:207]
s_add_u32 m0, s50, 0
v_mul_f32 v133, v69, v133
v_mul_f32 v134, v70, v134
v_mfma_f32_16x16x32_bf16 v[204:207], v[36:39], a[188:191], v[204:207]
s_waitcnt vmcnt(8) lgkmcnt(0)
v_mul_f32 v135, v71, v135
v_mul_f32 v136, v72, v136
v_mul_f32 v137, v73, v137
v_mfma_f32_16x16x32_bf16 v[208:211], v[40:43], a[160:163], v[208:211]
ds_read_b64_tr_b16 v[32:33], v2 offset:8192
ds_read_b64_tr_b16 v[34:35], v4 offset:8704
v_mfma_f32_16x16x32_bf16 v[208:211], v[44:47], a[176:179], v[208:211]
buffer_load_dwordx4 v14, s[24:27], s52 offen lds
v_mfma_f32_16x16x32_bf16 v[212:215], v[40:43], a[164:167], v[212:215]
ds_read_b64_tr_b16 v[36:37], v2 offset:12288
ds_read_b64_tr_b16 v[38:39], v4 offset:12800
v_mul_f32 v138, v74, v138
v_mfma_f32_16x16x32_bf16 v[212:215], v[44:47], a[180:183], v[212:215]
buffer_load_dwordx4 v15, s[24:27], s52 offen offset:1024 lds
v_mfma_f32_16x16x32_bf16 v[216:219], v[40:43], a[168:171], v[216:219]
v_mul_f32 v139, v75, v139
v_mul_f32 v140, v76, v140
v_mfma_f32_16x16x32_bf16 v[216:219], v[44:47], a[184:187], v[216:219]
buffer_load_dwordx4 v16, s[24:27], s52 offen offset:2048 lds
v_mfma_f32_16x16x32_bf16 v[220:223], v[40:43], a[172:175], v[220:223]
v_mul_f32 v141, v77, v141
v_mul_f32 v142, v78, v142
v_mul_f32 v143, v79, v143
v_mfma_f32_16x16x32_bf16 v[220:223], v[44:47], a[188:191], v[220:223]
v_mul_f32 v144, v80, v144
v_mul_f32 v145, v81, v145
v_mfma_f32_16x16x32_bf16 v[224:227], v[48:51], a[160:163], v[224:227]
s_add_u32 s53, s52, 262144
ds_read_b64_tr_b16 v[40:41], v3 offset:8192
ds_read_b64_tr_b16 v[42:43], v5 offset:8704
v_mul_f32 v146, v82, v146
v_mfma_f32_16x16x32_bf16 v[224:227], v[52:55], a[176:179], v[224:227]
buffer_load_dwordx4 v17, s[24:27], s52 offen offset:3072 lds
v_mfma_f32_16x16x32_bf16 v[228:231], v[48:51], a[164:167], v[228:231]
s_add_u32 m0, s50, 4096
ds_read_b64_tr_b16 v[44:45], v3 offset:12288
ds_read_b64_tr_b16 v[46:47], v5 offset:12800
v_mfma_f32_16x16x32_bf16 v[228:231], v[52:55], a[180:183], v[228:231]
buffer_load_dwordx4 v14, s[24:27], s53 offen lds
v_mfma_f32_16x16x32_bf16 v[232:235], v[48:51], a[168:171], v[232:235]
v_mul_f32 v147, v83, v147
v_mul_f32 v148, v84, v148
v_mul_f32 v149, v85, v149
v_mfma_f32_16x16x32_bf16 v[232:235], v[52:55], a[184:187], v[232:235]
buffer_load_dwordx4 v15, s[24:27], s53 offen offset:1024 lds
v_mfma_f32_16x16x32_bf16 v[236:239], v[48:51], a[172:175], v[236:239]
v_mul_f32 v150, v86, v150
v_mul_f32 v151, v87, v151
v_mfma_f32_16x16x32_bf16 v[236:239], v[52:55], a[188:191], v[236:239]
v_mul_f32 v152, v88, v152
v_mul_f32 v153, v89, v153
v_mul_f32 v154, v90, v154
v_mfma_f32_16x16x32_bf16 v[240:243], v[56:59], a[160:163], v[240:243]
ds_read_b64_tr_b16 v[48:49], v4 offset:8192
ds_read_b64_tr_b16 v[50:51], v2 offset:8704
v_mfma_f32_16x16x32_bf16 v[240:243], v[60:63], a[176:179], v[240:243]
buffer_load_dwordx4 v16, s[24:27], s53 offen offset:2048 lds
v_mfma_f32_16x16x32_bf16 v[244:247], v[56:59], a[164:167], v[244:247]
ds_read_b64_tr_b16 v[52:53], v4 offset:12288
ds_read_b64_tr_b16 v[54:55], v2 offset:12800
v_mul_f32 v155, v91, v155
v_mfma_f32_16x16x32_bf16 v[244:247], v[60:63], a[180:183], v[244:247]
buffer_load_dwordx4 v17, s[24:27], s53 offen offset:3072 lds
v_mfma_f32_16x16x32_bf16 v[248:251], v[56:59], a[168:171], v[248:251]
v_mul_f32 v156, v92, v156
v_mul_f32 v157, v93, v157
v_mfma_f32_16x16x32_bf16 v[248:251], v[60:63], a[184:187], v[248:251]
v_mul_f32 v158, v94, v158
v_mul_f32 v159, v95, v159
v_mul_f32 v160, v96, v160
v_mfma_f32_16x16x32_bf16 v[252:255], v[56:59], a[172:175], v[252:255]
v_mul_f32 v161, v97, v161
v_mul_f32 v162, v98, v162
v_mfma_f32_16x16x32_bf16 v[252:255], v[60:63], a[188:191], v[252:255]
s_waitcnt lgkmcnt(8)
v_mul_f32 v163, v99, v163
v_mul_f32 v164, v100, v164
v_mul_f32 v165, v101, v165
v_mfma_f32_16x16x32_bf16 v[192:195], v[32:35], a[192:195], v[192:195]
ds_read_b64_tr_b16 v[56:57], v5 offset:8192
ds_read_b64_tr_b16 v[58:59], v3 offset:8704
v_mfma_f32_16x16x32_bf16 v[192:195], v[36:39], a[208:211], v[192:195]
s_add_u32 s51, s51, 1
ds_read_b64_tr_b16 v[60:61], v5 offset:12288
ds_read_b64_tr_b16 v[62:63], v3 offset:12800
v_mul_f32 v166, v102, v166
v_mfma_f32_16x16x32_bf16 v[196:199], v[32:35], a[196:199], v[196:199]
s_and_b32 s51, s51, 7
v_mul_f32 v167, v103, v167
v_mul_f32 v168, v104, v168
v_mfma_f32_16x16x32_bf16 v[196:199], v[36:39], a[212:215], v[196:199]
s_mul_i32 s52, s51, 524288
v_mul_f32 v169, v105, v169
v_mul_f32 v170, v106, v170
v_mul_f32 v171, v107, v171
v_mfma_f32_16x16x32_bf16 v[200:203], v[32:35], a[200:203], v[200:203]
s_add_u32 s52, s52, s56
v_mul_f32 v172, v108, v172
v_mul_f32 v173, v109, v173
v_mfma_f32_16x16x32_bf16 v[200:203], v[36:39], a[216:219], v[200:203]
s_add_u32 s52, s52, 128
v_mul_f32 v174, v110, v174
v_mul_f32 v175, v111, v175
v_mul_f32 v176, v112, v176
v_mfma_f32_16x16x32_bf16 v[204:207], v[32:35], a[204:207], v[204:207]
s_add_u32 m0, s50, 8192
v_mul_f32 v177, v113, v177
v_mul_f32 v178, v114, v178
v_mfma_f32_16x16x32_bf16 v[204:207], v[36:39], a[220:223], v[204:207]
s_waitcnt vmcnt(8) lgkmcnt(0)
v_mul_f32 v179, v115, v179
v_mul_f32 v180, v116, v180
v_mul_f32 v181, v117, v181
v_mfma_f32_16x16x32_bf16 v[208:211], v[40:43], a[192:195], v[208:211]
ds_read_b64_tr_b16 v[32:33], v2 offset:16384
ds_read_b64_tr_b16 v[34:35], v4 offset:16896
v_mfma_f32_16x16x32_bf16 v[208:211], v[44:47], a[208:211], v[208:211]
buffer_load_dwordx4 v14, s[24:27], s52 offen lds
v_mfma_f32_16x16x32_bf16 v[212:215], v[40:43], a[196:199], v[212:215]
ds_read_b64_tr_b16 v[36:37], v2 offset:20480
ds_read_b64_tr_b16 v[38:39], v4 offset:20992
v_mul_f32 v182, v118, v182
v_mfma_f32_16x16x32_bf16 v[212:215], v[44:47], a[212:215], v[212:215]
buffer_load_dwordx4 v15, s[24:27], s52 offen offset:1024 lds
v_mfma_f32_16x16x32_bf16 v[216:219], v[40:43], a[200:203], v[216:219]
v_mul_f32 v183, v119, v183
v_mul_f32 v184, v120, v184
v_mfma_f32_16x16x32_bf16 v[216:219], v[44:47], a[216:219], v[216:219]
buffer_load_dwordx4 v16, s[24:27], s52 offen offset:2048 lds
v_mfma_f32_16x16x32_bf16 v[220:223], v[40:43], a[204:207], v[220:223]
v_mul_f32 v185, v121, v185
v_mul_f32 v186, v122, v186
v_mul_f32 v187, v123, v187
v_mfma_f32_16x16x32_bf16 v[220:223], v[44:47], a[220:223], v[220:223]
v_mul_f32 v188, v124, v188
v_mul_f32 v189, v125, v189
v_mfma_f32_16x16x32_bf16 v[224:227], v[48:51], a[192:195], v[224:227]
s_add_u32 s53, s52, 262144
ds_read_b64_tr_b16 v[40:41], v3 offset:16384
ds_read_b64_tr_b16 v[42:43], v5 offset:16896
v_mul_f32 v190, v126, v190
v_mfma_f32_16x16x32_bf16 v[224:227], v[52:55], a[208:211], v[224:227]
buffer_load_dwordx4 v17, s[24:27], s52 offen offset:3072 lds
v_mfma_f32_16x16x32_bf16 v[228:231], v[48:51], a[196:199], v[228:231]
s_add_u32 m0, s50, 12288
ds_read_b64_tr_b16 v[44:45], v3 offset:20480
ds_read_b64_tr_b16 v[46:47], v5 offset:20992
v_mfma_f32_16x16x32_bf16 v[228:231], v[52:55], a[212:215], v[228:231]
buffer_load_dwordx4 v14, s[24:27], s53 offen lds
v_mfma_f32_16x16x32_bf16 v[232:235], v[48:51], a[200:203], v[232:235]
v_mul_f32 v191, v127, v191
v_cvt_pk_bf16_f32 v128, v128, v129
v_cvt_pk_bf16_f32 v129, v130, v131
v_mfma_f32_16x16x32_bf16 v[232:235], v[52:55], a[216:219], v[232:235]
buffer_load_dwordx4 v15, s[24:27], s53 offen offset:1024 lds
v_mfma_f32_16x16x32_bf16 v[236:239], v[48:51], a[204:207], v[236:239]
v_cvt_pk_bf16_f32 v130, v144, v145
v_cvt_pk_bf16_f32 v131, v146, v147
v_mfma_f32_16x16x32_bf16 v[236:239], v[52:55], a[220:223], v[236:239]
v_cvt_pk_bf16_f32 v132, v132, v133
v_cvt_pk_bf16_f32 v133, v134, v135
v_cvt_pk_bf16_f32 v134, v148, v149
v_mfma_f32_16x16x32_bf16 v[240:243], v[56:59], a[192:195], v[240:243]
ds_read_b64_tr_b16 v[48:49], v4 offset:16384
ds_read_b64_tr_b16 v[50:51], v2 offset:16896
v_mfma_f32_16x16x32_bf16 v[240:243], v[60:63], a[208:211], v[240:243]
buffer_load_dwordx4 v16, s[24:27], s53 offen offset:2048 lds
v_mfma_f32_16x16x32_bf16 v[244:247], v[56:59], a[196:199], v[244:247]
ds_read_b64_tr_b16 v[52:53], v4 offset:20480
ds_read_b64_tr_b16 v[54:55], v2 offset:20992
v_cvt_pk_bf16_f32 v135, v150, v151
v_mfma_f32_16x16x32_bf16 v[244:247], v[60:63], a[212:215], v[244:247]
buffer_load_dwordx4 v17, s[24:27], s53 offen offset:3072 lds
v_mfma_f32_16x16x32_bf16 v[248:251], v[56:59], a[200:203], v[248:251]
v_cvt_pk_bf16_f32 v136, v136, v137
v_cvt_pk_bf16_f32 v137, v138, v139
v_mfma_f32_16x16x32_bf16 v[248:251], v[60:63], a[216:219], v[248:251]
v_cvt_pk_bf16_f32 v138, v152, v153
v_cvt_pk_bf16_f32 v139, v154, v155
v_cvt_pk_bf16_f32 v140, v140, v141
v_mfma_f32_16x16x32_bf16 v[252:255], v[56:59], a[204:207], v[252:255]
v_cvt_pk_bf16_f32 v141, v142, v143
v_cvt_pk_bf16_f32 v142, v156, v157
v_mfma_f32_16x16x32_bf16 v[252:255], v[60:63], a[220:223], v[252:255]
s_waitcnt lgkmcnt(8)
v_cvt_pk_bf16_f32 v143, v158, v159
v_cvt_pk_bf16_f32 v160, v160, v161
v_cvt_pk_bf16_f32 v161, v162, v163
v_mfma_f32_16x16x32_bf16 v[192:195], v[32:35], a[224:227], v[192:195]
ds_read_b64_tr_b16 v[56:57], v5 offset:16384
ds_read_b64_tr_b16 v[58:59], v3 offset:16896
v_mfma_f32_16x16x32_bf16 v[192:195], v[36:39], a[240:243], v[192:195]
s_add_u32 s51, s51, 1
ds_read_b64_tr_b16 v[60:61], v5 offset:20480
ds_read_b64_tr_b16 v[62:63], v3 offset:20992
v_mfma_f32_16x16x32_bf16 v[196:199], v[32:35], a[228:231], v[196:199]
s_and_b32 s51, s51, 7
v_cvt_pk_bf16_f32 v162, v176, v177
v_cvt_pk_bf16_f32 v163, v178, v179
v_mfma_f32_16x16x32_bf16 v[196:199], v[36:39], a[244:247], v[196:199]
s_mul_i32 s52, s51, 524288
v_cvt_pk_bf16_f32 v164, v164, v165
v_cvt_pk_bf16_f32 v165, v166, v167
v_mfma_f32_16x16x32_bf16 v[200:203], v[32:35], a[232:235], v[200:203]
s_add_u32 s52, s52, s56
v_cvt_pk_bf16_f32 v166, v180, v181
v_cvt_pk_bf16_f32 v167, v182, v183
v_mfma_f32_16x16x32_bf16 v[200:203], v[36:39], a[248:251], v[200:203]
s_add_u32 s52, s52, 128
v_cvt_pk_bf16_f32 v168, v168, v169
v_cvt_pk_bf16_f32 v169, v170, v171
v_mfma_f32_16x16x32_bf16 v[204:207], v[32:35], a[236:239], v[204:207]
s_add_u32 m0, s50, 16384
v_cvt_pk_bf16_f32 v170, v184, v185
v_cvt_pk_bf16_f32 v171, v186, v187
v_mfma_f32_16x16x32_bf16 v[204:207], v[36:39], a[252:255], v[204:207]
s_waitcnt vmcnt(8) lgkmcnt(0)
v_cvt_pk_bf16_f32 v172, v172, v173
v_cvt_pk_bf16_f32 v173, v174, v175
v_mfma_f32_16x16x32_bf16 v[208:211], v[40:43], a[224:227], v[208:211]
ds_read_b64_tr_b16 v[32:33], v2 offset:0
ds_read_b64_tr_b16 v[34:35], v4 offset:512
v_mfma_f32_16x16x32_bf16 v[208:211], v[44:47], a[240:243], v[208:211]
buffer_load_dwordx4 v14, s[24:27], s52 offen lds
v_mfma_f32_16x16x32_bf16 v[212:215], v[40:43], a[228:231], v[212:215]
ds_read_b64_tr_b16 v[36:37], v2 offset:4096
ds_read_b64_tr_b16 v[38:39], v4 offset:4608
v_mfma_f32_16x16x32_bf16 v[212:215], v[44:47], a[244:247], v[212:215]
buffer_load_dwordx4 v15, s[24:27], s52 offen offset:1024 lds
v_mfma_f32_16x16x32_bf16 v[216:219], v[40:43], a[232:235], v[216:219]
v_cvt_pk_bf16_f32 v174, v188, v189
v_cvt_pk_bf16_f32 v175, v190, v191
v_mfma_f32_16x16x32_bf16 v[216:219], v[44:47], a[248:251], v[216:219]
buffer_load_dwordx4 v16, s[24:27], s52 offen offset:2048 lds
v_mfma_f32_16x16x32_bf16 v[220:223], v[40:43], a[236:239], v[220:223]
v_mfma_f32_16x16x32_bf16 v[220:223], v[44:47], a[252:255], v[220:223]
v_mfma_f32_16x16x32_bf16 v[224:227], v[48:51], a[224:227], v[224:227]
s_add_u32 s53, s52, 262144
ds_read_b64_tr_b16 v[40:41], v3 offset:0
ds_read_b64_tr_b16 v[42:43], v5 offset:512
v_mfma_f32_16x16x32_bf16 v[224:227], v[52:55], a[240:243], v[224:227]
buffer_load_dwordx4 v17, s[24:27], s52 offen offset:3072 lds
v_mfma_f32_16x16x32_bf16 v[228:231], v[48:51], a[228:231], v[228:231]
s_add_u32 m0, s50, 20480
ds_read_b64_tr_b16 v[44:45], v3 offset:4096
ds_read_b64_tr_b16 v[46:47], v5 offset:4608
v_mfma_f32_16x16x32_bf16 v[228:231], v[52:55], a[244:247], v[228:231]
buffer_load_dwordx4 v14, s[24:27], s53 offen lds
v_mfma_f32_16x16x32_bf16 v[232:235], v[48:51], a[232:235], v[232:235]
v_mfma_f32_16x16x32_bf16 v[232:235], v[52:55], a[248:251], v[232:235]
buffer_load_dwordx4 v15, s[24:27], s53 offen offset:1024 lds
v_mfma_f32_16x16x32_bf16 v[236:239], v[48:51], a[236:239], v[236:239]
v_mfma_f32_16x16x32_bf16 v[236:239], v[52:55], a[252:255], v[236:239]
v_mfma_f32_16x16x32_bf16 v[240:243], v[56:59], a[224:227], v[240:243]
ds_read_b64_tr_b16 v[48:49], v4 offset:0
ds_read_b64_tr_b16 v[50:51], v2 offset:512
v_mfma_f32_16x16x32_bf16 v[240:243], v[60:63], a[240:243], v[240:243]
buffer_load_dwordx4 v16, s[24:27], s53 offen offset:2048 lds
v_mfma_f32_16x16x32_bf16 v[244:247], v[56:59], a[228:231], v[244:247]
ds_read_b64_tr_b16 v[52:53], v4 offset:4096
ds_read_b64_tr_b16 v[54:55], v2 offset:4608
v_mfma_f32_16x16x32_bf16 v[244:247], v[60:63], a[244:247], v[244:247]
buffer_load_dwordx4 v17, s[24:27], s53 offen offset:3072 lds
v_mfma_f32_16x16x32_bf16 v[248:251], v[56:59], a[232:235], v[248:251]
v_mfma_f32_16x16x32_bf16 v[248:251], v[60:63], a[248:251], v[248:251]
v_mfma_f32_16x16x32_bf16 v[252:255], v[56:59], a[236:239], v[252:255]
v_mfma_f32_16x16x32_bf16 v[252:255], v[60:63], a[252:255], v[252:255]
s_waitcnt lgkmcnt(8)
v_mfma_f32_16x16x32_bf16 v[64:67], v[32:35], a[0:3], 0
ds_read_b64_tr_b16 v[56:57], v5 offset:0
ds_read_b64_tr_b16 v[58:59], v3 offset:512
v_mfma_f32_16x16x32_bf16 v[64:67], v[36:39], a[16:19], v[64:67]
s_add_u32 s51, s51, 1
ds_read_b64_tr_b16 v[60:61], v5 offset:4096
ds_read_b64_tr_b16 v[62:63], v3 offset:4608
v_bfe_u32 v26, v1, 4, 4
v_mfma_f32_16x16x32_bf16 v[68:71], v[32:35], a[4:7], 0
s_and_b32 s51, s51, 7
v_lshrrev_b32 v27, 8, v1
v_lshrrev_b32 v28, 3, v26
v_lshlrev_b32 v28, 12, v28
v_mfma_f32_16x16x32_bf16 v[68:71], v[36:39], a[20:23], v[68:71]
s_mul_i32 s52, s51, 524288
ds_write_b128 v31, v[128:131] offset:0
ds_write_b128 v31, v[132:135] offset:1024
ds_write_b128 v31, v[136:139] offset:2048
ds_write_b128 v31, v[140:143] offset:3072
ds_write_b128 v31, v[160:163] offset:4096
ds_write_b128 v31, v[164:167] offset:5120
ds_write_b128 v31, v[168:171] offset:6144
ds_write_b128 v31, v[172:175] offset:7168
v_mfma_f32_16x16x32_bf16 v[72:75], v[32:35], a[8:11], 0
s_add_u32 s52, s52, s56
v_and_b32 v29, 7, v26
v_lshlrev_b32 v29, 8, v29
v_add_u32 v28, v28, v29
v_mfma_f32_16x16x32_bf16 v[72:75], v[36:39], a[24:27], v[72:75]
s_add_u32 s52, s52, 128
v_add_u32 v28, 98304, v28
v_add_u32 v29, 0, v27
v_xor_b32 v29, v29, v26
v_mfma_f32_16x16x32_bf16 v[76:79], v[32:35], a[12:15], 0
s_add_u32 m0, s50, 0
v_lshl_add_u32 v10, v29, 4, v28
v_add_u32 v29, 4, v27
v_xor_b32 v29, v29, v26
v_mfma_f32_16x16x32_bf16 v[76:79], v[36:39], a[28:31], v[76:79]
s_waitcnt vmcnt(8) lgkmcnt(8)
v_lshl_add_u32 v11, v29, 4, v28
v_add_u32 v29, 8, v27
v_xor_b32 v29, v29, v26
v_mfma_f32_16x16x32_bf16 v[80:83], v[40:43], a[0:3], 0
ds_read_b64_tr_b16 v[32:33], v2 offset:8192
ds_read_b64_tr_b16 v[34:35], v4 offset:8704
v_mfma_f32_16x16x32_bf16 v[80:83], v[44:47], a[16:19], v[80:83]
buffer_load_dwordx4 v14, s[24:27], s52 offen lds
v_mfma_f32_16x16x32_bf16 v[84:87], v[40:43], a[4:7], 0
ds_read_b64_tr_b16 v[36:37], v2 offset:12288
ds_read_b64_tr_b16 v[38:39], v4 offset:12800
v_lshl_add_u32 v12, v29, 4, v28
v_mfma_f32_16x16x32_bf16 v[84:87], v[44:47], a[20:23], v[84:87]
buffer_load_dwordx4 v15, s[24:27], s52 offen offset:1024 lds
v_mfma_f32_16x16x32_bf16 v[88:91], v[40:43], a[8:11], 0
v_add_u32 v29, 12, v27
v_xor_b32 v29, v29, v26
v_lshl_add_u32 v13, v29, 4, v28
v_mfma_f32_16x16x32_bf16 v[88:91], v[44:47], a[24:27], v[88:91]
buffer_load_dwordx4 v16, s[24:27], s52 offen offset:2048 lds
v_mfma_f32_16x16x32_bf16 v[92:95], v[40:43], a[12:15], 0
v_mul_f32 v192, 0x3e0293ee, v192
v_mul_f32 v193, 0x3e0293ee, v193
v_mul_f32 v194, 0x3e0293ee, v194
v_mfma_f32_16x16x32_bf16 v[92:95], v[44:47], a[28:31], v[92:95]
v_mul_f32 v195, 0x3e0293ee, v195
v_mul_f32 v208, 0x3e0293ee, v208
v_mfma_f32_16x16x32_bf16 v[96:99], v[48:51], a[0:3], 0
s_add_u32 s53, s52, 262144
ds_read_b64_tr_b16 v[40:41], v3 offset:8192
ds_read_b64_tr_b16 v[42:43], v5 offset:8704
v_mul_f32 v209, 0x3e0293ee, v209
v_mfma_f32_16x16x32_bf16 v[96:99], v[52:55], a[16:19], v[96:99]
buffer_load_dwordx4 v17, s[24:27], s52 offen offset:3072 lds
v_mfma_f32_16x16x32_bf16 v[100:103], v[48:51], a[4:7], 0
s_add_u32 m0, s50, 4096
ds_read_b64_tr_b16 v[44:45], v3 offset:12288
ds_read_b64_tr_b16 v[46:47], v5 offset:12800
v_mul_f32 v210, 0x3e0293ee, v210
v_mfma_f32_16x16x32_bf16 v[100:103], v[52:55], a[20:23], v[100:103]
buffer_load_dwordx4 v14, s[24:27], s53 offen lds
v_mfma_f32_16x16x32_bf16 v[104:107], v[48:51], a[8:11], 0
v_mul_f32 v211, 0x3e0293ee, v211
v_cvt_pk_bf16_f32 v128, v192, v193
v_cvt_pk_bf16_f32 v129, v194, v195
v_mfma_f32_16x16x32_bf16 v[104:107], v[52:55], a[24:27], v[104:107]
buffer_load_dwordx4 v15, s[24:27], s53 offen offset:1024 lds
v_mfma_f32_16x16x32_bf16 v[108:111], v[48:51], a[12:15], 0
v_cvt_pk_bf16_f32 v130, v208, v209
v_cvt_pk_bf16_f32 v131, v210, v211
v_mfma_f32_16x16x32_bf16 v[108:111], v[52:55], a[28:31], v[108:111]
v_mul_f32 v196, 0x3e0293ee, v196
v_mul_f32 v197, 0x3e0293ee, v197
v_mul_f32 v198, 0x3e0293ee, v198
v_mfma_f32_16x16x32_bf16 v[112:115], v[56:59], a[0:3], 0
ds_read_b64_tr_b16 v[48:49], v4 offset:8192
ds_read_b64_tr_b16 v[50:51], v2 offset:8704
v_mul_f32 v199, 0x3e0293ee, v199
v_mfma_f32_16x16x32_bf16 v[112:115], v[60:63], a[16:19], v[112:115]
buffer_load_dwordx4 v16, s[24:27], s53 offen offset:2048 lds
v_mfma_f32_16x16x32_bf16 v[116:119], v[56:59], a[4:7], 0
ds_read_b64_tr_b16 v[52:53], v4 offset:12288
ds_read_b64_tr_b16 v[54:55], v2 offset:12800
v_mul_f32 v212, 0x3e0293ee, v212
v_mfma_f32_16x16x32_bf16 v[116:119], v[60:63], a[20:23], v[116:119]
buffer_load_dwordx4 v17, s[24:27], s53 offen offset:3072 lds
v_mfma_f32_16x16x32_bf16 v[120:123], v[56:59], a[8:11], 0
v_mul_f32 v213, 0x3e0293ee, v213
v_mul_f32 v214, 0x3e0293ee, v214
v_mfma_f32_16x16x32_bf16 v[120:123], v[60:63], a[24:27], v[120:123]
v_mul_f32 v215, 0x3e0293ee, v215
v_permlane32_swap_b32 v128, v130
v_mfma_f32_16x16x32_bf16 v[124:127], v[56:59], a[12:15], 0
v_permlane32_swap_b32 v129, v131
s_nop 0
v_mfma_f32_16x16x32_bf16 v[124:127], v[60:63], a[28:31], v[124:127]
s_waitcnt lgkmcnt(8)
v_permlane16_swap_b32 v128, v130
v_mfma_f32_16x16x32_bf16 v[64:67], v[32:35], a[32:35], v[64:67]
ds_read_b64_tr_b16 v[56:57], v5 offset:8192
ds_read_b64_tr_b16 v[58:59], v3 offset:8704
v_mfma_f32_16x16x32_bf16 v[64:67], v[36:39], a[48:51], v[64:67]
s_add_u32 s51, s51, 1
ds_read_b64_tr_b16 v[60:61], v5 offset:12288
ds_read_b64_tr_b16 v[62:63], v3 offset:12800
v_mfma_f32_16x16x32_bf16 v[68:71], v[32:35], a[36:39], v[68:71]
s_and_b32 s51, s51, 7
v_permlane16_swap_b32 v129, v131
v_cvt_pk_bf16_f32 v144, v196, v197
v_cvt_pk_bf16_f32 v145, v198, v199
v_mfma_f32_16x16x32_bf16 v[68:71], v[36:39], a[52:55], v[68:71]
s_mul_i32 s52, s51, 524288
v_cvt_pk_bf16_f32 v146, v212, v213
v_cvt_pk_bf16_f32 v147, v214, v215
v_mfma_f32_16x16x32_bf16 v[72:75], v[32:35], a[40:43], v[72:75]
s_add_u32 s52, s52, s56
v_mul_f32 v200, 0x3e0293ee, v200
v_mul_f32 v201, 0x3e0293ee, v201
v_mul_f32 v202, 0x3e0293ee, v202
v_mfma_f32_16x16x32_bf16 v[72:75], v[36:39], a[56:59], v[72:75]
s_add_u32 s52, s52, 128
v_mul_f32 v203, 0x3e0293ee, v203
v_mul_f32 v216, 0x3e0293ee, v216
v_mfma_f32_16x16x32_bf16 v[76:79], v[32:35], a[44:47], v[76:79]
s_add_u32 m0, s50, 8192
v_mul_f32 v217, 0x3e0293ee, v217
v_mul_f32 v218, 0x3e0293ee, v218
v_mul_f32 v219, 0x3e0293ee, v219
v_mfma_f32_16x16x32_bf16 v[76:79], v[36:39], a[60:63], v[76:79]
s_waitcnt vmcnt(8) lgkmcnt(0)
v_permlane32_swap_b32 v144, v146
v_mfma_f32_16x16x32_bf16 v[80:83], v[40:43], a[32:35], v[80:83]
ds_read_b64_tr_b16 v[32:33], v2 offset:16384
ds_read_b64_tr_b16 v[34:35], v4 offset:16896
v_mfma_f32_16x16x32_bf16 v[80:83], v[44:47], a[48:51], v[80:83]
buffer_load_dwordx4 v14, s[24:27], s52 offen lds
v_mfma_f32_16x16x32_bf16 v[84:87], v[40:43], a[36:39], v[84:87]
ds_read_b64_tr_b16 v[36:37], v2 offset:20480
ds_read_b64_tr_b16 v[38:39], v4 offset:20992
v_permlane32_swap_b32 v145, v147
v_mfma_f32_16x16x32_bf16 v[84:87], v[44:47], a[52:55], v[84:87]
buffer_load_dwordx4 v15, s[24:27], s52 offen offset:1024 lds
v_mfma_f32_16x16x32_bf16 v[88:91], v[40:43], a[40:43], v[88:91]
s_nop 0
v_permlane16_swap_b32 v144, v146
v_mfma_f32_16x16x32_bf16 v[88:91], v[44:47], a[56:59], v[88:91]
buffer_load_dwordx4 v16, s[24:27], s52 offen offset:2048 lds
v_mfma_f32_16x16x32_bf16 v[92:95], v[40:43], a[44:47], v[92:95]
v_permlane16_swap_b32 v145, v147
v_mfma_f32_16x16x32_bf16 v[92:95], v[44:47], a[60:63], v[92:95]
v_cvt_pk_bf16_f32 v160, v200, v201
v_cvt_pk_bf16_f32 v161, v202, v203
v_cvt_pk_bf16_f32 v162, v216, v217
v_mfma_f32_16x16x32_bf16 v[96:99], v[48:51], a[32:35], v[96:99]
s_add_u32 s53, s52, 262144
ds_read_b64_tr_b16 v[40:41], v3 offset:16384
ds_read_b64_tr_b16 v[42:43], v5 offset:16896
v_cvt_pk_bf16_f32 v163, v218, v219
v_mfma_f32_16x16x32_bf16 v[96:99], v[52:55], a[48:51], v[96:99]
buffer_load_dwordx4 v17, s[24:27], s52 offen offset:3072 lds
v_mfma_f32_16x16x32_bf16 v[100:103], v[48:51], a[36:39], v[100:103]
s_add_u32 m0, s50, 12288
ds_read_b64_tr_b16 v[44:45], v3 offset:20480
ds_read_b64_tr_b16 v[46:47], v5 offset:20992
v_mfma_f32_16x16x32_bf16 v[100:103], v[52:55], a[52:55], v[100:103]
buffer_load_dwordx4 v14, s[24:27], s53 offen lds
v_mfma_f32_16x16x32_bf16 v[104:107], v[48:51], a[40:43], v[104:107]
v_mul_f32 v204, 0x3e0293ee, v204
v_mul_f32 v205, 0x3e0293ee, v205
v_mul_f32 v206, 0x3e0293ee, v206
v_mfma_f32_16x16x32_bf16 v[104:107], v[52:55], a[56:59], v[104:107]
buffer_load_dwordx4 v15, s[24:27], s53 offen offset:1024 lds
v_mfma_f32_16x16x32_bf16 v[108:111], v[48:51], a[44:47], v[108:111]
v_mul_f32 v207, 0x3e0293ee, v207
v_mul_f32 v220, 0x3e0293ee, v220
v_mul_f32 v221, 0x3e0293ee, v221
v_mfma_f32_16x16x32_bf16 v[108:111], v[52:55], a[60:63], v[108:111]
v_mul_f32 v222, 0x3e0293ee, v222
v_mul_f32 v223, 0x3e0293ee, v223
v_mfma_f32_16x16x32_bf16 v[112:115], v[56:59], a[32:35], v[112:115]
ds_read_b64_tr_b16 v[48:49], v4 offset:16384
ds_read_b64_tr_b16 v[50:51], v2 offset:16896
v_mfma_f32_16x16x32_bf16 v[112:115], v[60:63], a[48:51], v[112:115]
buffer_load_dwordx4 v16, s[24:27], s53 offen offset:2048 lds
v_mfma_f32_16x16x32_bf16 v[116:119], v[56:59], a[36:39], v[116:119]
ds_read_b64_tr_b16 v[52:53], v4 offset:20480
ds_read_b64_tr_b16 v[54:55], v2 offset:20992
v_permlane32_swap_b32 v160, v162
v_mfma_f32_16x16x32_bf16 v[116:119], v[60:63], a[52:55], v[116:119]
buffer_load_dwordx4 v17, s[24:27], s53 offen offset:3072 lds
v_mfma_f32_16x16x32_bf16 v[120:123], v[56:59], a[40:43], v[120:123]
v_permlane32_swap_b32 v161, v163
v_mfma_f32_16x16x32_bf16 v[120:123], v[60:63], a[56:59], v[120:123]
s_nop 0
v_permlane16_swap_b32 v160, v162
v_mfma_f32_16x16x32_bf16 v[124:127], v[56:59], a[44:47], v[124:127]
v_permlane16_swap_b32 v161, v163
v_cvt_pk_bf16_f32 v176, v204, v205
v_mfma_f32_16x16x32_bf16 v[124:127], v[60:63], a[60:63], v[124:127]
s_waitcnt lgkmcnt(8)
v_cvt_pk_bf16_f32 v177, v206, v207
v_cvt_pk_bf16_f32 v178, v220, v221
v_mfma_f32_16x16x32_bf16 v[64:67], v[32:35], a[64:67], v[64:67]
s_barrier
ds_read_b64_tr_b16 v[56:57], v5 offset:16384
ds_read_b64_tr_b16 v[58:59], v3 offset:16896
v_mfma_f32_16x16x32_bf16 v[64:67], v[36:39], a[80:83], v[64:67]
s_add_u32 s51, s51, 1
ds_read_b64_tr_b16 v[60:61], v5 offset:20480
ds_read_b64_tr_b16 v[62:63], v3 offset:20992
v_cvt_pk_bf16_f32 v179, v222, v223
v_mfma_f32_16x16x32_bf16 v[68:71], v[32:35], a[68:71], v[68:71]
s_and_b32 s51, s51, 7
v_mul_f32 v224, 0x3e0293ee, v224
v_mul_f32 v225, 0x3e0293ee, v225
v_mfma_f32_16x16x32_bf16 v[68:71], v[36:39], a[84:87], v[68:71]
s_mul_i32 s52, s51, 524288
v_mul_f32 v226, 0x3e0293ee, v226
v_mul_f32 v227, 0x3e0293ee, v227
v_mul_f32 v240, 0x3e0293ee, v240
v_mfma_f32_16x16x32_bf16 v[72:75], v[32:35], a[72:75], v[72:75]
s_add_u32 s52, s52, s56
v_mul_f32 v241, 0x3e0293ee, v241
v_mul_f32 v242, 0x3e0293ee, v242
v_mul_f32 v243, 0x3e0293ee, v243
v_mfma_f32_16x16x32_bf16 v[72:75], v[36:39], a[88:91], v[72:75]
s_add_u32 s52, s52, 128
v_permlane32_swap_b32 v176, v178
v_mfma_f32_16x16x32_bf16 v[76:79], v[32:35], a[76:79], v[76:79]
s_add_u32 m0, s50, 16384
v_permlane32_swap_b32 v177, v179
s_nop 0
v_mfma_f32_16x16x32_bf16 v[76:79], v[36:39], a[92:95], v[76:79]
s_waitcnt vmcnt(8) lgkmcnt(0)
v_permlane16_swap_b32 v176, v178
v_mfma_f32_16x16x32_bf16 v[80:83], v[40:43], a[64:67], v[80:83]
ds_read_b64_tr_b16 v[32:33], v2 offset:0
ds_read_b64_tr_b16 v[34:35], v4 offset:512
v_mfma_f32_16x16x32_bf16 v[80:83], v[44:47], a[80:83], v[80:83]
buffer_load_dwordx4 v14, s[24:27], s52 offen lds
v_mfma_f32_16x16x32_bf16 v[84:87], v[40:43], a[68:71], v[84:87]
ds_read_b64_tr_b16 v[36:37], v2 offset:4096
ds_read_b64_tr_b16 v[38:39], v4 offset:4608
v_permlane16_swap_b32 v177, v179
v_mfma_f32_16x16x32_bf16 v[84:87], v[44:47], a[84:87], v[84:87]
buffer_load_dwordx4 v15, s[24:27], s52 offen offset:1024 lds
v_mfma_f32_16x16x32_bf16 v[88:91], v[40:43], a[72:75], v[88:91]
v_cvt_pk_bf16_f32 v132, v224, v225
v_cvt_pk_bf16_f32 v133, v226, v227
v_cvt_pk_bf16_f32 v134, v240, v241
v_mfma_f32_16x16x32_bf16 v[88:91], v[44:47], a[88:91], v[88:91]
buffer_load_dwordx4 v16, s[24:27], s52 offen offset:2048 lds
v_mfma_f32_16x16x32_bf16 v[92:95], v[40:43], a[76:79], v[92:95]
v_cvt_pk_bf16_f32 v135, v242, v243
v_mul_f32 v228, 0x3e0293ee, v228
v_mfma_f32_16x16x32_bf16 v[92:95], v[44:47], a[92:95], v[92:95]
v_mul_f32 v229, 0x3e0293ee, v229
v_mul_f32 v230, 0x3e0293ee, v230
v_mul_f32 v231, 0x3e0293ee, v231
v_mfma_f32_16x16x32_bf16 v[96:99], v[48:51], a[64:67], v[96:99]
s_add_u32 s53, s52, 262144
ds_read_b64_tr_b16 v[40:41], v3 offset:0
ds_read_b64_tr_b16 v[42:43], v5 offset:512
v_mul_f32 v244, 0x3e0293ee, v244
v_mfma_f32_16x16x32_bf16 v[96:99], v[52:55], a[80:83], v[96:99]
buffer_load_dwordx4 v17, s[24:27], s52 offen offset:3072 lds
v_mfma_f32_16x16x32_bf16 v[100:103], v[48:51], a[68:71], v[100:103]
s_add_u32 m0, s50, 20480
ds_read_b64_tr_b16 v[44:45], v3 offset:4096
ds_read_b64_tr_b16 v[46:47], v5 offset:4608
v_mfma_f32_16x16x32_bf16 v[100:103], v[52:55], a[84:87], v[100:103]
buffer_load_dwordx4 v14, s[24:27], s53 offen lds
v_mfma_f32_16x16x32_bf16 v[104:107], v[48:51], a[72:75], v[104:107]
v_mul_f32 v245, 0x3e0293ee, v245
v_mul_f32 v246, 0x3e0293ee, v246
v_mul_f32 v247, 0x3e0293ee, v247
v_mfma_f32_16x16x32_bf16 v[104:107], v[52:55], a[88:91], v[104:107]
buffer_load_dwordx4 v15, s[24:27], s53 offen offset:1024 lds
v_mfma_f32_16x16x32_bf16 v[108:111], v[48:51], a[76:79], v[108:111]
v_permlane32_swap_b32 v132, v134
v_mfma_f32_16x16x32_bf16 v[108:111], v[52:55], a[92:95], v[108:111]
v_permlane32_swap_b32 v133, v135
s_nop 0
v_mfma_f32_16x16x32_bf16 v[112:115], v[56:59], a[64:67], v[112:115]
ds_read_b64_tr_b16 v[48:49], v4 offset:0
ds_read_b64_tr_b16 v[50:51], v2 offset:512
v_mfma_f32_16x16x32_bf16 v[112:115], v[60:63], a[80:83], v[112:115]
buffer_load_dwordx4 v16, s[24:27], s53 offen offset:2048 lds
v_mfma_f32_16x16x32_bf16 v[116:119], v[56:59], a[68:71], v[116:119]
ds_read_b64_tr_b16 v[52:53], v4 offset:4096
ds_read_b64_tr_b16 v[54:55], v2 offset:4608
v_permlane16_swap_b32 v132, v134
v_mfma_f32_16x16x32_bf16 v[116:119], v[60:63], a[84:87], v[116:119]
buffer_load_dwordx4 v17, s[24:27], s53 offen offset:3072 lds
v_mfma_f32_16x16x32_bf16 v[120:123], v[56:59], a[72:75], v[120:123]
v_permlane16_swap_b32 v133, v135
v_mfma_f32_16x16x32_bf16 v[120:123], v[60:63], a[88:91], v[120:123]
v_cvt_pk_bf16_f32 v148, v228, v229
v_cvt_pk_bf16_f32 v149, v230, v231
v_cvt_pk_bf16_f32 v150, v244, v245
v_mfma_f32_16x16x32_bf16 v[124:127], v[56:59], a[76:79], v[124:127]
v_cvt_pk_bf16_f32 v151, v246, v247
v_mul_f32 v232, 0x3e0293ee, v232
v_mul_f32 v233, 0x3e0293ee, v233
v_mfma_f32_16x16x32_bf16 v[124:127], v[60:63], a[92:95], v[124:127]
s_waitcnt lgkmcnt(8)
v_mul_f32 v234, 0x3e0293ee, v234
v_mul_f32 v235, 0x3e0293ee, v235
v_mfma_f32_16x16x32_bf16 v[64:67], v[32:35], a[96:99], v[64:67]
ds_read_b64_tr_b16 v[56:57], v5 offset:0
ds_read_b64_tr_b16 v[58:59], v3 offset:512
v_mfma_f32_16x16x32_bf16 v[64:67], v[36:39], a[112:115], v[64:67]
s_add_u32 s51, s51, 1
ds_read_b64_tr_b16 v[60:61], v5 offset:4096
ds_read_b64_tr_b16 v[62:63], v3 offset:4608
v_mul_f32 v248, 0x3e0293ee, v248
v_mfma_f32_16x16x32_bf16 v[68:71], v[32:35], a[100:103], v[68:71]
s_and_b32 s51, s51, 7
v_mul_f32 v249, 0x3e0293ee, v249
v_mul_f32 v250, 0x3e0293ee, v250
v_mfma_f32_16x16x32_bf16 v[68:71], v[36:39], a[116:119], v[68:71]
s_mul_i32 s52, s51, 524288
v_mul_f32 v251, 0x3e0293ee, v251
v_permlane32_swap_b32 v148, v150
v_mfma_f32_16x16x32_bf16 v[72:75], v[32:35], a[104:107], v[72:75]
s_add_u32 s52, s52, s56
v_permlane32_swap_b32 v149, v151
s_nop 0
v_mfma_f32_16x16x32_bf16 v[72:75], v[36:39], a[120:123], v[72:75]
s_add_u32 s52, s52, 128
v_permlane16_swap_b32 v148, v150
v_mfma_f32_16x16x32_bf16 v[76:79], v[32:35], a[108:111], v[76:79]
s_add_u32 m0, s50, 0
v_permlane16_swap_b32 v149, v151
v_cvt_pk_bf16_f32 v164, v232, v233
v_mfma_f32_16x16x32_bf16 v[76:79], v[36:39], a[124:127], v[76:79]
s_waitcnt vmcnt(8) lgkmcnt(0)
v_cvt_pk_bf16_f32 v165, v234, v235
v_cvt_pk_bf16_f32 v166, v248, v249
v_cvt_pk_bf16_f32 v167, v250, v251
v_mfma_f32_16x16x32_bf16 v[80:83], v[40:43], a[96:99], v[80:83]
ds_read_b64_tr_b16 v[32:33], v2 offset:8192
ds_read_b64_tr_b16 v[34:35], v4 offset:8704
v_mfma_f32_16x16x32_bf16 v[80:83], v[44:47], a[112:115], v[80:83]
buffer_load_dwordx4 v14, s[24:27], s52 offen lds
v_mfma_f32_16x16x32_bf16 v[84:87], v[40:43], a[100:103], v[84:87]
ds_read_b64_tr_b16 v[36:37], v2 offset:12288
ds_read_b64_tr_b16 v[38:39], v4 offset:12800
v_mul_f32 v236, 0x3e0293ee, v236
v_mfma_f32_16x16x32_bf16 v[84:87], v[44:47], a[116:119], v[84:87]
buffer_load_dwordx4 v15, s[24:27], s52 offen offset:1024 lds
v_mfma_f32_16x16x32_bf16 v[88:91], v[40:43], a[104:107], v[88:91]
v_mul_f32 v237, 0x3e0293ee, v237
v_mul_f32 v238, 0x3e0293ee, v238
v_mul_f32 v239, 0x3e0293ee, v239
v_mfma_f32_16x16x32_bf16 v[88:91], v[44:47], a[120:123], v[88:91]
buffer_load_dwordx4 v16, s[24:27], s52 offen offset:2048 lds
v_mfma_f32_16x16x32_bf16 v[92:95], v[40:43], a[108:111], v[92:95]
v_mul_f32 v252, 0x3e0293ee, v252
v_mul_f32 v253, 0x3e0293ee, v253
v_mfma_f32_16x16x32_bf16 v[92:95], v[44:47], a[124:127], v[92:95]
v_mul_f32 v254, 0x3e0293ee, v254
v_mul_f32 v255, 0x3e0293ee, v255
v_mfma_f32_16x16x32_bf16 v[96:99], v[48:51], a[96:99], v[96:99]
s_add_u32 s53, s52, 262144
ds_read_b64_tr_b16 v[40:41], v3 offset:8192
ds_read_b64_tr_b16 v[42:43], v5 offset:8704
v_permlane32_swap_b32 v164, v166
v_mfma_f32_16x16x32_bf16 v[96:99], v[52:55], a[112:115], v[96:99]
buffer_load_dwordx4 v17, s[24:27], s52 offen offset:3072 lds
v_mfma_f32_16x16x32_bf16 v[100:103], v[48:51], a[100:103], v[100:103]
s_add_u32 m0, s50, 4096
ds_read_b64_tr_b16 v[44:45], v3 offset:12288
ds_read_b64_tr_b16 v[46:47], v5 offset:12800
v_mfma_f32_16x16x32_bf16 v[100:103], v[52:55], a[116:119], v[100:103]
buffer_load_dwordx4 v14, s[24:27], s53 offen lds
v_mfma_f32_16x16x32_bf16 v[104:107], v[48:51], a[104:107], v[104:107]
v_permlane32_swap_b32 v165, v167
s_nop 0
v_mfma_f32_16x16x32_bf16 v[104:107], v[52:55], a[120:123], v[104:107]
buffer_load_dwordx4 v15, s[24:27], s53 offen offset:1024 lds
v_mfma_f32_16x16x32_bf16 v[108:111], v[48:51], a[108:111], v[108:111]
v_permlane16_swap_b32 v164, v166
v_mfma_f32_16x16x32_bf16 v[108:111], v[52:55], a[124:127], v[108:111]
v_permlane16_swap_b32 v165, v167
v_cvt_pk_bf16_f32 v180, v236, v237
v_mfma_f32_16x16x32_bf16 v[112:115], v[56:59], a[96:99], v[112:115]
ds_read_b64_tr_b16 v[48:49], v4 offset:8192
ds_read_b64_tr_b16 v[50:51], v2 offset:8704
v_cvt_pk_bf16_f32 v181, v238, v239
v_mfma_f32_16x16x32_bf16 v[112:115], v[60:63], a[112:115], v[112:115]
buffer_load_dwordx4 v16, s[24:27], s53 offen offset:2048 lds
v_mfma_f32_16x16x32_bf16 v[116:119], v[56:59], a[100:103], v[116:119]
ds_read_b64_tr_b16 v[52:53], v4 offset:12288
ds_read_b64_tr_b16 v[54:55], v2 offset:12800
v_cvt_pk_bf16_f32 v182, v252, v253
v_mfma_f32_16x16x32_bf16 v[116:119], v[60:63], a[116:119], v[116:119]
buffer_load_dwordx4 v17, s[24:27], s53 offen offset:3072 lds
v_mfma_f32_16x16x32_bf16 v[120:123], v[56:59], a[104:107], v[120:123]
v_cvt_pk_bf16_f32 v183, v254, v255
s_nop 1
v_mfma_f32_16x16x32_bf16 v[120:123], v[60:63], a[120:123], v[120:123]
v_permlane32_swap_b32 v180, v182
v_mfma_f32_16x16x32_bf16 v[124:127], v[56:59], a[108:111], v[124:127]
v_permlane32_swap_b32 v181, v183
s_nop 0
v_mfma_f32_16x16x32_bf16 v[124:127], v[60:63], a[124:127], v[124:127]
s_waitcnt lgkmcnt(8)
v_permlane16_swap_b32 v180, v182
v_mfma_f32_16x16x32_bf16 v[64:67], v[32:35], a[128:131], v[64:67]
ds_read_b64_tr_b16 v[56:57], v5 offset:8192
ds_read_b64_tr_b16 v[58:59], v3 offset:8704
v_mfma_f32_16x16x32_bf16 v[64:67], v[36:39], a[144:147], v[64:67]
s_add_u32 s51, s51, 1
ds_read_b64_tr_b16 v[60:61], v5 offset:12288
ds_read_b64_tr_b16 v[62:63], v3 offset:12800
v_mfma_f32_16x16x32_bf16 v[68:71], v[32:35], a[132:135], v[68:71]
s_and_b32 s51, s51, 7
ds_read_b128 a[0:3], v0 offset:0
v_mfma_f32_16x16x32_bf16 v[68:71], v[36:39], a[148:151], v[68:71]
s_mul_i32 s52, s51, 524288
ds_read_b128 a[16:19], v0 offset:4096
v_mfma_f32_16x16x32_bf16 v[72:75], v[32:35], a[136:139], v[72:75]
s_add_u32 s52, s52, s56
ds_read_b128 a[4:7], v0 offset:1024
v_mfma_f32_16x16x32_bf16 v[72:75], v[36:39], a[152:155], v[72:75]
s_add_u32 s52, s52, 128
ds_read_b128 a[20:23], v0 offset:5120
v_mfma_f32_16x16x32_bf16 v[76:79], v[32:35], a[140:143], v[76:79]
s_add_u32 m0, s50, 8192
ds_read_b128 a[8:11], v0 offset:2048
v_mfma_f32_16x16x32_bf16 v[76:79], v[36:39], a[156:159], v[76:79]
s_waitcnt vmcnt(8) lgkmcnt(5)
v_permlane16_swap_b32 v181, v183
v_mfma_f32_16x16x32_bf16 v[80:83], v[40:43], a[128:131], v[80:83]
ds_read_b64_tr_b16 v[32:33], v2 offset:16384
ds_read_b64_tr_b16 v[34:35], v4 offset:16896
v_mfma_f32_16x16x32_bf16 v[80:83], v[44:47], a[144:147], v[80:83]
buffer_load_dwordx4 v14, s[24:27], s52 offen lds
v_mfma_f32_16x16x32_bf16 v[84:87], v[40:43], a[132:135], v[84:87]
ds_read_b64_tr_b16 v[36:37], v2 offset:20480
ds_read_b64_tr_b16 v[38:39], v4 offset:20992
v_mfma_f32_16x16x32_bf16 v[84:87], v[44:47], a[148:151], v[84:87]
buffer_load_dwordx4 v15, s[24:27], s52 offen offset:1024 lds
v_mfma_f32_16x16x32_bf16 v[88:91], v[40:43], a[136:139], v[88:91]
ds_read_b128 a[24:27], v0 offset:6144
v_mfma_f32_16x16x32_bf16 v[88:91], v[44:47], a[152:155], v[88:91]
buffer_load_dwordx4 v16, s[24:27], s52 offen offset:2048 lds
v_mfma_f32_16x16x32_bf16 v[92:95], v[40:43], a[140:143], v[92:95]
ds_read_b128 a[12:15], v0 offset:3072
v_mfma_f32_16x16x32_bf16 v[92:95], v[44:47], a[156:159], v[92:95]
v_mfma_f32_16x16x32_bf16 v[96:99], v[48:51], a[128:131], v[96:99]
s_add_u32 s53, s52, 262144
ds_read_b64_tr_b16 v[40:41], v3 offset:16384
ds_read_b64_tr_b16 v[42:43], v5 offset:16896
v_mfma_f32_16x16x32_bf16 v[96:99], v[52:55], a[144:147], v[96:99]
buffer_load_dwordx4 v17, s[24:27], s52 offen offset:3072 lds
v_mfma_f32_16x16x32_bf16 v[100:103], v[48:51], a[132:135], v[100:103]
s_add_u32 m0, s50, 12288
ds_read_b64_tr_b16 v[44:45], v3 offset:20480
ds_read_b64_tr_b16 v[46:47], v5 offset:20992
v_mfma_f32_16x16x32_bf16 v[100:103], v[52:55], a[148:151], v[100:103]
buffer_load_dwordx4 v14, s[24:27], s53 offen lds
v_mfma_f32_16x16x32_bf16 v[104:107], v[48:51], a[136:139], v[104:107]
ds_read_b128 a[28:31], v0 offset:7168
v_mfma_f32_16x16x32_bf16 v[104:107], v[52:55], a[152:155], v[104:107]
buffer_load_dwordx4 v15, s[24:27], s53 offen offset:1024 lds
v_mfma_f32_16x16x32_bf16 v[108:111], v[48:51], a[140:143], v[108:111]
v_mfma_f32_16x16x32_bf16 v[108:111], v[52:55], a[156:159], v[108:111]
v_mfma_f32_16x16x32_bf16 v[112:115], v[56:59], a[128:131], v[112:115]
ds_read_b64_tr_b16 v[48:49], v4 offset:16384
ds_read_b64_tr_b16 v[50:51], v2 offset:16896
v_mfma_f32_16x16x32_bf16 v[112:115], v[60:63], a[144:147], v[112:115]
buffer_load_dwordx4 v16, s[24:27], s53 offen offset:2048 lds
v_mfma_f32_16x16x32_bf16 v[116:119], v[56:59], a[132:135], v[116:119]
ds_read_b64_tr_b16 v[52:53], v4 offset:20480
ds_read_b64_tr_b16 v[54:55], v2 offset:20992
v_mfma_f32_16x16x32_bf16 v[116:119], v[60:63], a[148:151], v[116:119]
buffer_load_dwordx4 v17, s[24:27], s53 offen offset:3072 lds
v_mfma_f32_16x16x32_bf16 v[120:123], v[56:59], a[136:139], v[120:123]
v_mfma_f32_16x16x32_bf16 v[120:123], v[60:63], a[152:155], v[120:123]
v_mfma_f32_16x16x32_bf16 v[124:127], v[56:59], a[140:143], v[124:127]
v_mfma_f32_16x16x32_bf16 v[124:127], v[60:63], a[156:159], v[124:127]
s_waitcnt lgkmcnt(11)
v_mfma_f32_16x16x32_bf16 v[64:67], v[32:35], a[160:163], v[64:67]
ds_read_b64_tr_b16 v[56:57], v5 offset:16384
ds_read_b64_tr_b16 v[58:59], v3 offset:16896
v_mfma_f32_16x16x32_bf16 v[64:67], v[36:39], a[176:179], v[64:67]
ds_read_b64_tr_b16 v[60:61], v5 offset:20480
ds_read_b64_tr_b16 v[62:63], v3 offset:20992
v_mfma_f32_16x16x32_bf16 v[68:71], v[32:35], a[164:167], v[68:71]
ds_read_b128 a[32:35], v0 offset:8192
v_mfma_f32_16x16x32_bf16 v[68:71], v[36:39], a[180:183], v[68:71]
ds_read_b128 a[48:51], v0 offset:12288
v_mfma_f32_16x16x32_bf16 v[72:75], v[32:35], a[168:171], v[72:75]
ds_read_b128 a[36:39], v0 offset:9216
v_mfma_f32_16x16x32_bf16 v[72:75], v[36:39], a[184:187], v[72:75]
s_add_u32 s52, s57, 0
ds_read_b128 a[52:55], v0 offset:13312
v_mfma_f32_16x16x32_bf16 v[76:79], v[32:35], a[172:175], v[76:79]
s_add_u32 m0, s50, 16384
ds_read_b128 a[40:43], v0 offset:10240
v_mfma_f32_16x16x32_bf16 v[76:79], v[36:39], a[188:191], v[76:79]
s_waitcnt vmcnt(8) lgkmcnt(5)
v_mfma_f32_16x16x32_bf16 v[80:83], v[40:43], a[160:163], v[80:83]
ds_read_b64_tr_b16 v[32:33], v2 offset:0
ds_read_b64_tr_b16 v[34:35], v4 offset:512
v_mfma_f32_16x16x32_bf16 v[80:83], v[44:47], a[176:179], v[80:83]
buffer_load_dwordx4 v18, s[28:31], s52 offen lds
v_mfma_f32_16x16x32_bf16 v[84:87], v[40:43], a[164:167], v[84:87]
ds_read_b64_tr_b16 v[36:37], v2 offset:4096
ds_read_b64_tr_b16 v[38:39], v4 offset:4608
v_mfma_f32_16x16x32_bf16 v[84:87], v[44:47], a[180:183], v[84:87]
buffer_load_dwordx4 v19, s[28:31], s52 offen offset:1024 lds
v_mfma_f32_16x16x32_bf16 v[88:91], v[40:43], a[168:171], v[88:91]
ds_read_b128 a[56:59], v0 offset:14336
v_mfma_f32_16x16x32_bf16 v[88:91], v[44:47], a[184:187], v[88:91]
buffer_load_dwordx4 v20, s[28:31], s52 offen offset:2048 lds
v_mfma_f32_16x16x32_bf16 v[92:95], v[40:43], a[172:175], v[92:95]
ds_read_b128 a[44:47], v0 offset:11264
v_mfma_f32_16x16x32_bf16 v[92:95], v[44:47], a[188:191], v[92:95]
v_mfma_f32_16x16x32_bf16 v[96:99], v[48:51], a[160:163], v[96:99]
s_add_u32 s53, s52, 32768
ds_read_b64_tr_b16 v[40:41], v3 offset:0
ds_read_b64_tr_b16 v[42:43], v5 offset:512
v_mfma_f32_16x16x32_bf16 v[96:99], v[52:55], a[176:179], v[96:99]
buffer_load_dwordx4 v21, s[28:31], s52 offen offset:3072 lds
v_mfma_f32_16x16x32_bf16 v[100:103], v[48:51], a[164:167], v[100:103]
s_add_u32 m0, s50, 20480
ds_read_b64_tr_b16 v[44:45], v3 offset:4096
ds_read_b64_tr_b16 v[46:47], v5 offset:4608
v_mfma_f32_16x16x32_bf16 v[100:103], v[52:55], a[180:183], v[100:103]
buffer_load_dwordx4 v18, s[28:31], s53 offen lds
v_mfma_f32_16x16x32_bf16 v[104:107], v[48:51], a[168:171], v[104:107]
ds_read_b128 a[60:63], v0 offset:15360
v_mfma_f32_16x16x32_bf16 v[104:107], v[52:55], a[184:187], v[104:107]
buffer_load_dwordx4 v19, s[28:31], s53 offen offset:1024 lds
v_mfma_f32_16x16x32_bf16 v[108:111], v[48:51], a[172:175], v[108:111]
v_mfma_f32_16x16x32_bf16 v[108:111], v[52:55], a[188:191], v[108:111]
v_mfma_f32_16x16x32_bf16 v[112:115], v[56:59], a[160:163], v[112:115]
ds_read_b64_tr_b16 v[48:49], v4 offset:0
ds_read_b64_tr_b16 v[50:51], v2 offset:512
v_mfma_f32_16x16x32_bf16 v[112:115], v[60:63], a[176:179], v[112:115]
buffer_load_dwordx4 v20, s[28:31], s53 offen offset:2048 lds
v_mfma_f32_16x16x32_bf16 v[116:119], v[56:59], a[164:167], v[116:119]
ds_read_b64_tr_b16 v[52:53], v4 offset:4096
ds_read_b64_tr_b16 v[54:55], v2 offset:4608
v_mfma_f32_16x16x32_bf16 v[116:119], v[60:63], a[180:183], v[116:119]
buffer_load_dwordx4 v21, s[28:31], s53 offen offset:3072 lds
v_mfma_f32_16x16x32_bf16 v[120:123], v[56:59], a[168:171], v[120:123]
v_mfma_f32_16x16x32_bf16 v[120:123], v[60:63], a[184:187], v[120:123]
v_mfma_f32_16x16x32_bf16 v[124:127], v[56:59], a[172:175], v[124:127]
v_mfma_f32_16x16x32_bf16 v[124:127], v[60:63], a[188:191], v[124:127]
s_waitcnt lgkmcnt(11)
v_mfma_f32_16x16x32_bf16 v[64:67], v[32:35], a[192:195], v[64:67]
ds_read_b64_tr_b16 v[56:57], v5 offset:0
ds_read_b64_tr_b16 v[58:59], v3 offset:512
v_mfma_f32_16x16x32_bf16 v[64:67], v[36:39], a[208:211], v[64:67]
ds_read_b64_tr_b16 v[60:61], v5 offset:4096
ds_read_b64_tr_b16 v[62:63], v3 offset:4608
v_mfma_f32_16x16x32_bf16 v[68:71], v[32:35], a[196:199], v[68:71]
ds_read_b128 a[64:67], v0 offset:16384
v_mfma_f32_16x16x32_bf16 v[68:71], v[36:39], a[212:215], v[68:71]
ds_read_b128 a[80:83], v0 offset:20480
v_mfma_f32_16x16x32_bf16 v[72:75], v[32:35], a[200:203], v[72:75]
ds_read_b128 a[68:71], v0 offset:17408
v_mfma_f32_16x16x32_bf16 v[72:75], v[36:39], a[216:219], v[72:75]
s_add_u32 s52, s57, 65536
ds_read_b128 a[84:87], v0 offset:21504
v_mfma_f32_16x16x32_bf16 v[76:79], v[32:35], a[204:207], v[76:79]
s_add_u32 m0, s50, 0
ds_read_b128 a[72:75], v0 offset:18432
v_mfma_f32_16x16x32_bf16 v[76:79], v[36:39], a[220:223], v[76:79]
s_waitcnt vmcnt(8) lgkmcnt(5)
v_mfma_f32_16x16x32_bf16 v[80:83], v[40:43], a[192:195], v[80:83]
ds_read_b64_tr_b16 v[32:33], v2 offset:8192
ds_read_b64_tr_b16 v[34:35], v4 offset:8704
v_mfma_f32_16x16x32_bf16 v[80:83], v[44:47], a[208:211], v[80:83]
buffer_load_dwordx4 v18, s[28:31], s52 offen lds
v_mfma_f32_16x16x32_bf16 v[84:87], v[40:43], a[196:199], v[84:87]
ds_read_b64_tr_b16 v[36:37], v2 offset:12288
ds_read_b64_tr_b16 v[38:39], v4 offset:12800
v_mfma_f32_16x16x32_bf16 v[84:87], v[44:47], a[212:215], v[84:87]
buffer_load_dwordx4 v19, s[28:31], s52 offen offset:1024 lds
v_mfma_f32_16x16x32_bf16 v[88:91], v[40:43], a[200:203], v[88:91]
ds_read_b128 a[88:91], v0 offset:22528
v_mfma_f32_16x16x32_bf16 v[88:91], v[44:47], a[216:219], v[88:91]
buffer_load_dwordx4 v20, s[28:31], s52 offen offset:2048 lds
v_mfma_f32_16x16x32_bf16 v[92:95], v[40:43], a[204:207], v[92:95]
ds_read_b128 a[76:79], v0 offset:19456
v_mfma_f32_16x16x32_bf16 v[92:95], v[44:47], a[220:223], v[92:95]
v_mfma_f32_16x16x32_bf16 v[96:99], v[48:51], a[192:195], v[96:99]
s_add_u32 s53, s52, 32768
ds_read_b64_tr_b16 v[40:41], v3 offset:8192
ds_read_b64_tr_b16 v[42:43], v5 offset:8704
v_mfma_f32_16x16x32_bf16 v[96:99], v[52:55], a[208:211], v[96:99]
buffer_load_dwordx4 v21, s[28:31], s52 offen offset:3072 lds
v_mfma_f32_16x16x32_bf16 v[100:103], v[48:51], a[196:199], v[100:103]
s_add_u32 m0, s50, 4096
ds_read_b64_tr_b16 v[44:45], v3 offset:12288
ds_read_b64_tr_b16 v[46:47], v5 offset:12800
v_mfma_f32_16x16x32_bf16 v[100:103], v[52:55], a[212:215], v[100:103]
buffer_load_dwordx4 v18, s[28:31], s53 offen lds
v_mfma_f32_16x16x32_bf16 v[104:107], v[48:51], a[200:203], v[104:107]
ds_read_b128 a[92:95], v0 offset:23552
v_mfma_f32_16x16x32_bf16 v[104:107], v[52:55], a[216:219], v[104:107]
buffer_load_dwordx4 v19, s[28:31], s53 offen offset:1024 lds
v_mfma_f32_16x16x32_bf16 v[108:111], v[48:51], a[204:207], v[108:111]
v_mfma_f32_16x16x32_bf16 v[108:111], v[52:55], a[220:223], v[108:111]
v_mfma_f32_16x16x32_bf16 v[112:115], v[56:59], a[192:195], v[112:115]
ds_read_b64_tr_b16 v[48:49], v4 offset:8192
ds_read_b64_tr_b16 v[50:51], v2 offset:8704
v_mfma_f32_16x16x32_bf16 v[112:115], v[60:63], a[208:211], v[112:115]
buffer_load_dwordx4 v20, s[28:31], s53 offen offset:2048 lds
v_mfma_f32_16x16x32_bf16 v[116:119], v[56:59], a[196:199], v[116:119]
ds_read_b64_tr_b16 v[52:53], v4 offset:12288
ds_read_b64_tr_b16 v[54:55], v2 offset:12800
v_mfma_f32_16x16x32_bf16 v[116:119], v[60:63], a[212:215], v[116:119]
buffer_load_dwordx4 v21, s[28:31], s53 offen offset:3072 lds
v_mfma_f32_16x16x32_bf16 v[120:123], v[56:59], a[200:203], v[120:123]
v_mfma_f32_16x16x32_bf16 v[120:123], v[60:63], a[216:219], v[120:123]
v_mfma_f32_16x16x32_bf16 v[124:127], v[56:59], a[204:207], v[124:127]
v_mfma_f32_16x16x32_bf16 v[124:127], v[60:63], a[220:223], v[124:127]
s_waitcnt lgkmcnt(11)
v_mfma_f32_16x16x32_bf16 v[64:67], v[32:35], a[224:227], v[64:67]
ds_read_b64_tr_b16 v[56:57], v5 offset:8192
ds_read_b64_tr_b16 v[58:59], v3 offset:8704
v_mfma_f32_16x16x32_bf16 v[64:67], v[36:39], a[240:243], v[64:67]
ds_read_b64_tr_b16 v[60:61], v5 offset:12288
ds_read_b64_tr_b16 v[62:63], v3 offset:12800
v_mfma_f32_16x16x32_bf16 v[68:71], v[32:35], a[228:231], v[68:71]
ds_read_b128 a[96:99], v0 offset:24576
v_mfma_f32_16x16x32_bf16 v[68:71], v[36:39], a[244:247], v[68:71]
ds_read_b128 a[112:115], v0 offset:28672
v_mfma_f32_16x16x32_bf16 v[72:75], v[32:35], a[232:235], v[72:75]
ds_read_b128 a[100:103], v0 offset:25600
v_mfma_f32_16x16x32_bf16 v[72:75], v[36:39], a[248:251], v[72:75]
s_add_u32 s52, s57, 131072
ds_read_b128 a[116:119], v0 offset:29696
v_mfma_f32_16x16x32_bf16 v[76:79], v[32:35], a[236:239], v[76:79]
s_add_u32 m0, s50, 8192
ds_read_b128 a[104:107], v0 offset:26624
v_mfma_f32_16x16x32_bf16 v[76:79], v[36:39], a[252:255], v[76:79]
s_waitcnt vmcnt(8) lgkmcnt(5)
v_mfma_f32_16x16x32_bf16 v[80:83], v[40:43], a[224:227], v[80:83]
ds_read_b64_tr_b16 v[32:33], v6 offset:16384
ds_read_b64_tr_b16 v[34:35], v6 offset:18432
v_mfma_f32_16x16x32_bf16 v[80:83], v[44:47], a[240:243], v[80:83]
buffer_load_dwordx4 v18, s[28:31], s52 offen lds
v_mfma_f32_16x16x32_bf16 v[84:87], v[40:43], a[228:231], v[84:87]
ds_read_b64_tr_b16 v[36:37], v6 offset:20480
ds_read_b64_tr_b16 v[38:39], v6 offset:22528
v_mfma_f32_16x16x32_bf16 v[84:87], v[44:47], a[244:247], v[84:87]
buffer_load_dwordx4 v19, s[28:31], s52 offen offset:1024 lds
v_mfma_f32_16x16x32_bf16 v[88:91], v[40:43], a[232:235], v[88:91]
ds_read_b128 a[120:123], v0 offset:30720
v_mfma_f32_16x16x32_bf16 v[88:91], v[44:47], a[248:251], v[88:91]
buffer_load_dwordx4 v20, s[28:31], s52 offen offset:2048 lds
v_mfma_f32_16x16x32_bf16 v[92:95], v[40:43], a[236:239], v[92:95]
ds_read_b128 a[108:111], v0 offset:27648
v_mfma_f32_16x16x32_bf16 v[92:95], v[44:47], a[252:255], v[92:95]
v_mfma_f32_16x16x32_bf16 v[96:99], v[48:51], a[224:227], v[96:99]
s_add_u32 s53, s52, 32768
ds_read_b64_tr_b16 v[40:41], v7 offset:16384
ds_read_b64_tr_b16 v[42:43], v7 offset:18432
v_mfma_f32_16x16x32_bf16 v[96:99], v[52:55], a[240:243], v[96:99]
buffer_load_dwordx4 v21, s[28:31], s52 offen offset:3072 lds
v_mfma_f32_16x16x32_bf16 v[100:103], v[48:51], a[228:231], v[100:103]
s_add_u32 m0, s50, 12288
ds_read_b64_tr_b16 v[44:45], v7 offset:20480
ds_read_b64_tr_b16 v[46:47], v7 offset:22528
v_mfma_f32_16x16x32_bf16 v[100:103], v[52:55], a[244:247], v[100:103]
buffer_load_dwordx4 v18, s[28:31], s53 offen lds
v_mfma_f32_16x16x32_bf16 v[104:107], v[48:51], a[232:235], v[104:107]
ds_read_b128 a[124:127], v0 offset:31744
v_mfma_f32_16x16x32_bf16 v[104:107], v[52:55], a[248:251], v[104:107]
buffer_load_dwordx4 v19, s[28:31], s53 offen offset:1024 lds
v_mfma_f32_16x16x32_bf16 v[108:111], v[48:51], a[236:239], v[108:111]
v_mfma_f32_16x16x32_bf16 v[108:111], v[52:55], a[252:255], v[108:111]
v_mfma_f32_16x16x32_bf16 v[112:115], v[56:59], a[224:227], v[112:115]
ds_read_b64_tr_b16 v[48:49], v8 offset:16384
ds_read_b64_tr_b16 v[50:51], v8 offset:18432
v_mfma_f32_16x16x32_bf16 v[112:115], v[60:63], a[240:243], v[112:115]
buffer_load_dwordx4 v20, s[28:31], s53 offen offset:2048 lds
v_mfma_f32_16x16x32_bf16 v[116:119], v[56:59], a[228:231], v[116:119]
ds_read_b64_tr_b16 v[52:53], v8 offset:20480
ds_read_b64_tr_b16 v[54:55], v8 offset:22528
v_mfma_f32_16x16x32_bf16 v[116:119], v[60:63], a[244:247], v[116:119]
buffer_load_dwordx4 v21, s[28:31], s53 offen offset:3072 lds
v_mfma_f32_16x16x32_bf16 v[120:123], v[56:59], a[232:235], v[120:123]
v_mfma_f32_16x16x32_bf16 v[120:123], v[60:63], a[248:251], v[120:123]
v_mfma_f32_16x16x32_bf16 v[124:127], v[56:59], a[236:239], v[124:127]
v_mfma_f32_16x16x32_bf16 v[124:127], v[60:63], a[252:255], v[124:127]
s_waitcnt lgkmcnt(11)
v_mfma_f32_16x16x32_bf16 v[192:195], v[32:35], a[0:3], 0
ds_read_b64_tr_b16 v[56:57], v9 offset:16384
ds_read_b64_tr_b16 v[58:59], v9 offset:18432
v_mfma_f32_16x16x32_bf16 v[192:195], v[36:39], a[16:19], v[192:195]
ds_read_b64_tr_b16 v[60:61], v9 offset:20480
ds_read_b64_tr_b16 v[62:63], v9 offset:22528
v_mul_f32 v64, 0x3e0293ee, v64
v_mfma_f32_16x16x32_bf16 v[196:199], v[32:35], a[4:7], 0
v_mul_f32 v65, 0x3e0293ee, v65
v_mul_f32 v66, 0x3e0293ee, v66
v_mfma_f32_16x16x32_bf16 v[196:199], v[36:39], a[20:23], v[196:199]
s_waitcnt lgkmcnt(8)
s_barrier
v_mul_f32 v67, 0x3e0293ee, v67
v_mul_f32 v80, 0x3e0293ee, v80
v_mul_f32 v81, 0x3e0293ee, v81
v_mfma_f32_16x16x32_bf16 v[200:203], v[32:35], a[8:11], 0
v_mul_f32 v82, 0x3e0293ee, v82
v_mul_f32 v83, 0x3e0293ee, v83
v_cvt_pk_bf16_f32 v136, v64, v65
v_mfma_f32_16x16x32_bf16 v[200:203], v[36:39], a[24:27], v[200:203]
s_add_u32 s52, s58, 196608
v_cvt_pk_bf16_f32 v137, v66, v67
v_cvt_pk_bf16_f32 v138, v80, v81
v_mfma_f32_16x16x32_bf16 v[204:207], v[32:35], a[12:15], 0
s_add_u32 m0, s50, 16384
v_cvt_pk_bf16_f32 v139, v82, v83
v_mul_f32 v68, 0x3e0293ee, v68
v_mul_f32 v69, 0x3e0293ee, v69
v_mfma_f32_16x16x32_bf16 v[204:207], v[36:39], a[28:31], v[204:207]
s_waitcnt vmcnt(8) lgkmcnt(0)
v_mul_f32 v70, 0x3e0293ee, v70
v_mul_f32 v71, 0x3e0293ee, v71
v_mul_f32 v84, 0x3e0293ee, v84
v_mfma_f32_16x16x32_bf16 v[208:211], v[40:43], a[0:3], 0
ds_read_b64_tr_b16 v[32:33], v6 offset:0
ds_read_b64_tr_b16 v[34:35], v6 offset:2048
v_mfma_f32_16x16x32_bf16 v[208:211], v[44:47], a[16:19], v[208:211]
buffer_load_dwordx4 v18, s[28:31], s52 offen lds
v_mfma_f32_16x16x32_bf16 v[212:215], v[40:43], a[4:7], 0
s_lshl_b32 s47, s5, 15
ds_read_b64_tr_b16 v[36:37], v6 offset:4096
ds_read_b64_tr_b16 v[38:39], v6 offset:6144
v_mul_f32 v85, 0x3e0293ee, v85
v_mfma_f32_16x16x32_bf16 v[212:215], v[44:47], a[20:23], v[212:215]
buffer_load_dwordx4 v19, s[28:31], s52 offen offset:1024 lds
v_mfma_f32_16x16x32_bf16 v[216:219], v[40:43], a[8:11], 0
s_sub_u32 s47, s47, 8192
v_mul_f32 v86, 0x3e0293ee, v86
v_mul_f32 v87, 0x3e0293ee, v87
v_mfma_f32_16x16x32_bf16 v[216:219], v[44:47], a[24:27], v[216:219]
buffer_load_dwordx4 v20, s[28:31], s52 offen offset:2048 lds
v_mfma_f32_16x16x32_bf16 v[220:223], v[40:43], a[12:15], 0
v_permlane32_swap_b32 v136, v138
v_mfma_f32_16x16x32_bf16 v[220:223], v[44:47], a[28:31], v[220:223]
v_permlane32_swap_b32 v137, v139
s_nop 0
v_mfma_f32_16x16x32_bf16 v[224:227], v[48:51], a[0:3], 0
s_add_u32 s53, s52, 32768
ds_read_b64_tr_b16 v[40:41], v7 offset:0
ds_read_b64_tr_b16 v[42:43], v7 offset:2048
v_permlane16_swap_b32 v136, v138
v_mfma_f32_16x16x32_bf16 v[224:227], v[52:55], a[16:19], v[224:227]
buffer_load_dwordx4 v21, s[28:31], s52 offen offset:3072 lds
v_mfma_f32_16x16x32_bf16 v[228:231], v[48:51], a[4:7], 0
s_add_u32 m0, s50, 20480
ds_read_b64_tr_b16 v[44:45], v7 offset:4096
ds_read_b64_tr_b16 v[46:47], v7 offset:6144
v_mfma_f32_16x16x32_bf16 v[228:231], v[52:55], a[20:23], v[228:231]
buffer_load_dwordx4 v18, s[28:31], s53 offen lds
v_mfma_f32_16x16x32_bf16 v[232:235], v[48:51], a[8:11], 0
v_permlane16_swap_b32 v137, v139
v_cvt_pk_bf16_f32 v152, v68, v69
v_mfma_f32_16x16x32_bf16 v[232:235], v[52:55], a[24:27], v[232:235]
buffer_load_dwordx4 v19, s[28:31], s53 offen offset:1024 lds
v_mfma_f32_16x16x32_bf16 v[236:239], v[48:51], a[12:15], 0
v_cvt_pk_bf16_f32 v153, v70, v71
v_cvt_pk_bf16_f32 v154, v84, v85
v_cvt_pk_bf16_f32 v155, v86, v87
v_mfma_f32_16x16x32_bf16 v[236:239], v[52:55], a[28:31], v[236:239]
v_mul_f32 v72, 0x3e0293ee, v72
v_mul_f32 v73, 0x3e0293ee, v73
v_mfma_f32_16x16x32_bf16 v[240:243], v[56:59], a[0:3], 0
ds_read_b64_tr_b16 v[48:49], v8 offset:0
ds_read_b64_tr_b16 v[50:51], v8 offset:2048
v_mul_f32 v74, 0x3e0293ee, v74
v_mfma_f32_16x16x32_bf16 v[240:243], v[60:63], a[16:19], v[240:243]
buffer_load_dwordx4 v20, s[28:31], s53 offen offset:2048 lds
v_mfma_f32_16x16x32_bf16 v[244:247], v[56:59], a[4:7], 0
ds_read_b64_tr_b16 v[52:53], v8 offset:4096
ds_read_b64_tr_b16 v[54:55], v8 offset:6144
v_mul_f32 v75, 0x3e0293ee, v75
v_mfma_f32_16x16x32_bf16 v[244:247], v[60:63], a[20:23], v[244:247]
buffer_load_dwordx4 v21, s[28:31], s53 offen offset:3072 lds
v_mfma_f32_16x16x32_bf16 v[248:251], v[56:59], a[8:11], 0
v_mul_f32 v88, 0x3e0293ee, v88
v_mul_f32 v89, 0x3e0293ee, v89
v_mfma_f32_16x16x32_bf16 v[248:251], v[60:63], a[24:27], v[248:251]
v_mul_f32 v90, 0x3e0293ee, v90
v_mul_f32 v91, 0x3e0293ee, v91
v_mfma_f32_16x16x32_bf16 v[252:255], v[56:59], a[12:15], 0
v_permlane32_swap_b32 v152, v154
v_permlane32_swap_b32 v153, v155
v_mfma_f32_16x16x32_bf16 v[252:255], v[60:63], a[28:31], v[252:255]
s_waitcnt lgkmcnt(8)
s_nop 0
v_permlane16_swap_b32 v152, v154
v_mfma_f32_16x16x32_bf16 v[192:195], v[32:35], a[32:35], v[192:195]
ds_read_b64_tr_b16 v[56:57], v9 offset:0
ds_read_b64_tr_b16 v[58:59], v9 offset:2048
v_mfma_f32_16x16x32_bf16 v[192:195], v[36:39], a[48:51], v[192:195]
ds_read_b64_tr_b16 v[60:61], v9 offset:4096
ds_read_b64_tr_b16 v[62:63], v9 offset:6144
v_mfma_f32_16x16x32_bf16 v[196:199], v[32:35], a[36:39], v[196:199]
v_permlane16_swap_b32 v153, v155
v_cvt_pk_bf16_f32 v168, v72, v73
v_cvt_pk_bf16_f32 v169, v74, v75
v_mfma_f32_16x16x32_bf16 v[196:199], v[36:39], a[52:55], v[196:199]
v_cvt_pk_bf16_f32 v170, v88, v89
v_cvt_pk_bf16_f32 v171, v90, v91
v_mul_f32 v76, 0x3e0293ee, v76
v_mfma_f32_16x16x32_bf16 v[200:203], v[32:35], a[40:43], v[200:203]
v_mul_f32 v77, 0x3e0293ee, v77
v_mul_f32 v78, 0x3e0293ee, v78
v_mul_f32 v79, 0x3e0293ee, v79
v_mfma_f32_16x16x32_bf16 v[200:203], v[36:39], a[56:59], v[200:203]
s_add_u32 s52, s57, 128
v_mul_f32 v92, 0x3e0293ee, v92
v_mul_f32 v93, 0x3e0293ee, v93
v_mul_f32 v94, 0x3e0293ee, v94
v_mfma_f32_16x16x32_bf16 v[204:207], v[32:35], a[44:47], v[204:207]
s_add_u32 m0, s50, 0
v_mul_f32 v95, 0x3e0293ee, v95
v_permlane32_swap_b32 v168, v170
v_mfma_f32_16x16x32_bf16 v[204:207], v[36:39], a[60:63], v[204:207]
s_waitcnt vmcnt(8) lgkmcnt(0)
v_permlane32_swap_b32 v169, v171
v_mfma_f32_16x16x32_bf16 v[208:211], v[40:43], a[32:35], v[208:211]
ds_read_b64_tr_b16 v[32:33], v6 offset:8192
ds_read_b64_tr_b16 v[34:35], v6 offset:10240
s_nop 0
v_mfma_f32_16x16x32_bf16 v[208:211], v[44:47], a[48:51], v[208:211]
buffer_load_dwordx4 v18, s[28:31], s52 offen lds
v_mfma_f32_16x16x32_bf16 v[212:215], v[40:43], a[36:39], v[212:215]
ds_read_b64_tr_b16 v[36:37], v6 offset:12288
ds_read_b64_tr_b16 v[38:39], v6 offset:14336
v_mfma_f32_16x16x32_bf16 v[212:215], v[44:47], a[52:55], v[212:215]
buffer_load_dwordx4 v19, s[28:31], s52 offen offset:1024 lds
v_mfma_f32_16x16x32_bf16 v[216:219], v[40:43], a[40:43], v[216:219]
v_permlane16_swap_b32 v168, v170
v_permlane16_swap_b32 v169, v171
v_mfma_f32_16x16x32_bf16 v[216:219], v[44:47], a[56:59], v[216:219]
buffer_load_dwordx4 v20, s[28:31], s52 offen offset:2048 lds
v_mfma_f32_16x16x32_bf16 v[220:223], v[40:43], a[44:47], v[220:223]
v_cvt_pk_bf16_f32 v184, v76, v77
v_cvt_pk_bf16_f32 v185, v78, v79
v_cvt_pk_bf16_f32 v186, v92, v93
v_mfma_f32_16x16x32_bf16 v[220:223], v[44:47], a[60:63], v[220:223]
v_cvt_pk_bf16_f32 v187, v94, v95
v_mul_f32 v96, 0x3e0293ee, v96
v_mfma_f32_16x16x32_bf16 v[224:227], v[48:51], a[32:35], v[224:227]
s_add_u32 s53, s52, 32768
ds_read_b64_tr_b16 v[40:41], v7 offset:8192
ds_read_b64_tr_b16 v[42:43], v7 offset:10240
v_mul_f32 v97, 0x3e0293ee, v97
v_mfma_f32_16x16x32_bf16 v[224:227], v[52:55], a[48:51], v[224:227]
buffer_load_dwordx4 v21, s[28:31], s52 offen offset:3072 lds
v_mfma_f32_16x16x32_bf16 v[228:231], v[48:51], a[36:39], v[228:231]
s_add_u32 m0, s50, 4096
ds_read_b64_tr_b16 v[44:45], v7 offset:12288
ds_read_b64_tr_b16 v[46:47], v7 offset:14336
v_mul_f32 v98, 0x3e0293ee, v98
v_mfma_f32_16x16x32_bf16 v[228:231], v[52:55], a[52:55], v[228:231]
buffer_load_dwordx4 v18, s[28:31], s53 offen lds
v_mfma_f32_16x16x32_bf16 v[232:235], v[48:51], a[40:43], v[232:235]
s_add_u32 s44, s47, 8192
v_mul_f32 v99, 0x3e0293ee, v99
v_mul_f32 v112, 0x3e0293ee, v112
v_mul_f32 v113, 0x3e0293ee, v113
v_mfma_f32_16x16x32_bf16 v[232:235], v[52:55], a[56:59], v[232:235]
buffer_load_dwordx4 v19, s[28:31], s53 offen offset:1024 lds
v_mfma_f32_16x16x32_bf16 v[236:239], v[48:51], a[44:47], v[236:239]
s_and_b32 s44, s44, 0x7ffff
v_mul_f32 v114, 0x3e0293ee, v114
v_mul_f32 v115, 0x3e0293ee, v115
v_mfma_f32_16x16x32_bf16 v[236:239], v[52:55], a[60:63], v[236:239]
v_permlane32_swap_b32 v184, v186
v_permlane32_swap_b32 v185, v187
v_mfma_f32_16x16x32_bf16 v[240:243], v[56:59], a[32:35], v[240:243]
ds_read_b64_tr_b16 v[48:49], v8 offset:8192
ds_read_b64_tr_b16 v[50:51], v8 offset:10240
v_mfma_f32_16x16x32_bf16 v[240:243], v[60:63], a[48:51], v[240:243]
buffer_load_dwordx4 v20, s[28:31], s53 offen offset:2048 lds
v_mfma_f32_16x16x32_bf16 v[244:247], v[56:59], a[36:39], v[244:247]
ds_read_b64_tr_b16 v[52:53], v8 offset:12288
ds_read_b64_tr_b16 v[54:55], v8 offset:14336
s_nop 0
v_mfma_f32_16x16x32_bf16 v[244:247], v[60:63], a[52:55], v[244:247]
buffer_load_dwordx4 v21, s[28:31], s53 offen offset:3072 lds
v_mfma_f32_16x16x32_bf16 v[248:251], v[56:59], a[40:43], v[248:251]
s_add_u32 m0, s48, 32768
v_permlane16_swap_b32 v184, v186
v_mfma_f32_16x16x32_bf16 v[248:251], v[60:63], a[56:59], v[248:251]
buffer_load_dwordx4 v22, s[8:11], s44 offen lds
v_permlane16_swap_b32 v185, v187
v_mfma_f32_16x16x32_bf16 v[252:255], v[56:59], a[44:47], v[252:255]
buffer_load_dwordx4 v23, s[8:11], s44 offen offset:1024 lds
v_cvt_pk_bf16_f32 v140, v96, v97
v_mfma_f32_16x16x32_bf16 v[252:255], v[60:63], a[60:63], v[252:255]
s_waitcnt lgkmcnt(8)
v_cvt_pk_bf16_f32 v141, v98, v99
v_cvt_pk_bf16_f32 v142, v112, v113
v_cvt_pk_bf16_f32 v143, v114, v115
v_mfma_f32_16x16x32_bf16 v[192:195], v[32:35], a[64:67], v[192:195]
ds_read_b64_tr_b16 v[56:57], v9 offset:8192
ds_read_b64_tr_b16 v[58:59], v9 offset:10240
v_mfma_f32_16x16x32_bf16 v[192:195], v[36:39], a[80:83], v[192:195]
ds_read_b64_tr_b16 v[60:61], v9 offset:12288
ds_read_b64_tr_b16 v[62:63], v9 offset:14336
v_mul_f32 v100, 0x3e0293ee, v100
v_mfma_f32_16x16x32_bf16 v[196:199], v[32:35], a[68:71], v[196:199]
v_mul_f32 v101, 0x3e0293ee, v101
v_mul_f32 v102, 0x3e0293ee, v102
v_mul_f32 v103, 0x3e0293ee, v103
v_mfma_f32_16x16x32_bf16 v[196:199], v[36:39], a[84:87], v[196:199]
v_mul_f32 v116, 0x3e0293ee, v116
v_mul_f32 v117, 0x3e0293ee, v117
v_mul_f32 v118, 0x3e0293ee, v118
v_mfma_f32_16x16x32_bf16 v[200:203], v[32:35], a[72:75], v[200:203]
v_mul_f32 v119, 0x3e0293ee, v119
v_permlane32_swap_b32 v140, v142
v_mfma_f32_16x16x32_bf16 v[200:203], v[36:39], a[88:91], v[200:203]
s_add_u32 s52, s57, 65664
v_permlane32_swap_b32 v141, v143
s_nop 0
v_mfma_f32_16x16x32_bf16 v[204:207], v[32:35], a[76:79], v[204:207]
s_add_u32 m0, s50, 8192
v_permlane16_swap_b32 v140, v142
v_mfma_f32_16x16x32_bf16 v[204:207], v[36:39], a[92:95], v[204:207]
s_waitcnt vmcnt(10) lgkmcnt(0)
v_permlane16_swap_b32 v141, v143
v_cvt_pk_bf16_f32 v156, v100, v101
v_mfma_f32_16x16x32_bf16 v[208:211], v[40:43], a[64:67], v[208:211]
ds_read_b64_tr_b16 v[32:33], v6 offset:16384
ds_read_b64_tr_b16 v[34:35], v6 offset:18432
v_cvt_pk_bf16_f32 v157, v102, v103
v_mfma_f32_16x16x32_bf16 v[208:211], v[44:47], a[80:83], v[208:211]
buffer_load_dwordx4 v18, s[28:31], s52 offen lds
v_mfma_f32_16x16x32_bf16 v[212:215], v[40:43], a[68:71], v[212:215]
ds_read_b64_tr_b16 v[36:37], v6 offset:20480
ds_read_b64_tr_b16 v[38:39], v6 offset:22528
v_cvt_pk_bf16_f32 v158, v116, v117
v_mfma_f32_16x16x32_bf16 v[212:215], v[44:47], a[84:87], v[212:215]
buffer_load_dwordx4 v19, s[28:31], s52 offen offset:1024 lds
v_mfma_f32_16x16x32_bf16 v[216:219], v[40:43], a[72:75], v[216:219]
v_cvt_pk_bf16_f32 v159, v118, v119
v_mul_f32 v104, 0x3e0293ee, v104
v_mul_f32 v105, 0x3e0293ee, v105
v_mfma_f32_16x16x32_bf16 v[216:219], v[44:47], a[88:91], v[216:219]
buffer_load_dwordx4 v20, s[28:31], s52 offen offset:2048 lds
v_mfma_f32_16x16x32_bf16 v[220:223], v[40:43], a[76:79], v[220:223]
v_mul_f32 v106, 0x3e0293ee, v106
v_mul_f32 v107, 0x3e0293ee, v107
v_mul_f32 v120, 0x3e0293ee, v120
v_mfma_f32_16x16x32_bf16 v[220:223], v[44:47], a[92:95], v[220:223]
v_mul_f32 v121, 0x3e0293ee, v121
v_mul_f32 v122, 0x3e0293ee, v122
v_mfma_f32_16x16x32_bf16 v[224:227], v[48:51], a[64:67], v[224:227]
s_add_u32 s53, s52, 32768
ds_read_b64_tr_b16 v[40:41], v7 offset:16384
ds_read_b64_tr_b16 v[42:43], v7 offset:18432
v_mul_f32 v123, 0x3e0293ee, v123
v_mfma_f32_16x16x32_bf16 v[224:227], v[52:55], a[80:83], v[224:227]
buffer_load_dwordx4 v21, s[28:31], s52 offen offset:3072 lds
v_mfma_f32_16x16x32_bf16 v[228:231], v[48:51], a[68:71], v[228:231]
s_add_u32 m0, s50, 12288
ds_read_b64_tr_b16 v[44:45], v7 offset:20480
ds_read_b64_tr_b16 v[46:47], v7 offset:22528
v_mfma_f32_16x16x32_bf16 v[228:231], v[52:55], a[84:87], v[228:231]
buffer_load_dwordx4 v18, s[28:31], s53 offen lds
v_mfma_f32_16x16x32_bf16 v[232:235], v[48:51], a[72:75], v[232:235]
s_add_u32 s45, s44, 8192
v_permlane32_swap_b32 v156, v158
v_permlane32_swap_b32 v157, v159
v_mfma_f32_16x16x32_bf16 v[232:235], v[52:55], a[88:91], v[232:235]
buffer_load_dwordx4 v19, s[28:31], s53 offen offset:1024 lds
v_mfma_f32_16x16x32_bf16 v[236:239], v[48:51], a[76:79], v[236:239]
s_and_b32 s45, s45, 0x7ffff
s_nop 0
v_permlane16_swap_b32 v156, v158
v_mfma_f32_16x16x32_bf16 v[236:239], v[52:55], a[92:95], v[236:239]
v_permlane16_swap_b32 v157, v159
v_cvt_pk_bf16_f32 v172, v104, v105
v_mfma_f32_16x16x32_bf16 v[240:243], v[56:59], a[64:67], v[240:243]
ds_read_b64_tr_b16 v[48:49], v8 offset:16384
ds_read_b64_tr_b16 v[50:51], v8 offset:18432
v_mfma_f32_16x16x32_bf16 v[240:243], v[60:63], a[80:83], v[240:243]
buffer_load_dwordx4 v20, s[28:31], s53 offen offset:2048 lds
v_mfma_f32_16x16x32_bf16 v[244:247], v[56:59], a[68:71], v[244:247]
ds_read_b64_tr_b16 v[52:53], v8 offset:20480
ds_read_b64_tr_b16 v[54:55], v8 offset:22528
v_cvt_pk_bf16_f32 v173, v106, v107
v_mfma_f32_16x16x32_bf16 v[244:247], v[60:63], a[84:87], v[244:247]
buffer_load_dwordx4 v21, s[28:31], s53 offen offset:3072 lds
v_mfma_f32_16x16x32_bf16 v[248:251], v[56:59], a[72:75], v[248:251]
s_add_u32 m0, s48, 49152
v_cvt_pk_bf16_f32 v174, v120, v121
v_cvt_pk_bf16_f32 v175, v122, v123
v_mul_f32 v108, 0x3e0293ee, v108
v_mfma_f32_16x16x32_bf16 v[248:251], v[60:63], a[88:91], v[248:251]
buffer_load_dwordx4 v22, s[8:11], s45 offen lds
v_mul_f32 v109, 0x3e0293ee, v109
v_mfma_f32_16x16x32_bf16 v[252:255], v[56:59], a[76:79], v[252:255]
buffer_load_dwordx4 v23, s[8:11], s45 offen offset:1024 lds
v_mul_f32 v110, 0x3e0293ee, v110
v_mfma_f32_16x16x32_bf16 v[252:255], v[60:63], a[92:95], v[252:255]
s_waitcnt lgkmcnt(8)
v_mul_f32 v111, 0x3e0293ee, v111
v_mul_f32 v124, 0x3e0293ee, v124
v_mul_f32 v125, 0x3e0293ee, v125
v_mfma_f32_16x16x32_bf16 v[192:195], v[32:35], a[96:99], v[192:195]
ds_read_b64_tr_b16 v[56:57], v9 offset:16384
ds_read_b64_tr_b16 v[58:59], v9 offset:18432
v_mfma_f32_16x16x32_bf16 v[192:195], v[36:39], a[112:115], v[192:195]
ds_read_b64_tr_b16 v[60:61], v9 offset:20480
ds_read_b64_tr_b16 v[62:63], v9 offset:22528
v_mfma_f32_16x16x32_bf16 v[196:199], v[32:35], a[100:103], v[196:199]
v_mul_f32 v126, 0x3e0293ee, v126
v_mul_f32 v127, 0x3e0293ee, v127
v_mfma_f32_16x16x32_bf16 v[196:199], v[36:39], a[116:119], v[196:199]
v_permlane32_swap_b32 v172, v174
v_mfma_f32_16x16x32_bf16 v[200:203], v[32:35], a[104:107], v[200:203]
v_permlane32_swap_b32 v173, v175
v_mfma_f32_16x16x32_bf16 v[200:203], v[36:39], a[120:123], v[200:203]
s_add_u32 s52, s57, 131200
s_nop 0
v_mfma_f32_16x16x32_bf16 v[204:207], v[32:35], a[108:111], v[204:207]
s_add_u32 m0, s50, 16384
v_permlane16_swap_b32 v172, v174
v_mfma_f32_16x16x32_bf16 v[204:207], v[36:39], a[124:127], v[204:207]
s_waitcnt vmcnt(12) lgkmcnt(0)
v_permlane16_swap_b32 v173, v175
v_mfma_f32_16x16x32_bf16 v[208:211], v[40:43], a[96:99], v[208:211]
ds_read_b64_tr_b16 v[32:33], v6 offset:0
ds_read_b64_tr_b16 v[34:35], v6 offset:2048
v_mfma_f32_16x16x32_bf16 v[208:211], v[44:47], a[112:115], v[208:211]
buffer_load_dwordx4 v18, s[28:31], s52 offen lds
v_mfma_f32_16x16x32_bf16 v[212:215], v[40:43], a[100:103], v[212:215]
ds_read_b64_tr_b16 v[36:37], v6 offset:4096
ds_read_b64_tr_b16 v[38:39], v6 offset:6144
v_mfma_f32_16x16x32_bf16 v[212:215], v[44:47], a[116:119], v[212:215]
buffer_load_dwordx4 v19, s[28:31], s52 offen offset:1024 lds
v_mfma_f32_16x16x32_bf16 v[216:219], v[40:43], a[104:107], v[216:219]
v_cvt_pk_bf16_f32 v188, v108, v109
v_cvt_pk_bf16_f32 v189, v110, v111
v_mfma_f32_16x16x32_bf16 v[216:219], v[44:47], a[120:123], v[216:219]
buffer_load_dwordx4 v20, s[28:31], s52 offen offset:2048 lds
v_mfma_f32_16x16x32_bf16 v[220:223], v[40:43], a[108:111], v[220:223]
v_cvt_pk_bf16_f32 v190, v124, v125
v_cvt_pk_bf16_f32 v191, v126, v127
v_mfma_f32_16x16x32_bf16 v[220:223], v[44:47], a[124:127], v[220:223]
s_nop 1
v_mfma_f32_16x16x32_bf16 v[224:227], v[48:51], a[96:99], v[224:227]
s_add_u32 s53, s52, 32768
ds_read_b64_tr_b16 v[40:41], v7 offset:0
ds_read_b64_tr_b16 v[42:43], v7 offset:2048
v_mfma_f32_16x16x32_bf16 v[224:227], v[52:55], a[112:115], v[224:227]
buffer_load_dwordx4 v21, s[28:31], s52 offen offset:3072 lds
v_mfma_f32_16x16x32_bf16 v[228:231], v[48:51], a[100:103], v[228:231]
s_add_u32 m0, s50, 20480
ds_read_b64_tr_b16 v[44:45], v7 offset:4096
ds_read_b64_tr_b16 v[46:47], v7 offset:6144
v_mfma_f32_16x16x32_bf16 v[228:231], v[52:55], a[116:119], v[228:231]
buffer_load_dwordx4 v18, s[28:31], s53 offen lds
v_mfma_f32_16x16x32_bf16 v[232:235], v[48:51], a[104:107], v[232:235]
v_permlane32_swap_b32 v188, v190
v_mfma_f32_16x16x32_bf16 v[232:235], v[52:55], a[120:123], v[232:235]
buffer_load_dwordx4 v19, s[28:31], s53 offen offset:1024 lds
v_mfma_f32_16x16x32_bf16 v[236:239], v[48:51], a[108:111], v[236:239]
v_permlane32_swap_b32 v189, v191
v_mfma_f32_16x16x32_bf16 v[236:239], v[52:55], a[124:127], v[236:239]
s_nop 0
v_mfma_f32_16x16x32_bf16 v[240:243], v[56:59], a[96:99], v[240:243]
ds_read_b64_tr_b16 v[48:49], v8 offset:0
ds_read_b64_tr_b16 v[50:51], v8 offset:2048
v_mfma_f32_16x16x32_bf16 v[240:243], v[60:63], a[112:115], v[240:243]
buffer_load_dwordx4 v20, s[28:31], s53 offen offset:2048 lds
v_mfma_f32_16x16x32_bf16 v[244:247], v[56:59], a[100:103], v[244:247]
ds_read_b64_tr_b16 v[52:53], v8 offset:4096
ds_read_b64_tr_b16 v[54:55], v8 offset:6144
v_mfma_f32_16x16x32_bf16 v[244:247], v[60:63], a[116:119], v[244:247]
buffer_load_dwordx4 v21, s[28:31], s53 offen offset:3072 lds
v_mfma_f32_16x16x32_bf16 v[248:251], v[56:59], a[104:107], v[248:251]
v_permlane16_swap_b32 v188, v190
v_mfma_f32_16x16x32_bf16 v[248:251], v[60:63], a[120:123], v[248:251]
v_permlane16_swap_b32 v189, v191
v_mfma_f32_16x16x32_bf16 v[252:255], v[56:59], a[108:111], v[252:255]
v_mfma_f32_16x16x32_bf16 v[252:255], v[60:63], a[124:127], v[252:255]
s_waitcnt lgkmcnt(8)
v_mfma_f32_16x16x32_bf16 v[64:67], v[32:35], a[0:3], 0
ds_read_b64_tr_b16 v[56:57], v9 offset:0
ds_read_b64_tr_b16 v[58:59], v9 offset:2048
v_mfma_f32_16x16x32_bf16 v[64:67], v[36:39], a[16:19], v[64:67]
ds_read_b64_tr_b16 v[60:61], v9 offset:4096
ds_read_b64_tr_b16 v[62:63], v9 offset:6144
v_cvt_pk_bf16_f32 v192, v192, v193
v_mfma_f32_16x16x32_bf16 v[68:71], v[32:35], a[4:7], 0
v_cvt_pk_bf16_f32 v193, v194, v195
v_cvt_pk_bf16_f32 v194, v208, v209
v_mfma_f32_16x16x32_bf16 v[68:71], v[36:39], a[20:23], v[68:71]
v_cvt_pk_bf16_f32 v195, v210, v211
v_accvgpr_write_b32 a128, v192
v_accvgpr_write_b32 a129, v193
v_mfma_f32_16x16x32_bf16 v[72:75], v[32:35], a[8:11], 0
v_accvgpr_write_b32 a130, v194
v_accvgpr_write_b32 a131, v195
v_cvt_pk_bf16_f32 v196, v196, v197
v_mfma_f32_16x16x32_bf16 v[72:75], v[36:39], a[24:27], v[72:75]
s_add_u32 s52, s58, 196736
v_cvt_pk_bf16_f32 v197, v198, v199
v_cvt_pk_bf16_f32 v198, v212, v213
v_mfma_f32_16x16x32_bf16 v[76:79], v[32:35], a[12:15], 0
s_add_u32 m0, s50, 0
v_cvt_pk_bf16_f32 v199, v214, v215
v_accvgpr_write_b32 a132, v196
v_accvgpr_write_b32 a133, v197
v_mfma_f32_16x16x32_bf16 v[76:79], v[36:39], a[28:31], v[76:79]
s_waitcnt vmcnt(10) lgkmcnt(0)
v_accvgpr_write_b32 a134, v198
v_accvgpr_write_b32 a135, v199
v_cvt_pk_bf16_f32 v200, v200, v201
v_mfma_f32_16x16x32_bf16 v[80:83], v[40:43], a[0:3], 0
ds_read_b64_tr_b16 v[32:33], v6 offset:8192
ds_read_b64_tr_b16 v[34:35], v6 offset:10240
v_mfma_f32_16x16x32_bf16 v[80:83], v[44:47], a[16:19], v[80:83]
buffer_load_dwordx4 v18, s[28:31], s52 offen lds
v_mfma_f32_16x16x32_bf16 v[84:87], v[40:43], a[4:7], 0
ds_read_b64_tr_b16 v[36:37], v6 offset:12288
ds_read_b64_tr_b16 v[38:39], v6 offset:14336
v_cvt_pk_bf16_f32 v201, v202, v203
v_mfma_f32_16x16x32_bf16 v[84:87], v[44:47], a[20:23], v[84:87]
buffer_load_dwordx4 v19, s[28:31], s52 offen offset:1024 lds
v_mfma_f32_16x16x32_bf16 v[88:91], v[40:43], a[8:11], 0
v_cvt_pk_bf16_f32 v202, v216, v217
v_cvt_pk_bf16_f32 v203, v218, v219
v_accvgpr_write_b32 a136, v200
v_mfma_f32_16x16x32_bf16 v[88:91], v[44:47], a[24:27], v[88:91]
buffer_load_dwordx4 v20, s[28:31], s52 offen offset:2048 lds
v_mfma_f32_16x16x32_bf16 v[92:95], v[40:43], a[12:15], 0
v_accvgpr_write_b32 a137, v201
v_accvgpr_write_b32 a138, v202
v_mfma_f32_16x16x32_bf16 v[92:95], v[44:47], a[28:31], v[92:95]
v_accvgpr_write_b32 a139, v203
v_cvt_pk_bf16_f32 v204, v204, v205
v_cvt_pk_bf16_f32 v205, v206, v207
v_mfma_f32_16x16x32_bf16 v[96:99], v[48:51], a[0:3], 0
s_add_u32 s53, s52, 32768
ds_read_b64_tr_b16 v[40:41], v7 offset:8192
ds_read_b64_tr_b16 v[42:43], v7 offset:10240
v_cvt_pk_bf16_f32 v206, v220, v221
v_mfma_f32_16x16x32_bf16 v[96:99], v[52:55], a[16:19], v[96:99]
buffer_load_dwordx4 v21, s[28:31], s52 offen offset:3072 lds
v_mfma_f32_16x16x32_bf16 v[100:103], v[48:51], a[4:7], 0
s_add_u32 m0, s50, 4096
ds_read_b64_tr_b16 v[44:45], v7 offset:12288
ds_read_b64_tr_b16 v[46:47], v7 offset:14336
v_mfma_f32_16x16x32_bf16 v[100:103], v[52:55], a[20:23], v[100:103]
buffer_load_dwordx4 v18, s[28:31], s53 offen lds
v_mfma_f32_16x16x32_bf16 v[104:107], v[48:51], a[8:11], 0
v_cvt_pk_bf16_f32 v207, v222, v223
v_accvgpr_write_b32 a140, v204
v_accvgpr_write_b32 a141, v205
v_mfma_f32_16x16x32_bf16 v[104:107], v[52:55], a[24:27], v[104:107]
buffer_load_dwordx4 v19, s[28:31], s53 offen offset:1024 lds
v_mfma_f32_16x16x32_bf16 v[108:111], v[48:51], a[12:15], 0
v_accvgpr_write_b32 a142, v206
v_accvgpr_write_b32 a143, v207
v_cvt_pk_bf16_f32 v224, v224, v225
v_mfma_f32_16x16x32_bf16 v[108:111], v[52:55], a[28:31], v[108:111]
v_cvt_pk_bf16_f32 v225, v226, v227
v_cvt_pk_bf16_f32 v226, v240, v241
v_mfma_f32_16x16x32_bf16 v[112:115], v[56:59], a[0:3], 0
ds_read_b64_tr_b16 v[48:49], v8 offset:8192
ds_read_b64_tr_b16 v[50:51], v8 offset:10240
v_cvt_pk_bf16_f32 v227, v242, v243
v_mfma_f32_16x16x32_bf16 v[112:115], v[60:63], a[16:19], v[112:115]
buffer_load_dwordx4 v20, s[28:31], s53 offen offset:2048 lds
v_mfma_f32_16x16x32_bf16 v[116:119], v[56:59], a[4:7], 0
ds_read_b64_tr_b16 v[52:53], v8 offset:12288
ds_read_b64_tr_b16 v[54:55], v8 offset:14336
v_accvgpr_write_b32 a144, v224
v_mfma_f32_16x16x32_bf16 v[116:119], v[60:63], a[20:23], v[116:119]
buffer_load_dwordx4 v21, s[28:31], s53 offen offset:3072 lds
v_mfma_f32_16x16x32_bf16 v[120:123], v[56:59], a[8:11], 0
v_accvgpr_write_b32 a145, v225
v_accvgpr_write_b32 a146, v226
v_mfma_f32_16x16x32_bf16 v[120:123], v[60:63], a[24:27], v[120:123]
v_accvgpr_write_b32 a147, v227
v_cvt_pk_bf16_f32 v228, v228, v229
v_cvt_pk_bf16_f32 v229, v230, v231
v_mfma_f32_16x16x32_bf16 v[124:127], v[56:59], a[12:15], 0
v_cvt_pk_bf16_f32 v230, v244, v245
v_cvt_pk_bf16_f32 v231, v246, v247
v_accvgpr_write_b32 a148, v228
v_mfma_f32_16x16x32_bf16 v[124:127], v[60:63], a[28:31], v[124:127]
s_waitcnt lgkmcnt(8)
v_accvgpr_write_b32 a149, v229
v_accvgpr_write_b32 a150, v230
v_mfma_f32_16x16x32_bf16 v[64:67], v[32:35], a[32:35], v[64:67]
ds_read_b64_tr_b16 v[56:57], v9 offset:8192
ds_read_b64_tr_b16 v[58:59], v9 offset:10240
v_mfma_f32_16x16x32_bf16 v[64:67], v[36:39], a[48:51], v[64:67]
ds_read_b64_tr_b16 v[60:61], v9 offset:12288
ds_read_b64_tr_b16 v[62:63], v9 offset:14336
v_mfma_f32_16x16x32_bf16 v[68:71], v[32:35], a[36:39], v[68:71]
v_accvgpr_write_b32 a151, v231
v_cvt_pk_bf16_f32 v232, v232, v233
v_mfma_f32_16x16x32_bf16 v[68:71], v[36:39], a[52:55], v[68:71]
v_cvt_pk_bf16_f32 v233, v234, v235
v_cvt_pk_bf16_f32 v234, v248, v249
v_mfma_f32_16x16x32_bf16 v[72:75], v[32:35], a[40:43], v[72:75]
v_cvt_pk_bf16_f32 v235, v250, v251
v_accvgpr_write_b32 a152, v232
v_mfma_f32_16x16x32_bf16 v[72:75], v[36:39], a[56:59], v[72:75]
v_accvgpr_write_b32 a153, v233
v_accvgpr_write_b32 a154, v234
v_mfma_f32_16x16x32_bf16 v[76:79], v[32:35], a[44:47], v[76:79]
v_accvgpr_write_b32 a155, v235
v_cvt_pk_bf16_f32 v236, v236, v237
v_mfma_f32_16x16x32_bf16 v[76:79], v[36:39], a[60:63], v[76:79]
s_waitcnt vmcnt(8) lgkmcnt(0)
v_cvt_pk_bf16_f32 v237, v238, v239
v_cvt_pk_bf16_f32 v238, v252, v253
v_mfma_f32_16x16x32_bf16 v[80:83], v[40:43], a[32:35], v[80:83]
ds_read_b64_tr_b16 v[32:33], v6 offset:16384
ds_read_b64_tr_b16 v[34:35], v6 offset:18432
v_mfma_f32_16x16x32_bf16 v[80:83], v[44:47], a[48:51], v[80:83]
s_add_u32 s46, s45, 8192
v_cvt_pk_bf16_f32 v239, v254, v255
v_accvgpr_write_b32 a156, v236
v_mfma_f32_16x16x32_bf16 v[84:87], v[40:43], a[36:39], v[84:87]
s_and_b32 s46, s46, 0x7ffff
ds_read_b64_tr_b16 v[36:37], v6 offset:20480
ds_read_b64_tr_b16 v[38:39], v6 offset:22528
v_mfma_f32_16x16x32_bf16 v[84:87], v[44:47], a[52:55], v[84:87]
s_add_u32 m0, s48, 0
v_accvgpr_write_b32 a157, v237
v_accvgpr_write_b32 a158, v238
v_mfma_f32_16x16x32_bf16 v[88:91], v[40:43], a[40:43], v[88:91]
v_accvgpr_write_b32 a159, v239
v_bfe_u32 v26, v1, 6, 3
v_mfma_f32_16x16x32_bf16 v[88:91], v[44:47], a[56:59], v[88:91]
buffer_load_dwordx4 v22, s[8:11], s46 offen lds
v_mfma_f32_16x16x32_bf16 v[92:95], v[40:43], a[44:47], v[92:95]
v_lshrrev_b32 v28, 9, v1
v_lshlrev_b32 v28, 12, v28
v_mfma_f32_16x16x32_bf16 v[92:95], v[44:47], a[60:63], v[92:95]
v_lshl_add_u32 v28, v26, 8, v28
v_add_u32 v28, 100352, v28
v_mfma_f32_16x16x32_bf16 v[96:99], v[48:51], a[32:35], v[96:99]
ds_read_b64_tr_b16 v[40:41], v7 offset:16384
ds_read_b64_tr_b16 v[42:43], v7 offset:18432
v_mfma_f32_16x16x32_bf16 v[96:99], v[52:55], a[48:51], v[96:99]
buffer_load_dwordx4 v23, s[8:11], s46 offen offset:1024 lds
v_mfma_f32_16x16x32_bf16 v[100:103], v[48:51], a[36:39], v[100:103]
ds_read_b64_tr_b16 v[44:45], v7 offset:20480
ds_read_b64_tr_b16 v[46:47], v7 offset:22528
v_mfma_f32_16x16x32_bf16 v[100:103], v[52:55], a[52:55], v[100:103]
v_bfe_u32 v29, v1, 4, 2
v_lshl_add_u32 v28, v29, 3, v28
v_mfma_f32_16x16x32_bf16 v[104:107], v[48:51], a[40:43], v[104:107]
v_xor_b32 v29, 0, v26
v_lshl_add_u32 v2, v29, 5, v28
v_mfma_f32_16x16x32_bf16 v[104:107], v[52:55], a[56:59], v[104:107]
buffer_load_dwordx4 v24, s[12:15], s44 offen offset:2048 lds
v_mfma_f32_16x16x32_bf16 v[108:111], v[48:51], a[44:47], v[108:111]
v_xor_b32 v29, 1, v26
v_lshl_add_u32 v3, v29, 5, v28
v_mfma_f32_16x16x32_bf16 v[108:111], v[52:55], a[60:63], v[108:111]
v_xor_b32 v29, 2, v26
v_lshl_add_u32 v4, v29, 5, v28
v_mfma_f32_16x16x32_bf16 v[112:115], v[56:59], a[32:35], v[112:115]
ds_read_b64_tr_b16 v[48:49], v8 offset:16384
ds_read_b64_tr_b16 v[50:51], v8 offset:18432
v_mfma_f32_16x16x32_bf16 v[112:115], v[60:63], a[48:51], v[112:115]
v_xor_b32 v29, 3, v26
v_lshl_add_u32 v5, v29, 5, v28
v_mfma_f32_16x16x32_bf16 v[116:119], v[56:59], a[36:39], v[116:119]
ds_read_b64_tr_b16 v[52:53], v8 offset:20480
ds_read_b64_tr_b16 v[54:55], v8 offset:22528
v_mfma_f32_16x16x32_bf16 v[116:119], v[60:63], a[52:55], v[116:119]
buffer_load_dwordx4 v25, s[12:15], s44 offen offset:3072 lds
v_mfma_f32_16x16x32_bf16 v[120:123], v[56:59], a[40:43], v[120:123]
v_xor_b32 v29, 4, v26
v_lshl_add_u32 v14, v29, 5, v28
v_mfma_f32_16x16x32_bf16 v[120:123], v[60:63], a[56:59], v[120:123]
v_xor_b32 v29, 5, v26
v_lshl_add_u32 v15, v29, 5, v28
v_mfma_f32_16x16x32_bf16 v[124:127], v[56:59], a[44:47], v[124:127]
v_xor_b32 v29, 6, v26
v_lshl_add_u32 v16, v29, 5, v28
v_mfma_f32_16x16x32_bf16 v[124:127], v[60:63], a[60:63], v[124:127]
s_waitcnt lgkmcnt(8)
v_xor_b32 v29, 7, v26
v_lshl_add_u32 v17, v29, 5, v28
v_mfma_f32_16x16x32_bf16 v[64:67], v[32:35], a[64:67], v[64:67]
ds_read_b64_tr_b16 v[56:57], v9 offset:16384
ds_read_b64_tr_b16 v[58:59], v9 offset:18432
v_mfma_f32_16x16x32_bf16 v[64:67], v[36:39], a[80:83], v[64:67]
ds_read_b64_tr_b16 v[60:61], v9 offset:20480
ds_read_b64_tr_b16 v[62:63], v9 offset:22528
v_mfma_f32_16x16x32_bf16 v[68:71], v[32:35], a[68:71], v[68:71]
v_mfma_f32_16x16x32_bf16 v[68:71], v[36:39], a[84:87], v[68:71]
v_mfma_f32_16x16x32_bf16 v[72:75], v[32:35], a[72:75], v[72:75]
v_mfma_f32_16x16x32_bf16 v[72:75], v[36:39], a[88:91], v[72:75]
v_mfma_f32_16x16x32_bf16 v[76:79], v[32:35], a[76:79], v[76:79]
v_mfma_f32_16x16x32_bf16 v[76:79], v[36:39], a[92:95], v[76:79]
s_waitcnt vmcnt(4) lgkmcnt(0)
v_mfma_f32_16x16x32_bf16 v[80:83], v[40:43], a[64:67], v[80:83]
ds_read_b64_tr_b16 v[32:33], v6 offset:0
ds_read_b64_tr_b16 v[34:35], v6 offset:2048
v_mfma_f32_16x16x32_bf16 v[80:83], v[44:47], a[80:83], v[80:83]
s_add_u32 s47, s46, 8192
v_mfma_f32_16x16x32_bf16 v[84:87], v[40:43], a[68:71], v[84:87]
s_and_b32 s47, s47, 0x7ffff
ds_read_b64_tr_b16 v[36:37], v6 offset:4096
ds_read_b64_tr_b16 v[38:39], v6 offset:6144
v_mfma_f32_16x16x32_bf16 v[84:87], v[44:47], a[84:87], v[84:87]
s_add_u32 m0, s48, 16384
v_mfma_f32_16x16x32_bf16 v[88:91], v[40:43], a[72:75], v[88:91]
v_mfma_f32_16x16x32_bf16 v[88:91], v[44:47], a[88:91], v[88:91]
buffer_load_dwordx4 v22, s[8:11], s47 offen lds
v_mfma_f32_16x16x32_bf16 v[92:95], v[40:43], a[76:79], v[92:95]
v_mfma_f32_16x16x32_bf16 v[92:95], v[44:47], a[92:95], v[92:95]
v_mfma_f32_16x16x32_bf16 v[96:99], v[48:51], a[64:67], v[96:99]
ds_read_b64_tr_b16 v[40:41], v7 offset:0
ds_read_b64_tr_b16 v[42:43], v7 offset:2048
v_mfma_f32_16x16x32_bf16 v[96:99], v[52:55], a[80:83], v[96:99]
buffer_load_dwordx4 v23, s[8:11], s47 offen offset:1024 lds
v_mfma_f32_16x16x32_bf16 v[100:103], v[48:51], a[68:71], v[100:103]
ds_read_b64_tr_b16 v[44:45], v7 offset:4096
ds_read_b64_tr_b16 v[46:47], v7 offset:6144
v_mfma_f32_16x16x32_bf16 v[100:103], v[52:55], a[84:87], v[100:103]
v_mfma_f32_16x16x32_bf16 v[104:107], v[48:51], a[72:75], v[104:107]
v_mfma_f32_16x16x32_bf16 v[104:107], v[52:55], a[88:91], v[104:107]
buffer_load_dwordx4 v24, s[12:15], s45 offen offset:2048 lds
v_mfma_f32_16x16x32_bf16 v[108:111], v[48:51], a[76:79], v[108:111]
v_mfma_f32_16x16x32_bf16 v[108:111], v[52:55], a[92:95], v[108:111]
v_mfma_f32_16x16x32_bf16 v[112:115], v[56:59], a[64:67], v[112:115]
ds_read_b64_tr_b16 v[48:49], v8 offset:0
ds_read_b64_tr_b16 v[50:51], v8 offset:2048
v_mfma_f32_16x16x32_bf16 v[112:115], v[60:63], a[80:83], v[112:115]
v_mfma_f32_16x16x32_bf16 v[116:119], v[56:59], a[68:71], v[116:119]
ds_read_b64_tr_b16 v[52:53], v8 offset:4096
ds_read_b64_tr_b16 v[54:55], v8 offset:6144
v_mfma_f32_16x16x32_bf16 v[116:119], v[60:63], a[84:87], v[116:119]
buffer_load_dwordx4 v25, s[12:15], s45 offen offset:3072 lds
v_mfma_f32_16x16x32_bf16 v[120:123], v[56:59], a[72:75], v[120:123]
v_mfma_f32_16x16x32_bf16 v[120:123], v[60:63], a[88:91], v[120:123]
v_mfma_f32_16x16x32_bf16 v[124:127], v[56:59], a[76:79], v[124:127]
v_mfma_f32_16x16x32_bf16 v[124:127], v[60:63], a[92:95], v[124:127]
s_waitcnt lgkmcnt(8)
v_mfma_f32_16x16x32_bf16 v[64:67], v[32:35], a[96:99], v[64:67]
ds_read_b64_tr_b16 v[56:57], v9 offset:0
ds_read_b64_tr_b16 v[58:59], v9 offset:2048
v_mfma_f32_16x16x32_bf16 v[64:67], v[36:39], a[112:115], v[64:67]
ds_read_b64_tr_b16 v[60:61], v9 offset:4096
ds_read_b64_tr_b16 v[62:63], v9 offset:6144
v_mfma_f32_16x16x32_bf16 v[68:71], v[32:35], a[100:103], v[68:71]
v_mfma_f32_16x16x32_bf16 v[68:71], v[36:39], a[116:119], v[68:71]
s_barrier
v_mfma_f32_16x16x32_bf16 v[72:75], v[32:35], a[104:107], v[72:75]
v_mfma_f32_16x16x32_bf16 v[72:75], v[36:39], a[120:123], v[72:75]
v_mfma_f32_16x16x32_bf16 v[76:79], v[32:35], a[108:111], v[76:79]
v_mfma_f32_16x16x32_bf16 v[76:79], v[36:39], a[124:127], v[76:79]
s_waitcnt lgkmcnt(8)
v_mfma_f32_16x16x32_bf16 v[80:83], v[40:43], a[96:99], v[80:83]
ds_read_b128 a[192:195], v10 offset:32768
v_mfma_f32_16x16x32_bf16 v[80:83], v[44:47], a[112:115], v[80:83]
ds_read_b128 a[196:199], v11 offset:32768
v_mfma_f32_16x16x32_bf16 v[84:87], v[40:43], a[100:103], v[84:87]
ds_read_b128 a[200:203], v12 offset:32768
v_mfma_f32_16x16x32_bf16 v[84:87], v[44:47], a[116:119], v[84:87]
ds_read_b128 a[204:207], v13 offset:32768
v_mfma_f32_16x16x32_bf16 v[88:91], v[40:43], a[104:107], v[88:91]
ds_read_b128 a[208:211], v10 offset:40960
v_mfma_f32_16x16x32_bf16 v[88:91], v[44:47], a[120:123], v[88:91]
ds_read_b128 a[212:215], v11 offset:40960
v_mfma_f32_16x16x32_bf16 v[92:95], v[40:43], a[108:111], v[92:95]
ds_read_b128 a[216:219], v12 offset:40960
v_mfma_f32_16x16x32_bf16 v[92:95], v[44:47], a[124:127], v[92:95]
s_waitcnt lgkmcnt(11)
v_mfma_f32_16x16x32_bf16 v[96:99], v[48:51], a[96:99], v[96:99]
ds_read_b128 a[220:223], v13 offset:40960
v_mfma_f32_16x16x32_bf16 v[96:99], v[52:55], a[112:115], v[96:99]
v_mfma_f32_16x16x32_bf16 v[100:103], v[48:51], a[100:103], v[100:103]
v_mfma_f32_16x16x32_bf16 v[100:103], v[52:55], a[116:119], v[100:103]
v_mfma_f32_16x16x32_bf16 v[104:107], v[48:51], a[104:107], v[104:107]
v_mfma_f32_16x16x32_bf16 v[104:107], v[52:55], a[120:123], v[104:107]
v_mfma_f32_16x16x32_bf16 v[108:111], v[48:51], a[108:111], v[108:111]
v_mfma_f32_16x16x32_bf16 v[108:111], v[52:55], a[124:127], v[108:111]
s_waitcnt lgkmcnt(8)
v_mfma_f32_16x16x32_bf16 v[112:115], v[56:59], a[96:99], v[112:115]
v_mfma_f32_16x16x32_bf16 v[112:115], v[60:63], a[112:115], v[112:115]
v_mfma_f32_16x16x32_bf16 v[116:119], v[56:59], a[100:103], v[116:119]
v_mfma_f32_16x16x32_bf16 v[116:119], v[60:63], a[116:119], v[116:119]
v_mfma_f32_16x16x32_bf16 v[120:123], v[56:59], a[104:107], v[120:123]
v_mfma_f32_16x16x32_bf16 v[120:123], v[60:63], a[120:123], v[120:123]
v_mfma_f32_16x16x32_bf16 v[124:127], v[56:59], a[108:111], v[124:127]
v_mfma_f32_16x16x32_bf16 v[124:127], v[60:63], a[124:127], v[124:127]
s_waitcnt lgkmcnt(0)
v_mfma_f32_16x16x32_bf16 v[192:195], a[192:195], v[128:131], 0
v_mfma_f32_16x16x32_bf16 v[192:195], a[196:199], v[132:135], v[192:195]
v_mfma_f32_16x16x32_bf16 v[192:195], a[200:203], v[136:139], v[192:195]
v_mfma_f32_16x16x32_bf16 v[192:195], a[204:207], v[140:143], v[192:195]
v_cvt_pk_bf16_f32 v64, v64, v65
v_cvt_pk_bf16_f32 v65, v66, v67
v_mfma_f32_16x16x32_bf16 v[200:203], a[192:195], v[144:147], 0
v_cvt_pk_bf16_f32 v66, v80, v81
v_cvt_pk_bf16_f32 v67, v82, v83
v_mfma_f32_16x16x32_bf16 v[200:203], a[196:199], v[148:151], v[200:203]
v_accvgpr_write_b32 a160, v64
v_accvgpr_write_b32 a161, v65
v_mfma_f32_16x16x32_bf16 v[200:203], a[200:203], v[152:155], v[200:203]
v_accvgpr_write_b32 a162, v66
v_accvgpr_write_b32 a163, v67
v_mfma_f32_16x16x32_bf16 v[200:203], a[204:207], v[156:159], v[200:203]
v_cvt_pk_bf16_f32 v68, v68, v69
v_cvt_pk_bf16_f32 v69, v70, v71
v_mfma_f32_16x16x32_bf16 v[208:211], a[192:195], v[160:163], 0
v_cvt_pk_bf16_f32 v70, v84, v85
v_cvt_pk_bf16_f32 v71, v86, v87
v_mfma_f32_16x16x32_bf16 v[208:211], a[196:199], v[164:167], v[208:211]
v_accvgpr_write_b32 a164, v68
v_accvgpr_write_b32 a165, v69
v_mfma_f32_16x16x32_bf16 v[208:211], a[200:203], v[168:171], v[208:211]
v_accvgpr_write_b32 a166, v70
v_accvgpr_write_b32 a167, v71
v_mfma_f32_16x16x32_bf16 v[208:211], a[204:207], v[172:175], v[208:211]
v_cvt_pk_bf16_f32 v72, v72, v73
v_cvt_pk_bf16_f32 v73, v74, v75
v_mfma_f32_16x16x32_bf16 v[216:219], a[192:195], v[176:179], 0
v_cvt_pk_bf16_f32 v74, v88, v89
v_cvt_pk_bf16_f32 v75, v90, v91
v_mfma_f32_16x16x32_bf16 v[216:219], a[196:199], v[180:183], v[216:219]
v_accvgpr_write_b32 a168, v72
v_accvgpr_write_b32 a169, v73
v_mfma_f32_16x16x32_bf16 v[216:219], a[200:203], v[184:187], v[216:219]
v_accvgpr_write_b32 a170, v74
v_accvgpr_write_b32 a171, v75
v_mfma_f32_16x16x32_bf16 v[216:219], a[204:207], v[188:191], v[216:219]
v_cvt_pk_bf16_f32 v76, v76, v77
v_cvt_pk_bf16_f32 v77, v78, v79
v_mfma_f32_16x16x32_bf16 v[196:199], a[208:211], v[128:131], 0
ds_read_b128 a[192:195], v10 offset:49152
ds_read_b128 a[196:199], v11 offset:49152
v_mfma_f32_16x16x32_bf16 v[196:199], a[212:215], v[132:135], v[196:199]
ds_read_b128 a[200:203], v12 offset:49152
ds_read_b128 a[204:207], v13 offset:49152
v_mfma_f32_16x16x32_bf16 v[196:199], a[216:219], v[136:139], v[196:199]
v_cvt_pk_bf16_f32 v78, v92, v93
v_cvt_pk_bf16_f32 v79, v94, v95
v_mfma_f32_16x16x32_bf16 v[196:199], a[220:223], v[140:143], v[196:199]
v_accvgpr_write_b32 a172, v76
v_accvgpr_write_b32 a173, v77
v_mfma_f32_16x16x32_bf16 v[204:207], a[208:211], v[144:147], 0
v_accvgpr_write_b32 a174, v78
v_accvgpr_write_b32 a175, v79
v_mfma_f32_16x16x32_bf16 v[204:207], a[212:215], v[148:151], v[204:207]
v_cvt_pk_bf16_f32 v96, v96, v97
v_cvt_pk_bf16_f32 v97, v98, v99
v_mfma_f32_16x16x32_bf16 v[204:207], a[216:219], v[152:155], v[204:207]
v_cvt_pk_bf16_f32 v98, v112, v113
v_cvt_pk_bf16_f32 v99, v114, v115
v_mfma_f32_16x16x32_bf16 v[204:207], a[220:223], v[156:159], v[204:207]
v_accvgpr_write_b32 a176, v96
v_accvgpr_write_b32 a177, v97
v_mfma_f32_16x16x32_bf16 v[212:215], a[208:211], v[160:163], 0
v_accvgpr_write_b32 a178, v98
v_accvgpr_write_b32 a179, v99
v_mfma_f32_16x16x32_bf16 v[212:215], a[212:215], v[164:167], v[212:215]
v_cvt_pk_bf16_f32 v100, v100, v101
v_cvt_pk_bf16_f32 v101, v102, v103
v_mfma_f32_16x16x32_bf16 v[212:215], a[216:219], v[168:171], v[212:215]
v_cvt_pk_bf16_f32 v102, v116, v117
v_cvt_pk_bf16_f32 v103, v118, v119
v_mfma_f32_16x16x32_bf16 v[212:215], a[220:223], v[172:175], v[212:215]
v_accvgpr_write_b32 a180, v100
v_accvgpr_write_b32 a181, v101
v_mfma_f32_16x16x32_bf16 v[220:223], a[208:211], v[176:179], 0
v_accvgpr_write_b32 a182, v102
v_accvgpr_write_b32 a183, v103
v_mfma_f32_16x16x32_bf16 v[220:223], a[212:215], v[180:183], v[220:223]
v_cvt_pk_bf16_f32 v104, v104, v105
v_cvt_pk_bf16_f32 v105, v106, v107
v_mfma_f32_16x16x32_bf16 v[220:223], a[216:219], v[184:187], v[220:223]
v_cvt_pk_bf16_f32 v106, v120, v121
v_cvt_pk_bf16_f32 v107, v122, v123
v_mfma_f32_16x16x32_bf16 v[220:223], a[220:223], v[188:191], v[220:223]
v_accvgpr_write_b32 a184, v104
v_accvgpr_write_b32 a185, v105
ds_read_b128 a[208:211], v10 offset:57344
ds_read_b128 a[212:215], v11 offset:57344
ds_read_b128 a[216:219], v12 offset:57344
ds_read_b128 a[220:223], v13 offset:57344
v_accvgpr_write_b32 a186, v106
v_accvgpr_write_b32 a187, v107
v_cvt_pk_bf16_f32 v108, v108, v109
v_cvt_pk_bf16_f32 v109, v110, v111
v_cvt_pk_bf16_f32 v110, v124, v125
v_cvt_pk_bf16_f32 v111, v126, v127
v_accvgpr_write_b32 a188, v108
v_accvgpr_write_b32 a189, v109
v_accvgpr_write_b32 a190, v110
v_accvgpr_write_b32 a191, v111
v_mov_b32 v112, 0x3f803f80
v_mov_b32 v113, 0x3f803f80
v_mov_b32 v114, 0x3f803f80
v_mov_b32 v115, 0x3f803f80
v_mov_b32 v126, 0
v_mov_b32 v127, 0
v_max3_f32 v88, v192, v193, v194
v_max3_f32 v90, v200, v201, v202
v_max3_f32 v92, v208, v209, v210
v_max3_f32 v94, v216, v217, v218
v_max3_f32 v88, v88, v195, v196
v_max3_f32 v90, v90, v203, v204
v_max3_f32 v92, v92, v211, v212
v_max3_f32 v94, v94, v219, v220
v_max3_f32 v88, v88, v197, v198
v_max3_f32 v90, v90, v205, v206
v_max3_f32 v92, v92, v213, v214
v_max3_f32 v94, v94, v221, v222
v_max_f32 v88, v88, v199
v_max_f32 v90, v90, v207
v_max_f32 v92, v92, v215
v_max_f32 v94, v94, v223
v_mov_b32 v89, v88
v_mov_b32 v91, v90
v_mov_b32 v93, v92
v_mov_b32 v95, v94
v_permlane16_swap_b32 v88, v89
v_permlane16_swap_b32 v90, v91
v_permlane16_swap_b32 v92, v93
v_permlane16_swap_b32 v94, v95
v_max_f32 v88, v88, v89
v_max_f32 v90, v90, v91
v_max_f32 v92, v92, v93
v_max_f32 v94, v94, v95
v_mov_b32 v89, v88
v_mov_b32 v91, v90
v_mov_b32 v93, v92
v_mov_b32 v95, v94
v_permlane32_swap_b32 v88, v89
v_permlane32_swap_b32 v90, v91
v_permlane32_swap_b32 v92, v93
v_permlane32_swap_b32 v94, v95
v_max_f32 v88, v88, v89
v_max_f32 v90, v90, v91
v_max_f32 v92, v92, v93
v_max_f32 v94, v94, v95
v_sub_f32 v96, 0, v88
v_sub_f32 v97, 0, v88
v_sub_f32 v98, 0, v88
v_sub_f32 v99, 0, v88
v_sub_f32 v100, 0, v90
v_sub_f32 v101, 0, v90
v_sub_f32 v102, 0, v90
v_sub_f32 v103, 0, v90
v_sub_f32 v104, 0, v92
v_sub_f32 v105, 0, v92
v_sub_f32 v106, 0, v92
v_sub_f32 v107, 0, v92
v_sub_f32 v108, 0, v94
v_sub_f32 v109, 0, v94
v_sub_f32 v110, 0, v94
v_sub_f32 v111, 0, v94
s_waitcnt vmcnt(0) lgkmcnt(0)
s_barrier
v_mfma_f32_16x16x32_bf16 v[224:227], a[192:195], v[128:131], v[96:99]
s_add_u32 m0, s48, 32768
v_sub_f32 v192, v192, v88
v_sub_f32 v193, v193, v88
v_sub_f32 v194, v194, v88
v_mfma_f32_16x16x32_bf16 v[224:227], a[196:199], v[132:135], v[224:227]
s_add_u32 s44, s47, 8192
v_sub_f32 v195, v195, v88
v_sub_f32 v200, v200, v90
v_sub_f32 v201, v201, v90
v_mfma_f32_16x16x32_bf16 v[224:227], a[200:203], v[136:139], v[224:227]
s_and_b32 s44, s44, 0x7ffff
v_sub_f32 v202, v202, v90
v_sub_f32 v203, v203, v90
v_exp_f32 v192, v192
v_mfma_f32_16x16x32_bf16 v[224:227], a[204:207], v[140:143], v[224:227]
v_exp_f32 v193, v193
v_exp_f32 v194, v194
v_mfma_f32_16x16x32_bf16 v[232:235], a[192:195], v[144:147], v[100:103]
buffer_load_dwordx4 v22, s[8:11], s44 offen lds
v_cvt_pk_bf16_f32 v32, v192, v193
v_mfma_f32_16x16x32_bf16 v[232:235], a[196:199], v[148:151], v[232:235]
v_exp_f32 v195, v195
v_sub_f32 v208, v208, v92
v_mfma_f32_16x16x32_bf16 v[232:235], a[200:203], v[152:155], v[232:235]
v_sub_f32 v209, v209, v92
v_sub_f32 v210, v210, v92
v_sub_f32 v211, v211, v92
v_mfma_f32_16x16x32_bf16 v[232:235], a[204:207], v[156:159], v[232:235]
v_exp_f32 v200, v200
v_cvt_pk_bf16_f32 v33, v194, v195
v_mfma_f32_16x16x32_bf16 v[240:243], a[192:195], v[160:163], v[104:107]
v_exp_f32 v201, v201
v_exp_f32 v202, v202
v_mfma_f32_16x16x32_bf16 v[240:243], a[196:199], v[164:167], v[240:243]
buffer_load_dwordx4 v23, s[8:11], s44 offen offset:1024 lds
v_cvt_pk_bf16_f32 v36, v200, v201
v_mfma_f32_16x16x32_bf16 v[240:243], a[200:203], v[168:171], v[240:243]
v_exp_f32 v203, v203
v_sub_f32 v216, v216, v94
v_mfma_f32_16x16x32_bf16 v[240:243], a[204:207], v[172:175], v[240:243]
v_sub_f32 v217, v217, v94
v_sub_f32 v218, v218, v94
v_sub_f32 v219, v219, v94
v_mfma_f32_16x16x32_bf16 v[248:251], a[192:195], v[176:179], v[108:111]
v_exp_f32 v208, v208
v_cvt_pk_bf16_f32 v37, v202, v203
v_mfma_f32_16x16x32_bf16 v[248:251], a[196:199], v[180:183], v[248:251]
v_exp_f32 v209, v209
v_add_f32 v126, v126, v208
v_mfma_f32_16x16x32_bf16 v[248:251], a[200:203], v[184:187], v[248:251]
v_exp_f32 v210, v210
v_add_f32 v126, v126, v209
v_mfma_f32_16x16x32_bf16 v[248:251], a[204:207], v[188:191], v[248:251]
v_cvt_pk_bf16_f32 v40, v208, v209
v_exp_f32 v211, v211
v_mfma_f32_16x16x32_bf16 v[228:231], a[208:211], v[128:131], v[96:99]
ds_read_b128 a[192:195], v10 offset:0
ds_read_b128 a[196:199], v11 offset:0
v_sub_f32 v196, v196, v88
v_mfma_f32_16x16x32_bf16 v[228:231], a[212:215], v[132:135], v[228:231]
ds_read_b128 a[200:203], v12 offset:0
ds_read_b128 a[204:207], v13 offset:0
v_sub_f32 v197, v197, v88
v_mfma_f32_16x16x32_bf16 v[228:231], a[216:219], v[136:139], v[228:231]
v_sub_f32 v198, v198, v88
v_sub_f32 v199, v199, v88
v_add_f32 v126, v126, v210
v_mfma_f32_16x16x32_bf16 v[228:231], a[220:223], v[140:143], v[228:231]
v_exp_f32 v216, v216
v_add_f32 v126, v126, v211
v_mfma_f32_16x16x32_bf16 v[236:239], a[208:211], v[144:147], v[100:103]
v_cvt_pk_bf16_f32 v41, v210, v211
v_exp_f32 v217, v217
v_mfma_f32_16x16x32_bf16 v[236:239], a[212:215], v[148:151], v[236:239]
buffer_load_dwordx4 v24, s[12:15], s46 offen offset:2048 lds
v_add_f32 v127, v127, v216
v_mfma_f32_16x16x32_bf16 v[236:239], a[216:219], v[152:155], v[236:239]
v_exp_f32 v218, v218
v_add_f32 v127, v127, v217
v_mfma_f32_16x16x32_bf16 v[236:239], a[220:223], v[156:159], v[236:239]
v_cvt_pk_bf16_f32 v44, v216, v217
v_exp_f32 v219, v219
v_mfma_f32_16x16x32_bf16 v[244:247], a[208:211], v[160:163], v[104:107]
v_sub_f32 v204, v204, v90
v_sub_f32 v205, v205, v90
v_sub_f32 v206, v206, v90
v_mfma_f32_16x16x32_bf16 v[244:247], a[212:215], v[164:167], v[244:247]
v_sub_f32 v207, v207, v90
v_add_f32 v127, v127, v218
v_exp_f32 v196, v196
v_mfma_f32_16x16x32_bf16 v[244:247], a[216:219], v[168:171], v[244:247]
buffer_load_dwordx4 v25, s[12:15], s46 offen offset:3072 lds
v_add_f32 v127, v127, v219
v_mfma_f32_16x16x32_bf16 v[244:247], a[220:223], v[172:175], v[244:247]
v_cvt_pk_bf16_f32 v45, v218, v219
v_exp_f32 v197, v197
v_mfma_f32_16x16x32_bf16 v[252:255], a[208:211], v[176:179], v[108:111]
v_exp_f32 v198, v198
v_cvt_pk_bf16_f32 v34, v196, v197
v_mfma_f32_16x16x32_bf16 v[252:255], a[212:215], v[180:183], v[252:255]
v_exp_f32 v199, v199
v_sub_f32 v212, v212, v92
v_mfma_f32_16x16x32_bf16 v[252:255], a[216:219], v[184:187], v[252:255]
v_sub_f32 v213, v213, v92
v_sub_f32 v214, v214, v92
v_sub_f32 v215, v215, v92
v_mfma_f32_16x16x32_bf16 v[252:255], a[220:223], v[188:191], v[252:255]
v_exp_f32 v204, v204
v_cvt_pk_bf16_f32 v35, v198, v199
ds_read_b128 a[208:211], v10 offset:8192
ds_read_b128 a[212:215], v11 offset:8192
ds_read_b128 a[216:219], v12 offset:8192
ds_read_b128 a[220:223], v13 offset:8192
v_exp_f32 v205, v205
v_exp_f32 v206, v206
v_cvt_pk_bf16_f32 v38, v204, v205
v_exp_f32 v207, v207
v_sub_f32 v220, v220, v94
v_sub_f32 v221, v221, v94
v_sub_f32 v222, v222, v94
v_sub_f32 v223, v223, v94
v_exp_f32 v212, v212
v_cvt_pk_bf16_f32 v39, v206, v207
v_exp_f32 v213, v213
v_add_f32 v126, v126, v212
v_exp_f32 v214, v214
v_add_f32 v126, v126, v213
v_cvt_pk_bf16_f32 v42, v212, v213
v_exp_f32 v215, v215
v_add_f32 v126, v126, v214
v_exp_f32 v220, v220
v_add_f32 v126, v126, v215
v_cvt_pk_bf16_f32 v43, v214, v215
v_exp_f32 v221, v221
v_add_f32 v127, v127, v220
v_exp_f32 v222, v222
v_add_f32 v127, v127, v221
v_cvt_pk_bf16_f32 v46, v220, v221
v_exp_f32 v223, v223
v_add_f32 v127, v127, v222
s_nop 0
v_add_f32 v127, v127, v223
v_cvt_pk_bf16_f32 v47, v222, v223
s_lshl_b32 s0, s5, 3
v_mov_b32 v26, s0
s_lshl_b32 s0, 0x100, s4
v_mov_b32 v27, s0
s_and_b32 s0, s5, 15
s_lshl_b32 s0, s0, 2
s_add_u32 s0, s0, s3
s_lshl_b32 s0, s0, 13
v_lshlrev_b32 v31, 3, v1
v_add_u32 v31, s0, v31
s_cmp_eq_u32 s3, 0
s_cselect_b32 s0, 1, 0
s_mov_b32 s1, 0
v_exp_f32 v224, v224
v_exp_f32 v225, v225
v_exp_f32 v226, v226
v_exp_f32 v227, v227
v_exp_f32 v232, v232
v_exp_f32 v233, v233
v_exp_f32 v234, v234
v_exp_f32 v235, v235
v_exp_f32 v240, v240
v_exp_f32 v241, v241
v_exp_f32 v242, v242
v_exp_f32 v243, v243
v_exp_f32 v248, v248
v_exp_f32 v249, v249
v_exp_f32 v250, v250
v_cvt_pk_bf16_f32 v48, v224, v225
v_cvt_pk_bf16_f32 v49, v226, v227
v_cvt_pk_bf16_f32 v52, v232, v233
v_cvt_pk_bf16_f32 v53, v234, v235
v_add_f32 v126, v126, v240
v_add_f32 v126, v126, v241
v_cvt_pk_bf16_f32 v56, v240, v241
v_add_f32 v126, v126, v242
v_add_f32 v126, v126, v243
v_cvt_pk_bf16_f32 v57, v242, v243
v_add_f32 v127, v127, v248
v_add_f32 v127, v127, v249
s_waitcnt lgkmcnt(0)
v_mfma_f32_16x16x32_bf16 v[192:195], a[192:195], v[128:131], v[96:99]
v_exp_f32 v251, v251
v_mfma_f32_16x16x32_bf16 v[192:195], a[196:199], v[132:135], v[192:195]
s_add_u32 m0, s48, 49152
v_cvt_pk_bf16_f32 v60, v248, v249
v_add_f32 v127, v127, v250
v_mfma_f32_16x16x32_bf16 v[192:195], a[200:203], v[136:139], v[192:195]
s_add_u32 s45, s44, 8192
v_exp_f32 v228, v228
v_mfma_f32_16x16x32_bf16 v[192:195], a[204:207], v[140:143], v[192:195]
s_and_b32 s45, s45, 0x7ffff
v_add_f32 v127, v127, v251
v_cvt_pk_bf16_f32 v61, v250, v251
v_mfma_f32_16x16x32_bf16 v[200:203], a[192:195], v[144:147], v[100:103]
v_exp_f32 v229, v229
v_mfma_f32_16x16x32_bf16 v[200:203], a[196:199], v[148:151], v[200:203]
buffer_load_dwordx4 v22, s[8:11], s45 offen lds
v_mfma_f32_16x16x32_bf16 v[200:203], a[200:203], v[152:155], v[200:203]
v_exp_f32 v230, v230
v_mfma_f32_16x16x32_bf16 v[200:203], a[204:207], v[156:159], v[200:203]
v_exp_f32 v231, v231
v_mfma_f32_16x16x32_bf16 v[208:211], a[192:195], v[160:163], v[104:107]
v_cvt_pk_bf16_f32 v50, v228, v229
v_cvt_pk_bf16_f32 v51, v230, v231
v_mfma_f32_16x16x32_bf16 v[208:211], a[196:199], v[164:167], v[208:211]
v_exp_f32 v236, v236
v_mfma_f32_16x16x32_bf16 v[208:211], a[200:203], v[168:171], v[208:211]
buffer_load_dwordx4 v23, s[8:11], s45 offen offset:1024 lds
v_mfma_f32_16x16x32_bf16 v[208:211], a[204:207], v[172:175], v[208:211]
v_exp_f32 v237, v237
v_mfma_f32_16x16x32_bf16 v[216:219], a[192:195], v[176:179], v[108:111]
v_exp_f32 v238, v238
v_mfma_f32_16x16x32_bf16 v[216:219], a[196:199], v[180:183], v[216:219]
v_exp_f32 v239, v239
v_mfma_f32_16x16x32_bf16 v[216:219], a[200:203], v[184:187], v[216:219]
v_cvt_pk_bf16_f32 v54, v236, v237
v_cvt_pk_bf16_f32 v55, v238, v239
v_mfma_f32_16x16x32_bf16 v[216:219], a[204:207], v[188:191], v[216:219]
v_exp_f32 v244, v244
v_mfma_f32_16x16x32_bf16 v[196:199], a[208:211], v[128:131], v[96:99]
v_exp_f32 v245, v245
v_mfma_f32_16x16x32_bf16 v[196:199], a[212:215], v[132:135], v[196:199]
ds_read_b128 a[192:195], v10 offset:16384
v_add_f32 v126, v126, v244
v_mfma_f32_16x16x32_bf16 v[196:199], a[216:219], v[136:139], v[196:199]
v_add_f32 v126, v126, v245
v_cvt_pk_bf16_f32 v58, v244, v245
v_mfma_f32_16x16x32_bf16 v[196:199], a[220:223], v[140:143], v[196:199]
v_exp_f32 v246, v246
v_mfma_f32_16x16x32_bf16 v[204:207], a[208:211], v[144:147], v[100:103]
ds_read_b128 a[196:199], v11 offset:16384
v_add_f32 v126, v126, v246
v_mfma_f32_16x16x32_bf16 v[204:207], a[212:215], v[148:151], v[204:207]
ds_read_b128 a[200:203], v12 offset:16384
v_exp_f32 v247, v247
v_mfma_f32_16x16x32_bf16 v[204:207], a[216:219], v[152:155], v[204:207]
buffer_load_dwordx4 v24, s[12:15], s47 offen offset:2048 lds
v_mfma_f32_16x16x32_bf16 v[204:207], a[220:223], v[156:159], v[204:207]
ds_read_b128 a[204:207], v13 offset:16384
v_add_f32 v126, v126, v247
v_mfma_f32_16x16x32_bf16 v[212:215], a[208:211], v[160:163], v[104:107]
v_exp_f32 v252, v252
v_mfma_f32_16x16x32_bf16 v[212:215], a[212:215], v[164:167], v[212:215]
v_cvt_pk_bf16_f32 v59, v246, v247
v_add_f32 v127, v127, v252
v_mfma_f32_16x16x32_bf16 v[212:215], a[216:219], v[168:171], v[212:215]
v_exp_f32 v253, v253
v_mfma_f32_16x16x32_bf16 v[212:215], a[220:223], v[172:175], v[212:215]
v_add_f32 v127, v127, v253
v_cvt_pk_bf16_f32 v62, v252, v253
v_mfma_f32_16x16x32_bf16 v[220:223], a[208:211], v[176:179], v[108:111]
buffer_load_dwordx4 v25, s[12:15], s47 offen offset:3072 lds
v_mfma_f32_16x16x32_bf16 v[220:223], a[212:215], v[180:183], v[220:223]
v_exp_f32 v254, v254
v_mfma_f32_16x16x32_bf16 v[220:223], a[216:219], v[184:187], v[220:223]
v_exp_f32 v255, v255
v_mfma_f32_16x16x32_bf16 v[220:223], a[220:223], v[188:191], v[220:223]
s_waitcnt lgkmcnt(0)
v_add_f32 v127, v127, v254
v_add_f32 v127, v127, v255
v_mfma_f32_16x16x32_bf16 v[224:227], a[192:195], v[128:131], v[96:99]
v_cvt_pk_bf16_f32 v63, v254, v255
v_mfma_f32_16x16x32_bf16 v[224:227], a[196:199], v[132:135], v[224:227]
ds_read_b128 a[208:211], v10 offset:24576
v_mfma_f32_16x16x32_bf16 v[224:227], a[200:203], v[136:139], v[224:227]
v_exp_f32 v192, v192
v_mfma_f32_16x16x32_bf16 v[224:227], a[204:207], v[140:143], v[224:227]
v_exp_f32 v193, v193
v_mfma_f32_16x16x32_bf16 v[232:235], a[192:195], v[144:147], v[100:103]
buffer_store_dwordx4 a[128:131], v1, s[40:43], s76 offen offset:0 sc1
v_mfma_f32_16x16x32_bf16 v[232:235], a[196:199], v[148:151], v[232:235]
ds_read_b128 a[212:215], v11 offset:24576
ds_read_b128 a[216:219], v12 offset:24576
v_mfma_f32_16x16x32_bf16 v[232:235], a[200:203], v[152:155], v[232:235]
v_exp_f32 v194, v194
v_mfma_f32_16x16x32_bf16 v[232:235], a[204:207], v[156:159], v[232:235]
ds_read_b128 a[220:223], v13 offset:24576
v_cvt_pk_bf16_f32 v64, v192, v193
v_mfma_f32_16x16x32_bf16 v[240:243], a[192:195], v[160:163], v[104:107]
v_exp_f32 v195, v195
v_mfma_f32_16x16x32_bf16 v[240:243], a[196:199], v[164:167], v[240:243]
ds_read_b64_tr_b16 a[224:225], v2 offset:0
v_cvt_pk_bf16_f32 v65, v194, v195
v_mfma_f32_16x16x32_bf16 v[240:243], a[200:203], v[168:171], v[240:243]
v_exp_f32 v200, v200
v_mfma_f32_16x16x32_bf16 v[240:243], a[204:207], v[172:175], v[240:243]
ds_read_b64_tr_b16 a[226:227], v2 offset:8192
ds_read_b64_tr_b16 a[228:229], v2 offset:16384
v_mfma_f32_16x16x32_bf16 v[248:251], a[192:195], v[176:179], v[108:111]
v_exp_f32 v201, v201
v_mfma_f32_16x16x32_bf16 v[248:251], a[196:199], v[180:183], v[248:251]
buffer_store_dwordx4 a[132:135], v1, s[40:43], s76 offen offset:1024 sc1
v_mfma_f32_16x16x32_bf16 v[248:251], a[200:203], v[184:187], v[248:251]
ds_read_b64_tr_b16 a[230:231], v2 offset:24576
ds_read_b64_tr_b16 a[232:233], v3 offset:0
v_mfma_f32_16x16x32_bf16 v[248:251], a[204:207], v[188:191], v[248:251]
s_waitcnt lgkmcnt(5)
ds_read_b64_tr_b16 a[234:235], v3 offset:8192
v_cvt_pk_bf16_f32 v68, v200, v201
v_mfma_f32_16x16x32_bf16 v[228:231], a[208:211], v[128:131], v[96:99]
v_exp_f32 v202, v202
v_mfma_f32_16x16x32_bf16 v[228:231], a[212:215], v[132:135], v[228:231]
ds_read_b64_tr_b16 a[236:237], v3 offset:16384
ds_read_b64_tr_b16 a[238:239], v3 offset:24576
v_mfma_f32_16x16x32_bf16 v[228:231], a[216:219], v[136:139], v[228:231]
v_exp_f32 v203, v203
v_mfma_f32_16x16x32_bf16 v[228:231], a[220:223], v[140:143], v[228:231]
ds_read_b64_tr_b16 a[240:241], v4 offset:0
v_cvt_pk_bf16_f32 v69, v202, v203
v_mfma_f32_16x16x32_bf16 v[236:239], a[208:211], v[144:147], v[100:103]
v_exp_f32 v208, v208
v_mfma_f32_16x16x32_bf16 v[236:239], a[212:215], v[148:151], v[236:239]
ds_read_b64_tr_b16 a[242:243], v4 offset:8192
ds_read_b64_tr_b16 a[244:245], v4 offset:16384
v_mfma_f32_16x16x32_bf16 v[236:239], a[216:219], v[152:155], v[236:239]
v_exp_f32 v209, v209
v_mfma_f32_16x16x32_bf16 v[236:239], a[220:223], v[156:159], v[236:239]
ds_read_b64_tr_b16 a[246:247], v4 offset:24576
v_add_f32 v126, v126, v208
v_mfma_f32_16x16x32_bf16 v[244:247], a[208:211], v[160:163], v[104:107]
buffer_store_dwordx4 a[136:139], v1, s[40:43], s76 offen offset:2048 sc1
v_mfma_f32_16x16x32_bf16 v[244:247], a[212:215], v[164:167], v[244:247]
v_exp_f32 v210, v210
v_mfma_f32_16x16x32_bf16 v[244:247], a[216:219], v[168:171], v[244:247]
ds_read_b64_tr_b16 a[248:249], v5 offset:0
ds_read_b64_tr_b16 a[250:251], v5 offset:8192
v_mfma_f32_16x16x32_bf16 v[244:247], a[220:223], v[172:175], v[244:247]
v_exp_f32 v211, v211
v_mfma_f32_16x16x32_bf16 v[252:255], a[208:211], v[176:179], v[108:111]
ds_read_b64_tr_b16 a[252:253], v5 offset:16384
ds_read_b64_tr_b16 a[254:255], v5 offset:24576
v_mfma_f32_16x16x32_bf16 v[252:255], a[212:215], v[180:183], v[252:255]
v_exp_f32 v216, v216
v_mfma_f32_16x16x32_bf16 v[252:255], a[216:219], v[184:187], v[252:255]
v_exp_f32 v217, v217
v_mfma_f32_16x16x32_bf16 v[252:255], a[220:223], v[188:191], v[252:255]
s_waitcnt lgkmcnt(12)
v_add_f32 v126, v126, v209
v_cvt_pk_bf16_f32 v72, v208, v209
v_mfma_f32_16x16x32_bf16 a[0:3], a[224:227], v[32:35], 0
v_exp_f32 v218, v218
v_mfma_f32_16x16x32_bf16 a[0:3], a[228:231], v[48:51], a[0:3]
v_add_f32 v126, v126, v210
v_add_f32 v126, v126, v211
v_cvt_pk_bf16_f32 v73, v210, v211
v_mfma_f32_16x16x32_bf16 a[4:7], a[224:227], v[36:39], 0
v_exp_f32 v219, v219
v_mfma_f32_16x16x32_bf16 a[4:7], a[228:231], v[52:55], a[4:7]
buffer_store_dwordx4 a[140:143], v1, s[40:43], s76 offen offset:3072 sc1
v_mfma_f32_16x16x32_bf16 a[8:11], a[224:227], v[40:43], 0
v_exp_f32 v196, v196
v_mfma_f32_16x16x32_bf16 a[8:11], a[228:231], v[56:59], a[8:11]
v_add_f32 v127, v127, v216
v_add_f32 v127, v127, v217
v_mfma_f32_16x16x32_bf16 a[12:15], a[224:227], v[44:47], 0
v_exp_f32 v197, v197
v_mfma_f32_16x16x32_bf16 a[12:15], a[228:231], v[60:63], a[12:15]
s_waitcnt lgkmcnt(8)
v_cvt_pk_bf16_f32 v76, v216, v217
v_add_f32 v127, v127, v218
v_mfma_f32_16x16x32_bf16 a[16:19], a[232:235], v[32:35], 0
v_exp_f32 v198, v198
v_mfma_f32_16x16x32_bf16 a[16:19], a[236:239], v[48:51], a[16:19]
ds_read_b64_tr_b16 a[224:225], v14 offset:0
ds_read_b64_tr_b16 a[226:227], v14 offset:8192
v_mfma_f32_16x16x32_bf16 a[20:23], a[232:235], v[36:39], 0
v_exp_f32 v199, v199
v_mfma_f32_16x16x32_bf16 a[20:23], a[236:239], v[52:55], a[20:23]
ds_read_b64_tr_b16 a[228:229], v14 offset:16384
ds_read_b64_tr_b16 a[230:231], v14 offset:24576
v_mfma_f32_16x16x32_bf16 a[24:27], a[232:235], v[40:43], 0
v_exp_f32 v204, v204
v_mfma_f32_16x16x32_bf16 a[24:27], a[236:239], v[56:59], a[24:27]
buffer_store_dwordx4 a[144:147], v1, s[40:43], s77 offen offset:0 sc1
v_mfma_f32_16x16x32_bf16 a[28:31], a[232:235], v[44:47], 0
v_exp_f32 v205, v205
v_mfma_f32_16x16x32_bf16 a[28:31], a[236:239], v[60:63], a[28:31]
v_add_f32 v127, v127, v219
v_cvt_pk_bf16_f32 v77, v218, v219
v_mfma_f32_16x16x32_bf16 v[116:119], v[112:115], v[32:35], 0
v_exp_f32 v206, v206
v_mfma_f32_16x16x32_bf16 v[116:119], v[112:115], v[48:51], v[116:119]
s_waitcnt lgkmcnt(8)
v_cvt_pk_bf16_f32 v66, v196, v197
v_cvt_pk_bf16_f32 v67, v198, v199
v_mfma_f32_16x16x32_bf16 a[32:35], a[240:243], v[32:35], 0
v_exp_f32 v207, v207
v_mfma_f32_16x16x32_bf16 a[32:35], a[244:247], v[48:51], a[32:35]
ds_read_b64_tr_b16 a[232:233], v15 offset:0
ds_read_b64_tr_b16 a[234:235], v15 offset:8192
v_mfma_f32_16x16x32_bf16 a[36:39], a[240:243], v[36:39], 0
v_exp_f32 v212, v212
v_mfma_f32_16x16x32_bf16 a[36:39], a[244:247], v[52:55], a[36:39]
ds_read_b64_tr_b16 a[236:237], v15 offset:16384
ds_read_b64_tr_b16 a[238:239], v15 offset:24576
v_mfma_f32_16x16x32_bf16 a[40:43], a[240:243], v[40:43], 0
v_exp_f32 v213, v213
v_mfma_f32_16x16x32_bf16 a[40:43], a[244:247], v[56:59], a[40:43]
v_cvt_pk_bf16_f32 v70, v204, v205
v_cvt_pk_bf16_f32 v71, v206, v207
v_add_f32 v126, v126, v212
v_mfma_f32_16x16x32_bf16 a[44:47], a[240:243], v[44:47], 0
buffer_store_dwordx4 a[148:151], v1, s[40:43], s77 offen offset:1024 sc1
v_mfma_f32_16x16x32_bf16 a[44:47], a[244:247], v[60:63], a[44:47]
s_waitcnt lgkmcnt(8)
v_exp_f32 v214, v214
v_mfma_f32_16x16x32_bf16 a[48:51], a[248:251], v[32:35], 0
v_exp_f32 v215, v215
v_mfma_f32_16x16x32_bf16 a[48:51], a[252:255], v[48:51], a[48:51]
ds_read_b64_tr_b16 a[240:241], v16 offset:0
ds_read_b64_tr_b16 a[242:243], v16 offset:8192
v_mfma_f32_16x16x32_bf16 a[52:55], a[248:251], v[36:39], 0
v_exp_f32 v220, v220
v_mfma_f32_16x16x32_bf16 a[52:55], a[252:255], v[52:55], a[52:55]
ds_read_b64_tr_b16 a[244:245], v16 offset:16384
ds_read_b64_tr_b16 a[246:247], v16 offset:24576
v_mfma_f32_16x16x32_bf16 a[56:59], a[248:251], v[40:43], 0
v_exp_f32 v221, v221
v_mfma_f32_16x16x32_bf16 a[56:59], a[252:255], v[56:59], a[56:59]
v_add_f32 v126, v126, v213
v_cvt_pk_bf16_f32 v74, v212, v213
v_mfma_f32_16x16x32_bf16 a[60:63], a[248:251], v[44:47], 0
v_exp_f32 v222, v222
v_mfma_f32_16x16x32_bf16 a[60:63], a[252:255], v[60:63], a[60:63]
v_add_f32 v126, v126, v214
v_add_f32 v126, v126, v215
v_mfma_f32_16x16x32_bf16 v[120:123], v[112:115], v[36:39], 0
v_exp_f32 v223, v223
v_mfma_f32_16x16x32_bf16 v[120:123], v[112:115], v[52:55], v[120:123]
s_waitcnt lgkmcnt(8)
v_cvt_pk_bf16_f32 v75, v214, v215
v_add_f32 v127, v127, v220
v_mfma_f32_16x16x32_bf16 a[64:67], a[224:227], v[32:35], 0
ds_read_b64_tr_b16 a[248:249], v17 offset:0
v_add_f32 v127, v127, v221
v_mfma_f32_16x16x32_bf16 a[64:67], a[228:231], v[48:51], a[64:67]
ds_read_b64_tr_b16 a[250:251], v17 offset:8192
v_cvt_pk_bf16_f32 v78, v220, v221
v_mfma_f32_16x16x32_bf16 a[68:71], a[224:227], v[36:39], 0
v_exp_f32 v224, v224
v_mfma_f32_16x16x32_bf16 a[68:71], a[228:231], v[52:55], a[68:71]
ds_read_b64_tr_b16 a[252:253], v17 offset:16384
ds_read_b64_tr_b16 a[254:255], v17 offset:24576
v_mfma_f32_16x16x32_bf16 a[72:75], a[224:227], v[40:43], 0
v_exp_f32 v225, v225
v_mfma_f32_16x16x32_bf16 a[72:75], a[228:231], v[56:59], a[72:75]
v_add_f32 v127, v127, v222
v_add_f32 v127, v127, v223
v_mfma_f32_16x16x32_bf16 a[76:79], a[224:227], v[44:47], 0
v_exp_f32 v226, v226
v_mfma_f32_16x16x32_bf16 a[76:79], a[228:231], v[60:63], a[76:79]
s_waitcnt lgkmcnt(10)
v_cvt_pk_bf16_f32 v79, v222, v223
v_cvt_pk_bf16_f32 v80, v224, v225
v_mfma_f32_16x16x32_bf16 a[80:83], a[232:235], v[32:35], 0
s_waitcnt vmcnt(6) lgkmcnt(0)
v_exp_f32 v227, v227
v_mfma_f32_16x16x32_bf16 a[80:83], a[236:239], v[48:51], a[80:83]
s_barrier
v_mfma_f32_16x16x32_bf16 a[84:87], a[232:235], v[36:39], 0
s_add_u32 m0, s48, 0
ds_read_b128 a[192:195], v10 offset:32768
v_exp_f32 v232, v232
v_mfma_f32_16x16x32_bf16 a[84:87], a[236:239], v[52:55], a[84:87]
s_add_u32 s46, s45, 8192
ds_read_b128 a[196:199], v11 offset:32768
v_cvt_pk_bf16_f32 v81, v226, v227
v_mfma_f32_16x16x32_bf16 a[88:91], a[232:235], v[40:43], 0
s_and_b32 s46, s46, 0x7ffff
v_exp_f32 v233, v233
v_mfma_f32_16x16x32_bf16 a[88:91], a[236:239], v[56:59], a[88:91]
ds_read_b128 a[200:203], v12 offset:32768
ds_read_b128 a[204:207], v13 offset:32768
v_mfma_f32_16x16x32_bf16 a[92:95], a[232:235], v[44:47], 0
v_exp_f32 v234, v234
v_mfma_f32_16x16x32_bf16 a[92:95], a[236:239], v[60:63], a[92:95]
ds_read_b128 a[208:211], v10 offset:40960
v_cvt_pk_bf16_f32 v84, v232, v233
v_mfma_f32_16x16x32_bf16 a[96:99], a[240:243], v[32:35], 0
v_exp_f32 v235, v235
v_mfma_f32_16x16x32_bf16 a[96:99], a[244:247], v[48:51], a[96:99]
buffer_load_dwordx4 v22, s[8:11], s46 offen lds
v_mfma_f32_16x16x32_bf16 a[100:103], a[240:243], v[36:39], 0
ds_read_b128 a[212:215], v11 offset:40960
ds_read_b128 a[216:219], v12 offset:40960
v_mfma_f32_16x16x32_bf16 a[100:103], a[244:247], v[52:55], a[100:103]
v_exp_f32 v240, v240
v_mfma_f32_16x16x32_bf16 a[104:107], a[240:243], v[40:43], 0
v_exp_f32 v241, v241
v_mfma_f32_16x16x32_bf16 a[104:107], a[244:247], v[56:59], a[104:107]
buffer_load_dwordx4 v23, s[8:11], s46 offen offset:1024 lds
v_mfma_f32_16x16x32_bf16 a[108:111], a[240:243], v[44:47], 0
v_exp_f32 v242, v242
v_mfma_f32_16x16x32_bf16 a[108:111], a[244:247], v[60:63], a[108:111]
ds_read_b128 a[220:223], v13 offset:40960
v_cvt_pk_bf16_f32 v85, v234, v235
v_mfma_f32_16x16x32_bf16 a[112:115], a[248:251], v[32:35], 0
v_exp_f32 v243, v243
v_mfma_f32_16x16x32_bf16 a[112:115], a[252:255], v[48:51], a[112:115]
v_add_f32 v126, v126, v240
v_add_f32 v126, v126, v241
v_mfma_f32_16x16x32_bf16 a[116:119], a[248:251], v[36:39], 0
buffer_load_dwordx4 v24, s[12:15], s44 offen offset:2048 lds
v_mfma_f32_16x16x32_bf16 a[116:119], a[252:255], v[52:55], a[116:119]
v_exp_f32 v248, v248
v_mfma_f32_16x16x32_bf16 a[120:123], a[248:251], v[40:43], 0
v_exp_f32 v249, v249
v_mfma_f32_16x16x32_bf16 a[120:123], a[252:255], v[56:59], a[120:123]
v_cvt_pk_bf16_f32 v88, v240, v241
v_add_f32 v126, v126, v242
v_mfma_f32_16x16x32_bf16 a[124:127], a[248:251], v[44:47], 0
buffer_load_dwordx4 v25, s[12:15], s44 offen offset:3072 lds
v_mfma_f32_16x16x32_bf16 a[124:127], a[252:255], v[60:63], a[124:127]
s_waitcnt lgkmcnt(0)
v_exp_f32 v250, v250
v_add_f32 v126, v126, v243
v_mfma_f32_16x16x32_bf16 v[192:195], a[192:195], v[128:131], v[96:99]
v_exp_f32 v251, v251
v_mfma_f32_16x16x32_bf16 v[192:195], a[196:199], v[132:135], v[192:195]
s_add_u32 m0, s48, 16384
v_cvt_pk_bf16_f32 v89, v242, v243
v_add_f32 v127, v127, v248
v_mfma_f32_16x16x32_bf16 v[192:195], a[200:203], v[136:139], v[192:195]
s_add_u32 s47, s46, 8192
v_exp_f32 v228, v228
v_mfma_f32_16x16x32_bf16 v[192:195], a[204:207], v[140:143], v[192:195]
s_and_b32 s47, s47, 0x7ffff
v_add_f32 v127, v127, v249
v_cvt_pk_bf16_f32 v92, v248, v249
v_mfma_f32_16x16x32_bf16 v[200:203], a[192:195], v[144:147], v[100:103]
v_exp_f32 v229, v229
v_mfma_f32_16x16x32_bf16 v[200:203], a[196:199], v[148:151], v[200:203]
buffer_load_dwordx4 v22, s[8:11], s47 offen lds
v_mfma_f32_16x16x32_bf16 v[200:203], a[200:203], v[152:155], v[200:203]
v_exp_f32 v230, v230
v_mfma_f32_16x16x32_bf16 v[200:203], a[204:207], v[156:159], v[200:203]
v_add_f32 v127, v127, v250
v_add_f32 v127, v127, v251
v_mfma_f32_16x16x32_bf16 v[208:211], a[192:195], v[160:163], v[104:107]
v_exp_f32 v231, v231
v_mfma_f32_16x16x32_bf16 v[208:211], a[196:199], v[164:167], v[208:211]
v_cvt_pk_bf16_f32 v93, v250, v251
v_cvt_pk_bf16_f32 v82, v228, v229
v_mfma_f32_16x16x32_bf16 v[208:211], a[200:203], v[168:171], v[208:211]
buffer_load_dwordx4 v23, s[8:11], s47 offen offset:1024 lds
v_mfma_f32_16x16x32_bf16 v[208:211], a[204:207], v[172:175], v[208:211]
v_exp_f32 v236, v236
v_mfma_f32_16x16x32_bf16 v[216:219], a[192:195], v[176:179], v[108:111]
v_exp_f32 v237, v237
v_mfma_f32_16x16x32_bf16 v[216:219], a[196:199], v[180:183], v[216:219]
v_cvt_pk_bf16_f32 v83, v230, v231
v_cvt_pk_bf16_f32 v86, v236, v237
v_mfma_f32_16x16x32_bf16 v[216:219], a[200:203], v[184:187], v[216:219]
v_exp_f32 v238, v238
v_mfma_f32_16x16x32_bf16 v[216:219], a[204:207], v[188:191], v[216:219]
v_exp_f32 v239, v239
v_mfma_f32_16x16x32_bf16 v[196:199], a[208:211], v[128:131], v[96:99]
v_exp_f32 v244, v244
v_mfma_f32_16x16x32_bf16 v[196:199], a[212:215], v[132:135], v[196:199]
ds_read_b128 a[192:195], v10 offset:49152
v_cvt_pk_bf16_f32 v87, v238, v239
v_mfma_f32_16x16x32_bf16 v[196:199], a[216:219], v[136:139], v[196:199]
v_exp_f32 v245, v245
v_mfma_f32_16x16x32_bf16 v[196:199], a[220:223], v[140:143], v[196:199]
ds_read_b128 a[196:199], v11 offset:49152
v_add_f32 v126, v126, v244
v_mfma_f32_16x16x32_bf16 v[204:207], a[208:211], v[144:147], v[100:103]
v_add_f32 v126, v126, v245
v_cvt_pk_bf16_f32 v90, v244, v245
v_mfma_f32_16x16x32_bf16 v[204:207], a[212:215], v[148:151], v[204:207]
v_exp_f32 v246, v246
v_mfma_f32_16x16x32_bf16 v[204:207], a[216:219], v[152:155], v[204:207]
buffer_load_dwordx4 v24, s[12:15], s45 offen offset:2048 lds
v_mfma_f32_16x16x32_bf16 v[204:207], a[220:223], v[156:159], v[204:207]
ds_read_b128 a[200:203], v12 offset:49152
ds_read_b128 a[204:207], v13 offset:49152
v_mfma_f32_16x16x32_bf16 v[212:215], a[208:211], v[160:163], v[104:107]
v_exp_f32 v247, v247
v_mfma_f32_16x16x32_bf16 v[212:215], a[212:215], v[164:167], v[212:215]
v_add_f32 v126, v126, v246
v_add_f32 v126, v126, v247
v_mfma_f32_16x16x32_bf16 v[212:215], a[216:219], v[168:171], v[212:215]
v_exp_f32 v252, v252
v_mfma_f32_16x16x32_bf16 v[212:215], a[220:223], v[172:175], v[212:215]
v_cvt_pk_bf16_f32 v91, v246, v247
v_add_f32 v127, v127, v252
v_mfma_f32_16x16x32_bf16 v[220:223], a[208:211], v[176:179], v[108:111]
buffer_load_dwordx4 v25, s[12:15], s45 offen offset:3072 lds
v_mfma_f32_16x16x32_bf16 v[220:223], a[212:215], v[180:183], v[220:223]
v_exp_f32 v253, v253
v_mfma_f32_16x16x32_bf16 v[220:223], a[216:219], v[184:187], v[220:223]
v_exp_f32 v254, v254
v_mfma_f32_16x16x32_bf16 v[220:223], a[220:223], v[188:191], v[220:223]
s_waitcnt lgkmcnt(0)
v_add_f32 v127, v127, v253
v_cvt_pk_bf16_f32 v94, v252, v253
v_mfma_f32_16x16x32_bf16 v[224:227], a[192:195], v[128:131], v[96:99]
v_exp_f32 v255, v255
v_add_f32 v127, v127, v254
v_mfma_f32_16x16x32_bf16 v[224:227], a[196:199], v[132:135], v[224:227]
ds_read_b128 a[208:211], v10 offset:57344
v_add_f32 v127, v127, v255
v_mfma_f32_16x16x32_bf16 v[224:227], a[200:203], v[136:139], v[224:227]
v_exp_f32 v192, v192
v_mfma_f32_16x16x32_bf16 v[224:227], a[204:207], v[140:143], v[224:227]
ds_read_b128 a[212:215], v11 offset:57344
v_cvt_pk_bf16_f32 v95, v254, v255
v_mfma_f32_16x16x32_bf16 v[232:235], a[192:195], v[144:147], v[100:103]
buffer_store_dwordx4 a[152:155], v1, s[40:43], s77 offen offset:2048 sc1
v_mfma_f32_16x16x32_bf16 v[232:235], a[196:199], v[148:151], v[232:235]
v_exp_f32 v193, v193
v_mfma_f32_16x16x32_bf16 v[232:235], a[200:203], v[152:155], v[232:235]
ds_read_b128 a[216:219], v12 offset:57344
v_cvt_pk_bf16_f32 v32, v192, v193
v_mfma_f32_16x16x32_bf16 v[232:235], a[204:207], v[156:159], v[232:235]
v_exp_f32 v194, v194
v_mfma_f32_16x16x32_bf16 v[240:243], a[192:195], v[160:163], v[104:107]
v_exp_f32 v195, v195
v_mfma_f32_16x16x32_bf16 v[240:243], a[196:199], v[164:167], v[240:243]
ds_read_b128 a[220:223], v13 offset:57344
ds_read_b64_tr_b16 a[224:225], v2 offset:32768
v_mfma_f32_16x16x32_bf16 v[240:243], a[200:203], v[168:171], v[240:243]
ds_read_b64_tr_b16 a[226:227], v2 offset:40960
v_cvt_pk_bf16_f32 v33, v194, v195
v_mfma_f32_16x16x32_bf16 v[240:243], a[204:207], v[172:175], v[240:243]
v_exp_f32 v200, v200
v_mfma_f32_16x16x32_bf16 v[248:251], a[192:195], v[176:179], v[108:111]
ds_read_b64_tr_b16 a[228:229], v2 offset:49152
ds_read_b64_tr_b16 a[230:231], v2 offset:57344
v_mfma_f32_16x16x32_bf16 v[248:251], a[196:199], v[180:183], v[248:251]
v_exp_f32 v201, v201
v_mfma_f32_16x16x32_bf16 v[248:251], a[200:203], v[184:187], v[248:251]
ds_read_b64_tr_b16 a[232:233], v3 offset:32768
v_cvt_pk_bf16_f32 v36, v200, v201
v_mfma_f32_16x16x32_bf16 v[248:251], a[204:207], v[188:191], v[248:251]
s_waitcnt lgkmcnt(5)
v_exp_f32 v202, v202
v_mfma_f32_16x16x32_bf16 v[228:231], a[208:211], v[128:131], v[96:99]
buffer_store_dwordx4 a[156:159], v1, s[40:43], s77 offen offset:3072 sc1
v_mfma_f32_16x16x32_bf16 v[228:231], a[212:215], v[132:135], v[228:231]
ds_read_b64_tr_b16 a[234:235], v3 offset:40960
ds_read_b64_tr_b16 a[236:237], v3 offset:49152
v_mfma_f32_16x16x32_bf16 v[228:231], a[216:219], v[136:139], v[228:231]
v_exp_f32 v203, v203
v_mfma_f32_16x16x32_bf16 v[228:231], a[220:223], v[140:143], v[228:231]
ds_read_b64_tr_b16 a[238:239], v3 offset:57344
ds_read_b64_tr_b16 a[240:241], v4 offset:32768
v_mfma_f32_16x16x32_bf16 v[236:239], a[208:211], v[144:147], v[100:103]
v_exp_f32 v208, v208
v_mfma_f32_16x16x32_bf16 v[236:239], a[212:215], v[148:151], v[236:239]
ds_read_b64_tr_b16 a[242:243], v4 offset:40960
ds_read_b64_tr_b16 a[244:245], v4 offset:49152
v_mfma_f32_16x16x32_bf16 v[236:239], a[216:219], v[152:155], v[236:239]
v_exp_f32 v209, v209
v_mfma_f32_16x16x32_bf16 v[236:239], a[220:223], v[156:159], v[236:239]
ds_read_b64_tr_b16 a[246:247], v4 offset:57344
v_cvt_pk_bf16_f32 v37, v202, v203
v_mfma_f32_16x16x32_bf16 v[244:247], a[208:211], v[160:163], v[104:107]
v_exp_f32 v210, v210
v_mfma_f32_16x16x32_bf16 v[244:247], a[212:215], v[164:167], v[244:247]
ds_read_b64_tr_b16 a[248:249], v5 offset:32768
ds_read_b64_tr_b16 a[250:251], v5 offset:40960
v_mfma_f32_16x16x32_bf16 v[244:247], a[216:219], v[168:171], v[244:247]
v_exp_f32 v211, v211
v_mfma_f32_16x16x32_bf16 v[244:247], a[220:223], v[172:175], v[244:247]
ds_read_b64_tr_b16 a[252:253], v5 offset:49152
ds_read_b64_tr_b16 a[254:255], v5 offset:57344
v_mfma_f32_16x16x32_bf16 v[252:255], a[208:211], v[176:179], v[108:111]
buffer_store_dwordx4 a[160:163], v1, s[40:43], s78 offen offset:0 sc1
v_mfma_f32_16x16x32_bf16 v[252:255], a[212:215], v[180:183], v[252:255]
v_exp_f32 v216, v216
v_mfma_f32_16x16x32_bf16 v[252:255], a[216:219], v[184:187], v[252:255]
v_exp_f32 v217, v217
v_mfma_f32_16x16x32_bf16 v[252:255], a[220:223], v[188:191], v[252:255]
s_waitcnt lgkmcnt(12)
v_add_f32 v126, v126, v208
v_add_f32 v126, v126, v209
v_mfma_f32_16x16x32_bf16 a[0:3], a[224:227], v[64:67], a[0:3]
v_exp_f32 v218, v218
v_mfma_f32_16x16x32_bf16 a[0:3], a[228:231], v[80:83], a[0:3]
v_cvt_pk_bf16_f32 v40, v208, v209
v_add_f32 v126, v126, v210
v_add_f32 v126, v126, v211
v_mfma_f32_16x16x32_bf16 a[4:7], a[224:227], v[68:71], a[4:7]
v_exp_f32 v219, v219
v_mfma_f32_16x16x32_bf16 a[4:7], a[228:231], v[84:87], a[4:7]
v_cvt_pk_bf16_f32 v41, v210, v211
v_add_f32 v127, v127, v216
v_mfma_f32_16x16x32_bf16 a[8:11], a[224:227], v[72:75], a[8:11]
v_exp_f32 v196, v196
v_mfma_f32_16x16x32_bf16 a[8:11], a[228:231], v[88:91], a[8:11]
v_add_f32 v127, v127, v217
v_cvt_pk_bf16_f32 v44, v216, v217
v_mfma_f32_16x16x32_bf16 a[12:15], a[224:227], v[76:79], a[12:15]
v_exp_f32 v197, v197
v_mfma_f32_16x16x32_bf16 a[12:15], a[228:231], v[92:95], a[12:15]
s_waitcnt lgkmcnt(8)
v_add_f32 v127, v127, v218
v_add_f32 v127, v127, v219
v_mfma_f32_16x16x32_bf16 a[16:19], a[232:235], v[64:67], a[16:19]
v_exp_f32 v198, v198
v_mfma_f32_16x16x32_bf16 a[16:19], a[236:239], v[80:83], a[16:19]
buffer_store_dwordx4 a[164:167], v1, s[40:43], s78 offen offset:1024 sc1
v_mfma_f32_16x16x32_bf16 a[20:23], a[232:235], v[68:71], a[20:23]
ds_read_b64_tr_b16 a[224:225], v14 offset:32768
ds_read_b64_tr_b16 a[226:227], v14 offset:40960
v_mfma_f32_16x16x32_bf16 a[20:23], a[236:239], v[84:87], a[20:23]
v_exp_f32 v199, v199
v_mfma_f32_16x16x32_bf16 a[24:27], a[232:235], v[72:75], a[24:27]
ds_read_b64_tr_b16 a[228:229], v14 offset:49152
ds_read_b64_tr_b16 a[230:231], v14 offset:57344
v_mfma_f32_16x16x32_bf16 a[24:27], a[236:239], v[88:91], a[24:27]
v_exp_f32 v204, v204
v_mfma_f32_16x16x32_bf16 a[28:31], a[232:235], v[76:79], a[28:31]
v_exp_f32 v205, v205
v_mfma_f32_16x16x32_bf16 a[28:31], a[236:239], v[92:95], a[28:31]
v_cvt_pk_bf16_f32 v45, v218, v219
v_cvt_pk_bf16_f32 v34, v196, v197
v_mfma_f32_16x16x32_bf16 v[116:119], v[112:115], v[64:67], v[116:119]
v_exp_f32 v206, v206
v_mfma_f32_16x16x32_bf16 v[116:119], v[112:115], v[80:83], v[116:119]
s_waitcnt lgkmcnt(8)
v_cvt_pk_bf16_f32 v35, v198, v199
v_cvt_pk_bf16_f32 v38, v204, v205
v_mfma_f32_16x16x32_bf16 a[32:35], a[240:243], v[64:67], a[32:35]
v_exp_f32 v207, v207
v_mfma_f32_16x16x32_bf16 a[32:35], a[244:247], v[80:83], a[32:35]
ds_read_b64_tr_b16 a[232:233], v15 offset:32768
ds_read_b64_tr_b16 a[234:235], v15 offset:40960
v_mfma_f32_16x16x32_bf16 a[36:39], a[240:243], v[68:71], a[36:39]
v_exp_f32 v212, v212
v_mfma_f32_16x16x32_bf16 a[36:39], a[244:247], v[84:87], a[36:39]
ds_read_b64_tr_b16 a[236:237], v15 offset:49152
ds_read_b64_tr_b16 a[238:239], v15 offset:57344
v_mfma_f32_16x16x32_bf16 a[40:43], a[240:243], v[72:75], a[40:43]
buffer_store_dwordx4 a[168:171], v1, s[40:43], s78 offen offset:2048 sc1
v_mfma_f32_16x16x32_bf16 a[40:43], a[244:247], v[88:91], a[40:43]
v_exp_f32 v213, v213
v_mfma_f32_16x16x32_bf16 a[44:47], a[240:243], v[76:79], a[44:47]
v_exp_f32 v214, v214
v_mfma_f32_16x16x32_bf16 a[44:47], a[244:247], v[92:95], a[44:47]
s_waitcnt lgkmcnt(8)
v_cvt_pk_bf16_f32 v39, v206, v207
v_add_f32 v126, v126, v212
v_mfma_f32_16x16x32_bf16 a[48:51], a[248:251], v[64:67], a[48:51]
v_exp_f32 v215, v215
v_mfma_f32_16x16x32_bf16 a[48:51], a[252:255], v[80:83], a[48:51]
ds_read_b64_tr_b16 a[240:241], v16 offset:32768
ds_read_b64_tr_b16 a[242:243], v16 offset:40960
v_mfma_f32_16x16x32_bf16 a[52:55], a[248:251], v[68:71], a[52:55]
v_exp_f32 v220, v220
v_mfma_f32_16x16x32_bf16 a[52:55], a[252:255], v[84:87], a[52:55]
ds_read_b64_tr_b16 a[244:245], v16 offset:49152
ds_read_b64_tr_b16 a[246:247], v16 offset:57344
v_mfma_f32_16x16x32_bf16 a[56:59], a[248:251], v[72:75], a[56:59]
v_exp_f32 v221, v221
v_mfma_f32_16x16x32_bf16 a[56:59], a[252:255], v[88:91], a[56:59]
v_add_f32 v126, v126, v213
v_cvt_pk_bf16_f32 v42, v212, v213
v_mfma_f32_16x16x32_bf16 a[60:63], a[248:251], v[76:79], a[60:63]
v_exp_f32 v222, v222
v_mfma_f32_16x16x32_bf16 a[60:63], a[252:255], v[92:95], a[60:63]
v_add_f32 v126, v126, v214
v_add_f32 v126, v126, v215
v_mfma_f32_16x16x32_bf16 v[120:123], v[112:115], v[68:71], v[120:123]
v_exp_f32 v223, v223
v_cvt_pk_bf16_f32 v43, v214, v215
v_mfma_f32_16x16x32_bf16 v[120:123], v[112:115], v[84:87], v[120:123]
s_waitcnt lgkmcnt(8)
v_add_f32 v127, v127, v220
v_add_f32 v127, v127, v221
v_mfma_f32_16x16x32_bf16 a[64:67], a[224:227], v[64:67], a[64:67]
ds_read_b64_tr_b16 a[248:249], v17 offset:32768
v_cvt_pk_bf16_f32 v46, v220, v221
v_mfma_f32_16x16x32_bf16 a[64:67], a[228:231], v[80:83], a[64:67]
ds_read_b64_tr_b16 a[250:251], v17 offset:40960
v_add_f32 v127, v127, v222
v_mfma_f32_16x16x32_bf16 a[68:71], a[224:227], v[68:71], a[68:71]
v_exp_f32 v224, v224
v_mfma_f32_16x16x32_bf16 a[68:71], a[228:231], v[84:87], a[68:71]
ds_read_b64_tr_b16 a[252:253], v17 offset:49152
ds_read_b64_tr_b16 a[254:255], v17 offset:57344
v_mfma_f32_16x16x32_bf16 a[72:75], a[224:227], v[72:75], a[72:75]
v_exp_f32 v225, v225
v_mfma_f32_16x16x32_bf16 a[72:75], a[228:231], v[88:91], a[72:75]
v_add_f32 v127, v127, v223
v_cvt_pk_bf16_f32 v47, v222, v223
v_mfma_f32_16x16x32_bf16 a[76:79], a[224:227], v[76:79], a[76:79]
v_exp_f32 v226, v226
v_mfma_f32_16x16x32_bf16 a[76:79], a[228:231], v[92:95], a[76:79]
s_waitcnt lgkmcnt(10)
v_exp_f32 v227, v227
v_mfma_f32_16x16x32_bf16 a[80:83], a[232:235], v[64:67], a[80:83]
s_waitcnt vmcnt(5) lgkmcnt(0)
v_cvt_pk_bf16_f32 v48, v224, v225
v_cvt_pk_bf16_f32 v49, v226, v227
v_mfma_f32_16x16x32_bf16 a[80:83], a[236:239], v[80:83], a[80:83]
s_barrier
v_mfma_f32_16x16x32_bf16 a[84:87], a[232:235], v[68:71], a[84:87]
s_add_u32 m0, s48, 32768
v_exp_f32 v232, v232
v_mfma_f32_16x16x32_bf16 a[84:87], a[236:239], v[84:87], a[84:87]
s_add_u32 s44, s47, 8192
ds_read_b128 a[192:195], v10 offset:0
ds_read_b128 a[196:199], v11 offset:0
v_mfma_f32_16x16x32_bf16 a[88:91], a[232:235], v[72:75], a[88:91]
s_and_b32 s44, s44, 0x7ffff
v_exp_f32 v233, v233
v_mfma_f32_16x16x32_bf16 a[88:91], a[236:239], v[88:91], a[88:91]
ds_read_b128 a[200:203], v12 offset:0
ds_read_b128 a[204:207], v13 offset:0
v_mfma_f32_16x16x32_bf16 a[92:95], a[232:235], v[76:79], a[92:95]
v_exp_f32 v234, v234
v_mfma_f32_16x16x32_bf16 a[92:95], a[236:239], v[92:95], a[92:95]
ds_read_b128 a[208:211], v10 offset:8192
v_cvt_pk_bf16_f32 v52, v232, v233
v_mfma_f32_16x16x32_bf16 a[96:99], a[240:243], v[64:67], a[96:99]
v_exp_f32 v235, v235
v_mfma_f32_16x16x32_bf16 a[96:99], a[244:247], v[80:83], a[96:99]
buffer_load_dwordx4 v22, s[8:11], s44 offen lds
v_mfma_f32_16x16x32_bf16 a[100:103], a[240:243], v[68:71], a[100:103]
ds_read_b128 a[212:215], v11 offset:8192
ds_read_b128 a[216:219], v12 offset:8192
v_mfma_f32_16x16x32_bf16 a[100:103], a[244:247], v[84:87], a[100:103]
v_exp_f32 v240, v240
v_mfma_f32_16x16x32_bf16 a[104:107], a[240:243], v[72:75], a[104:107]
v_exp_f32 v241, v241
v_mfma_f32_16x16x32_bf16 a[104:107], a[244:247], v[88:91], a[104:107]
buffer_load_dwordx4 v23, s[8:11], s44 offen offset:1024 lds
v_mfma_f32_16x16x32_bf16 a[108:111], a[240:243], v[76:79], a[108:111]
v_exp_f32 v242, v242
v_mfma_f32_16x16x32_bf16 a[108:111], a[244:247], v[92:95], a[108:111]
ds_read_b128 a[220:223], v13 offset:8192
v_cvt_pk_bf16_f32 v53, v234, v235
v_mfma_f32_16x16x32_bf16 a[112:115], a[248:251], v[64:67], a[112:115]
v_exp_f32 v243, v243
v_mfma_f32_16x16x32_bf16 a[112:115], a[252:255], v[80:83], a[112:115]
v_add_f32 v126, v126, v240
v_add_f32 v126, v126, v241
v_mfma_f32_16x16x32_bf16 a[116:119], a[248:251], v[68:71], a[116:119]
buffer_load_dwordx4 v24, s[12:15], s46 offen offset:2048 lds
v_mfma_f32_16x16x32_bf16 a[116:119], a[252:255], v[84:87], a[116:119]
v_exp_f32 v248, v248
v_mfma_f32_16x16x32_bf16 a[120:123], a[248:251], v[72:75], a[120:123]
v_exp_f32 v249, v249
v_mfma_f32_16x16x32_bf16 a[120:123], a[252:255], v[88:91], a[120:123]
v_cvt_pk_bf16_f32 v56, v240, v241
v_add_f32 v126, v126, v242
v_mfma_f32_16x16x32_bf16 a[124:127], a[248:251], v[76:79], a[124:127]
buffer_load_dwordx4 v25, s[12:15], s46 offen offset:3072 lds
v_mfma_f32_16x16x32_bf16 a[124:127], a[252:255], v[92:95], a[124:127]
s_waitcnt lgkmcnt(0)
v_exp_f32 v250, v250
v_add_f32 v126, v126, v243
v_mfma_f32_16x16x32_bf16 v[192:195], a[192:195], v[128:131], v[96:99]
v_exp_f32 v251, v251
v_mfma_f32_16x16x32_bf16 v[192:195], a[196:199], v[132:135], v[192:195]
s_add_u32 m0, s48, 49152
v_cvt_pk_bf16_f32 v57, v242, v243
v_add_f32 v127, v127, v248
v_mfma_f32_16x16x32_bf16 v[192:195], a[200:203], v[136:139], v[192:195]
s_add_u32 s45, s44, 8192
v_exp_f32 v228, v228
v_mfma_f32_16x16x32_bf16 v[192:195], a[204:207], v[140:143], v[192:195]
s_and_b32 s45, s45, 0x7ffff
v_add_f32 v127, v127, v249
v_cvt_pk_bf16_f32 v60, v248, v249
v_mfma_f32_16x16x32_bf16 v[200:203], a[192:195], v[144:147], v[100:103]
v_exp_f32 v229, v229
v_mfma_f32_16x16x32_bf16 v[200:203], a[196:199], v[148:151], v[200:203]
buffer_load_dwordx4 v22, s[8:11], s45 offen lds
v_mfma_f32_16x16x32_bf16 v[200:203], a[200:203], v[152:155], v[200:203]
v_exp_f32 v230, v230
v_mfma_f32_16x16x32_bf16 v[200:203], a[204:207], v[156:159], v[200:203]
v_add_f32 v127, v127, v250
v_add_f32 v127, v127, v251
v_mfma_f32_16x16x32_bf16 v[208:211], a[192:195], v[160:163], v[104:107]
v_exp_f32 v231, v231
v_mfma_f32_16x16x32_bf16 v[208:211], a[196:199], v[164:167], v[208:211]
v_cvt_pk_bf16_f32 v61, v250, v251
v_cvt_pk_bf16_f32 v50, v228, v229
v_mfma_f32_16x16x32_bf16 v[208:211], a[200:203], v[168:171], v[208:211]
buffer_load_dwordx4 v23, s[8:11], s45 offen offset:1024 lds
v_mfma_f32_16x16x32_bf16 v[208:211], a[204:207], v[172:175], v[208:211]
v_exp_f32 v236, v236
v_mfma_f32_16x16x32_bf16 v[216:219], a[192:195], v[176:179], v[108:111]
v_exp_f32 v237, v237
v_mfma_f32_16x16x32_bf16 v[216:219], a[196:199], v[180:183], v[216:219]
v_cvt_pk_bf16_f32 v51, v230, v231
v_cvt_pk_bf16_f32 v54, v236, v237
v_mfma_f32_16x16x32_bf16 v[216:219], a[200:203], v[184:187], v[216:219]
v_exp_f32 v238, v238
v_mfma_f32_16x16x32_bf16 v[216:219], a[204:207], v[188:191], v[216:219]
v_exp_f32 v239, v239
v_mfma_f32_16x16x32_bf16 v[196:199], a[208:211], v[128:131], v[96:99]
v_exp_f32 v244, v244
v_mfma_f32_16x16x32_bf16 v[196:199], a[212:215], v[132:135], v[196:199]
ds_read_b128 a[192:195], v10 offset:16384
v_cvt_pk_bf16_f32 v55, v238, v239
v_mfma_f32_16x16x32_bf16 v[196:199], a[216:219], v[136:139], v[196:199]
v_exp_f32 v245, v245
v_mfma_f32_16x16x32_bf16 v[196:199], a[220:223], v[140:143], v[196:199]
ds_read_b128 a[196:199], v11 offset:16384
v_add_f32 v126, v126, v244
v_mfma_f32_16x16x32_bf16 v[204:207], a[208:211], v[144:147], v[100:103]
v_add_f32 v126, v126, v245
v_cvt_pk_bf16_f32 v58, v244, v245
v_mfma_f32_16x16x32_bf16 v[204:207], a[212:215], v[148:151], v[204:207]
v_exp_f32 v246, v246
v_mfma_f32_16x16x32_bf16 v[204:207], a[216:219], v[152:155], v[204:207]
buffer_load_dwordx4 v24, s[12:15], s47 offen offset:2048 lds
v_mfma_f32_16x16x32_bf16 v[204:207], a[220:223], v[156:159], v[204:207]
ds_read_b128 a[200:203], v12 offset:16384
ds_read_b128 a[204:207], v13 offset:16384
v_mfma_f32_16x16x32_bf16 v[212:215], a[208:211], v[160:163], v[104:107]
v_exp_f32 v247, v247
v_mfma_f32_16x16x32_bf16 v[212:215], a[212:215], v[164:167], v[212:215]
v_add_f32 v126, v126, v246
v_add_f32 v126, v126, v247
v_mfma_f32_16x16x32_bf16 v[212:215], a[216:219], v[168:171], v[212:215]
v_exp_f32 v252, v252
v_mfma_f32_16x16x32_bf16 v[212:215], a[220:223], v[172:175], v[212:215]
v_cvt_pk_bf16_f32 v59, v246, v247
v_add_f32 v127, v127, v252
v_mfma_f32_16x16x32_bf16 v[220:223], a[208:211], v[176:179], v[108:111]
buffer_load_dwordx4 v25, s[12:15], s47 offen offset:3072 lds
v_mfma_f32_16x16x32_bf16 v[220:223], a[212:215], v[180:183], v[220:223]
v_exp_f32 v253, v253
v_mfma_f32_16x16x32_bf16 v[220:223], a[216:219], v[184:187], v[220:223]
v_exp_f32 v254, v254
v_mfma_f32_16x16x32_bf16 v[220:223], a[220:223], v[188:191], v[220:223]
s_waitcnt lgkmcnt(0)
v_add_f32 v127, v127, v253
v_cvt_pk_bf16_f32 v62, v252, v253
v_mfma_f32_16x16x32_bf16 v[224:227], a[192:195], v[128:131], v[96:99]
v_exp_f32 v255, v255
v_add_f32 v127, v127, v254
v_mfma_f32_16x16x32_bf16 v[224:227], a[196:199], v[132:135], v[224:227]
ds_read_b128 a[208:211], v10 offset:24576
v_add_f32 v127, v127, v255
v_mfma_f32_16x16x32_bf16 v[224:227], a[200:203], v[136:139], v[224:227]
v_exp_f32 v192, v192
v_mfma_f32_16x16x32_bf16 v[224:227], a[204:207], v[140:143], v[224:227]
ds_read_b128 a[212:215], v11 offset:24576
v_cvt_pk_bf16_f32 v63, v254, v255
v_mfma_f32_16x16x32_bf16 v[232:235], a[192:195], v[144:147], v[100:103]
buffer_store_dwordx4 a[172:175], v1, s[40:43], s78 offen offset:3072 sc1
v_mfma_f32_16x16x32_bf16 v[232:235], a[196:199], v[148:151], v[232:235]
v_exp_f32 v193, v193
v_mfma_f32_16x16x32_bf16 v[232:235], a[200:203], v[152:155], v[232:235]
ds_read_b128 a[216:219], v12 offset:24576
v_cvt_pk_bf16_f32 v64, v192, v193
v_mfma_f32_16x16x32_bf16 v[232:235], a[204:207], v[156:159], v[232:235]
v_exp_f32 v194, v194
v_mfma_f32_16x16x32_bf16 v[240:243], a[192:195], v[160:163], v[104:107]
v_exp_f32 v195, v195
v_mfma_f32_16x16x32_bf16 v[240:243], a[196:199], v[164:167], v[240:243]
ds_read_b128 a[220:223], v13 offset:24576
ds_read_b64_tr_b16 a[224:225], v2 offset:0
v_mfma_f32_16x16x32_bf16 v[240:243], a[200:203], v[168:171], v[240:243]
ds_read_b64_tr_b16 a[226:227], v2 offset:8192
v_cvt_pk_bf16_f32 v65, v194, v195
v_mfma_f32_16x16x32_bf16 v[240:243], a[204:207], v[172:175], v[240:243]
v_exp_f32 v200, v200
v_mfma_f32_16x16x32_bf16 v[248:251], a[192:195], v[176:179], v[108:111]
ds_read_b64_tr_b16 a[228:229], v2 offset:16384
ds_read_b64_tr_b16 a[230:231], v2 offset:24576
v_mfma_f32_16x16x32_bf16 v[248:251], a[196:199], v[180:183], v[248:251]
v_exp_f32 v201, v201
v_mfma_f32_16x16x32_bf16 v[248:251], a[200:203], v[184:187], v[248:251]
ds_read_b64_tr_b16 a[232:233], v3 offset:0
v_cvt_pk_bf16_f32 v68, v200, v201
v_mfma_f32_16x16x32_bf16 v[248:251], a[204:207], v[188:191], v[248:251]
s_waitcnt lgkmcnt(5)
v_exp_f32 v202, v202
v_mfma_f32_16x16x32_bf16 v[228:231], a[208:211], v[128:131], v[96:99]
buffer_store_dwordx4 a[176:179], v1, s[40:43], s79 offen offset:0 sc1
v_mfma_f32_16x16x32_bf16 v[228:231], a[212:215], v[132:135], v[228:231]
ds_read_b64_tr_b16 a[234:235], v3 offset:8192
ds_read_b64_tr_b16 a[236:237], v3 offset:16384
v_mfma_f32_16x16x32_bf16 v[228:231], a[216:219], v[136:139], v[228:231]
v_exp_f32 v203, v203
v_mfma_f32_16x16x32_bf16 v[228:231], a[220:223], v[140:143], v[228:231]
ds_read_b64_tr_b16 a[238:239], v3 offset:24576
ds_read_b64_tr_b16 a[240:241], v4 offset:0
v_mfma_f32_16x16x32_bf16 v[236:239], a[208:211], v[144:147], v[100:103]
v_exp_f32 v208, v208
v_mfma_f32_16x16x32_bf16 v[236:239], a[212:215], v[148:151], v[236:239]
ds_read_b64_tr_b16 a[242:243], v4 offset:8192
ds_read_b64_tr_b16 a[244:245], v4 offset:16384
v_mfma_f32_16x16x32_bf16 v[236:239], a[216:219], v[152:155], v[236:239]
v_exp_f32 v209, v209
v_mfma_f32_16x16x32_bf16 v[236:239], a[220:223], v[156:159], v[236:239]
ds_read_b64_tr_b16 a[246:247], v4 offset:24576
v_cvt_pk_bf16_f32 v69, v202, v203
v_mfma_f32_16x16x32_bf16 v[244:247], a[208:211], v[160:163], v[104:107]
v_exp_f32 v210, v210
v_mfma_f32_16x16x32_bf16 v[244:247], a[212:215], v[164:167], v[244:247]
ds_read_b64_tr_b16 a[248:249], v5 offset:0
ds_read_b64_tr_b16 a[250:251], v5 offset:8192
v_mfma_f32_16x16x32_bf16 v[244:247], a[216:219], v[168:171], v[244:247]
v_exp_f32 v211, v211
v_mfma_f32_16x16x32_bf16 v[244:247], a[220:223], v[172:175], v[244:247]
ds_read_b64_tr_b16 a[252:253], v5 offset:16384
ds_read_b64_tr_b16 a[254:255], v5 offset:24576
v_mfma_f32_16x16x32_bf16 v[252:255], a[208:211], v[176:179], v[108:111]
buffer_store_dwordx4 a[180:183], v1, s[40:43], s79 offen offset:1024 sc1
v_mfma_f32_16x16x32_bf16 v[252:255], a[212:215], v[180:183], v[252:255]
v_exp_f32 v216, v216
v_mfma_f32_16x16x32_bf16 v[252:255], a[216:219], v[184:187], v[252:255]
v_exp_f32 v217, v217
v_mfma_f32_16x16x32_bf16 v[252:255], a[220:223], v[188:191], v[252:255]
s_waitcnt lgkmcnt(12)
v_add_f32 v126, v126, v208
v_add_f32 v126, v126, v209
v_mfma_f32_16x16x32_bf16 a[0:3], a[224:227], v[32:35], a[0:3]
v_exp_f32 v218, v218
v_mfma_f32_16x16x32_bf16 a[0:3], a[228:231], v[48:51], a[0:3]
v_cvt_pk_bf16_f32 v72, v208, v209
v_add_f32 v126, v126, v210
v_add_f32 v126, v126, v211
v_mfma_f32_16x16x32_bf16 a[4:7], a[224:227], v[36:39], a[4:7]
v_exp_f32 v219, v219
v_mfma_f32_16x16x32_bf16 a[4:7], a[228:231], v[52:55], a[4:7]
v_cvt_pk_bf16_f32 v73, v210, v211
v_add_f32 v127, v127, v216
v_mfma_f32_16x16x32_bf16 a[8:11], a[224:227], v[40:43], a[8:11]
v_exp_f32 v196, v196
v_mfma_f32_16x16x32_bf16 a[8:11], a[228:231], v[56:59], a[8:11]
v_add_f32 v127, v127, v217
v_cvt_pk_bf16_f32 v76, v216, v217
v_mfma_f32_16x16x32_bf16 a[12:15], a[224:227], v[44:47], a[12:15]
v_exp_f32 v197, v197
v_mfma_f32_16x16x32_bf16 a[12:15], a[228:231], v[60:63], a[12:15]
s_waitcnt lgkmcnt(8)
v_add_f32 v127, v127, v218
v_add_f32 v127, v127, v219
v_mfma_f32_16x16x32_bf16 a[16:19], a[232:235], v[32:35], a[16:19]
v_exp_f32 v198, v198
v_mfma_f32_16x16x32_bf16 a[16:19], a[236:239], v[48:51], a[16:19]
buffer_store_dwordx4 a[184:187], v1, s[40:43], s79 offen offset:2048 sc1
v_mfma_f32_16x16x32_bf16 a[20:23], a[232:235], v[36:39], a[20:23]
ds_read_b64_tr_b16 a[224:225], v14 offset:0
ds_read_b64_tr_b16 a[226:227], v14 offset:8192
v_mfma_f32_16x16x32_bf16 a[20:23], a[236:239], v[52:55], a[20:23]
v_exp_f32 v199, v199
v_mfma_f32_16x16x32_bf16 a[24:27], a[232:235], v[40:43], a[24:27]
ds_read_b64_tr_b16 a[228:229], v14 offset:16384
ds_read_b64_tr_b16 a[230:231], v14 offset:24576
v_mfma_f32_16x16x32_bf16 a[24:27], a[236:239], v[56:59], a[24:27]
v_exp_f32 v204, v204
v_mfma_f32_16x16x32_bf16 a[28:31], a[232:235], v[44:47], a[28:31]
v_exp_f32 v205, v205
v_mfma_f32_16x16x32_bf16 a[28:31], a[236:239], v[60:63], a[28:31]
v_cvt_pk_bf16_f32 v77, v218, v219
v_cvt_pk_bf16_f32 v66, v196, v197
v_mfma_f32_16x16x32_bf16 v[116:119], v[112:115], v[32:35], v[116:119]
v_exp_f32 v206, v206
v_mfma_f32_16x16x32_bf16 v[116:119], v[112:115], v[48:51], v[116:119]
s_waitcnt lgkmcnt(8)
v_cvt_pk_bf16_f32 v67, v198, v199
v_cvt_pk_bf16_f32 v70, v204, v205
v_mfma_f32_16x16x32_bf16 a[32:35], a[240:243], v[32:35], a[32:35]
v_exp_f32 v207, v207
v_mfma_f32_16x16x32_bf16 a[32:35], a[244:247], v[48:51], a[32:35]
ds_read_b64_tr_b16 a[232:233], v15 offset:0
ds_read_b64_tr_b16 a[234:235], v15 offset:8192
v_mfma_f32_16x16x32_bf16 a[36:39], a[240:243], v[36:39], a[36:39]
v_exp_f32 v212, v212
v_mfma_f32_16x16x32_bf16 a[36:39], a[244:247], v[52:55], a[36:39]
ds_read_b64_tr_b16 a[236:237], v15 offset:16384
ds_read_b64_tr_b16 a[238:239], v15 offset:24576
v_mfma_f32_16x16x32_bf16 a[40:43], a[240:243], v[40:43], a[40:43]
buffer_store_dwordx4 a[188:191], v1, s[40:43], s79 offen offset:3072 sc1
v_mfma_f32_16x16x32_bf16 a[40:43], a[244:247], v[56:59], a[40:43]
v_exp_f32 v213, v213
v_mfma_f32_16x16x32_bf16 a[44:47], a[240:243], v[44:47], a[44:47]
v_exp_f32 v214, v214
v_mfma_f32_16x16x32_bf16 a[44:47], a[244:247], v[60:63], a[44:47]
s_waitcnt lgkmcnt(8)
v_cvt_pk_bf16_f32 v71, v206, v207
v_add_f32 v126, v126, v212
v_mfma_f32_16x16x32_bf16 a[48:51], a[248:251], v[32:35], a[48:51]
v_exp_f32 v215, v215
v_mfma_f32_16x16x32_bf16 a[48:51], a[252:255], v[48:51], a[48:51]
ds_read_b64_tr_b16 a[240:241], v16 offset:0
ds_read_b64_tr_b16 a[242:243], v16 offset:8192
v_mfma_f32_16x16x32_bf16 a[52:55], a[248:251], v[36:39], a[52:55]
v_exp_f32 v220, v220
v_mfma_f32_16x16x32_bf16 a[52:55], a[252:255], v[52:55], a[52:55]
ds_read_b64_tr_b16 a[244:245], v16 offset:16384
ds_read_b64_tr_b16 a[246:247], v16 offset:24576
v_mfma_f32_16x16x32_bf16 a[56:59], a[248:251], v[40:43], a[56:59]
v_exp_f32 v221, v221
v_mfma_f32_16x16x32_bf16 a[56:59], a[252:255], v[56:59], a[56:59]
v_add_f32 v126, v126, v213
v_cvt_pk_bf16_f32 v74, v212, v213
v_mfma_f32_16x16x32_bf16 a[60:63], a[248:251], v[44:47], a[60:63]
v_exp_f32 v222, v222
v_mfma_f32_16x16x32_bf16 a[60:63], a[252:255], v[60:63], a[60:63]
v_add_f32 v126, v126, v214
v_add_f32 v126, v126, v215
v_mfma_f32_16x16x32_bf16 v[120:123], v[112:115], v[36:39], v[120:123]
v_exp_f32 v223, v223
v_cvt_pk_bf16_f32 v75, v214, v215
v_mfma_f32_16x16x32_bf16 v[120:123], v[112:115], v[52:55], v[120:123]
s_waitcnt lgkmcnt(8)
v_add_f32 v127, v127, v220
v_add_f32 v127, v127, v221
v_mfma_f32_16x16x32_bf16 a[64:67], a[224:227], v[32:35], a[64:67]
ds_read_b64_tr_b16 a[248:249], v17 offset:0
v_cvt_pk_bf16_f32 v78, v220, v221
v_mfma_f32_16x16x32_bf16 a[64:67], a[228:231], v[48:51], a[64:67]
ds_read_b64_tr_b16 a[250:251], v17 offset:8192
v_add_f32 v127, v127, v222
v_mfma_f32_16x16x32_bf16 a[68:71], a[224:227], v[36:39], a[68:71]
v_exp_f32 v224, v224
v_mfma_f32_16x16x32_bf16 a[68:71], a[228:231], v[52:55], a[68:71]
ds_read_b64_tr_b16 a[252:253], v17 offset:16384
ds_read_b64_tr_b16 a[254:255], v17 offset:24576
v_mfma_f32_16x16x32_bf16 a[72:75], a[224:227], v[40:43], a[72:75]
v_exp_f32 v225, v225
v_mfma_f32_16x16x32_bf16 a[72:75], a[228:231], v[56:59], a[72:75]
v_add_f32 v127, v127, v223
v_cvt_pk_bf16_f32 v79, v222, v223
v_mfma_f32_16x16x32_bf16 a[76:79], a[224:227], v[44:47], a[76:79]
v_exp_f32 v226, v226
v_mfma_f32_16x16x32_bf16 a[76:79], a[228:231], v[60:63], a[76:79]
s_waitcnt lgkmcnt(10)
v_exp_f32 v227, v227
v_mfma_f32_16x16x32_bf16 a[80:83], a[232:235], v[32:35], a[80:83]
s_waitcnt vmcnt(5) lgkmcnt(0)
v_cvt_pk_bf16_f32 v80, v224, v225
v_cvt_pk_bf16_f32 v81, v226, v227
v_mfma_f32_16x16x32_bf16 a[80:83], a[236:239], v[48:51], a[80:83]
s_barrier
v_mfma_f32_16x16x32_bf16 a[84:87], a[232:235], v[36:39], a[84:87]
s_add_u32 m0, s48, 0
v_exp_f32 v232, v232
v_mfma_f32_16x16x32_bf16 a[84:87], a[236:239], v[52:55], a[84:87]
s_add_u32 s46, s45, 8192
ds_read_b128 a[192:195], v10 offset:32768
ds_read_b128 a[196:199], v11 offset:32768
v_mfma_f32_16x16x32_bf16 a[88:91], a[232:235], v[40:43], a[88:91]
s_and_b32 s46, s46, 0x7ffff
v_exp_f32 v233, v233
v_mfma_f32_16x16x32_bf16 a[88:91], a[236:239], v[56:59], a[88:91]
ds_read_b128 a[200:203], v12 offset:32768
ds_read_b128 a[204:207], v13 offset:32768
v_mfma_f32_16x16x32_bf16 a[92:95], a[232:235], v[44:47], a[92:95]
v_exp_f32 v234, v234
v_mfma_f32_16x16x32_bf16 a[92:95], a[236:239], v[60:63], a[92:95]
ds_read_b128 a[208:211], v10 offset:40960
v_cvt_pk_bf16_f32 v84, v232, v233
v_mfma_f32_16x16x32_bf16 a[96:99], a[240:243], v[32:35], a[96:99]
v_exp_f32 v235, v235
v_mfma_f32_16x16x32_bf16 a[96:99], a[244:247], v[48:51], a[96:99]
buffer_load_dwordx4 v22, s[8:11], s46 offen lds
v_mfma_f32_16x16x32_bf16 a[100:103], a[240:243], v[36:39], a[100:103]
ds_read_b128 a[212:215], v11 offset:40960
ds_read_b128 a[216:219], v12 offset:40960
v_mfma_f32_16x16x32_bf16 a[100:103], a[244:247], v[52:55], a[100:103]
v_exp_f32 v240, v240
v_mfma_f32_16x16x32_bf16 a[104:107], a[240:243], v[40:43], a[104:107]
v_exp_f32 v241, v241
v_mfma_f32_16x16x32_bf16 a[104:107], a[244:247], v[56:59], a[104:107]
buffer_load_dwordx4 v23, s[8:11], s46 offen offset:1024 lds
v_mfma_f32_16x16x32_bf16 a[108:111], a[240:243], v[44:47], a[108:111]
v_exp_f32 v242, v242
v_mfma_f32_16x16x32_bf16 a[108:111], a[244:247], v[60:63], a[108:111]
ds_read_b128 a[220:223], v13 offset:40960
v_cvt_pk_bf16_f32 v85, v234, v235
v_mfma_f32_16x16x32_bf16 a[112:115], a[248:251], v[32:35], a[112:115]
v_exp_f32 v243, v243
v_mfma_f32_16x16x32_bf16 a[112:115], a[252:255], v[48:51], a[112:115]
v_add_f32 v126, v126, v240
v_add_f32 v126, v126, v241
v_mfma_f32_16x16x32_bf16 a[116:119], a[248:251], v[36:39], a[116:119]
buffer_load_dwordx4 v24, s[12:15], s44 offen offset:2048 lds
v_mfma_f32_16x16x32_bf16 a[116:119], a[252:255], v[52:55], a[116:119]
v_exp_f32 v248, v248
v_mfma_f32_16x16x32_bf16 a[120:123], a[248:251], v[40:43], a[120:123]
v_exp_f32 v249, v249
v_mfma_f32_16x16x32_bf16 a[120:123], a[252:255], v[56:59], a[120:123]
v_cvt_pk_bf16_f32 v88, v240, v241
v_add_f32 v126, v126, v242
v_mfma_f32_16x16x32_bf16 a[124:127], a[248:251], v[44:47], a[124:127]
buffer_load_dwordx4 v25, s[12:15], s44 offen offset:3072 lds
v_mfma_f32_16x16x32_bf16 a[124:127], a[252:255], v[60:63], a[124:127]
s_waitcnt lgkmcnt(0)
v_exp_f32 v250, v250
v_add_f32 v126, v126, v243
v_mfma_f32_16x16x32_bf16 v[192:195], a[192:195], v[128:131], v[96:99]
v_exp_f32 v251, v251
v_mfma_f32_16x16x32_bf16 v[192:195], a[196:199], v[132:135], v[192:195]
s_add_u32 m0, s48, 16384
v_cvt_pk_bf16_f32 v89, v242, v243
v_add_f32 v127, v127, v248
v_mfma_f32_16x16x32_bf16 v[192:195], a[200:203], v[136:139], v[192:195]
s_add_u32 s47, s46, 8192
v_exp_f32 v228, v228
v_mfma_f32_16x16x32_bf16 v[192:195], a[204:207], v[140:143], v[192:195]
s_and_b32 s47, s47, 0x7ffff
v_add_f32 v127, v127, v249
v_cvt_pk_bf16_f32 v92, v248, v249
v_mfma_f32_16x16x32_bf16 v[200:203], a[192:195], v[144:147], v[100:103]
v_exp_f32 v229, v229
v_mfma_f32_16x16x32_bf16 v[200:203], a[196:199], v[148:151], v[200:203]
buffer_load_dwordx4 v22, s[8:11], s47 offen lds
v_mfma_f32_16x16x32_bf16 v[200:203], a[200:203], v[152:155], v[200:203]
v_exp_f32 v230, v230
v_mfma_f32_16x16x32_bf16 v[200:203], a[204:207], v[156:159], v[200:203]
v_add_f32 v127, v127, v250
v_add_f32 v127, v127, v251
v_mfma_f32_16x16x32_bf16 v[208:211], a[192:195], v[160:163], v[104:107]
v_exp_f32 v231, v231
v_mfma_f32_16x16x32_bf16 v[208:211], a[196:199], v[164:167], v[208:211]
v_cvt_pk_bf16_f32 v93, v250, v251
v_cvt_pk_bf16_f32 v82, v228, v229
v_mfma_f32_16x16x32_bf16 v[208:211], a[200:203], v[168:171], v[208:211]
buffer_load_dwordx4 v23, s[8:11], s47 offen offset:1024 lds
v_mfma_f32_16x16x32_bf16 v[208:211], a[204:207], v[172:175], v[208:211]
v_exp_f32 v236, v236
v_mfma_f32_16x16x32_bf16 v[216:219], a[192:195], v[176:179], v[108:111]
v_exp_f32 v237, v237
v_mfma_f32_16x16x32_bf16 v[216:219], a[196:199], v[180:183], v[216:219]
v_cvt_pk_bf16_f32 v83, v230, v231
v_cvt_pk_bf16_f32 v86, v236, v237
v_mfma_f32_16x16x32_bf16 v[216:219], a[200:203], v[184:187], v[216:219]
v_exp_f32 v238, v238
v_mfma_f32_16x16x32_bf16 v[216:219], a[204:207], v[188:191], v[216:219]
v_exp_f32 v239, v239
v_mfma_f32_16x16x32_bf16 v[196:199], a[208:211], v[128:131], v[96:99]
v_exp_f32 v244, v244
v_mfma_f32_16x16x32_bf16 v[196:199], a[212:215], v[132:135], v[196:199]
ds_read_b128 a[192:195], v10 offset:49152
v_cvt_pk_bf16_f32 v87, v238, v239
v_mfma_f32_16x16x32_bf16 v[196:199], a[216:219], v[136:139], v[196:199]
v_exp_f32 v245, v245
v_mfma_f32_16x16x32_bf16 v[196:199], a[220:223], v[140:143], v[196:199]
ds_read_b128 a[196:199], v11 offset:49152
v_add_f32 v126, v126, v244
v_mfma_f32_16x16x32_bf16 v[204:207], a[208:211], v[144:147], v[100:103]
v_add_f32 v126, v126, v245
v_cvt_pk_bf16_f32 v90, v244, v245
v_mfma_f32_16x16x32_bf16 v[204:207], a[212:215], v[148:151], v[204:207]
v_exp_f32 v246, v246
v_mfma_f32_16x16x32_bf16 v[204:207], a[216:219], v[152:155], v[204:207]
buffer_load_dwordx4 v24, s[12:15], s45 offen offset:2048 lds
v_mfma_f32_16x16x32_bf16 v[204:207], a[220:223], v[156:159], v[204:207]
ds_read_b128 a[200:203], v12 offset:49152
ds_read_b128 a[204:207], v13 offset:49152
v_mfma_f32_16x16x32_bf16 v[212:215], a[208:211], v[160:163], v[104:107]
v_exp_f32 v247, v247
v_mfma_f32_16x16x32_bf16 v[212:215], a[212:215], v[164:167], v[212:215]
v_add_f32 v126, v126, v246
v_add_f32 v126, v126, v247
v_mfma_f32_16x16x32_bf16 v[212:215], a[216:219], v[168:171], v[212:215]
v_exp_f32 v252, v252
v_mfma_f32_16x16x32_bf16 v[212:215], a[220:223], v[172:175], v[212:215]
v_cvt_pk_bf16_f32 v91, v246, v247
v_add_f32 v127, v127, v252
v_mfma_f32_16x16x32_bf16 v[220:223], a[208:211], v[176:179], v[108:111]
buffer_load_dwordx4 v25, s[12:15], s45 offen offset:3072 lds
v_mfma_f32_16x16x32_bf16 v[220:223], a[212:215], v[180:183], v[220:223]
v_exp_f32 v253, v253
v_mfma_f32_16x16x32_bf16 v[220:223], a[216:219], v[184:187], v[220:223]
v_exp_f32 v254, v254
v_mfma_f32_16x16x32_bf16 v[220:223], a[220:223], v[188:191], v[220:223]
s_waitcnt lgkmcnt(0)
v_add_f32 v127, v127, v253
v_cvt_pk_bf16_f32 v94, v252, v253
v_mfma_f32_16x16x32_bf16 v[224:227], a[192:195], v[128:131], v[96:99]
v_exp_f32 v255, v255
v_mfma_f32_16x16x32_bf16 v[224:227], a[196:199], v[132:135], v[224:227]
ds_read_b128 a[208:211], v10 offset:57344
v_add_f32 v127, v127, v254
v_mfma_f32_16x16x32_bf16 v[224:227], a[200:203], v[136:139], v[224:227]
v_add_f32 v127, v127, v255
v_cvt_pk_bf16_f32 v95, v254, v255
v_mfma_f32_16x16x32_bf16 v[224:227], a[204:207], v[140:143], v[224:227]
v_exp_f32 v192, v192
v_mfma_f32_16x16x32_bf16 v[232:235], a[192:195], v[144:147], v[100:103]
v_exp_f32 v193, v193
v_mfma_f32_16x16x32_bf16 v[232:235], a[196:199], v[148:151], v[232:235]
ds_read_b128 a[212:215], v11 offset:57344
ds_read_b128 a[216:219], v12 offset:57344
v_mfma_f32_16x16x32_bf16 v[232:235], a[200:203], v[152:155], v[232:235]
v_exp_f32 v194, v194
v_mfma_f32_16x16x32_bf16 v[232:235], a[204:207], v[156:159], v[232:235]
ds_read_b128 a[220:223], v13 offset:57344
v_cvt_pk_bf16_f32 v32, v192, v193
v_mfma_f32_16x16x32_bf16 v[240:243], a[192:195], v[160:163], v[104:107]
v_exp_f32 v195, v195
v_mfma_f32_16x16x32_bf16 v[240:243], a[196:199], v[164:167], v[240:243]
ds_read_b64_tr_b16 a[224:225], v2 offset:32768
v_cvt_pk_bf16_f32 v33, v194, v195
v_mfma_f32_16x16x32_bf16 v[240:243], a[200:203], v[168:171], v[240:243]
v_exp_f32 v200, v200
v_mfma_f32_16x16x32_bf16 v[240:243], a[204:207], v[172:175], v[240:243]
ds_read_b64_tr_b16 a[226:227], v2 offset:40960
ds_read_b64_tr_b16 a[228:229], v2 offset:49152
v_mfma_f32_16x16x32_bf16 v[248:251], a[192:195], v[176:179], v[108:111]
v_exp_f32 v201, v201
v_mfma_f32_16x16x32_bf16 v[248:251], a[196:199], v[180:183], v[248:251]
ds_read_b64_tr_b16 a[230:231], v2 offset:57344
v_cvt_pk_bf16_f32 v36, v200, v201
v_mfma_f32_16x16x32_bf16 v[248:251], a[200:203], v[184:187], v[248:251]
v_exp_f32 v202, v202
v_mfma_f32_16x16x32_bf16 v[248:251], a[204:207], v[188:191], v[248:251]
s_waitcnt lgkmcnt(4)
ds_read_b64_tr_b16 a[232:233], v3 offset:32768
ds_read_b64_tr_b16 a[234:235], v3 offset:40960
v_mfma_f32_16x16x32_bf16 v[228:231], a[208:211], v[128:131], v[96:99]
v_exp_f32 v203, v203
v_mfma_f32_16x16x32_bf16 v[228:231], a[212:215], v[132:135], v[228:231]
ds_read_b64_tr_b16 a[236:237], v3 offset:49152
ds_read_b64_tr_b16 a[238:239], v3 offset:57344
v_mfma_f32_16x16x32_bf16 v[228:231], a[216:219], v[136:139], v[228:231]
v_exp_f32 v208, v208
v_mfma_f32_16x16x32_bf16 v[228:231], a[220:223], v[140:143], v[228:231]
ds_read_b64_tr_b16 a[240:241], v4 offset:32768
v_cvt_pk_bf16_f32 v37, v202, v203
v_mfma_f32_16x16x32_bf16 v[236:239], a[208:211], v[144:147], v[100:103]
ds_read_b64_tr_b16 a[242:243], v4 offset:40960
v_add_f32 v126, v126, v208
v_mfma_f32_16x16x32_bf16 v[236:239], a[212:215], v[148:151], v[236:239]
v_exp_f32 v209, v209
v_mfma_f32_16x16x32_bf16 v[236:239], a[216:219], v[152:155], v[236:239]
ds_read_b64_tr_b16 a[244:245], v4 offset:49152
ds_read_b64_tr_b16 a[246:247], v4 offset:57344
v_mfma_f32_16x16x32_bf16 v[236:239], a[220:223], v[156:159], v[236:239]
v_add_f32 v126, v126, v209
v_cvt_pk_bf16_f32 v40, v208, v209
v_mfma_f32_16x16x32_bf16 v[244:247], a[208:211], v[160:163], v[104:107]
v_exp_f32 v210, v210
v_mfma_f32_16x16x32_bf16 v[244:247], a[212:215], v[164:167], v[244:247]
ds_read_b64_tr_b16 a[248:249], v5 offset:32768
ds_read_b64_tr_b16 a[250:251], v5 offset:40960
v_mfma_f32_16x16x32_bf16 v[244:247], a[216:219], v[168:171], v[244:247]
v_exp_f32 v211, v211
v_mfma_f32_16x16x32_bf16 v[244:247], a[220:223], v[172:175], v[244:247]
ds_read_b64_tr_b16 a[252:253], v5 offset:49152
ds_read_b64_tr_b16 a[254:255], v5 offset:57344
v_mfma_f32_16x16x32_bf16 v[252:255], a[208:211], v[176:179], v[108:111]
v_exp_f32 v216, v216
v_mfma_f32_16x16x32_bf16 v[252:255], a[212:215], v[180:183], v[252:255]
v_add_f32 v126, v126, v210
v_add_f32 v126, v126, v211
v_mfma_f32_16x16x32_bf16 v[252:255], a[216:219], v[184:187], v[252:255]
v_exp_f32 v217, v217
v_mfma_f32_16x16x32_bf16 v[252:255], a[220:223], v[188:191], v[252:255]
s_waitcnt lgkmcnt(12)
v_cvt_pk_bf16_f32 v41, v210, v211
v_add_f32 v127, v127, v216
v_mfma_f32_16x16x32_bf16 a[0:3], a[224:227], v[64:67], a[0:3]
v_exp_f32 v218, v218
v_mfma_f32_16x16x32_bf16 a[0:3], a[228:231], v[80:83], a[0:3]
v_add_f32 v127, v127, v217
v_cvt_pk_bf16_f32 v44, v216, v217
v_mfma_f32_16x16x32_bf16 a[4:7], a[224:227], v[68:71], a[4:7]
v_exp_f32 v219, v219
v_mfma_f32_16x16x32_bf16 a[4:7], a[228:231], v[84:87], a[4:7]
v_add_f32 v127, v127, v218
v_add_f32 v127, v127, v219
v_mfma_f32_16x16x32_bf16 a[8:11], a[224:227], v[72:75], a[8:11]
v_exp_f32 v196, v196
v_mfma_f32_16x16x32_bf16 a[8:11], a[228:231], v[88:91], a[8:11]
v_exp_f32 v197, v197
v_mfma_f32_16x16x32_bf16 a[12:15], a[224:227], v[76:79], a[12:15]
v_cvt_pk_bf16_f32 v45, v218, v219
v_cvt_pk_bf16_f32 v34, v196, v197
v_mfma_f32_16x16x32_bf16 a[12:15], a[228:231], v[92:95], a[12:15]
s_waitcnt lgkmcnt(8)
v_exp_f32 v198, v198
v_mfma_f32_16x16x32_bf16 a[16:19], a[232:235], v[64:67], a[16:19]
v_exp_f32 v199, v199
v_mfma_f32_16x16x32_bf16 a[16:19], a[236:239], v[80:83], a[16:19]
ds_read_b64_tr_b16 a[224:225], v14 offset:32768
ds_read_b64_tr_b16 a[226:227], v14 offset:40960
v_mfma_f32_16x16x32_bf16 a[20:23], a[232:235], v[68:71], a[20:23]
ds_read_b64_tr_b16 a[228:229], v14 offset:49152
v_cvt_pk_bf16_f32 v35, v198, v199
v_mfma_f32_16x16x32_bf16 a[20:23], a[236:239], v[84:87], a[20:23]
v_exp_f32 v204, v204
v_mfma_f32_16x16x32_bf16 a[24:27], a[232:235], v[72:75], a[24:27]
v_exp_f32 v205, v205
v_mfma_f32_16x16x32_bf16 a[24:27], a[236:239], v[88:91], a[24:27]
ds_read_b64_tr_b16 a[230:231], v14 offset:57344
v_cvt_pk_bf16_f32 v38, v204, v205
v_mfma_f32_16x16x32_bf16 a[28:31], a[232:235], v[76:79], a[28:31]
v_exp_f32 v206, v206
v_mfma_f32_16x16x32_bf16 a[28:31], a[236:239], v[92:95], a[28:31]
v_exp_f32 v207, v207
v_mfma_f32_16x16x32_bf16 v[116:119], v[112:115], v[64:67], v[116:119]
v_exp_f32 v212, v212
v_mfma_f32_16x16x32_bf16 v[116:119], v[112:115], v[80:83], v[116:119]
s_waitcnt lgkmcnt(8)
v_cvt_pk_bf16_f32 v39, v206, v207
v_add_f32 v126, v126, v212
v_mfma_f32_16x16x32_bf16 a[32:35], a[240:243], v[64:67], a[32:35]
v_exp_f32 v213, v213
v_mfma_f32_16x16x32_bf16 a[32:35], a[244:247], v[80:83], a[32:35]
ds_read_b64_tr_b16 a[232:233], v15 offset:32768
ds_read_b64_tr_b16 a[234:235], v15 offset:40960
v_mfma_f32_16x16x32_bf16 a[36:39], a[240:243], v[68:71], a[36:39]
ds_read_b64_tr_b16 a[236:237], v15 offset:49152
v_add_f32 v126, v126, v213
v_mfma_f32_16x16x32_bf16 a[36:39], a[244:247], v[84:87], a[36:39]
ds_read_b64_tr_b16 a[238:239], v15 offset:57344
v_cvt_pk_bf16_f32 v42, v212, v213
v_mfma_f32_16x16x32_bf16 a[40:43], a[240:243], v[72:75], a[40:43]
v_exp_f32 v214, v214
v_mfma_f32_16x16x32_bf16 a[40:43], a[244:247], v[88:91], a[40:43]
v_exp_f32 v215, v215
v_mfma_f32_16x16x32_bf16 a[44:47], a[240:243], v[76:79], a[44:47]
v_add_f32 v126, v126, v214
v_add_f32 v126, v126, v215
v_mfma_f32_16x16x32_bf16 a[44:47], a[244:247], v[92:95], a[44:47]
s_waitcnt lgkmcnt(8)
v_exp_f32 v220, v220
v_mfma_f32_16x16x32_bf16 a[48:51], a[248:251], v[64:67], a[48:51]
ds_read_b64_tr_b16 a[240:241], v16 offset:32768
v_cvt_pk_bf16_f32 v43, v214, v215
v_mfma_f32_16x16x32_bf16 a[48:51], a[252:255], v[80:83], a[48:51]
ds_read_b64_tr_b16 a[242:243], v16 offset:40960
v_add_f32 v127, v127, v220
v_mfma_f32_16x16x32_bf16 a[52:55], a[248:251], v[68:71], a[52:55]
v_exp_f32 v221, v221
v_mfma_f32_16x16x32_bf16 a[52:55], a[252:255], v[84:87], a[52:55]
ds_read_b64_tr_b16 a[244:245], v16 offset:49152
ds_read_b64_tr_b16 a[246:247], v16 offset:57344
v_mfma_f32_16x16x32_bf16 a[56:59], a[248:251], v[72:75], a[56:59]
v_add_f32 v127, v127, v221
v_cvt_pk_bf16_f32 v46, v220, v221
v_mfma_f32_16x16x32_bf16 a[56:59], a[252:255], v[88:91], a[56:59]
v_exp_f32 v222, v222
v_mfma_f32_16x16x32_bf16 a[60:63], a[248:251], v[76:79], a[60:63]
v_exp_f32 v223, v223
v_mfma_f32_16x16x32_bf16 a[60:63], a[252:255], v[92:95], a[60:63]
v_add_f32 v127, v127, v222
v_add_f32 v127, v127, v223
v_mfma_f32_16x16x32_bf16 v[120:123], v[112:115], v[68:71], v[120:123]
v_cvt_pk_bf16_f32 v47, v222, v223
v_mfma_f32_16x16x32_bf16 v[120:123], v[112:115], v[84:87], v[120:123]
s_waitcnt lgkmcnt(8)
v_mfma_f32_16x16x32_bf16 a[64:67], a[224:227], v[64:67], a[64:67]
v_exp_f32 v224, v224
v_mfma_f32_16x16x32_bf16 a[64:67], a[228:231], v[80:83], a[64:67]
ds_read_b64_tr_b16 a[248:249], v17 offset:32768
ds_read_b64_tr_b16 a[250:251], v17 offset:40960
v_mfma_f32_16x16x32_bf16 a[68:71], a[224:227], v[68:71], a[68:71]
v_exp_f32 v225, v225
v_mfma_f32_16x16x32_bf16 a[68:71], a[228:231], v[84:87], a[68:71]
ds_read_b64_tr_b16 a[252:253], v17 offset:49152
ds_read_b64_tr_b16 a[254:255], v17 offset:57344
v_mfma_f32_16x16x32_bf16 a[72:75], a[224:227], v[72:75], a[72:75]
v_exp_f32 v226, v226
v_mfma_f32_16x16x32_bf16 a[72:75], a[228:231], v[88:91], a[72:75]
v_exp_f32 v227, v227
v_mfma_f32_16x16x32_bf16 a[76:79], a[224:227], v[76:79], a[76:79]
v_cvt_pk_bf16_f32 v48, v224, v225
v_cvt_pk_bf16_f32 v49, v226, v227
v_mfma_f32_16x16x32_bf16 a[76:79], a[228:231], v[92:95], a[76:79]
s_waitcnt lgkmcnt(10)
v_exp_f32 v232, v232
v_mfma_f32_16x16x32_bf16 a[80:83], a[232:235], v[64:67], a[80:83]
s_waitcnt vmcnt(0) lgkmcnt(0)
v_exp_f32 v233, v233
v_mfma_f32_16x16x32_bf16 a[80:83], a[236:239], v[80:83], a[80:83]
s_barrier
v_mfma_f32_16x16x32_bf16 a[84:87], a[232:235], v[68:71], a[84:87]
s_add_u32 m0, s48, 32768
ds_read_b128 a[192:195], v10 offset:0
v_cvt_pk_bf16_f32 v52, v232, v233
v_mfma_f32_16x16x32_bf16 a[84:87], a[236:239], v[84:87], a[84:87]
s_add_u32 s44, s47, 8192
v_exp_f32 v234, v234
v_mfma_f32_16x16x32_bf16 a[88:91], a[232:235], v[72:75], a[88:91]
s_and_b32 s44, s44, 0x7ffff
ds_read_b128 a[196:199], v11 offset:0
ds_read_b128 a[200:203], v12 offset:0
v_mfma_f32_16x16x32_bf16 a[88:91], a[236:239], v[88:91], a[88:91]
s_mov_b64 exec, s[0:1]
buffer_atomic_or v27, v26, s[68:71], 0 offen
s_mov_b64 exec, -1
v_mfma_f32_16x16x32_bf16 a[92:95], a[232:235], v[76:79], a[92:95]
v_exp_f32 v235, v235
v_mfma_f32_16x16x32_bf16 a[92:95], a[236:239], v[92:95], a[92:95]
ds_read_b128 a[204:207], v13 offset:0
ds_read_b128 a[208:211], v10 offset:8192
v_mfma_f32_16x16x32_bf16 a[96:99], a[240:243], v[64:67], a[96:99]
ds_read_b128 a[212:215], v11 offset:8192
v_cvt_pk_bf16_f32 v53, v234, v235
v_mfma_f32_16x16x32_bf16 a[96:99], a[244:247], v[80:83], a[96:99]
buffer_load_dwordx4 v22, s[8:11], s44 offen lds
v_mfma_f32_16x16x32_bf16 a[100:103], a[240:243], v[68:71], a[100:103]
v_exp_f32 v240, v240
v_mfma_f32_16x16x32_bf16 a[100:103], a[244:247], v[84:87], a[100:103]
ds_read_b128 a[216:219], v12 offset:8192
ds_read_b128 a[220:223], v13 offset:8192
v_mfma_f32_16x16x32_bf16 a[104:107], a[240:243], v[72:75], a[104:107]
v_exp_f32 v241, v241
v_mfma_f32_16x16x32_bf16 a[104:107], a[244:247], v[88:91], a[104:107]
buffer_load_dwordx4 v23, s[8:11], s44 offen offset:1024 lds
v_mfma_f32_16x16x32_bf16 a[108:111], a[240:243], v[76:79], a[108:111]
v_exp_f32 v242, v242
v_mfma_f32_16x16x32_bf16 a[108:111], a[244:247], v[92:95], a[108:111]
v_add_f32 v126, v126, v240
v_add_f32 v126, v126, v241
v_mfma_f32_16x16x32_bf16 a[112:115], a[248:251], v[64:67], a[112:115]
v_exp_f32 v243, v243
v_mfma_f32_16x16x32_bf16 a[112:115], a[252:255], v[80:83], a[112:115]
v_cvt_pk_bf16_f32 v56, v240, v241
v_add_f32 v126, v126, v242
v_mfma_f32_16x16x32_bf16 a[116:119], a[248:251], v[68:71], a[116:119]
buffer_load_dwordx4 v24, s[12:15], s46 offen offset:2048 lds
v_mfma_f32_16x16x32_bf16 a[116:119], a[252:255], v[84:87], a[116:119]
v_exp_f32 v248, v248
v_mfma_f32_16x16x32_bf16 a[120:123], a[248:251], v[72:75], a[120:123]
v_exp_f32 v249, v249
v_mfma_f32_16x16x32_bf16 a[120:123], a[252:255], v[88:91], a[120:123]
v_add_f32 v126, v126, v243
v_cvt_pk_bf16_f32 v57, v242, v243
v_mfma_f32_16x16x32_bf16 a[124:127], a[248:251], v[76:79], a[124:127]
buffer_load_dwordx4 v25, s[12:15], s46 offen offset:3072 lds
v_mfma_f32_16x16x32_bf16 a[124:127], a[252:255], v[92:95], a[124:127]
s_waitcnt lgkmcnt(0)
v_exp_f32 v250, v250
s_nop 0
v_add_f32 v127, v127, v248
v_add_f32 v127, v127, v249
s_mov_b32 s49, 12
s_branch L_attn_mid
.p2align 6
L_attn_head:
v_exp_f32 v250, v250
L_attn_mid:
L_attn_loop:
v_mfma_f32_16x16x32_bf16 v[192:195], a[192:195], v[128:131], v[96:99]
v_exp_f32 v251, v251
v_mfma_f32_16x16x32_bf16 v[192:195], a[196:199], v[132:135], v[192:195]
s_add_u32 m0, s48, 49152
v_cvt_pk_bf16_f32 v60, v248, v249
v_add_f32 v127, v127, v250
v_mfma_f32_16x16x32_bf16 v[192:195], a[200:203], v[136:139], v[192:195]
s_add_u32 s45, s44, 8192
v_exp_f32 v228, v228
v_mfma_f32_16x16x32_bf16 v[192:195], a[204:207], v[140:143], v[192:195]
s_and_b32 s45, s45, 0x7ffff
v_add_f32 v127, v127, v251
v_cvt_pk_bf16_f32 v61, v250, v251
v_mfma_f32_16x16x32_bf16 v[200:203], a[192:195], v[144:147], v[100:103]
v_exp_f32 v229, v229
v_mfma_f32_16x16x32_bf16 v[200:203], a[196:199], v[148:151], v[200:203]
buffer_load_dwordx4 v22, s[8:11], s45 offen lds
v_mfma_f32_16x16x32_bf16 v[200:203], a[200:203], v[152:155], v[200:203]
v_exp_f32 v230, v230
v_mfma_f32_16x16x32_bf16 v[200:203], a[204:207], v[156:159], v[200:203]
v_exp_f32 v231, v231
v_mfma_f32_16x16x32_bf16 v[208:211], a[192:195], v[160:163], v[104:107]
v_cvt_pk_bf16_f32 v50, v228, v229
v_cvt_pk_bf16_f32 v51, v230, v231
v_mfma_f32_16x16x32_bf16 v[208:211], a[196:199], v[164:167], v[208:211]
v_exp_f32 v236, v236
v_mfma_f32_16x16x32_bf16 v[208:211], a[200:203], v[168:171], v[208:211]
buffer_load_dwordx4 v23, s[8:11], s45 offen offset:1024 lds
v_mfma_f32_16x16x32_bf16 v[208:211], a[204:207], v[172:175], v[208:211]
v_exp_f32 v237, v237
v_mfma_f32_16x16x32_bf16 v[216:219], a[192:195], v[176:179], v[108:111]
v_exp_f32 v238, v238
v_mfma_f32_16x16x32_bf16 v[216:219], a[196:199], v[180:183], v[216:219]
v_exp_f32 v239, v239
v_mfma_f32_16x16x32_bf16 v[216:219], a[200:203], v[184:187], v[216:219]
v_cvt_pk_bf16_f32 v54, v236, v237
v_cvt_pk_bf16_f32 v55, v238, v239
v_mfma_f32_16x16x32_bf16 v[216:219], a[204:207], v[188:191], v[216:219]
v_exp_f32 v244, v244
v_mfma_f32_16x16x32_bf16 v[196:199], a[208:211], v[128:131], v[96:99]
v_exp_f32 v245, v245
v_mfma_f32_16x16x32_bf16 v[196:199], a[212:215], v[132:135], v[196:199]
ds_read_b128 a[192:195], v10 offset:16384
v_add_f32 v126, v126, v244
v_mfma_f32_16x16x32_bf16 v[196:199], a[216:219], v[136:139], v[196:199]
v_add_f32 v126, v126, v245
v_cvt_pk_bf16_f32 v58, v244, v245
v_mfma_f32_16x16x32_bf16 v[196:199], a[220:223], v[140:143], v[196:199]
v_exp_f32 v246, v246
v_mfma_f32_16x16x32_bf16 v[204:207], a[208:211], v[144:147], v[100:103]
ds_read_b128 a[196:199], v11 offset:16384
v_add_f32 v126, v126, v246
v_mfma_f32_16x16x32_bf16 v[204:207], a[212:215], v[148:151], v[204:207]
v_exp_f32 v247, v247
v_mfma_f32_16x16x32_bf16 v[204:207], a[216:219], v[152:155], v[204:207]
buffer_load_dwordx4 v24, s[12:15], s47 offen offset:2048 lds
v_mfma_f32_16x16x32_bf16 v[204:207], a[220:223], v[156:159], v[204:207]
ds_read_b128 a[200:203], v12 offset:16384
ds_read_b128 a[204:207], v13 offset:16384
v_mfma_f32_16x16x32_bf16 v[212:215], a[208:211], v[160:163], v[104:107]
v_add_f32 v126, v126, v247
v_cvt_pk_bf16_f32 v59, v246, v247
v_mfma_f32_16x16x32_bf16 v[212:215], a[212:215], v[164:167], v[212:215]
v_exp_f32 v252, v252
v_mfma_f32_16x16x32_bf16 v[212:215], a[216:219], v[168:171], v[212:215]
v_exp_f32 v253, v253
v_mfma_f32_16x16x32_bf16 v[212:215], a[220:223], v[172:175], v[212:215]
v_add_f32 v127, v127, v252
v_add_f32 v127, v127, v253
v_mfma_f32_16x16x32_bf16 v[220:223], a[208:211], v[176:179], v[108:111]
buffer_load_dwordx4 v25, s[12:15], s47 offen offset:3072 lds
v_mfma_f32_16x16x32_bf16 v[220:223], a[212:215], v[180:183], v[220:223]
v_exp_f32 v254, v254
v_mfma_f32_16x16x32_bf16 v[220:223], a[216:219], v[184:187], v[220:223]
v_cvt_pk_bf16_f32 v62, v252, v253
v_add_f32 v127, v127, v254
v_mfma_f32_16x16x32_bf16 v[220:223], a[220:223], v[188:191], v[220:223]
s_waitcnt lgkmcnt(0)
v_exp_f32 v255, v255
v_mfma_f32_16x16x32_bf16 v[224:227], a[192:195], v[128:131], v[96:99]
v_add_f32 v127, v127, v255
v_cvt_pk_bf16_f32 v63, v254, v255
v_mfma_f32_16x16x32_bf16 v[224:227], a[196:199], v[132:135], v[224:227]
ds_read_b128 a[208:211], v10 offset:24576
v_mfma_f32_16x16x32_bf16 v[224:227], a[200:203], v[136:139], v[224:227]
v_exp_f32 v192, v192
v_mfma_f32_16x16x32_bf16 v[224:227], a[204:207], v[140:143], v[224:227]
v_exp_f32 v193, v193
v_mfma_f32_16x16x32_bf16 v[232:235], a[192:195], v[144:147], v[100:103]
ds_read_b128 a[212:215], v11 offset:24576
v_cvt_pk_bf16_f32 v64, v192, v193
v_mfma_f32_16x16x32_bf16 v[232:235], a[196:199], v[148:151], v[232:235]
v_exp_f32 v194, v194
v_mfma_f32_16x16x32_bf16 v[232:235], a[200:203], v[152:155], v[232:235]
v_exp_f32 v195, v195
v_mfma_f32_16x16x32_bf16 v[232:235], a[204:207], v[156:159], v[232:235]
ds_read_b128 a[216:219], v12 offset:24576
ds_read_b128 a[220:223], v13 offset:24576
v_mfma_f32_16x16x32_bf16 v[240:243], a[192:195], v[160:163], v[104:107]
v_exp_f32 v200, v200
v_mfma_f32_16x16x32_bf16 v[240:243], a[196:199], v[164:167], v[240:243]
ds_read_b64_tr_b16 a[224:225], v2 offset:0
v_cvt_pk_bf16_f32 v65, v194, v195
v_mfma_f32_16x16x32_bf16 v[240:243], a[200:203], v[168:171], v[240:243]
v_exp_f32 v201, v201
v_mfma_f32_16x16x32_bf16 v[240:243], a[204:207], v[172:175], v[240:243]
ds_read_b64_tr_b16 a[226:227], v2 offset:8192
ds_read_b64_tr_b16 a[228:229], v2 offset:16384
v_mfma_f32_16x16x32_bf16 v[248:251], a[192:195], v[176:179], v[108:111]
ds_read_b64_tr_b16 a[230:231], v2 offset:24576
v_cvt_pk_bf16_f32 v68, v200, v201
v_mfma_f32_16x16x32_bf16 v[248:251], a[196:199], v[180:183], v[248:251]
v_exp_f32 v202, v202
v_mfma_f32_16x16x32_bf16 v[248:251], a[200:203], v[184:187], v[248:251]
v_exp_f32 v203, v203
v_mfma_f32_16x16x32_bf16 v[248:251], a[204:207], v[188:191], v[248:251]
s_waitcnt lgkmcnt(4)
ds_read_b64_tr_b16 a[232:233], v3 offset:0
ds_read_b64_tr_b16 a[234:235], v3 offset:8192
v_mfma_f32_16x16x32_bf16 v[228:231], a[208:211], v[128:131], v[96:99]
ds_read_b64_tr_b16 a[236:237], v3 offset:16384
v_cvt_pk_bf16_f32 v69, v202, v203
v_mfma_f32_16x16x32_bf16 v[228:231], a[212:215], v[132:135], v[228:231]
v_exp_f32 v208, v208
v_mfma_f32_16x16x32_bf16 v[228:231], a[216:219], v[136:139], v[228:231]
ds_read_b64_tr_b16 a[238:239], v3 offset:24576
v_add_f32 v126, v126, v208
v_mfma_f32_16x16x32_bf16 v[228:231], a[220:223], v[140:143], v[228:231]
v_exp_f32 v209, v209
v_mfma_f32_16x16x32_bf16 v[236:239], a[208:211], v[144:147], v[100:103]
ds_read_b64_tr_b16 a[240:241], v4 offset:0
ds_read_b64_tr_b16 a[242:243], v4 offset:8192
v_mfma_f32_16x16x32_bf16 v[236:239], a[212:215], v[148:151], v[236:239]
ds_read_b64_tr_b16 a[244:245], v4 offset:16384
v_add_f32 v126, v126, v209
v_mfma_f32_16x16x32_bf16 v[236:239], a[216:219], v[152:155], v[236:239]
ds_read_b64_tr_b16 a[246:247], v4 offset:24576
v_cvt_pk_bf16_f32 v72, v208, v209
v_mfma_f32_16x16x32_bf16 v[236:239], a[220:223], v[156:159], v[236:239]
v_exp_f32 v210, v210
v_mfma_f32_16x16x32_bf16 v[244:247], a[208:211], v[160:163], v[104:107]
ds_read_b64_tr_b16 a[248:249], v5 offset:0
v_add_f32 v126, v126, v210
v_mfma_f32_16x16x32_bf16 v[244:247], a[212:215], v[164:167], v[244:247]
v_exp_f32 v211, v211
v_mfma_f32_16x16x32_bf16 v[244:247], a[216:219], v[168:171], v[244:247]
ds_read_b64_tr_b16 a[250:251], v5 offset:8192
ds_read_b64_tr_b16 a[252:253], v5 offset:16384
v_mfma_f32_16x16x32_bf16 v[244:247], a[220:223], v[172:175], v[244:247]
ds_read_b64_tr_b16 a[254:255], v5 offset:24576
v_add_f32 v126, v126, v211
v_mfma_f32_16x16x32_bf16 v[252:255], a[208:211], v[176:179], v[108:111]
v_exp_f32 v216, v216
v_mfma_f32_16x16x32_bf16 v[252:255], a[212:215], v[180:183], v[252:255]
v_cvt_pk_bf16_f32 v73, v210, v211
v_add_f32 v127, v127, v216
v_mfma_f32_16x16x32_bf16 v[252:255], a[216:219], v[184:187], v[252:255]
v_exp_f32 v217, v217
v_mfma_f32_16x16x32_bf16 v[252:255], a[220:223], v[188:191], v[252:255]
s_waitcnt lgkmcnt(12)
v_add_f32 v127, v127, v217
v_cvt_pk_bf16_f32 v76, v216, v217
v_mfma_f32_16x16x32_bf16 a[0:3], a[224:227], v[32:35], a[0:3]
v_exp_f32 v218, v218
v_mfma_f32_16x16x32_bf16 a[0:3], a[228:231], v[48:51], a[0:3]
v_exp_f32 v219, v219
v_mfma_f32_16x16x32_bf16 a[4:7], a[224:227], v[36:39], a[4:7]
v_add_f32 v127, v127, v218
v_add_f32 v127, v127, v219
v_mfma_f32_16x16x32_bf16 a[4:7], a[228:231], v[52:55], a[4:7]
v_exp_f32 v196, v196
v_mfma_f32_16x16x32_bf16 a[8:11], a[224:227], v[40:43], a[8:11]
v_exp_f32 v197, v197
v_mfma_f32_16x16x32_bf16 a[8:11], a[228:231], v[56:59], a[8:11]
v_cvt_pk_bf16_f32 v77, v218, v219
v_cvt_pk_bf16_f32 v66, v196, v197
v_mfma_f32_16x16x32_bf16 a[12:15], a[224:227], v[44:47], a[12:15]
v_exp_f32 v198, v198
v_mfma_f32_16x16x32_bf16 a[12:15], a[228:231], v[60:63], a[12:15]
s_waitcnt lgkmcnt(8)
v_exp_f32 v199, v199
v_mfma_f32_16x16x32_bf16 a[16:19], a[232:235], v[32:35], a[16:19]
ds_read_b64_tr_b16 a[224:225], v14 offset:0
v_cvt_pk_bf16_f32 v67, v198, v199
v_mfma_f32_16x16x32_bf16 a[16:19], a[236:239], v[48:51], a[16:19]
v_exp_f32 v204, v204
v_mfma_f32_16x16x32_bf16 a[20:23], a[232:235], v[36:39], a[20:23]
ds_read_b64_tr_b16 a[226:227], v14 offset:8192
ds_read_b64_tr_b16 a[228:229], v14 offset:16384
v_mfma_f32_16x16x32_bf16 a[20:23], a[236:239], v[52:55], a[20:23]
v_exp_f32 v205, v205
v_mfma_f32_16x16x32_bf16 a[24:27], a[232:235], v[40:43], a[24:27]
ds_read_b64_tr_b16 a[230:231], v14 offset:24576
v_cvt_pk_bf16_f32 v70, v204, v205
v_mfma_f32_16x16x32_bf16 a[24:27], a[236:239], v[56:59], a[24:27]
v_exp_f32 v206, v206
v_mfma_f32_16x16x32_bf16 a[28:31], a[232:235], v[44:47], a[28:31]
v_exp_f32 v207, v207
v_mfma_f32_16x16x32_bf16 a[28:31], a[236:239], v[60:63], a[28:31]
v_exp_f32 v212, v212
v_mfma_f32_16x16x32_bf16 v[116:119], v[112:115], v[32:35], v[116:119]
v_cvt_pk_bf16_f32 v71, v206, v207
v_add_f32 v126, v126, v212
v_mfma_f32_16x16x32_bf16 v[116:119], v[112:115], v[48:51], v[116:119]
s_waitcnt lgkmcnt(8)
v_exp_f32 v213, v213
v_mfma_f32_16x16x32_bf16 a[32:35], a[240:243], v[32:35], a[32:35]
ds_read_b64_tr_b16 a[232:233], v15 offset:0
v_add_f32 v126, v126, v213
v_mfma_f32_16x16x32_bf16 a[32:35], a[244:247], v[48:51], a[32:35]
ds_read_b64_tr_b16 a[234:235], v15 offset:8192
v_cvt_pk_bf16_f32 v74, v212, v213
v_mfma_f32_16x16x32_bf16 a[36:39], a[240:243], v[36:39], a[36:39]
v_exp_f32 v214, v214
v_mfma_f32_16x16x32_bf16 a[36:39], a[244:247], v[52:55], a[36:39]
ds_read_b64_tr_b16 a[236:237], v15 offset:16384
ds_read_b64_tr_b16 a[238:239], v15 offset:24576
v_mfma_f32_16x16x32_bf16 a[40:43], a[240:243], v[40:43], a[40:43]
v_exp_f32 v215, v215
v_mfma_f32_16x16x32_bf16 a[40:43], a[244:247], v[56:59], a[40:43]
v_add_f32 v126, v126, v214
v_add_f32 v126, v126, v215
v_mfma_f32_16x16x32_bf16 a[44:47], a[240:243], v[44:47], a[44:47]
v_exp_f32 v220, v220
v_mfma_f32_16x16x32_bf16 a[44:47], a[244:247], v[60:63], a[44:47]
s_waitcnt lgkmcnt(8)
v_cvt_pk_bf16_f32 v75, v214, v215
v_add_f32 v127, v127, v220
v_mfma_f32_16x16x32_bf16 a[48:51], a[248:251], v[32:35], a[48:51]
v_exp_f32 v221, v221
v_mfma_f32_16x16x32_bf16 a[48:51], a[252:255], v[48:51], a[48:51]
ds_read_b64_tr_b16 a[240:241], v16 offset:0
ds_read_b64_tr_b16 a[242:243], v16 offset:8192
v_mfma_f32_16x16x32_bf16 a[52:55], a[248:251], v[36:39], a[52:55]
ds_read_b64_tr_b16 a[244:245], v16 offset:16384
v_add_f32 v127, v127, v221
v_mfma_f32_16x16x32_bf16 a[52:55], a[252:255], v[52:55], a[52:55]
ds_read_b64_tr_b16 a[246:247], v16 offset:24576
v_cvt_pk_bf16_f32 v78, v220, v221
v_mfma_f32_16x16x32_bf16 a[56:59], a[248:251], v[40:43], a[56:59]
v_exp_f32 v222, v222
v_mfma_f32_16x16x32_bf16 a[56:59], a[252:255], v[56:59], a[56:59]
v_exp_f32 v223, v223
v_mfma_f32_16x16x32_bf16 a[60:63], a[248:251], v[44:47], a[60:63]
v_add_f32 v127, v127, v222
v_add_f32 v127, v127, v223
v_mfma_f32_16x16x32_bf16 a[60:63], a[252:255], v[60:63], a[60:63]
v_cvt_pk_bf16_f32 v79, v222, v223
v_mfma_f32_16x16x32_bf16 v[120:123], v[112:115], v[36:39], v[120:123]
v_mfma_f32_16x16x32_bf16 v[120:123], v[112:115], v[52:55], v[120:123]
s_waitcnt lgkmcnt(8)
v_mfma_f32_16x16x32_bf16 a[64:67], a[224:227], v[32:35], a[64:67]
v_exp_f32 v224, v224
v_mfma_f32_16x16x32_bf16 a[64:67], a[228:231], v[48:51], a[64:67]
ds_read_b64_tr_b16 a[248:249], v17 offset:0
ds_read_b64_tr_b16 a[250:251], v17 offset:8192
v_mfma_f32_16x16x32_bf16 a[68:71], a[224:227], v[36:39], a[68:71]
v_exp_f32 v225, v225
v_mfma_f32_16x16x32_bf16 a[68:71], a[228:231], v[52:55], a[68:71]
ds_read_b64_tr_b16 a[252:253], v17 offset:16384
ds_read_b64_tr_b16 a[254:255], v17 offset:24576
v_mfma_f32_16x16x32_bf16 a[72:75], a[224:227], v[40:43], a[72:75]
v_exp_f32 v226, v226
v_mfma_f32_16x16x32_bf16 a[72:75], a[228:231], v[56:59], a[72:75]
v_exp_f32 v227, v227
v_mfma_f32_16x16x32_bf16 a[76:79], a[224:227], v[44:47], a[76:79]
v_cvt_pk_bf16_f32 v80, v224, v225
v_cvt_pk_bf16_f32 v81, v226, v227
v_mfma_f32_16x16x32_bf16 a[76:79], a[228:231], v[60:63], a[76:79]
s_waitcnt lgkmcnt(10)
v_exp_f32 v232, v232
v_mfma_f32_16x16x32_bf16 a[80:83], a[232:235], v[32:35], a[80:83]
s_waitcnt vmcnt(0) lgkmcnt(0)
v_exp_f32 v233, v233
v_mfma_f32_16x16x32_bf16 a[80:83], a[236:239], v[48:51], a[80:83]
s_barrier
v_mfma_f32_16x16x32_bf16 a[84:87], a[232:235], v[36:39], a[84:87]
s_add_u32 m0, s48, 0
ds_read_b128 a[192:195], v10 offset:32768
v_cvt_pk_bf16_f32 v84, v232, v233
v_mfma_f32_16x16x32_bf16 a[84:87], a[236:239], v[52:55], a[84:87]
s_add_u32 s46, s45, 8192
v_exp_f32 v234, v234
v_mfma_f32_16x16x32_bf16 a[88:91], a[232:235], v[40:43], a[88:91]
s_and_b32 s46, s46, 0x7ffff
ds_read_b128 a[196:199], v11 offset:32768
ds_read_b128 a[200:203], v12 offset:32768
v_mfma_f32_16x16x32_bf16 a[88:91], a[236:239], v[56:59], a[88:91]
buffer_load_dword v28, v26, s[68:71], 0 offen sc1
v_mfma_f32_16x16x32_bf16 a[92:95], a[232:235], v[44:47], a[92:95]
v_exp_f32 v235, v235
v_mfma_f32_16x16x32_bf16 a[92:95], a[236:239], v[60:63], a[92:95]
ds_read_b128 a[204:207], v13 offset:32768
ds_read_b128 a[208:211], v10 offset:40960
v_mfma_f32_16x16x32_bf16 a[96:99], a[240:243], v[32:35], a[96:99]
ds_read_b128 a[212:215], v11 offset:40960
v_cvt_pk_bf16_f32 v85, v234, v235
v_mfma_f32_16x16x32_bf16 a[96:99], a[244:247], v[48:51], a[96:99]
buffer_load_dwordx4 v22, s[8:11], s46 offen lds
v_mfma_f32_16x16x32_bf16 a[100:103], a[240:243], v[36:39], a[100:103]
v_exp_f32 v240, v240
v_mfma_f32_16x16x32_bf16 a[100:103], a[244:247], v[52:55], a[100:103]
ds_read_b128 a[216:219], v12 offset:40960
ds_read_b128 a[220:223], v13 offset:40960
v_mfma_f32_16x16x32_bf16 a[104:107], a[240:243], v[40:43], a[104:107]
v_exp_f32 v241, v241
v_mfma_f32_16x16x32_bf16 a[104:107], a[244:247], v[56:59], a[104:107]
buffer_load_dwordx4 v23, s[8:11], s46 offen offset:1024 lds
v_mfma_f32_16x16x32_bf16 a[108:111], a[240:243], v[44:47], a[108:111]
v_exp_f32 v242, v242
v_mfma_f32_16x16x32_bf16 a[108:111], a[244:247], v[60:63], a[108:111]
v_add_f32 v126, v126, v240
v_add_f32 v126, v126, v241
v_mfma_f32_16x16x32_bf16 a[112:115], a[248:251], v[32:35], a[112:115]
v_exp_f32 v243, v243
v_mfma_f32_16x16x32_bf16 a[112:115], a[252:255], v[48:51], a[112:115]
v_cvt_pk_bf16_f32 v88, v240, v241
v_add_f32 v126, v126, v242
v_mfma_f32_16x16x32_bf16 a[116:119], a[248:251], v[36:39], a[116:119]
buffer_load_dwordx4 v24, s[12:15], s44 offen offset:2048 lds
v_mfma_f32_16x16x32_bf16 a[116:119], a[252:255], v[52:55], a[116:119]
v_exp_f32 v248, v248
v_mfma_f32_16x16x32_bf16 a[120:123], a[248:251], v[40:43], a[120:123]
v_exp_f32 v249, v249
v_mfma_f32_16x16x32_bf16 a[120:123], a[252:255], v[56:59], a[120:123]
v_add_f32 v126, v126, v243
v_cvt_pk_bf16_f32 v89, v242, v243
v_mfma_f32_16x16x32_bf16 a[124:127], a[248:251], v[44:47], a[124:127]
buffer_load_dwordx4 v25, s[12:15], s44 offen offset:3072 lds
v_mfma_f32_16x16x32_bf16 a[124:127], a[252:255], v[60:63], a[124:127]
s_waitcnt lgkmcnt(0)
v_exp_f32 v250, v250
v_mfma_f32_16x16x32_bf16 v[192:195], a[192:195], v[128:131], v[96:99]
v_exp_f32 v251, v251
v_mfma_f32_16x16x32_bf16 v[192:195], a[196:199], v[132:135], v[192:195]
s_add_u32 m0, s48, 16384
v_add_f32 v127, v127, v248
v_add_f32 v127, v127, v249
v_mfma_f32_16x16x32_bf16 v[192:195], a[200:203], v[136:139], v[192:195]
s_add_u32 s47, s46, 8192
v_exp_f32 v228, v228
v_mfma_f32_16x16x32_bf16 v[192:195], a[204:207], v[140:143], v[192:195]
s_and_b32 s47, s47, 0x7ffff
v_cvt_pk_bf16_f32 v92, v248, v249
v_add_f32 v127, v127, v250
v_mfma_f32_16x16x32_bf16 v[200:203], a[192:195], v[144:147], v[100:103]
v_exp_f32 v229, v229
v_mfma_f32_16x16x32_bf16 v[200:203], a[196:199], v[148:151], v[200:203]
buffer_load_dwordx4 v22, s[8:11], s47 offen lds
v_mfma_f32_16x16x32_bf16 v[200:203], a[200:203], v[152:155], v[200:203]
v_exp_f32 v230, v230
v_mfma_f32_16x16x32_bf16 v[200:203], a[204:207], v[156:159], v[200:203]
v_add_f32 v127, v127, v251
v_cvt_pk_bf16_f32 v93, v250, v251
v_mfma_f32_16x16x32_bf16 v[208:211], a[192:195], v[160:163], v[104:107]
v_exp_f32 v231, v231
v_mfma_f32_16x16x32_bf16 v[208:211], a[196:199], v[164:167], v[208:211]
v_cvt_pk_bf16_f32 v82, v228, v229
v_cvt_pk_bf16_f32 v83, v230, v231
v_mfma_f32_16x16x32_bf16 v[208:211], a[200:203], v[168:171], v[208:211]
buffer_load_dwordx4 v23, s[8:11], s47 offen offset:1024 lds
v_mfma_f32_16x16x32_bf16 v[208:211], a[204:207], v[172:175], v[208:211]
v_exp_f32 v236, v236
v_mfma_f32_16x16x32_bf16 v[216:219], a[192:195], v[176:179], v[108:111]
v_exp_f32 v237, v237
v_mfma_f32_16x16x32_bf16 v[216:219], a[196:199], v[180:183], v[216:219]
v_exp_f32 v238, v238
v_mfma_f32_16x16x32_bf16 v[216:219], a[200:203], v[184:187], v[216:219]
v_exp_f32 v239, v239
v_mfma_f32_16x16x32_bf16 v[216:219], a[204:207], v[188:191], v[216:219]
v_cvt_pk_bf16_f32 v86, v236, v237
v_cvt_pk_bf16_f32 v87, v238, v239
v_mfma_f32_16x16x32_bf16 v[196:199], a[208:211], v[128:131], v[96:99]
v_exp_f32 v244, v244
v_mfma_f32_16x16x32_bf16 v[196:199], a[212:215], v[132:135], v[196:199]
ds_read_b128 a[192:195], v10 offset:49152
v_add_f32 v126, v126, v244
v_mfma_f32_16x16x32_bf16 v[196:199], a[216:219], v[136:139], v[196:199]
v_exp_f32 v245, v245
v_mfma_f32_16x16x32_bf16 v[196:199], a[220:223], v[140:143], v[196:199]
ds_read_b128 a[196:199], v11 offset:49152
v_add_f32 v126, v126, v245
v_mfma_f32_16x16x32_bf16 v[204:207], a[208:211], v[144:147], v[100:103]
v_exp_f32 v246, v246
v_mfma_f32_16x16x32_bf16 v[204:207], a[212:215], v[148:151], v[204:207]
ds_read_b128 a[200:203], v12 offset:49152
v_cvt_pk_bf16_f32 v90, v244, v245
v_mfma_f32_16x16x32_bf16 v[204:207], a[216:219], v[152:155], v[204:207]
buffer_load_dwordx4 v24, s[12:15], s45 offen offset:2048 lds
v_mfma_f32_16x16x32_bf16 v[204:207], a[220:223], v[156:159], v[204:207]
ds_read_b128 a[204:207], v13 offset:49152
v_add_f32 v126, v126, v246
v_mfma_f32_16x16x32_bf16 v[212:215], a[208:211], v[160:163], v[104:107]
v_exp_f32 v247, v247
v_mfma_f32_16x16x32_bf16 v[212:215], a[212:215], v[164:167], v[212:215]
v_add_f32 v126, v126, v247
v_cvt_pk_bf16_f32 v91, v246, v247
v_mfma_f32_16x16x32_bf16 v[212:215], a[216:219], v[168:171], v[212:215]
v_exp_f32 v252, v252
v_mfma_f32_16x16x32_bf16 v[212:215], a[220:223], v[172:175], v[212:215]
v_exp_f32 v253, v253
v_mfma_f32_16x16x32_bf16 v[220:223], a[208:211], v[176:179], v[108:111]
buffer_load_dwordx4 v25, s[12:15], s45 offen offset:3072 lds
v_mfma_f32_16x16x32_bf16 v[220:223], a[212:215], v[180:183], v[220:223]
v_add_f32 v127, v127, v252
v_add_f32 v127, v127, v253
v_mfma_f32_16x16x32_bf16 v[220:223], a[216:219], v[184:187], v[220:223]
v_exp_f32 v254, v254
v_mfma_f32_16x16x32_bf16 v[220:223], a[220:223], v[188:191], v[220:223]
s_waitcnt lgkmcnt(0)
v_cvt_pk_bf16_f32 v94, v252, v253
v_add_f32 v127, v127, v254
v_mfma_f32_16x16x32_bf16 v[224:227], a[192:195], v[128:131], v[96:99]
v_exp_f32 v255, v255
v_mfma_f32_16x16x32_bf16 v[224:227], a[196:199], v[132:135], v[224:227]
ds_read_b128 a[208:211], v10 offset:57344
v_add_f32 v127, v127, v255
v_mfma_f32_16x16x32_bf16 v[224:227], a[200:203], v[136:139], v[224:227]
v_exp_f32 v192, v192
v_mfma_f32_16x16x32_bf16 v[224:227], a[204:207], v[140:143], v[224:227]
ds_read_b128 a[212:215], v11 offset:57344
v_cvt_pk_bf16_f32 v95, v254, v255
v_mfma_f32_16x16x32_bf16 v[232:235], a[192:195], v[144:147], v[100:103]
v_exp_f32 v193, v193
v_mfma_f32_16x16x32_bf16 v[232:235], a[196:199], v[148:151], v[232:235]
ds_read_b128 a[216:219], v12 offset:57344
v_cvt_pk_bf16_f32 v32, v192, v193
v_mfma_f32_16x16x32_bf16 v[232:235], a[200:203], v[152:155], v[232:235]
v_exp_f32 v194, v194
v_mfma_f32_16x16x32_bf16 v[232:235], a[204:207], v[156:159], v[232:235]
v_exp_f32 v195, v195
v_mfma_f32_16x16x32_bf16 v[240:243], a[192:195], v[160:163], v[104:107]
ds_read_b128 a[220:223], v13 offset:57344
v_cvt_pk_bf16_f32 v33, v194, v195
v_mfma_f32_16x16x32_bf16 v[240:243], a[196:199], v[164:167], v[240:243]
v_exp_f32 v200, v200
v_mfma_f32_16x16x32_bf16 v[240:243], a[200:203], v[168:171], v[240:243]
ds_read_b64_tr_b16 a[224:225], v2 offset:32768
ds_read_b64_tr_b16 a[226:227], v2 offset:40960
v_mfma_f32_16x16x32_bf16 v[240:243], a[204:207], v[172:175], v[240:243]
v_exp_f32 v201, v201
v_mfma_f32_16x16x32_bf16 v[248:251], a[192:195], v[176:179], v[108:111]
ds_read_b64_tr_b16 a[228:229], v2 offset:49152
ds_read_b64_tr_b16 a[230:231], v2 offset:57344
v_mfma_f32_16x16x32_bf16 v[248:251], a[196:199], v[180:183], v[248:251]
v_exp_f32 v202, v202
v_mfma_f32_16x16x32_bf16 v[248:251], a[200:203], v[184:187], v[248:251]
ds_read_b64_tr_b16 a[232:233], v3 offset:32768
v_cvt_pk_bf16_f32 v36, v200, v201
v_mfma_f32_16x16x32_bf16 v[248:251], a[204:207], v[188:191], v[248:251]
s_waitcnt lgkmcnt(5)
v_exp_f32 v203, v203
v_mfma_f32_16x16x32_bf16 v[228:231], a[208:211], v[128:131], v[96:99]
ds_read_b64_tr_b16 a[234:235], v3 offset:40960
ds_read_b64_tr_b16 a[236:237], v3 offset:49152
v_mfma_f32_16x16x32_bf16 v[228:231], a[212:215], v[132:135], v[228:231]
ds_read_b64_tr_b16 a[238:239], v3 offset:57344
v_cvt_pk_bf16_f32 v37, v202, v203
v_mfma_f32_16x16x32_bf16 v[228:231], a[216:219], v[136:139], v[228:231]
v_exp_f32 v208, v208
v_mfma_f32_16x16x32_bf16 v[228:231], a[220:223], v[140:143], v[228:231]
ds_read_b64_tr_b16 a[240:241], v4 offset:32768
v_add_f32 v126, v126, v208
v_mfma_f32_16x16x32_bf16 v[236:239], a[208:211], v[144:147], v[100:103]
v_exp_f32 v209, v209
v_mfma_f32_16x16x32_bf16 v[236:239], a[212:215], v[148:151], v[236:239]
ds_read_b64_tr_b16 a[242:243], v4 offset:40960
ds_read_b64_tr_b16 a[244:245], v4 offset:49152
v_mfma_f32_16x16x32_bf16 v[236:239], a[216:219], v[152:155], v[236:239]
ds_read_b64_tr_b16 a[246:247], v4 offset:57344
v_add_f32 v126, v126, v209
v_mfma_f32_16x16x32_bf16 v[236:239], a[220:223], v[156:159], v[236:239]
v_exp_f32 v210, v210
v_mfma_f32_16x16x32_bf16 v[244:247], a[208:211], v[160:163], v[104:107]
ds_read_b64_tr_b16 a[248:249], v5 offset:32768
v_cvt_pk_bf16_f32 v40, v208, v209
v_mfma_f32_16x16x32_bf16 v[244:247], a[212:215], v[164:167], v[244:247]
ds_read_b64_tr_b16 a[250:251], v5 offset:40960
v_add_f32 v126, v126, v210
v_mfma_f32_16x16x32_bf16 v[244:247], a[216:219], v[168:171], v[244:247]
v_exp_f32 v211, v211
v_mfma_f32_16x16x32_bf16 v[244:247], a[220:223], v[172:175], v[244:247]
ds_read_b64_tr_b16 a[252:253], v5 offset:49152
ds_read_b64_tr_b16 a[254:255], v5 offset:57344
v_mfma_f32_16x16x32_bf16 v[252:255], a[208:211], v[176:179], v[108:111]
v_exp_f32 v216, v216
v_mfma_f32_16x16x32_bf16 v[252:255], a[212:215], v[180:183], v[252:255]
v_add_f32 v126, v126, v211
v_cvt_pk_bf16_f32 v41, v210, v211
v_mfma_f32_16x16x32_bf16 v[252:255], a[216:219], v[184:187], v[252:255]
v_exp_f32 v217, v217
v_mfma_f32_16x16x32_bf16 v[252:255], a[220:223], v[188:191], v[252:255]
s_waitcnt lgkmcnt(12)
v_add_f32 v127, v127, v216
v_add_f32 v127, v127, v217
v_mfma_f32_16x16x32_bf16 a[0:3], a[224:227], v[64:67], a[0:3]
v_exp_f32 v218, v218
v_mfma_f32_16x16x32_bf16 a[0:3], a[228:231], v[80:83], a[0:3]
v_cvt_pk_bf16_f32 v44, v216, v217
v_add_f32 v127, v127, v218
v_mfma_f32_16x16x32_bf16 a[4:7], a[224:227], v[68:71], a[4:7]
v_exp_f32 v219, v219
v_mfma_f32_16x16x32_bf16 a[4:7], a[228:231], v[84:87], a[4:7]
v_add_f32 v127, v127, v219
v_cvt_pk_bf16_f32 v45, v218, v219
v_mfma_f32_16x16x32_bf16 a[8:11], a[224:227], v[72:75], a[8:11]
v_exp_f32 v196, v196
v_mfma_f32_16x16x32_bf16 a[8:11], a[228:231], v[88:91], a[8:11]
v_exp_f32 v197, v197
v_mfma_f32_16x16x32_bf16 a[12:15], a[224:227], v[76:79], a[12:15]
v_exp_f32 v198, v198
v_mfma_f32_16x16x32_bf16 a[12:15], a[228:231], v[92:95], a[12:15]
s_waitcnt lgkmcnt(8)
v_exp_f32 v199, v199
v_mfma_f32_16x16x32_bf16 a[16:19], a[232:235], v[64:67], a[16:19]
ds_read_b64_tr_b16 a[224:225], v14 offset:32768
v_cvt_pk_bf16_f32 v34, v196, v197
v_mfma_f32_16x16x32_bf16 a[16:19], a[236:239], v[80:83], a[16:19]
ds_read_b64_tr_b16 a[226:227], v14 offset:40960
v_cvt_pk_bf16_f32 v35, v198, v199
v_mfma_f32_16x16x32_bf16 a[20:23], a[232:235], v[68:71], a[20:23]
v_exp_f32 v204, v204
v_mfma_f32_16x16x32_bf16 a[20:23], a[236:239], v[84:87], a[20:23]
ds_read_b64_tr_b16 a[228:229], v14 offset:49152
ds_read_b64_tr_b16 a[230:231], v14 offset:57344
v_mfma_f32_16x16x32_bf16 a[24:27], a[232:235], v[72:75], a[24:27]
v_exp_f32 v205, v205
v_mfma_f32_16x16x32_bf16 a[24:27], a[236:239], v[88:91], a[24:27]
v_exp_f32 v206, v206
v_mfma_f32_16x16x32_bf16 a[28:31], a[232:235], v[76:79], a[28:31]
v_exp_f32 v207, v207
v_mfma_f32_16x16x32_bf16 a[28:31], a[236:239], v[92:95], a[28:31]
v_cvt_pk_bf16_f32 v38, v204, v205
v_cvt_pk_bf16_f32 v39, v206, v207
v_mfma_f32_16x16x32_bf16 v[116:119], v[112:115], v[64:67], v[116:119]
v_exp_f32 v212, v212
v_mfma_f32_16x16x32_bf16 v[116:119], v[112:115], v[80:83], v[116:119]
s_waitcnt lgkmcnt(8)
v_exp_f32 v213, v213
v_mfma_f32_16x16x32_bf16 a[32:35], a[240:243], v[64:67], a[32:35]
ds_read_b64_tr_b16 a[232:233], v15 offset:32768
v_add_f32 v126, v126, v212
v_mfma_f32_16x16x32_bf16 a[32:35], a[244:247], v[80:83], a[32:35]
ds_read_b64_tr_b16 a[234:235], v15 offset:40960
v_add_f32 v126, v126, v213
v_mfma_f32_16x16x32_bf16 a[36:39], a[240:243], v[68:71], a[36:39]
ds_read_b64_tr_b16 a[236:237], v15 offset:49152
v_cvt_pk_bf16_f32 v42, v212, v213
v_mfma_f32_16x16x32_bf16 a[36:39], a[244:247], v[84:87], a[36:39]
v_exp_f32 v214, v214
v_mfma_f32_16x16x32_bf16 a[40:43], a[240:243], v[72:75], a[40:43]
ds_read_b64_tr_b16 a[238:239], v15 offset:57344
v_add_f32 v126, v126, v214
v_mfma_f32_16x16x32_bf16 a[40:43], a[244:247], v[88:91], a[40:43]
v_exp_f32 v215, v215
v_mfma_f32_16x16x32_bf16 a[44:47], a[240:243], v[76:79], a[44:47]
v_add_f32 v126, v126, v215
v_cvt_pk_bf16_f32 v43, v214, v215
v_mfma_f32_16x16x32_bf16 a[44:47], a[244:247], v[92:95], a[44:47]
s_waitcnt lgkmcnt(8)
v_exp_f32 v220, v220
v_mfma_f32_16x16x32_bf16 a[48:51], a[248:251], v[64:67], a[48:51]
ds_read_b64_tr_b16 a[240:241], v16 offset:32768
v_add_f32 v127, v127, v220
v_mfma_f32_16x16x32_bf16 a[48:51], a[252:255], v[80:83], a[48:51]
v_exp_f32 v221, v221
v_mfma_f32_16x16x32_bf16 a[52:55], a[248:251], v[68:71], a[52:55]
ds_read_b64_tr_b16 a[242:243], v16 offset:40960
ds_read_b64_tr_b16 a[244:245], v16 offset:49152
v_mfma_f32_16x16x32_bf16 a[52:55], a[252:255], v[84:87], a[52:55]
ds_read_b64_tr_b16 a[246:247], v16 offset:57344
v_add_f32 v127, v127, v221
v_mfma_f32_16x16x32_bf16 a[56:59], a[248:251], v[72:75], a[56:59]
v_exp_f32 v222, v222
v_mfma_f32_16x16x32_bf16 a[56:59], a[252:255], v[88:91], a[56:59]
v_cvt_pk_bf16_f32 v46, v220, v221
v_add_f32 v127, v127, v222
v_mfma_f32_16x16x32_bf16 a[60:63], a[248:251], v[76:79], a[60:63]
v_exp_f32 v223, v223
v_mfma_f32_16x16x32_bf16 a[60:63], a[252:255], v[92:95], a[60:63]
v_add_f32 v127, v127, v223
v_cvt_pk_bf16_f32 v47, v222, v223
v_mfma_f32_16x16x32_bf16 v[120:123], v[112:115], v[68:71], v[120:123]
v_mfma_f32_16x16x32_bf16 v[120:123], v[112:115], v[84:87], v[120:123]
s_waitcnt lgkmcnt(8)
v_mfma_f32_16x16x32_bf16 a[64:67], a[224:227], v[64:67], a[64:67]
v_exp_f32 v224, v224
v_mfma_f32_16x16x32_bf16 a[64:67], a[228:231], v[80:83], a[64:67]
ds_read_b64_tr_b16 a[248:249], v17 offset:32768
ds_read_b64_tr_b16 a[250:251], v17 offset:40960
v_mfma_f32_16x16x32_bf16 a[68:71], a[224:227], v[68:71], a[68:71]
v_exp_f32 v225, v225
v_mfma_f32_16x16x32_bf16 a[68:71], a[228:231], v[84:87], a[68:71]
ds_read_b64_tr_b16 a[252:253], v17 offset:49152
ds_read_b64_tr_b16 a[254:255], v17 offset:57344
v_mfma_f32_16x16x32_bf16 a[72:75], a[224:227], v[72:75], a[72:75]
v_exp_f32 v226, v226
v_mfma_f32_16x16x32_bf16 a[72:75], a[228:231], v[88:91], a[72:75]
v_exp_f32 v227, v227
v_mfma_f32_16x16x32_bf16 a[76:79], a[224:227], v[76:79], a[76:79]
v_cvt_pk_bf16_f32 v48, v224, v225
v_cvt_pk_bf16_f32 v49, v226, v227
v_mfma_f32_16x16x32_bf16 a[76:79], a[228:231], v[92:95], a[76:79]
s_waitcnt lgkmcnt(10)
v_exp_f32 v232, v232
v_mfma_f32_16x16x32_bf16 a[80:83], a[232:235], v[64:67], a[80:83]
s_waitcnt vmcnt(0) lgkmcnt(0)
v_exp_f32 v233, v233
v_mfma_f32_16x16x32_bf16 a[80:83], a[236:239], v[80:83], a[80:83]
s_barrier
v_mfma_f32_16x16x32_bf16 a[84:87], a[232:235], v[68:71], a[84:87]
s_add_u32 m0, s48, 32768
ds_read_b128 a[192:195], v10 offset:0
v_cvt_pk_bf16_f32 v52, v232, v233
v_mfma_f32_16x16x32_bf16 a[84:87], a[236:239], v[84:87], a[84:87]
s_add_u32 s44, s47, 8192
v_exp_f32 v234, v234
v_mfma_f32_16x16x32_bf16 a[88:91], a[232:235], v[72:75], a[88:91]
s_and_b32 s44, s44, 0x7ffff
ds_read_b128 a[196:199], v11 offset:0
ds_read_b128 a[200:203], v12 offset:0
v_mfma_f32_16x16x32_bf16 a[88:91], a[236:239], v[88:91], a[88:91]
v_exp_f32 v235, v235
v_mfma_f32_16x16x32_bf16 a[92:95], a[232:235], v[76:79], a[92:95]
ds_read_b128 a[204:207], v13 offset:0
v_cvt_pk_bf16_f32 v53, v234, v235
v_mfma_f32_16x16x32_bf16 a[92:95], a[236:239], v[92:95], a[92:95]
v_exp_f32 v240, v240
v_mfma_f32_16x16x32_bf16 a[96:99], a[240:243], v[64:67], a[96:99]
ds_read_b128 a[208:211], v10 offset:8192
ds_read_b128 a[212:215], v11 offset:8192
v_mfma_f32_16x16x32_bf16 a[96:99], a[244:247], v[80:83], a[96:99]
buffer_load_dwordx4 v22, s[8:11], s44 offen lds
v_mfma_f32_16x16x32_bf16 a[100:103], a[240:243], v[68:71], a[100:103]
ds_read_b128 a[216:219], v12 offset:8192
ds_read_b128 a[220:223], v13 offset:8192
v_mfma_f32_16x16x32_bf16 a[100:103], a[244:247], v[84:87], a[100:103]
v_exp_f32 v241, v241
v_mfma_f32_16x16x32_bf16 a[104:107], a[240:243], v[72:75], a[104:107]
v_add_f32 v126, v126, v240
v_add_f32 v126, v126, v241
v_mfma_f32_16x16x32_bf16 a[104:107], a[244:247], v[88:91], a[104:107]
buffer_load_dwordx4 v23, s[8:11], s44 offen offset:1024 lds
v_mfma_f32_16x16x32_bf16 a[108:111], a[240:243], v[76:79], a[108:111]
v_exp_f32 v242, v242
v_mfma_f32_16x16x32_bf16 a[108:111], a[244:247], v[92:95], a[108:111]
v_cvt_pk_bf16_f32 v56, v240, v241
v_add_f32 v126, v126, v242
v_mfma_f32_16x16x32_bf16 a[112:115], a[248:251], v[64:67], a[112:115]
v_exp_f32 v243, v243
v_mfma_f32_16x16x32_bf16 a[112:115], a[252:255], v[80:83], a[112:115]
v_add_f32 v126, v126, v243
v_cvt_pk_bf16_f32 v57, v242, v243
v_mfma_f32_16x16x32_bf16 a[116:119], a[248:251], v[68:71], a[116:119]
buffer_load_dwordx4 v24, s[12:15], s46 offen offset:2048 lds
v_mfma_f32_16x16x32_bf16 a[116:119], a[252:255], v[84:87], a[116:119]
v_exp_f32 v248, v248
v_mfma_f32_16x16x32_bf16 a[120:123], a[248:251], v[72:75], a[120:123]
s_sub_u32 s49, s49, 1
v_exp_f32 v249, v249
v_mfma_f32_16x16x32_bf16 a[120:123], a[252:255], v[88:91], a[120:123]
s_cmp_lg_u32 s49, 0
v_add_f32 v127, v127, v248
v_add_f32 v127, v127, v249
v_mfma_f32_16x16x32_bf16 a[124:127], a[248:251], v[76:79], a[124:127]
buffer_load_dwordx4 v25, s[12:15], s46 offen offset:3072 lds
v_mfma_f32_16x16x32_bf16 a[124:127], a[252:255], v[92:95], a[124:127]
s_waitcnt lgkmcnt(0)
s_cbranch_scc1 L_attn_head
v_exp_f32 v250, v250
v_readfirstlane_b32 s1, v28
v_mfma_f32_16x16x32_bf16 v[192:195], a[192:195], v[128:131], v[96:99]
v_exp_f32 v251, v251
v_mfma_f32_16x16x32_bf16 v[192:195], a[196:199], v[132:135], v[192:195]
s_add_u32 m0, s48, 49152
v_cvt_pk_bf16_f32 v60, v248, v249
v_add_f32 v127, v127, v250
v_mfma_f32_16x16x32_bf16 v[192:195], a[200:203], v[136:139], v[192:195]
s_add_u32 s45, s44, 8192
v_exp_f32 v228, v228
v_mfma_f32_16x16x32_bf16 v[192:195], a[204:207], v[140:143], v[192:195]
s_and_b32 s45, s45, 0x7ffff
v_add_f32 v127, v127, v251
v_cvt_pk_bf16_f32 v61, v250, v251
v_mfma_f32_16x16x32_bf16 v[200:203], a[192:195], v[144:147], v[100:103]
v_exp_f32 v229, v229
v_mfma_f32_16x16x32_bf16 v[200:203], a[196:199], v[148:151], v[200:203]
buffer_load_dwordx4 v22, s[8:11], s45 offen lds
v_mfma_f32_16x16x32_bf16 v[200:203], a[200:203], v[152:155], v[200:203]
v_exp_f32 v230, v230
v_mfma_f32_16x16x32_bf16 v[200:203], a[204:207], v[156:159], v[200:203]
v_exp_f32 v231, v231
v_mfma_f32_16x16x32_bf16 v[208:211], a[192:195], v[160:163], v[104:107]
v_cvt_pk_bf16_f32 v50, v228, v229
v_cvt_pk_bf16_f32 v51, v230, v231
v_mfma_f32_16x16x32_bf16 v[208:211], a[196:199], v[164:167], v[208:211]
v_exp_f32 v236, v236
v_mfma_f32_16x16x32_bf16 v[208:211], a[200:203], v[168:171], v[208:211]
buffer_load_dwordx4 v23, s[8:11], s45 offen offset:1024 lds
v_mfma_f32_16x16x32_bf16 v[208:211], a[204:207], v[172:175], v[208:211]
v_exp_f32 v237, v237
v_mfma_f32_16x16x32_bf16 v[216:219], a[192:195], v[176:179], v[108:111]
v_exp_f32 v238, v238
v_mfma_f32_16x16x32_bf16 v[216:219], a[196:199], v[180:183], v[216:219]
v_exp_f32 v239, v239
v_cvt_pk_bf16_f32 v54, v236, v237
v_mfma_f32_16x16x32_bf16 v[216:219], a[200:203], v[184:187], v[216:219]
v_exp_f32 v244, v244
v_mfma_f32_16x16x32_bf16 v[216:219], a[204:207], v[188:191], v[216:219]
v_cvt_pk_bf16_f32 v55, v238, v239
v_add_f32 v126, v126, v244
v_mfma_f32_16x16x32_bf16 v[196:199], a[208:211], v[128:131], v[96:99]
v_exp_f32 v245, v245
v_mfma_f32_16x16x32_bf16 v[196:199], a[212:215], v[132:135], v[196:199]
ds_read_b128 a[192:195], v10 offset:16384
v_add_f32 v126, v126, v245
v_mfma_f32_16x16x32_bf16 v[196:199], a[216:219], v[136:139], v[196:199]
v_exp_f32 v246, v246
v_mfma_f32_16x16x32_bf16 v[196:199], a[220:223], v[140:143], v[196:199]
ds_read_b128 a[196:199], v11 offset:16384
v_cvt_pk_bf16_f32 v58, v244, v245
v_mfma_f32_16x16x32_bf16 v[204:207], a[208:211], v[144:147], v[100:103]
v_exp_f32 v247, v247
v_mfma_f32_16x16x32_bf16 v[204:207], a[212:215], v[148:151], v[204:207]
ds_read_b128 a[200:203], v12 offset:16384
v_add_f32 v126, v126, v246
v_mfma_f32_16x16x32_bf16 v[204:207], a[216:219], v[152:155], v[204:207]
buffer_load_dwordx4 v24, s[12:15], s47 offen offset:2048 lds
v_mfma_f32_16x16x32_bf16 v[204:207], a[220:223], v[156:159], v[204:207]
ds_read_b128 a[204:207], v13 offset:16384
v_add_f32 v126, v126, v247
v_mfma_f32_16x16x32_bf16 v[212:215], a[208:211], v[160:163], v[104:107]
v_exp_f32 v252, v252
v_mfma_f32_16x16x32_bf16 v[212:215], a[212:215], v[164:167], v[212:215]
v_cvt_pk_bf16_f32 v59, v246, v247
v_add_f32 v127, v127, v252
v_mfma_f32_16x16x32_bf16 v[212:215], a[216:219], v[168:171], v[212:215]
v_exp_f32 v253, v253
v_mfma_f32_16x16x32_bf16 v[212:215], a[220:223], v[172:175], v[212:215]
v_add_f32 v127, v127, v253
v_cvt_pk_bf16_f32 v62, v252, v253
v_mfma_f32_16x16x32_bf16 v[220:223], a[208:211], v[176:179], v[108:111]
buffer_load_dwordx4 v25, s[12:15], s47 offen offset:3072 lds
v_mfma_f32_16x16x32_bf16 v[220:223], a[212:215], v[180:183], v[220:223]
v_exp_f32 v254, v254
v_mfma_f32_16x16x32_bf16 v[220:223], a[216:219], v[184:187], v[220:223]
s_lshl_b32 s62, s5, 3
v_exp_f32 v255, v255
v_mfma_f32_16x16x32_bf16 v[220:223], a[220:223], v[188:191], v[220:223]
s_waitcnt lgkmcnt(0)
v_add_f32 v127, v127, v254
v_add_f32 v127, v127, v255
v_mfma_f32_16x16x32_bf16 v[224:227], a[192:195], v[128:131], v[96:99]
s_add_u32 s62, s62, s4
v_cvt_pk_bf16_f32 v63, v254, v255
v_mfma_f32_16x16x32_bf16 v[224:227], a[196:199], v[132:135], v[224:227]
s_lshl_b32 s62, s62, 2
ds_read_b128 a[208:211], v10 offset:24576
v_mfma_f32_16x16x32_bf16 v[224:227], a[200:203], v[136:139], v[224:227]
v_exp_f32 v192, v192
v_mfma_f32_16x16x32_bf16 v[224:227], a[204:207], v[140:143], v[224:227]
s_add_u32 s62, s62, s3
v_exp_f32 v193, v193
v_mfma_f32_16x16x32_bf16 v[232:235], a[192:195], v[144:147], v[100:103]
s_lshl_b32 s62, s62, 11
ds_read_b128 a[212:215], v11 offset:24576
v_cvt_pk_bf16_f32 v64, v192, v193
v_mfma_f32_16x16x32_bf16 v[232:235], a[196:199], v[148:151], v[232:235]
s_lshl_b32 s63, s4, 1
v_exp_f32 v194, v194
v_mfma_f32_16x16x32_bf16 v[232:235], a[200:203], v[152:155], v[232:235]
v_exp_f32 v195, v195
v_mfma_f32_16x16x32_bf16 v[232:235], a[204:207], v[156:159], v[232:235]
s_lshr_b32 s0, s3, 1
ds_read_b128 a[216:219], v12 offset:24576
ds_read_b128 a[220:223], v13 offset:24576
v_cvt_pk_bf16_f32 v65, v194, v195
v_mfma_f32_16x16x32_bf16 v[240:243], a[192:195], v[160:163], v[104:107]
s_add_u32 s63, s63, s0
v_exp_f32 v200, v200
v_mfma_f32_16x16x32_bf16 v[240:243], a[196:199], v[164:167], v[240:243]
s_lshl_b32 s63, s63, 6
v_exp_f32 v201, v201
v_mfma_f32_16x16x32_bf16 v[240:243], a[200:203], v[168:171], v[240:243]
ds_read_b64_tr_b16 a[224:225], v2 offset:0
ds_read_b64_tr_b16 a[226:227], v2 offset:8192
v_mfma_f32_16x16x32_bf16 v[240:243], a[204:207], v[172:175], v[240:243]
s_and_b32 s0, s3, 1
ds_read_b64_tr_b16 a[228:229], v2 offset:16384
v_cvt_pk_bf16_f32 v68, v200, v201
v_mfma_f32_16x16x32_bf16 v[248:251], a[192:195], v[176:179], v[108:111]
s_lshl_b32 s0, s0, 15
v_exp_f32 v202, v202
v_mfma_f32_16x16x32_bf16 v[248:251], a[196:199], v[180:183], v[248:251]
s_add_u32 s63, s63, s0
v_exp_f32 v203, v203
v_mfma_f32_16x16x32_bf16 v[248:251], a[200:203], v[184:187], v[248:251]
ds_read_b64_tr_b16 a[230:231], v2 offset:24576
ds_read_b64_tr_b16 a[232:233], v3 offset:0
v_mfma_f32_16x16x32_bf16 v[248:251], a[204:207], v[188:191], v[248:251]
s_waitcnt lgkmcnt(5)
ds_read_b64_tr_b16 a[234:235], v3 offset:8192
v_cvt_pk_bf16_f32 v69, v202, v203
v_mfma_f32_16x16x32_bf16 v[228:231], a[208:211], v[128:131], v[96:99]
s_lshl_b32 s0, s5, 16
v_exp_f32 v208, v208
v_mfma_f32_16x16x32_bf16 v[228:231], a[212:215], v[132:135], v[228:231]
s_add_u32 s63, s63, s0
ds_read_b64_tr_b16 a[236:237], v3 offset:16384
ds_read_b64_tr_b16 a[238:239], v3 offset:24576
v_mfma_f32_16x16x32_bf16 v[228:231], a[216:219], v[136:139], v[228:231]
s_bfe_u32 s1, s1, 0x80008
v_exp_f32 v209, v209
v_mfma_f32_16x16x32_bf16 v[228:231], a[220:223], v[140:143], v[228:231]
ds_read_b64_tr_b16 a[240:241], v4 offset:0
v_add_f32 v126, v126, v208
v_mfma_f32_16x16x32_bf16 v[236:239], a[208:211], v[144:147], v[100:103]
s_cmp_lg_u32 s1, 0xff
ds_read_b64_tr_b16 a[242:243], v4 offset:8192
v_add_f32 v126, v126, v209
v_cvt_pk_bf16_f32 v72, v208, v209
v_mfma_f32_16x16x32_bf16 v[236:239], a[212:215], v[148:151], v[236:239]
s_cselect_b32 s61, 1, 0
v_exp_f32 v210, v210
v_mfma_f32_16x16x32_bf16 v[236:239], a[216:219], v[152:155], v[236:239]
s_cselect_b32 s1, 0x40000000, s62
ds_read_b64_tr_b16 a[244:245], v4 offset:16384
ds_read_b64_tr_b16 a[246:247], v4 offset:24576
v_mfma_f32_16x16x32_bf16 v[236:239], a[220:223], v[156:159], v[236:239]
v_exp_f32 v211, v211
v_mfma_f32_16x16x32_bf16 v[244:247], a[208:211], v[160:163], v[104:107]
s_add_u32 s0, s1, 16777216
ds_read_b64_tr_b16 a[248:249], v5 offset:0
v_add_f32 v126, v126, v210
v_mfma_f32_16x16x32_bf16 v[244:247], a[212:215], v[164:167], v[244:247]
ds_read_b64_tr_b16 a[250:251], v5 offset:8192
v_add_f32 v126, v126, v211
v_mfma_f32_16x16x32_bf16 v[244:247], a[216:219], v[168:171], v[244:247]
buffer_load_dwordx4 a[160:163], v1, s[40:43], s0 offen offset:1024 sc1
v_mfma_f32_16x16x32_bf16 v[244:247], a[220:223], v[172:175], v[244:247]
ds_read_b64_tr_b16 a[252:253], v5 offset:16384
ds_read_b64_tr_b16 a[254:255], v5 offset:24576
v_mfma_f32_16x16x32_bf16 v[252:255], a[208:211], v[176:179], v[108:111]
v_exp_f32 v216, v216
v_mfma_f32_16x16x32_bf16 v[252:255], a[212:215], v[180:183], v[252:255]
s_add_u32 s0, s1, 18874368
v_cvt_pk_bf16_f32 v73, v210, v211
v_add_f32 v127, v127, v216
v_mfma_f32_16x16x32_bf16 v[252:255], a[216:219], v[184:187], v[252:255]
v_exp_f32 v217, v217
v_mfma_f32_16x16x32_bf16 v[252:255], a[220:223], v[188:191], v[252:255]
s_waitcnt lgkmcnt(12)
v_add_f32 v127, v127, v217
v_cvt_pk_bf16_f32 v76, v216, v217
v_mfma_f32_16x16x32_bf16 a[0:3], a[224:227], v[32:35], a[0:3]
v_exp_f32 v218, v218
v_mfma_f32_16x16x32_bf16 a[0:3], a[228:231], v[48:51], a[0:3]
buffer_load_dwordx4 a[164:167], v1, s[40:43], s0 offen offset:1024 sc1
v_mfma_f32_16x16x32_bf16 a[4:7], a[224:227], v[36:39], a[4:7]
v_exp_f32 v219, v219
v_add_f32 v127, v127, v218
v_mfma_f32_16x16x32_bf16 a[4:7], a[228:231], v[52:55], a[4:7]
s_add_u32 s0, s1, 20971520
v_add_f32 v127, v127, v219
v_cvt_pk_bf16_f32 v77, v218, v219
v_mfma_f32_16x16x32_bf16 a[8:11], a[224:227], v[40:43], a[8:11]
v_exp_f32 v196, v196
v_mfma_f32_16x16x32_bf16 a[8:11], a[228:231], v[56:59], a[8:11]
v_exp_f32 v197, v197
v_mfma_f32_16x16x32_bf16 a[12:15], a[224:227], v[44:47], a[12:15]
buffer_load_dwordx4 a[168:171], v1, s[40:43], s0 offen offset:1024 sc1
v_mfma_f32_16x16x32_bf16 a[12:15], a[228:231], v[60:63], a[12:15]
s_waitcnt lgkmcnt(8)
v_exp_f32 v198, v198
v_mfma_f32_16x16x32_bf16 a[16:19], a[232:235], v[32:35], a[16:19]
ds_read_b64_tr_b16 a[224:225], v14 offset:0
v_cvt_pk_bf16_f32 v66, v196, v197
v_mfma_f32_16x16x32_bf16 a[16:19], a[236:239], v[48:51], a[16:19]
v_exp_f32 v199, v199
v_mfma_f32_16x16x32_bf16 a[20:23], a[232:235], v[36:39], a[20:23]
s_add_u32 s0, s1, 23068672
ds_read_b64_tr_b16 a[226:227], v14 offset:8192
ds_read_b64_tr_b16 a[228:229], v14 offset:16384
v_mfma_f32_16x16x32_bf16 a[20:23], a[236:239], v[52:55], a[20:23]
ds_read_b64_tr_b16 a[230:231], v14 offset:24576
v_cvt_pk_bf16_f32 v67, v198, v199
v_mfma_f32_16x16x32_bf16 a[24:27], a[232:235], v[40:43], a[24:27]
buffer_load_dwordx4 a[172:175], v1, s[40:43], s0 offen offset:1024 sc1
v_mfma_f32_16x16x32_bf16 a[24:27], a[236:239], v[56:59], a[24:27]
v_exp_f32 v204, v204
v_mfma_f32_16x16x32_bf16 a[28:31], a[232:235], v[44:47], a[28:31]
v_exp_f32 v205, v205
v_mfma_f32_16x16x32_bf16 a[28:31], a[236:239], v[60:63], a[28:31]
s_add_u32 s0, s1, 25165824
v_exp_f32 v206, v206
v_cvt_pk_bf16_f32 v70, v204, v205
v_mfma_f32_16x16x32_bf16 v[116:119], v[112:115], v[32:35], v[116:119]
v_exp_f32 v207, v207
v_mfma_f32_16x16x32_bf16 v[116:119], v[112:115], v[48:51], v[116:119]
s_waitcnt lgkmcnt(8)
v_exp_f32 v212, v212
v_mfma_f32_16x16x32_bf16 a[32:35], a[240:243], v[32:35], a[32:35]
ds_read_b64_tr_b16 a[232:233], v15 offset:0
v_cvt_pk_bf16_f32 v71, v206, v207
v_mfma_f32_16x16x32_bf16 a[32:35], a[244:247], v[48:51], a[32:35]
buffer_load_dwordx4 a[176:179], v1, s[40:43], s0 offen offset:1024 sc1
v_mfma_f32_16x16x32_bf16 a[36:39], a[240:243], v[36:39], a[36:39]
ds_read_b64_tr_b16 a[234:235], v15 offset:8192
ds_read_b64_tr_b16 a[236:237], v15 offset:16384
v_mfma_f32_16x16x32_bf16 a[36:39], a[244:247], v[52:55], a[36:39]
s_add_u32 s0, s1, 27262976
ds_read_b64_tr_b16 a[238:239], v15 offset:24576
v_add_f32 v126, v126, v212
v_mfma_f32_16x16x32_bf16 a[40:43], a[240:243], v[40:43], a[40:43]
v_exp_f32 v213, v213
v_mfma_f32_16x16x32_bf16 a[40:43], a[244:247], v[56:59], a[40:43]
v_add_f32 v126, v126, v213
v_cvt_pk_bf16_f32 v74, v212, v213
v_mfma_f32_16x16x32_bf16 a[44:47], a[240:243], v[44:47], a[44:47]
buffer_load_dwordx4 a[180:183], v1, s[40:43], s0 offen offset:1024 sc1
v_mfma_f32_16x16x32_bf16 a[44:47], a[244:247], v[60:63], a[44:47]
s_waitcnt lgkmcnt(8)
v_exp_f32 v214, v214
v_mfma_f32_16x16x32_bf16 a[48:51], a[248:251], v[32:35], a[48:51]
v_exp_f32 v215, v215
v_mfma_f32_16x16x32_bf16 a[48:51], a[252:255], v[48:51], a[48:51]
ds_read_b64_tr_b16 a[240:241], v16 offset:0
ds_read_b64_tr_b16 a[242:243], v16 offset:8192
v_mfma_f32_16x16x32_bf16 a[52:55], a[248:251], v[36:39], a[52:55]
s_add_u32 s0, s1, 29360128
ds_read_b64_tr_b16 a[244:245], v16 offset:16384
v_exp_f32 v220, v220
v_mfma_f32_16x16x32_bf16 a[52:55], a[252:255], v[52:55], a[52:55]
ds_read_b64_tr_b16 a[246:247], v16 offset:24576
v_add_f32 v126, v126, v214
v_mfma_f32_16x16x32_bf16 a[56:59], a[248:251], v[40:43], a[56:59]
buffer_load_dwordx4 a[184:187], v1, s[40:43], s0 offen offset:1024 sc1
v_mfma_f32_16x16x32_bf16 a[56:59], a[252:255], v[56:59], a[56:59]
v_exp_f32 v221, v221
v_mfma_f32_16x16x32_bf16 a[60:63], a[248:251], v[44:47], a[60:63]
v_exp_f32 v222, v222
v_mfma_f32_16x16x32_bf16 a[60:63], a[252:255], v[60:63], a[60:63]
s_add_u32 s0, s1, 31457280
v_add_f32 v126, v126, v215
v_cvt_pk_bf16_f32 v75, v214, v215
v_mfma_f32_16x16x32_bf16 v[120:123], v[112:115], v[36:39], v[120:123]
v_exp_f32 v223, v223
v_mfma_f32_16x16x32_bf16 v[120:123], v[112:115], v[52:55], v[120:123]
s_waitcnt lgkmcnt(8)
v_add_f32 v127, v127, v220
v_add_f32 v127, v127, v221
v_mfma_f32_16x16x32_bf16 a[64:67], a[224:227], v[32:35], a[64:67]
ds_read_b64_tr_b16 a[248:249], v17 offset:0
v_cvt_pk_bf16_f32 v78, v220, v221
v_mfma_f32_16x16x32_bf16 a[64:67], a[228:231], v[48:51], a[64:67]
buffer_load_dwordx4 a[188:191], v1, s[40:43], s0 offen offset:1024 sc1
v_mfma_f32_16x16x32_bf16 a[68:71], a[224:227], v[36:39], a[68:71]
v_exp_f32 v224, v224
v_mfma_f32_16x16x32_bf16 a[68:71], a[228:231], v[52:55], a[68:71]
ds_read_b64_tr_b16 a[250:251], v17 offset:8192
ds_read_b64_tr_b16 a[252:253], v17 offset:16384
v_mfma_f32_16x16x32_bf16 a[72:75], a[224:227], v[40:43], a[72:75]
v_exp_f32 v225, v225
v_mfma_f32_16x16x32_bf16 a[72:75], a[228:231], v[56:59], a[72:75]
ds_read_b64_tr_b16 a[254:255], v17 offset:24576
v_add_f32 v127, v127, v222
v_add_f32 v127, v127, v223
v_mfma_f32_16x16x32_bf16 a[76:79], a[224:227], v[44:47], a[76:79]
v_exp_f32 v226, v226
v_mfma_f32_16x16x32_bf16 a[76:79], a[228:231], v[60:63], a[76:79]
s_waitcnt lgkmcnt(10)
v_cvt_pk_bf16_f32 v79, v222, v223
v_cvt_pk_bf16_f32 v80, v224, v225
v_mfma_f32_16x16x32_bf16 a[80:83], a[232:235], v[32:35], a[80:83]
s_waitcnt vmcnt(8) lgkmcnt(0)
v_exp_f32 v227, v227
v_mfma_f32_16x16x32_bf16 a[80:83], a[236:239], v[48:51], a[80:83]
s_barrier
v_mfma_f32_16x16x32_bf16 a[84:87], a[232:235], v[36:39], a[84:87]
s_add_u32 m0, s48, 0
v_exp_f32 v232, v232
v_mfma_f32_16x16x32_bf16 a[84:87], a[236:239], v[52:55], a[84:87]
s_add_u32 s46, s45, 8192
ds_read_b128 a[192:195], v10 offset:32768
ds_read_b128 a[196:199], v11 offset:32768
v_mfma_f32_16x16x32_bf16 a[88:91], a[232:235], v[40:43], a[88:91]
s_and_b32 s46, s46, 0x7ffff
v_exp_f32 v233, v233
v_mfma_f32_16x16x32_bf16 a[88:91], a[236:239], v[56:59], a[88:91]
ds_read_b128 a[200:203], v12 offset:32768
ds_read_b128 a[204:207], v13 offset:32768
v_mfma_f32_16x16x32_bf16 a[92:95], a[232:235], v[44:47], a[92:95]
v_exp_f32 v234, v234
v_mfma_f32_16x16x32_bf16 a[92:95], a[236:239], v[60:63], a[92:95]
ds_read_b128 a[208:211], v10 offset:40960
v_cvt_pk_bf16_f32 v81, v226, v227
v_mfma_f32_16x16x32_bf16 a[96:99], a[240:243], v[32:35], a[96:99]
v_exp_f32 v235, v235
v_mfma_f32_16x16x32_bf16 a[96:99], a[244:247], v[48:51], a[96:99]
buffer_load_dwordx4 v22, s[8:11], s46 offen lds
v_mfma_f32_16x16x32_bf16 a[100:103], a[240:243], v[36:39], a[100:103]
ds_read_b128 a[212:215], v11 offset:40960
ds_read_b128 a[216:219], v12 offset:40960
ds_read_b128 a[220:223], v13 offset:40960
v_mfma_f32_16x16x32_bf16 a[100:103], a[244:247], v[52:55], a[100:103]
v_exp_f32 v240, v240
v_mfma_f32_16x16x32_bf16 a[104:107], a[240:243], v[40:43], a[104:107]
v_exp_f32 v241, v241
v_mfma_f32_16x16x32_bf16 a[104:107], a[244:247], v[56:59], a[104:107]
buffer_load_dwordx4 v23, s[8:11], s46 offen offset:1024 lds
v_mfma_f32_16x16x32_bf16 a[108:111], a[240:243], v[44:47], a[108:111]
v_exp_f32 v242, v242
v_mfma_f32_16x16x32_bf16 a[108:111], a[244:247], v[60:63], a[108:111]
v_cvt_pk_bf16_f32 v84, v232, v233
v_cvt_pk_bf16_f32 v85, v234, v235
v_mfma_f32_16x16x32_bf16 a[112:115], a[248:251], v[32:35], a[112:115]
v_exp_f32 v243, v243
v_mfma_f32_16x16x32_bf16 a[112:115], a[252:255], v[48:51], a[112:115]
v_add_f32 v126, v126, v240
v_add_f32 v126, v126, v241
v_mfma_f32_16x16x32_bf16 a[116:119], a[248:251], v[36:39], a[116:119]
buffer_load_dwordx4 v24, s[12:15], s44 offen offset:2048 lds
v_mfma_f32_16x16x32_bf16 a[116:119], a[252:255], v[52:55], a[116:119]
v_exp_f32 v248, v248
v_mfma_f32_16x16x32_bf16 a[120:123], a[248:251], v[40:43], a[120:123]
v_exp_f32 v249, v249
v_mfma_f32_16x16x32_bf16 a[120:123], a[252:255], v[56:59], a[120:123]
v_cvt_pk_bf16_f32 v88, v240, v241
v_add_f32 v126, v126, v242
v_mfma_f32_16x16x32_bf16 a[124:127], a[248:251], v[44:47], a[124:127]
buffer_load_dwordx4 v25, s[12:15], s44 offen offset:3072 lds
v_mfma_f32_16x16x32_bf16 a[124:127], a[252:255], v[60:63], a[124:127]
s_waitcnt lgkmcnt(0)
v_exp_f32 v250, v250
v_add_f32 v126, v126, v243
v_mfma_f32_16x16x32_bf16 v[192:195], a[192:195], v[128:131], v[96:99]
v_exp_f32 v251, v251
v_mfma_f32_16x16x32_bf16 v[192:195], a[196:199], v[132:135], v[192:195]
s_add_u32 m0, s48, 16384
v_cvt_pk_bf16_f32 v89, v242, v243
v_add_f32 v127, v127, v248
v_mfma_f32_16x16x32_bf16 v[192:195], a[200:203], v[136:139], v[192:195]
s_add_u32 s47, s46, 8192
v_exp_f32 v228, v228
v_mfma_f32_16x16x32_bf16 v[192:195], a[204:207], v[140:143], v[192:195]
s_and_b32 s47, s47, 0x7ffff
v_add_f32 v127, v127, v249
v_cvt_pk_bf16_f32 v92, v248, v249
v_mfma_f32_16x16x32_bf16 v[200:203], a[192:195], v[144:147], v[100:103]
v_exp_f32 v229, v229
v_mfma_f32_16x16x32_bf16 v[200:203], a[196:199], v[148:151], v[200:203]
buffer_load_dwordx4 v22, s[8:11], s47 offen lds
v_mfma_f32_16x16x32_bf16 v[200:203], a[200:203], v[152:155], v[200:203]
v_exp_f32 v230, v230
v_add_f32 v127, v127, v250
v_mfma_f32_16x16x32_bf16 v[200:203], a[204:207], v[156:159], v[200:203]
v_add_f32 v127, v127, v251
v_cvt_pk_bf16_f32 v93, v250, v251
v_mfma_f32_16x16x32_bf16 v[208:211], a[192:195], v[160:163], v[104:107]
v_exp_f32 v231, v231
v_mfma_f32_16x16x32_bf16 v[208:211], a[196:199], v[164:167], v[208:211]
v_cvt_pk_bf16_f32 v82, v228, v229
v_cvt_pk_bf16_f32 v83, v230, v231
v_mfma_f32_16x16x32_bf16 v[208:211], a[200:203], v[168:171], v[208:211]
buffer_load_dwordx4 v23, s[8:11], s47 offen offset:1024 lds
v_mfma_f32_16x16x32_bf16 v[208:211], a[204:207], v[172:175], v[208:211]
v_exp_f32 v236, v236
v_mfma_f32_16x16x32_bf16 v[216:219], a[192:195], v[176:179], v[108:111]
v_exp_f32 v237, v237
v_mfma_f32_16x16x32_bf16 v[216:219], a[196:199], v[180:183], v[216:219]
v_exp_f32 v238, v238
v_mfma_f32_16x16x32_bf16 v[216:219], a[200:203], v[184:187], v[216:219]
v_exp_f32 v239, v239
v_mfma_f32_16x16x32_bf16 v[216:219], a[204:207], v[188:191], v[216:219]
v_cvt_pk_bf16_f32 v86, v236, v237
v_cvt_pk_bf16_f32 v87, v238, v239
v_mfma_f32_16x16x32_bf16 v[196:199], a[208:211], v[128:131], v[96:99]
v_exp_f32 v244, v244
v_mfma_f32_16x16x32_bf16 v[196:199], a[212:215], v[132:135], v[196:199]
ds_read_b128 a[192:195], v10 offset:49152
v_add_f32 v126, v126, v244
v_mfma_f32_16x16x32_bf16 v[196:199], a[216:219], v[136:139], v[196:199]
v_exp_f32 v245, v245
v_mfma_f32_16x16x32_bf16 v[196:199], a[220:223], v[140:143], v[196:199]
ds_read_b128 a[196:199], v11 offset:49152
v_add_f32 v126, v126, v245
v_mfma_f32_16x16x32_bf16 v[204:207], a[208:211], v[144:147], v[100:103]
v_exp_f32 v246, v246
v_mfma_f32_16x16x32_bf16 v[204:207], a[212:215], v[148:151], v[204:207]
ds_read_b128 a[200:203], v12 offset:49152
v_cvt_pk_bf16_f32 v90, v244, v245
v_mfma_f32_16x16x32_bf16 v[204:207], a[216:219], v[152:155], v[204:207]
buffer_load_dwordx4 v24, s[12:15], s45 offen offset:2048 lds
v_mfma_f32_16x16x32_bf16 v[204:207], a[220:223], v[156:159], v[204:207]
ds_read_b128 a[204:207], v13 offset:49152
v_add_f32 v126, v126, v246
v_mfma_f32_16x16x32_bf16 v[212:215], a[208:211], v[160:163], v[104:107]
v_exp_f32 v247, v247
v_mfma_f32_16x16x32_bf16 v[212:215], a[212:215], v[164:167], v[212:215]
v_add_f32 v126, v126, v247
v_cvt_pk_bf16_f32 v91, v246, v247
v_mfma_f32_16x16x32_bf16 v[212:215], a[216:219], v[168:171], v[212:215]
v_exp_f32 v252, v252
v_mfma_f32_16x16x32_bf16 v[212:215], a[220:223], v[172:175], v[212:215]
v_exp_f32 v253, v253
v_mfma_f32_16x16x32_bf16 v[220:223], a[208:211], v[176:179], v[108:111]
buffer_load_dwordx4 v25, s[12:15], s45 offen offset:3072 lds
v_mfma_f32_16x16x32_bf16 v[220:223], a[212:215], v[180:183], v[220:223]
v_add_f32 v127, v127, v252
v_add_f32 v127, v127, v253
v_cvt_pk_bf16_f32 v94, v252, v253
v_mfma_f32_16x16x32_bf16 v[220:223], a[216:219], v[184:187], v[220:223]
v_exp_f32 v254, v254
v_mfma_f32_16x16x32_bf16 v[220:223], a[220:223], v[188:191], v[220:223]
s_waitcnt lgkmcnt(0)
v_exp_f32 v255, v255
v_mfma_f32_16x16x32_bf16 v[224:227], a[192:195], v[128:131], v[96:99]
v_add_f32 v127, v127, v254
v_add_f32 v127, v127, v255
v_mfma_f32_16x16x32_bf16 v[224:227], a[196:199], v[132:135], v[224:227]
ds_read_b128 a[208:211], v10 offset:57344
v_cvt_pk_bf16_f32 v95, v254, v255
v_mfma_f32_16x16x32_bf16 v[224:227], a[200:203], v[136:139], v[224:227]
s_add_u32 s0, s3, 0
s_and_b32 s0, s0, 3
s_lshl_b32 s0, s0, 17
s_add_u32 s44, s0, s59
v_exp_f32 v192, v192
v_mfma_f32_16x16x32_bf16 v[224:227], a[204:207], v[140:143], v[224:227]
ds_read_b128 a[212:215], v11 offset:57344
v_exp_f32 v193, v193
v_mfma_f32_16x16x32_bf16 v[232:235], a[192:195], v[144:147], v[100:103]
s_add_u32 s52, s44, 0
v_exp_f32 v194, v194
v_mfma_f32_16x16x32_bf16 v[232:235], a[196:199], v[148:151], v[232:235]
ds_read_b128 a[216:219], v12 offset:57344
v_cvt_pk_bf16_f32 v32, v192, v193
v_mfma_f32_16x16x32_bf16 v[232:235], a[200:203], v[152:155], v[232:235]
s_add_u32 m0, s50, 8192
v_exp_f32 v195, v195
v_mfma_f32_16x16x32_bf16 v[232:235], a[204:207], v[156:159], v[232:235]
ds_read_b128 a[220:223], v13 offset:57344
v_cvt_pk_bf16_f32 v33, v194, v195
v_mfma_f32_16x16x32_bf16 v[240:243], a[192:195], v[160:163], v[104:107]
buffer_load_dwordx4 v18, s[32:35], s52 offen lds
v_mfma_f32_16x16x32_bf16 v[240:243], a[196:199], v[164:167], v[240:243]
ds_read_b64_tr_b16 a[224:225], v2 offset:32768
v_exp_f32 v200, v200
v_mfma_f32_16x16x32_bf16 v[240:243], a[200:203], v[168:171], v[240:243]
v_exp_f32 v201, v201
v_mfma_f32_16x16x32_bf16 v[240:243], a[204:207], v[172:175], v[240:243]
buffer_load_dwordx4 v19, s[32:35], s52 offen offset:1024 lds
v_mfma_f32_16x16x32_bf16 v[248:251], a[192:195], v[176:179], v[108:111]
ds_read_b64_tr_b16 a[226:227], v2 offset:40960
ds_read_b64_tr_b16 a[228:229], v2 offset:49152
v_mfma_f32_16x16x32_bf16 v[248:251], a[196:199], v[180:183], v[248:251]
buffer_load_dwordx4 v20, s[32:35], s52 offen offset:2048 lds
v_mfma_f32_16x16x32_bf16 v[248:251], a[200:203], v[184:187], v[248:251]
ds_read_b64_tr_b16 a[230:231], v2 offset:57344
ds_read_b64_tr_b16 a[232:233], v3 offset:32768
v_mfma_f32_16x16x32_bf16 v[248:251], a[204:207], v[188:191], v[248:251]
s_waitcnt lgkmcnt(5)
ds_read_b64_tr_b16 a[234:235], v3 offset:40960
v_cvt_pk_bf16_f32 v36, v200, v201
v_mfma_f32_16x16x32_bf16 v[228:231], a[208:211], v[128:131], v[96:99]
buffer_load_dwordx4 v21, s[32:35], s52 offen offset:3072 lds
v_mfma_f32_16x16x32_bf16 v[228:231], a[212:215], v[132:135], v[228:231]
v_exp_f32 v202, v202
v_mfma_f32_16x16x32_bf16 v[228:231], a[216:219], v[136:139], v[228:231]
ds_read_b64_tr_b16 a[236:237], v3 offset:49152
ds_read_b64_tr_b16 a[238:239], v3 offset:57344
v_mfma_f32_16x16x32_bf16 v[228:231], a[220:223], v[140:143], v[228:231]
s_add_u32 s53, s52, 32768
v_exp_f32 v203, v203
v_mfma_f32_16x16x32_bf16 v[236:239], a[208:211], v[144:147], v[100:103]
v_exp_f32 v208, v208
v_mfma_f32_16x16x32_bf16 v[236:239], a[212:215], v[148:151], v[236:239]
s_add_u32 m0, s50, 12288
ds_read_b64_tr_b16 a[240:241], v4 offset:32768
ds_read_b64_tr_b16 a[242:243], v4 offset:40960
ds_read_b64_tr_b16 a[244:245], v4 offset:49152
v_mfma_f32_16x16x32_bf16 v[236:239], a[216:219], v[152:155], v[236:239]
v_exp_f32 v209, v209
v_mfma_f32_16x16x32_bf16 v[236:239], a[220:223], v[156:159], v[236:239]
buffer_load_dwordx4 v18, s[32:35], s53 offen lds
v_mfma_f32_16x16x32_bf16 v[244:247], a[208:211], v[160:163], v[104:107]
ds_read_b64_tr_b16 a[246:247], v4 offset:57344
ds_read_b64_tr_b16 a[248:249], v5 offset:32768
v_mfma_f32_16x16x32_bf16 v[244:247], a[212:215], v[164:167], v[244:247]
v_exp_f32 v210, v210
v_mfma_f32_16x16x32_bf16 v[244:247], a[216:219], v[168:171], v[244:247]
buffer_load_dwordx4 v19, s[32:35], s53 offen offset:1024 lds
v_mfma_f32_16x16x32_bf16 v[244:247], a[220:223], v[172:175], v[244:247]
ds_read_b64_tr_b16 a[250:251], v5 offset:40960
ds_read_b64_tr_b16 a[252:253], v5 offset:49152
ds_read_b64_tr_b16 a[254:255], v5 offset:57344
v_mfma_f32_16x16x32_bf16 v[252:255], a[208:211], v[176:179], v[108:111]
buffer_load_dwordx4 v20, s[32:35], s53 offen offset:2048 lds
v_mfma_f32_16x16x32_bf16 v[252:255], a[212:215], v[180:183], v[252:255]
v_exp_f32 v211, v211
v_mfma_f32_16x16x32_bf16 v[252:255], a[216:219], v[184:187], v[252:255]
buffer_load_dwordx4 v21, s[32:35], s53 offen offset:3072 lds
v_mfma_f32_16x16x32_bf16 v[252:255], a[220:223], v[188:191], v[252:255]
s_waitcnt lgkmcnt(12)
v_exp_f32 v216, v216
v_mfma_f32_16x16x32_bf16 a[0:3], a[224:227], v[64:67], a[0:3]
v_exp_f32 v217, v217
v_mfma_f32_16x16x32_bf16 a[0:3], a[228:231], v[80:83], a[0:3]
s_add_u32 s0, s3, 1
s_and_b32 s0, s0, 3
s_lshl_b32 s0, s0, 17
s_add_u32 s45, s0, s59
v_exp_f32 v218, v218
v_cvt_pk_bf16_f32 v37, v202, v203
v_mfma_f32_16x16x32_bf16 a[4:7], a[224:227], v[68:71], a[4:7]
v_exp_f32 v219, v219
v_mfma_f32_16x16x32_bf16 a[4:7], a[228:231], v[84:87], a[4:7]
v_add_f32 v126, v126, v208
v_add_f32 v126, v126, v209
v_mfma_f32_16x16x32_bf16 a[8:11], a[224:227], v[72:75], a[8:11]
s_add_u32 s52, s45, 0
v_exp_f32 v196, v196
v_mfma_f32_16x16x32_bf16 a[8:11], a[228:231], v[88:91], a[8:11]
v_cvt_pk_bf16_f32 v40, v208, v209
v_add_f32 v126, v126, v210
v_mfma_f32_16x16x32_bf16 a[12:15], a[224:227], v[76:79], a[12:15]
s_add_u32 m0, s50, 16384
v_exp_f32 v197, v197
v_mfma_f32_16x16x32_bf16 a[12:15], a[228:231], v[92:95], a[12:15]
s_waitcnt lgkmcnt(8)
v_add_f32 v126, v126, v211
v_cvt_pk_bf16_f32 v41, v210, v211
v_add_f32 v127, v127, v216
v_mfma_f32_16x16x32_bf16 a[16:19], a[232:235], v[64:67], a[16:19]
v_exp_f32 v198, v198
v_mfma_f32_16x16x32_bf16 a[16:19], a[236:239], v[80:83], a[16:19]
buffer_load_dwordx4 v18, s[32:35], s52 offen lds
v_mfma_f32_16x16x32_bf16 a[20:23], a[232:235], v[68:71], a[20:23]
ds_read_b64_tr_b16 a[224:225], v14 offset:32768
ds_read_b64_tr_b16 a[226:227], v14 offset:40960
v_mfma_f32_16x16x32_bf16 a[20:23], a[236:239], v[84:87], a[20:23]
v_exp_f32 v199, v199
v_mfma_f32_16x16x32_bf16 a[24:27], a[232:235], v[72:75], a[24:27]
buffer_load_dwordx4 v19, s[32:35], s52 offen offset:1024 lds
v_mfma_f32_16x16x32_bf16 a[24:27], a[236:239], v[88:91], a[24:27]
ds_read_b64_tr_b16 a[228:229], v14 offset:49152
ds_read_b64_tr_b16 a[230:231], v14 offset:57344
v_add_f32 v127, v127, v217
v_mfma_f32_16x16x32_bf16 a[28:31], a[232:235], v[76:79], a[28:31]
buffer_load_dwordx4 v20, s[32:35], s52 offen offset:2048 lds
v_mfma_f32_16x16x32_bf16 a[28:31], a[236:239], v[92:95], a[28:31]
v_exp_f32 v204, v204
v_mfma_f32_16x16x32_bf16 v[116:119], v[112:115], v[64:67], v[116:119]
buffer_load_dwordx4 v21, s[32:35], s52 offen offset:3072 lds
v_mfma_f32_16x16x32_bf16 v[116:119], v[112:115], v[80:83], v[116:119]
s_waitcnt lgkmcnt(8)
v_exp_f32 v205, v205
v_mfma_f32_16x16x32_bf16 a[32:35], a[240:243], v[64:67], a[32:35]
v_exp_f32 v206, v206
v_mfma_f32_16x16x32_bf16 a[32:35], a[244:247], v[80:83], a[32:35]
ds_read_b64_tr_b16 a[232:233], v15 offset:32768
v_exp_f32 v207, v207
v_mfma_f32_16x16x32_bf16 a[36:39], a[240:243], v[68:71], a[36:39]
s_add_u32 s53, s52, 32768
v_exp_f32 v212, v212
v_mfma_f32_16x16x32_bf16 a[36:39], a[244:247], v[84:87], a[36:39]
ds_read_b64_tr_b16 a[234:235], v15 offset:40960
ds_read_b64_tr_b16 a[236:237], v15 offset:49152
v_mfma_f32_16x16x32_bf16 a[40:43], a[240:243], v[72:75], a[40:43]
s_add_u32 m0, s50, 20480
v_exp_f32 v213, v213
v_mfma_f32_16x16x32_bf16 a[40:43], a[244:247], v[88:91], a[40:43]
ds_read_b64_tr_b16 a[238:239], v15 offset:57344
v_cvt_pk_bf16_f32 v44, v216, v217
v_mfma_f32_16x16x32_bf16 a[44:47], a[240:243], v[76:79], a[44:47]
buffer_load_dwordx4 v18, s[32:35], s53 offen lds
v_mfma_f32_16x16x32_bf16 a[44:47], a[244:247], v[92:95], a[44:47]
s_waitcnt lgkmcnt(8)
v_exp_f32 v214, v214
v_add_f32 v127, v127, v218
v_mfma_f32_16x16x32_bf16 a[48:51], a[248:251], v[64:67], a[48:51]
v_exp_f32 v215, v215
v_mfma_f32_16x16x32_bf16 a[48:51], a[252:255], v[80:83], a[48:51]
ds_read_b64_tr_b16 a[240:241], v16 offset:32768
ds_read_b64_tr_b16 a[242:243], v16 offset:40960
v_mfma_f32_16x16x32_bf16 a[52:55], a[248:251], v[68:71], a[52:55]
buffer_load_dwordx4 v19, s[32:35], s53 offen offset:1024 lds
v_mfma_f32_16x16x32_bf16 a[52:55], a[252:255], v[84:87], a[52:55]
v_exp_f32 v220, v220
v_mfma_f32_16x16x32_bf16 a[56:59], a[248:251], v[72:75], a[56:59]
buffer_load_dwordx4 v20, s[32:35], s53 offen offset:2048 lds
v_mfma_f32_16x16x32_bf16 a[56:59], a[252:255], v[88:91], a[56:59]
ds_read_b64_tr_b16 a[244:245], v16 offset:49152
ds_read_b64_tr_b16 a[246:247], v16 offset:57344
v_add_f32 v127, v127, v219
v_mfma_f32_16x16x32_bf16 a[60:63], a[248:251], v[76:79], a[60:63]
buffer_load_dwordx4 v21, s[32:35], s53 offen offset:3072 lds
v_mfma_f32_16x16x32_bf16 a[60:63], a[252:255], v[92:95], a[60:63]
v_exp_f32 v221, v221
v_mfma_f32_16x16x32_bf16 v[120:123], v[112:115], v[68:71], v[120:123]
v_exp_f32 v222, v222
v_mfma_f32_16x16x32_bf16 v[120:123], v[112:115], v[84:87], v[120:123]
s_waitcnt lgkmcnt(8)
v_exp_f32 v223, v223
v_mfma_f32_16x16x32_bf16 a[64:67], a[224:227], v[64:67], a[64:67]
ds_read_b64_tr_b16 a[248:249], v17 offset:32768
v_cvt_pk_bf16_f32 v45, v218, v219
v_mfma_f32_16x16x32_bf16 a[64:67], a[228:231], v[80:83], a[64:67]
ds_read_b64_tr_b16 a[250:251], v17 offset:40960
v_cvt_pk_bf16_f32 v34, v196, v197
v_cvt_pk_bf16_f32 v35, v198, v199
v_mfma_f32_16x16x32_bf16 a[68:71], a[224:227], v[68:71], a[68:71]
v_exp_f32 v224, v224
v_mfma_f32_16x16x32_bf16 a[68:71], a[228:231], v[84:87], a[68:71]
ds_read_b64_tr_b16 a[252:253], v17 offset:49152
ds_read_b64_tr_b16 a[254:255], v17 offset:57344
v_mfma_f32_16x16x32_bf16 a[72:75], a[224:227], v[72:75], a[72:75]
v_exp_f32 v225, v225
v_mfma_f32_16x16x32_bf16 a[72:75], a[228:231], v[88:91], a[72:75]
v_cvt_pk_bf16_f32 v38, v204, v205
v_cvt_pk_bf16_f32 v39, v206, v207
v_mfma_f32_16x16x32_bf16 a[76:79], a[224:227], v[76:79], a[76:79]
v_exp_f32 v226, v226
v_mfma_f32_16x16x32_bf16 a[76:79], a[228:231], v[92:95], a[76:79]
s_waitcnt lgkmcnt(10)
v_add_f32 v126, v126, v212
v_add_f32 v126, v126, v213
v_cvt_pk_bf16_f32 v42, v212, v213
v_mfma_f32_16x16x32_bf16 a[80:83], a[232:235], v[64:67], a[80:83]
s_waitcnt vmcnt(16) lgkmcnt(0)
v_exp_f32 v227, v227
v_mfma_f32_16x16x32_bf16 a[80:83], a[236:239], v[80:83], a[80:83]
s_barrier
v_mfma_f32_16x16x32_bf16 a[84:87], a[232:235], v[68:71], a[84:87]
s_add_u32 m0, s48, 32768
v_exp_f32 v232, v232
v_mfma_f32_16x16x32_bf16 a[84:87], a[236:239], v[84:87], a[84:87]
ds_read_b128 a[192:195], v10 offset:0
ds_read_b128 a[196:199], v11 offset:0
v_mfma_f32_16x16x32_bf16 a[88:91], a[232:235], v[72:75], a[88:91]
v_exp_f32 v233, v233
v_mfma_f32_16x16x32_bf16 a[88:91], a[236:239], v[88:91], a[88:91]
ds_read_b128 a[200:203], v12 offset:0
ds_read_b128 a[204:207], v13 offset:0
v_add_f32 v126, v126, v214
v_mfma_f32_16x16x32_bf16 a[92:95], a[232:235], v[76:79], a[92:95]
v_exp_f32 v234, v234
v_mfma_f32_16x16x32_bf16 a[92:95], a[236:239], v[92:95], a[92:95]
ds_read_b128 a[208:211], v10 offset:8192
v_add_f32 v126, v126, v215
v_mfma_f32_16x16x32_bf16 a[96:99], a[240:243], v[64:67], a[96:99]
v_exp_f32 v235, v235
v_mfma_f32_16x16x32_bf16 a[96:99], a[244:247], v[80:83], a[96:99]
buffer_load_dwordx4 v24, s[12:15], s46 offen offset:2048 lds
v_mfma_f32_16x16x32_bf16 a[100:103], a[240:243], v[68:71], a[100:103]
ds_read_b128 a[212:215], v11 offset:8192
ds_read_b128 a[216:219], v12 offset:8192
v_mfma_f32_16x16x32_bf16 a[100:103], a[244:247], v[84:87], a[100:103]
ds_read_b128 a[220:223], v13 offset:8192
v_exp_f32 v240, v240
v_mfma_f32_16x16x32_bf16 a[104:107], a[240:243], v[72:75], a[104:107]
v_exp_f32 v241, v241
v_mfma_f32_16x16x32_bf16 a[104:107], a[244:247], v[88:91], a[104:107]
buffer_load_dwordx4 v25, s[12:15], s46 offen offset:3072 lds
v_mfma_f32_16x16x32_bf16 a[108:111], a[240:243], v[76:79], a[108:111]
v_exp_f32 v242, v242
v_mfma_f32_16x16x32_bf16 a[108:111], a[244:247], v[92:95], a[108:111]
v_cvt_pk_bf16_f32 v43, v214, v215
v_add_f32 v127, v127, v220
v_mfma_f32_16x16x32_bf16 a[112:115], a[248:251], v[64:67], a[112:115]
v_exp_f32 v243, v243
v_mfma_f32_16x16x32_bf16 a[112:115], a[252:255], v[80:83], a[112:115]
v_add_f32 v127, v127, v221
v_cvt_pk_bf16_f32 v46, v220, v221
v_add_f32 v127, v127, v222
v_mfma_f32_16x16x32_bf16 a[116:119], a[248:251], v[68:71], a[116:119]
v_exp_f32 v248, v248
v_mfma_f32_16x16x32_bf16 a[116:119], a[252:255], v[84:87], a[116:119]
v_add_f32 v127, v127, v223
v_cvt_pk_bf16_f32 v47, v222, v223
v_mfma_f32_16x16x32_bf16 a[120:123], a[248:251], v[72:75], a[120:123]
v_exp_f32 v249, v249
v_mfma_f32_16x16x32_bf16 a[120:123], a[252:255], v[88:91], a[120:123]
v_cvt_pk_bf16_f32 v48, v224, v225
v_cvt_pk_bf16_f32 v49, v226, v227
v_mfma_f32_16x16x32_bf16 a[124:127], a[248:251], v[76:79], a[124:127]
v_exp_f32 v250, v250
v_mfma_f32_16x16x32_bf16 a[124:127], a[252:255], v[92:95], a[124:127]
s_waitcnt lgkmcnt(0)
v_cvt_pk_bf16_f32 v52, v232, v233
v_cvt_pk_bf16_f32 v53, v234, v235
v_add_f32 v126, v126, v240
v_mfma_f32_16x16x32_bf16 v[192:195], a[192:195], v[128:131], v[96:99]
v_exp_f32 v251, v251
v_mfma_f32_16x16x32_bf16 v[192:195], a[196:199], v[132:135], v[192:195]
s_add_u32 m0, s48, 49152
v_add_f32 v126, v126, v241
v_cvt_pk_bf16_f32 v56, v240, v241
v_mfma_f32_16x16x32_bf16 v[192:195], a[200:203], v[136:139], v[192:195]
v_exp_f32 v228, v228
v_mfma_f32_16x16x32_bf16 v[192:195], a[204:207], v[140:143], v[192:195]
v_add_f32 v126, v126, v242
v_add_f32 v126, v126, v243
v_mfma_f32_16x16x32_bf16 v[200:203], a[192:195], v[144:147], v[100:103]
v_exp_f32 v229, v229
v_mfma_f32_16x16x32_bf16 v[200:203], a[196:199], v[148:151], v[200:203]
buffer_load_dwordx4 v24, s[12:15], s47 offen offset:2048 lds
v_mfma_f32_16x16x32_bf16 v[200:203], a[200:203], v[152:155], v[200:203]
v_exp_f32 v230, v230
v_cvt_pk_bf16_f32 v57, v242, v243
v_mfma_f32_16x16x32_bf16 v[200:203], a[204:207], v[156:159], v[200:203]
v_add_f32 v127, v127, v248
v_add_f32 v127, v127, v249
v_mfma_f32_16x16x32_bf16 v[208:211], a[192:195], v[160:163], v[104:107]
v_exp_f32 v231, v231
v_mfma_f32_16x16x32_bf16 v[208:211], a[196:199], v[164:167], v[208:211]
v_cvt_pk_bf16_f32 v60, v248, v249
v_add_f32 v127, v127, v250
v_mfma_f32_16x16x32_bf16 v[208:211], a[200:203], v[168:171], v[208:211]
buffer_load_dwordx4 v25, s[12:15], s47 offen offset:3072 lds
v_mfma_f32_16x16x32_bf16 v[208:211], a[204:207], v[172:175], v[208:211]
v_exp_f32 v236, v236
v_add_f32 v127, v127, v251
v_mfma_f32_16x16x32_bf16 v[216:219], a[192:195], v[176:179], v[108:111]
v_exp_f32 v237, v237
v_mfma_f32_16x16x32_bf16 v[216:219], a[196:199], v[180:183], v[216:219]
buffer_load_dword v22, v31, s[32:35], s81 offen
v_mfma_f32_16x16x32_bf16 v[216:219], a[200:203], v[184:187], v[216:219]
v_exp_f32 v238, v238
v_mfma_f32_16x16x32_bf16 v[216:219], a[204:207], v[188:191], v[216:219]
v_cvt_pk_bf16_f32 v61, v250, v251
v_cvt_pk_bf16_f32 v50, v228, v229
v_mfma_f32_16x16x32_bf16 v[196:199], a[208:211], v[128:131], v[96:99]
v_exp_f32 v239, v239
v_cvt_pk_bf16_f32 v51, v230, v231
v_mfma_f32_16x16x32_bf16 v[196:199], a[212:215], v[132:135], v[196:199]
ds_read_b128 a[192:195], v10 offset:16384
v_cvt_pk_bf16_f32 v54, v236, v237
v_mfma_f32_16x16x32_bf16 v[196:199], a[216:219], v[136:139], v[196:199]
v_exp_f32 v244, v244
v_mfma_f32_16x16x32_bf16 v[196:199], a[220:223], v[140:143], v[196:199]
ds_read_b128 a[196:199], v11 offset:16384
v_cvt_pk_bf16_f32 v55, v238, v239
v_mfma_f32_16x16x32_bf16 v[204:207], a[208:211], v[144:147], v[100:103]
v_exp_f32 v245, v245
v_mfma_f32_16x16x32_bf16 v[204:207], a[212:215], v[148:151], v[204:207]
ds_read_b128 a[200:203], v12 offset:16384
v_add_f32 v126, v126, v244
v_add_f32 v126, v126, v245
v_mfma_f32_16x16x32_bf16 v[204:207], a[216:219], v[152:155], v[204:207]
v_exp_f32 v246, v246
v_mfma_f32_16x16x32_bf16 v[204:207], a[220:223], v[156:159], v[204:207]
ds_read_b128 a[204:207], v13 offset:16384
v_cvt_pk_bf16_f32 v58, v244, v245
v_mfma_f32_16x16x32_bf16 v[212:215], a[208:211], v[160:163], v[104:107]
v_exp_f32 v247, v247
v_mfma_f32_16x16x32_bf16 v[212:215], a[212:215], v[164:167], v[212:215]
v_add_f32 v126, v126, v246
v_add_f32 v126, v126, v247
v_mfma_f32_16x16x32_bf16 v[212:215], a[216:219], v[168:171], v[212:215]
v_exp_f32 v252, v252
v_mfma_f32_16x16x32_bf16 v[212:215], a[220:223], v[172:175], v[212:215]
v_cvt_pk_bf16_f32 v59, v246, v247
v_add_f32 v127, v127, v252
v_mfma_f32_16x16x32_bf16 v[220:223], a[208:211], v[176:179], v[108:111]
v_exp_f32 v253, v253
v_mfma_f32_16x16x32_bf16 v[220:223], a[212:215], v[180:183], v[220:223]
v_add_f32 v127, v127, v253
v_cvt_pk_bf16_f32 v62, v252, v253
v_mfma_f32_16x16x32_bf16 v[220:223], a[216:219], v[184:187], v[220:223]
s_add_u32 s0, s3, 2
s_and_b32 s0, s0, 3
s_lshl_b32 s0, s0, 17
s_add_u32 s46, s0, s59
v_exp_f32 v254, v254
v_mfma_f32_16x16x32_bf16 v[220:223], a[220:223], v[188:191], v[220:223]
s_waitcnt lgkmcnt(0)
v_exp_f32 v255, v255
v_mfma_f32_16x16x32_bf16 v[224:227], a[192:195], v[128:131], v[96:99]
v_add_f32 v127, v127, v254
v_add_f32 v127, v127, v255
v_cvt_pk_bf16_f32 v63, v254, v255
v_mfma_f32_16x16x32_bf16 v[224:227], a[196:199], v[132:135], v[224:227]
ds_read_b128 a[208:211], v10 offset:24576
v_mfma_f32_16x16x32_bf16 v[224:227], a[200:203], v[136:139], v[224:227]
v_exp_f32 v192, v192
v_mfma_f32_16x16x32_bf16 v[224:227], a[204:207], v[140:143], v[224:227]
s_add_u32 s52, s46, 0
v_exp_f32 v193, v193
v_mfma_f32_16x16x32_bf16 v[232:235], a[192:195], v[144:147], v[100:103]
ds_read_b128 a[212:215], v11 offset:24576
v_cvt_pk_bf16_f32 v64, v192, v193
v_mfma_f32_16x16x32_bf16 v[232:235], a[196:199], v[148:151], v[232:235]
v_exp_f32 v194, v194
v_mfma_f32_16x16x32_bf16 v[232:235], a[200:203], v[152:155], v[232:235]
ds_read_b128 a[216:219], v12 offset:24576
v_exp_f32 v195, v195
v_mfma_f32_16x16x32_bf16 v[232:235], a[204:207], v[156:159], v[232:235]
ds_read_b128 a[220:223], v13 offset:24576
v_cvt_pk_bf16_f32 v65, v194, v195
v_mfma_f32_16x16x32_bf16 v[240:243], a[192:195], v[160:163], v[104:107]
s_add_u32 m0, s50, 0
v_exp_f32 v200, v200
v_mfma_f32_16x16x32_bf16 v[240:243], a[196:199], v[164:167], v[240:243]
v_exp_f32 v201, v201
v_mfma_f32_16x16x32_bf16 v[240:243], a[200:203], v[168:171], v[240:243]
ds_read_b64_tr_b16 a[224:225], v2 offset:0
ds_read_b64_tr_b16 a[226:227], v2 offset:8192
v_mfma_f32_16x16x32_bf16 v[240:243], a[204:207], v[172:175], v[240:243]
ds_read_b64_tr_b16 a[228:229], v2 offset:16384
v_cvt_pk_bf16_f32 v68, v200, v201
v_mfma_f32_16x16x32_bf16 v[248:251], a[192:195], v[176:179], v[108:111]
buffer_load_dwordx4 v18, s[32:35], s52 offen lds
v_mfma_f32_16x16x32_bf16 v[248:251], a[196:199], v[180:183], v[248:251]
v_exp_f32 v202, v202
v_mfma_f32_16x16x32_bf16 v[248:251], a[200:203], v[184:187], v[248:251]
ds_read_b64_tr_b16 a[230:231], v2 offset:24576
ds_read_b64_tr_b16 a[232:233], v3 offset:0
v_mfma_f32_16x16x32_bf16 v[248:251], a[204:207], v[188:191], v[248:251]
s_waitcnt lgkmcnt(5)
v_exp_f32 v203, v203
v_mfma_f32_16x16x32_bf16 v[228:231], a[208:211], v[128:131], v[96:99]
ds_read_b64_tr_b16 a[234:235], v3 offset:8192
ds_read_b64_tr_b16 a[236:237], v3 offset:16384
v_mfma_f32_16x16x32_bf16 v[228:231], a[212:215], v[132:135], v[228:231]
ds_read_b64_tr_b16 a[238:239], v3 offset:24576
v_cvt_pk_bf16_f32 v69, v202, v203
v_mfma_f32_16x16x32_bf16 v[228:231], a[216:219], v[136:139], v[228:231]
buffer_load_dwordx4 v19, s[32:35], s52 offen offset:1024 lds
v_mfma_f32_16x16x32_bf16 v[228:231], a[220:223], v[140:143], v[228:231]
v_exp_f32 v208, v208
v_mfma_f32_16x16x32_bf16 v[236:239], a[208:211], v[144:147], v[100:103]
ds_read_b64_tr_b16 a[240:241], v4 offset:0
ds_read_b64_tr_b16 a[242:243], v4 offset:8192
v_mfma_f32_16x16x32_bf16 v[236:239], a[212:215], v[148:151], v[236:239]
ds_read_b64_tr_b16 a[244:245], v4 offset:16384
v_add_f32 v126, v126, v208
v_mfma_f32_16x16x32_bf16 v[236:239], a[216:219], v[152:155], v[236:239]
buffer_load_dwordx4 v20, s[32:35], s52 offen offset:2048 lds
v_mfma_f32_16x16x32_bf16 v[236:239], a[220:223], v[156:159], v[236:239]
ds_read_b64_tr_b16 a[246:247], v4 offset:24576
v_exp_f32 v209, v209
v_mfma_f32_16x16x32_bf16 v[244:247], a[208:211], v[160:163], v[104:107]
v_exp_f32 v210, v210
v_mfma_f32_16x16x32_bf16 v[244:247], a[212:215], v[164:167], v[244:247]
ds_read_b64_tr_b16 a[248:249], v5 offset:0
ds_read_b64_tr_b16 a[250:251], v5 offset:8192
v_mfma_f32_16x16x32_bf16 v[244:247], a[216:219], v[168:171], v[244:247]
v_exp_f32 v211, v211
v_mfma_f32_16x16x32_bf16 v[244:247], a[220:223], v[172:175], v[244:247]
buffer_load_dwordx4 v21, s[32:35], s52 offen offset:3072 lds
v_mfma_f32_16x16x32_bf16 v[252:255], a[208:211], v[176:179], v[108:111]
ds_read_b64_tr_b16 a[252:253], v5 offset:16384
ds_read_b64_tr_b16 a[254:255], v5 offset:24576
v_add_f32 v126, v126, v209
v_mfma_f32_16x16x32_bf16 v[252:255], a[212:215], v[180:183], v[252:255]
v_exp_f32 v216, v216
v_mfma_f32_16x16x32_bf16 v[252:255], a[216:219], v[184:187], v[252:255]
v_exp_f32 v217, v217
v_mfma_f32_16x16x32_bf16 v[252:255], a[220:223], v[188:191], v[252:255]
s_waitcnt lgkmcnt(12)
v_cvt_pk_bf16_f32 v72, v208, v209
v_add_f32 v126, v126, v210
v_mfma_f32_16x16x32_bf16 a[0:3], a[224:227], v[32:35], a[0:3]
s_add_u32 s53, s52, 32768
v_exp_f32 v218, v218
v_mfma_f32_16x16x32_bf16 a[0:3], a[228:231], v[48:51], a[0:3]
v_add_f32 v126, v126, v211
v_cvt_pk_bf16_f32 v73, v210, v211
v_add_f32 v127, v127, v216
v_mfma_f32_16x16x32_bf16 a[4:7], a[224:227], v[36:39], a[4:7]
v_exp_f32 v219, v219
v_mfma_f32_16x16x32_bf16 a[4:7], a[228:231], v[52:55], a[4:7]
v_add_f32 v127, v127, v217
v_cvt_pk_bf16_f32 v76, v216, v217
v_mfma_f32_16x16x32_bf16 a[8:11], a[224:227], v[40:43], a[8:11]
v_exp_f32 v196, v196
v_mfma_f32_16x16x32_bf16 a[8:11], a[228:231], v[56:59], a[8:11]
s_add_u32 m0, s50, 4096
v_add_f32 v127, v127, v218
v_add_f32 v127, v127, v219
v_mfma_f32_16x16x32_bf16 a[12:15], a[224:227], v[44:47], a[12:15]
v_exp_f32 v197, v197
v_mfma_f32_16x16x32_bf16 a[12:15], a[228:231], v[60:63], a[12:15]
s_waitcnt lgkmcnt(8)
v_cvt_pk_bf16_f32 v77, v218, v219
v_cvt_pk_bf16_f32 v66, v196, v197
v_mfma_f32_16x16x32_bf16 a[16:19], a[232:235], v[32:35], a[16:19]
v_exp_f32 v198, v198
v_mfma_f32_16x16x32_bf16 a[16:19], a[236:239], v[48:51], a[16:19]
ds_read_b64_tr_b16 a[224:225], v14 offset:0
ds_read_b64_tr_b16 a[226:227], v14 offset:8192
v_mfma_f32_16x16x32_bf16 a[20:23], a[232:235], v[36:39], a[20:23]
buffer_load_dwordx4 v18, s[32:35], s53 offen lds
v_mfma_f32_16x16x32_bf16 a[20:23], a[236:239], v[52:55], a[20:23]
v_exp_f32 v199, v199
v_mfma_f32_16x16x32_bf16 a[24:27], a[232:235], v[40:43], a[24:27]
ds_read_b64_tr_b16 a[228:229], v14 offset:16384
ds_read_b64_tr_b16 a[230:231], v14 offset:24576
v_cvt_pk_bf16_f32 v67, v198, v199
v_mfma_f32_16x16x32_bf16 a[24:27], a[236:239], v[56:59], a[24:27]
v_exp_f32 v204, v204
v_mfma_f32_16x16x32_bf16 a[28:31], a[232:235], v[44:47], a[28:31]
v_exp_f32 v205, v205
v_mfma_f32_16x16x32_bf16 a[28:31], a[236:239], v[60:63], a[28:31]
buffer_load_dwordx4 v19, s[32:35], s53 offen offset:1024 lds
v_mfma_f32_16x16x32_bf16 v[116:119], v[112:115], v[32:35], v[116:119]
v_exp_f32 v206, v206
v_mfma_f32_16x16x32_bf16 v[116:119], v[112:115], v[48:51], v[116:119]
s_waitcnt lgkmcnt(8)
v_exp_f32 v207, v207
v_mfma_f32_16x16x32_bf16 a[32:35], a[240:243], v[32:35], a[32:35]
ds_read_b64_tr_b16 a[232:233], v15 offset:0
v_cvt_pk_bf16_f32 v70, v204, v205
v_cvt_pk_bf16_f32 v71, v206, v207
v_mfma_f32_16x16x32_bf16 a[32:35], a[244:247], v[48:51], a[32:35]
v_exp_f32 v212, v212
v_mfma_f32_16x16x32_bf16 a[36:39], a[240:243], v[36:39], a[36:39]
buffer_load_dwordx4 v20, s[32:35], s53 offen offset:2048 lds
v_mfma_f32_16x16x32_bf16 a[36:39], a[244:247], v[52:55], a[36:39]
ds_read_b64_tr_b16 a[234:235], v15 offset:8192
ds_read_b64_tr_b16 a[236:237], v15 offset:16384
v_mfma_f32_16x16x32_bf16 a[40:43], a[240:243], v[40:43], a[40:43]
v_exp_f32 v213, v213
v_mfma_f32_16x16x32_bf16 a[40:43], a[244:247], v[56:59], a[40:43]
ds_read_b64_tr_b16 a[238:239], v15 offset:24576
v_add_f32 v126, v126, v212
v_add_f32 v126, v126, v213
v_mfma_f32_16x16x32_bf16 a[44:47], a[240:243], v[44:47], a[44:47]
v_exp_f32 v214, v214
v_mfma_f32_16x16x32_bf16 a[44:47], a[244:247], v[60:63], a[44:47]
s_waitcnt lgkmcnt(8)
v_cvt_pk_bf16_f32 v74, v212, v213
v_add_f32 v126, v126, v214
v_mfma_f32_16x16x32_bf16 a[48:51], a[248:251], v[32:35], a[48:51]
buffer_load_dwordx4 v21, s[32:35], s53 offen offset:3072 lds
v_mfma_f32_16x16x32_bf16 a[48:51], a[252:255], v[48:51], a[48:51]
v_exp_f32 v215, v215
v_mfma_f32_16x16x32_bf16 a[52:55], a[248:251], v[36:39], a[52:55]
ds_read_b64_tr_b16 a[240:241], v16 offset:0
ds_read_b64_tr_b16 a[242:243], v16 offset:8192
v_mfma_f32_16x16x32_bf16 a[52:55], a[252:255], v[52:55], a[52:55]
ds_read_b64_tr_b16 a[244:245], v16 offset:16384
v_exp_f32 v220, v220
v_mfma_f32_16x16x32_bf16 a[56:59], a[248:251], v[40:43], a[56:59]
s_add_u32 s0, s3, 3
s_and_b32 s0, s0, 3
s_lshl_b32 s0, s0, 17
s_add_u32 s47, s0, s59
v_exp_f32 v221, v221
v_mfma_f32_16x16x32_bf16 a[56:59], a[252:255], v[56:59], a[56:59]
ds_read_b64_tr_b16 a[246:247], v16 offset:24576
v_add_f32 v126, v126, v215
v_mfma_f32_16x16x32_bf16 a[60:63], a[248:251], v[44:47], a[60:63]
v_exp_f32 v222, v222
v_mfma_f32_16x16x32_bf16 a[60:63], a[252:255], v[60:63], a[60:63]
v_cvt_pk_bf16_f32 v75, v214, v215
v_add_f32 v127, v127, v220
v_mfma_f32_16x16x32_bf16 v[120:123], v[112:115], v[36:39], v[120:123]
v_exp_f32 v223, v223
v_add_f32 v127, v127, v221
v_mfma_f32_16x16x32_bf16 v[120:123], v[112:115], v[52:55], v[120:123]
s_waitcnt lgkmcnt(8)
v_cvt_pk_bf16_f32 v78, v220, v221
v_add_f32 v127, v127, v222
v_mfma_f32_16x16x32_bf16 a[64:67], a[224:227], v[32:35], a[64:67]
ds_read_b64_tr_b16 a[248:249], v17 offset:0
v_add_f32 v127, v127, v223
v_mfma_f32_16x16x32_bf16 a[64:67], a[228:231], v[48:51], a[64:67]
ds_read_b64_tr_b16 a[250:251], v17 offset:8192
v_cvt_pk_bf16_f32 v79, v222, v223
v_mfma_f32_16x16x32_bf16 a[68:71], a[224:227], v[36:39], a[68:71]
v_exp_f32 v224, v224
v_mfma_f32_16x16x32_bf16 a[68:71], a[228:231], v[52:55], a[68:71]
ds_read_b64_tr_b16 a[252:253], v17 offset:16384
ds_read_b64_tr_b16 a[254:255], v17 offset:24576
v_mfma_f32_16x16x32_bf16 a[72:75], a[224:227], v[40:43], a[72:75]
v_exp_f32 v225, v225
v_mfma_f32_16x16x32_bf16 a[72:75], a[228:231], v[56:59], a[72:75]
v_exp_f32 v226, v226
v_mfma_f32_16x16x32_bf16 a[76:79], a[224:227], v[44:47], a[76:79]
v_exp_f32 v227, v227
v_mfma_f32_16x16x32_bf16 a[76:79], a[228:231], v[60:63], a[76:79]
s_waitcnt lgkmcnt(10)
v_cvt_pk_bf16_f32 v80, v224, v225
v_cvt_pk_bf16_f32 v81, v226, v227
v_mfma_f32_16x16x32_bf16 a[80:83], a[232:235], v[32:35], a[80:83]
s_waitcnt vmcnt(9) lgkmcnt(0)
v_exp_f32 v232, v232
v_mfma_f32_16x16x32_bf16 a[80:83], a[236:239], v[48:51], a[80:83]
s_barrier
v_mfma_f32_16x16x32_bf16 a[84:87], a[232:235], v[36:39], a[84:87]
ds_read_b64_tr_b16 a[192:193], v2 offset:32768
ds_read_b64_tr_b16 a[194:195], v2 offset:40960
v_mfma_f32_16x16x32_bf16 a[84:87], a[236:239], v[52:55], a[84:87]
ds_read_b64_tr_b16 a[196:197], v3 offset:32768
ds_read_b64_tr_b16 a[198:199], v3 offset:40960
v_mfma_f32_16x16x32_bf16 a[88:91], a[232:235], v[40:43], a[88:91]
v_exp_f32 v233, v233
v_mfma_f32_16x16x32_bf16 a[88:91], a[236:239], v[56:59], a[88:91]
ds_read_b64_tr_b16 a[200:201], v4 offset:32768
ds_read_b64_tr_b16 a[202:203], v4 offset:40960
v_mfma_f32_16x16x32_bf16 a[92:95], a[232:235], v[44:47], a[92:95]
v_exp_f32 v234, v234
v_mfma_f32_16x16x32_bf16 a[92:95], a[236:239], v[60:63], a[92:95]
ds_read_b64_tr_b16 a[204:205], v5 offset:32768
ds_read_b64_tr_b16 a[206:207], v5 offset:40960
ds_read_b64_tr_b16 a[208:209], v14 offset:32768
v_mfma_f32_16x16x32_bf16 a[96:99], a[240:243], v[32:35], a[96:99]
ds_read_b64_tr_b16 a[210:211], v14 offset:40960
ds_read_b64_tr_b16 a[212:213], v15 offset:32768
v_mfma_f32_16x16x32_bf16 a[96:99], a[244:247], v[48:51], a[96:99]
ds_read_b64_tr_b16 a[214:215], v15 offset:40960
ds_read_b64_tr_b16 a[216:217], v16 offset:32768
v_mfma_f32_16x16x32_bf16 a[100:103], a[240:243], v[36:39], a[100:103]
ds_read_b64_tr_b16 a[218:219], v16 offset:40960
ds_read_b64_tr_b16 a[220:221], v17 offset:32768
v_mfma_f32_16x16x32_bf16 a[100:103], a[244:247], v[52:55], a[100:103]
ds_read_b64_tr_b16 a[222:223], v17 offset:40960
ds_read_b64_tr_b16 a[128:129], v2 offset:49152
v_mfma_f32_16x16x32_bf16 a[104:107], a[240:243], v[40:43], a[104:107]
ds_read_b64_tr_b16 a[130:131], v2 offset:57344
ds_read_b64_tr_b16 a[132:133], v3 offset:49152
ds_read_b64_tr_b16 a[134:135], v3 offset:57344
v_mfma_f32_16x16x32_bf16 a[104:107], a[244:247], v[56:59], a[104:107]
v_exp_f32 v235, v235
v_mfma_f32_16x16x32_bf16 a[108:111], a[240:243], v[44:47], a[108:111]
ds_read_b64_tr_b16 a[136:137], v4 offset:49152
ds_read_b64_tr_b16 a[138:139], v4 offset:57344
v_mfma_f32_16x16x32_bf16 a[108:111], a[244:247], v[60:63], a[108:111]
ds_read_b64_tr_b16 a[140:141], v5 offset:49152
ds_read_b64_tr_b16 a[142:143], v5 offset:57344
v_mfma_f32_16x16x32_bf16 a[112:115], a[248:251], v[32:35], a[112:115]
ds_read_b64_tr_b16 a[144:145], v14 offset:49152
ds_read_b64_tr_b16 a[146:147], v14 offset:57344
v_mfma_f32_16x16x32_bf16 a[112:115], a[252:255], v[48:51], a[112:115]
ds_read_b64_tr_b16 a[148:149], v15 offset:49152
ds_read_b64_tr_b16 a[150:151], v15 offset:57344
v_mfma_f32_16x16x32_bf16 a[116:119], a[248:251], v[36:39], a[116:119]
ds_read_b64_tr_b16 a[152:153], v16 offset:49152
ds_read_b64_tr_b16 a[154:155], v16 offset:57344
ds_read_b64_tr_b16 a[156:157], v17 offset:49152
v_mfma_f32_16x16x32_bf16 a[116:119], a[252:255], v[52:55], a[116:119]
v_exp_f32 v240, v240
v_mfma_f32_16x16x32_bf16 a[120:123], a[248:251], v[40:43], a[120:123]
v_exp_f32 v241, v241
v_mfma_f32_16x16x32_bf16 a[120:123], a[252:255], v[56:59], a[120:123]
v_exp_f32 v242, v242
v_mfma_f32_16x16x32_bf16 a[124:127], a[248:251], v[44:47], a[124:127]
v_exp_f32 v243, v243
v_mfma_f32_16x16x32_bf16 a[124:127], a[252:255], v[60:63], a[124:127]
s_waitcnt lgkmcnt(0)
ds_read_b64_tr_b16 a[158:159], v17 offset:57344
v_exp_f32 v248, v248
v_mfma_f32_16x16x32_bf16 a[0:3], a[192:195], v[64:67], a[0:3]
v_exp_f32 v249, v249
v_mfma_f32_16x16x32_bf16 a[16:19], a[196:199], v[64:67], a[16:19]
v_cvt_pk_bf16_f32 v84, v232, v233
v_cvt_pk_bf16_f32 v85, v234, v235
v_mfma_f32_16x16x32_bf16 a[32:35], a[200:203], v[64:67], a[32:35]
s_waitcnt lgkmcnt(0)
s_barrier
v_exp_f32 v250, v250
v_mfma_f32_16x16x32_bf16 a[48:51], a[204:207], v[64:67], a[48:51]
v_add_f32 v126, v126, v240
v_add_f32 v126, v126, v241
v_mfma_f32_16x16x32_bf16 a[64:67], a[208:211], v[64:67], a[64:67]
v_exp_f32 v251, v251
v_mfma_f32_16x16x32_bf16 a[80:83], a[212:215], v[64:67], a[80:83]
v_cvt_pk_bf16_f32 v88, v240, v241
v_add_f32 v126, v126, v242
v_mfma_f32_16x16x32_bf16 a[96:99], a[216:219], v[64:67], a[96:99]
v_exp_f32 v228, v228
v_mfma_f32_16x16x32_bf16 a[112:115], a[220:223], v[64:67], a[112:115]
v_add_f32 v126, v126, v243
v_cvt_pk_bf16_f32 v89, v242, v243
v_mfma_f32_16x16x32_bf16 v[116:119], v[112:115], v[64:67], v[116:119]
v_exp_f32 v229, v229
v_mfma_f32_16x16x32_bf16 a[4:7], a[192:195], v[68:71], a[4:7]
v_add_f32 v127, v127, v248
v_add_f32 v127, v127, v249
v_mfma_f32_16x16x32_bf16 a[20:23], a[196:199], v[68:71], a[20:23]
v_exp_f32 v230, v230
v_mfma_f32_16x16x32_bf16 a[36:39], a[200:203], v[68:71], a[36:39]
v_cvt_pk_bf16_f32 v92, v248, v249
v_add_f32 v127, v127, v250
v_mfma_f32_16x16x32_bf16 a[52:55], a[204:207], v[68:71], a[52:55]
v_exp_f32 v231, v231
v_mfma_f32_16x16x32_bf16 a[68:71], a[208:211], v[68:71], a[68:71]
v_add_f32 v127, v127, v251
v_cvt_pk_bf16_f32 v93, v250, v251
v_mfma_f32_16x16x32_bf16 a[84:87], a[212:215], v[68:71], a[84:87]
v_exp_f32 v236, v236
v_mfma_f32_16x16x32_bf16 a[100:103], a[216:219], v[68:71], a[100:103]
v_cvt_pk_bf16_f32 v82, v228, v229
v_cvt_pk_bf16_f32 v83, v230, v231
v_mfma_f32_16x16x32_bf16 a[116:119], a[220:223], v[68:71], a[116:119]
v_exp_f32 v237, v237
v_mfma_f32_16x16x32_bf16 v[120:123], v[112:115], v[68:71], v[120:123]
v_exp_f32 v238, v238
v_mfma_f32_16x16x32_bf16 a[8:11], a[192:195], v[72:75], a[8:11]
v_exp_f32 v239, v239
v_mfma_f32_16x16x32_bf16 a[24:27], a[196:199], v[72:75], a[24:27]
v_cvt_pk_bf16_f32 v86, v236, v237
v_cvt_pk_bf16_f32 v87, v238, v239
v_mfma_f32_16x16x32_bf16 a[40:43], a[200:203], v[72:75], a[40:43]
v_exp_f32 v244, v244
v_mfma_f32_16x16x32_bf16 a[56:59], a[204:207], v[72:75], a[56:59]
v_exp_f32 v245, v245
v_mfma_f32_16x16x32_bf16 a[72:75], a[208:211], v[72:75], a[72:75]
v_exp_f32 v246, v246
v_mfma_f32_16x16x32_bf16 a[88:91], a[212:215], v[72:75], a[88:91]
v_add_f32 v126, v126, v244
v_add_f32 v126, v126, v245
v_mfma_f32_16x16x32_bf16 a[104:107], a[216:219], v[72:75], a[104:107]
v_exp_f32 v247, v247
v_mfma_f32_16x16x32_bf16 a[120:123], a[220:223], v[72:75], a[120:123]
v_cvt_pk_bf16_f32 v90, v244, v245
v_add_f32 v126, v126, v246
v_mfma_f32_16x16x32_bf16 a[12:15], a[192:195], v[76:79], a[12:15]
v_exp_f32 v252, v252
v_mfma_f32_16x16x32_bf16 a[28:31], a[196:199], v[76:79], a[28:31]
v_add_f32 v126, v126, v247
v_cvt_pk_bf16_f32 v91, v246, v247
v_mfma_f32_16x16x32_bf16 a[44:47], a[200:203], v[76:79], a[44:47]
v_exp_f32 v253, v253
v_mfma_f32_16x16x32_bf16 a[60:63], a[204:207], v[76:79], a[60:63]
v_add_f32 v127, v127, v252
v_add_f32 v127, v127, v253
v_mfma_f32_16x16x32_bf16 a[76:79], a[208:211], v[76:79], a[76:79]
v_exp_f32 v254, v254
v_mfma_f32_16x16x32_bf16 a[92:95], a[212:215], v[76:79], a[92:95]
v_cvt_pk_bf16_f32 v94, v252, v253
v_add_f32 v127, v127, v254
v_mfma_f32_16x16x32_bf16 a[108:111], a[216:219], v[76:79], a[108:111]
v_exp_f32 v255, v255
v_mfma_f32_16x16x32_bf16 a[124:127], a[220:223], v[76:79], a[124:127]
v_add_f32 v127, v127, v255
v_cvt_pk_bf16_f32 v95, v254, v255
v_mfma_f32_16x16x32_bf16 a[0:3], a[128:131], v[80:83], a[0:3]
v_mov_b32 v98, v126
v_mov_b32 v99, v127
v_mfma_f32_16x16x32_bf16 a[16:19], a[132:135], v[80:83], a[16:19]
s_nop 1
v_mfma_f32_16x16x32_bf16 a[32:35], a[136:139], v[80:83], a[32:35]
v_permlane16_swap_b32 v126, v98
v_mfma_f32_16x16x32_bf16 a[48:51], a[140:143], v[80:83], a[48:51]
v_permlane16_swap_b32 v127, v99
v_mfma_f32_16x16x32_bf16 a[64:67], a[144:147], v[80:83], a[64:67]
v_add_f32 v126, v126, v98
v_add_f32 v127, v127, v99
v_mfma_f32_16x16x32_bf16 a[80:83], a[148:151], v[80:83], a[80:83]
v_mov_b32 v98, v126
v_mov_b32 v99, v127
v_mfma_f32_16x16x32_bf16 a[96:99], a[152:155], v[80:83], a[96:99]
s_nop 1
v_mfma_f32_16x16x32_bf16 a[112:115], a[156:159], v[80:83], a[112:115]
v_permlane32_swap_b32 v126, v98
v_mfma_f32_16x16x32_bf16 v[116:119], v[112:115], v[80:83], v[116:119]
v_permlane32_swap_b32 v127, v99
v_mfma_f32_16x16x32_bf16 a[4:7], a[128:131], v[84:87], a[4:7]
v_add_f32 v126, v126, v98
v_add_f32 v127, v127, v99
v_mfma_f32_16x16x32_bf16 a[20:23], a[132:135], v[84:87], a[20:23]
v_add_u32 v31, s83, v0
v_mov_b32 v11, v26
v_mfma_f32_16x16x32_bf16 a[36:39], a[136:139], v[84:87], a[36:39]
v_bfe_u32 v10, v1, 4, 4
v_lshlrev_b32 v10, 10, v10
v_mfma_f32_16x16x32_bf16 a[52:55], a[140:143], v[84:87], a[52:55]
v_lshrrev_b32 v29, 8, v1
v_lshl_add_u32 v10, v29, 3, v10
v_mfma_f32_16x16x32_bf16 a[68:71], a[144:147], v[84:87], a[68:71]
s_add_u32 s0, s1, 16777216
v_mfma_f32_16x16x32_bf16 a[84:87], a[148:151], v[84:87], a[84:87]
buffer_load_dwordx4 v[192:195], v1, s[40:43], s0 offen sc1
v_mfma_f32_16x16x32_bf16 a[100:103], a[152:155], v[84:87], a[100:103]
v_mfma_f32_16x16x32_bf16 a[116:119], a[156:159], v[84:87], a[116:119]
s_add_u32 s0, s1, 18874368
v_mfma_f32_16x16x32_bf16 v[120:123], v[112:115], v[84:87], v[120:123]
buffer_load_dwordx4 v[196:199], v1, s[40:43], s0 offen sc1
v_mfma_f32_16x16x32_bf16 a[8:11], a[128:131], v[88:91], a[8:11]
v_mfma_f32_16x16x32_bf16 a[24:27], a[132:135], v[88:91], a[24:27]
s_add_u32 s0, s1, 20971520
v_mfma_f32_16x16x32_bf16 a[40:43], a[136:139], v[88:91], a[40:43]
buffer_load_dwordx4 v[200:203], v1, s[40:43], s0 offen sc1
v_mfma_f32_16x16x32_bf16 a[56:59], a[140:143], v[88:91], a[56:59]
v_mfma_f32_16x16x32_bf16 a[72:75], a[144:147], v[88:91], a[72:75]
s_add_u32 s0, s1, 23068672
v_mfma_f32_16x16x32_bf16 a[88:91], a[148:151], v[88:91], a[88:91]
buffer_load_dwordx4 v[204:207], v1, s[40:43], s0 offen sc1
v_mfma_f32_16x16x32_bf16 a[104:107], a[152:155], v[88:91], a[104:107]
v_mfma_f32_16x16x32_bf16 a[120:123], a[156:159], v[88:91], a[120:123]
s_add_u32 s0, s1, 25165824
v_mfma_f32_16x16x32_bf16 a[12:15], a[128:131], v[92:95], a[12:15]
buffer_load_dwordx4 v[208:211], v1, s[40:43], s0 offen sc1
v_mfma_f32_16x16x32_bf16 a[28:31], a[132:135], v[92:95], a[28:31]
v_mfma_f32_16x16x32_bf16 a[44:47], a[136:139], v[92:95], a[44:47]
s_add_u32 s0, s1, 27262976
v_mfma_f32_16x16x32_bf16 a[60:63], a[140:143], v[92:95], a[60:63]
buffer_load_dwordx4 v[212:215], v1, s[40:43], s0 offen sc1
v_mfma_f32_16x16x32_bf16 a[76:79], a[144:147], v[92:95], a[76:79]
v_mfma_f32_16x16x32_bf16 a[92:95], a[148:151], v[92:95], a[92:95]
s_add_u32 s0, s1, 29360128
v_mfma_f32_16x16x32_bf16 a[108:111], a[152:155], v[92:95], a[108:111]
buffer_load_dwordx4 v[216:219], v1, s[40:43], s0 offen sc1
v_mfma_f32_16x16x32_bf16 a[124:127], a[156:159], v[92:95], a[124:127]
s_add_u32 s0, s1, 31457280
buffer_load_dwordx4 v[220:223], v1, s[40:43], s0 offen sc1
s_add_u32 s0, s63, 0
buffer_load_dwordx2 v[2:3], v10, s[36:39], s0 offen offset:0
buffer_load_dwordx2 v[4:5], v10, s[36:39], s0 offen offset:32
s_add_u32 s0, s63, 16384
buffer_load_dwordx2 v[12:13], v10, s[36:39], s0 offen offset:0
buffer_load_dwordx2 v[14:15], v10, s[36:39], s0 offen offset:32
s_nop 3
v_mov_b32 v124, v116
v_mov_b32 v125, v120
v_add_f32 v27, v124, v125
v_add_f32 v28, v126, v127
v_add_f32 v27, v27, v28
v_cmp_nge_f32 vcc, 0x4b800000, v27
s_nop 1
s_cbranch_vccnz L_fallback
L_fb_ret:
v_rcp_f32 v124, v124
v_rcp_f32 v125, v125
v_rcp_f32 v126, v126
v_rcp_f32 v127, v127
s_add_u32 s0, s3, 0
s_and_b32 s0, s0, 3
s_lshl_b32 s0, s0, 14
v_add_u32 v120, s0, v0
s_add_u32 s0, s3, 1
s_and_b32 s0, s0, 3
s_lshl_b32 s0, s0, 14
v_add_u32 v121, s0, v0
s_add_u32 s0, s3, 2
s_and_b32 s0, s0, 3
s_lshl_b32 s0, s0, 14
v_add_u32 v122, s0, v0
s_add_u32 s0, s3, 3
s_and_b32 s0, s0, 3
s_lshl_b32 s0, s0, 14
v_add_u32 v123, s0, v0
v_accvgpr_read_b32 v64, a0
v_accvgpr_read_b32 v65, a1
v_accvgpr_read_b32 v66, a2
v_accvgpr_read_b32 v67, a3
v_accvgpr_read_b32 v68, a16
v_accvgpr_read_b32 v69, a17
v_accvgpr_read_b32 v70, a18
v_accvgpr_read_b32 v71, a19
v_pk_mul_f32 v[64:65], v[64:65], v[124:125] op_sel_hi:[1,0]
v_pk_mul_f32 v[66:67], v[66:67], v[124:125] op_sel_hi:[1,0]
v_pk_mul_f32 v[68:69], v[68:69], v[124:125] op_sel_hi:[1,0]
v_pk_mul_f32 v[70:71], v[70:71], v[124:125] op_sel_hi:[1,0]
v_cvt_pk_bf16_f32 v72, v64, v65
v_cvt_pk_bf16_f32 v73, v66, v67
v_cvt_pk_bf16_f32 v74, v68, v69
v_cvt_pk_bf16_f32 v75, v70, v71
ds_write_b128 v31, v[72:75] offset:0
v_accvgpr_read_b32 v76, a4
v_accvgpr_read_b32 v77, a5
v_accvgpr_read_b32 v78, a6
v_accvgpr_read_b32 v79, a7
v_accvgpr_read_b32 v80, a20
v_accvgpr_read_b32 v81, a21
v_accvgpr_read_b32 v82, a22
v_accvgpr_read_b32 v83, a23
v_pk_mul_f32 v[76:77], v[76:77], v[124:125] op_sel:[0,1]
v_pk_mul_f32 v[78:79], v[78:79], v[124:125] op_sel:[0,1]
v_pk_mul_f32 v[80:81], v[80:81], v[124:125] op_sel:[0,1]
v_pk_mul_f32 v[82:83], v[82:83], v[124:125] op_sel:[0,1]
v_cvt_pk_bf16_f32 v84, v76, v77
v_cvt_pk_bf16_f32 v85, v78, v79
v_cvt_pk_bf16_f32 v86, v80, v81
v_cvt_pk_bf16_f32 v87, v82, v83
ds_write_b128 v31, v[84:87] offset:1024
v_accvgpr_read_b32 v88, a8
v_accvgpr_read_b32 v89, a9
v_accvgpr_read_b32 v90, a10
v_accvgpr_read_b32 v91, a11
v_accvgpr_read_b32 v92, a24
v_accvgpr_read_b32 v93, a25
v_accvgpr_read_b32 v94, a26
v_accvgpr_read_b32 v95, a27
v_pk_mul_f32 v[88:89], v[88:89], v[126:127] op_sel_hi:[1,0]
v_pk_mul_f32 v[90:91], v[90:91], v[126:127] op_sel_hi:[1,0]
v_pk_mul_f32 v[92:93], v[92:93], v[126:127] op_sel_hi:[1,0]
v_pk_mul_f32 v[94:95], v[94:95], v[126:127] op_sel_hi:[1,0]
v_cvt_pk_bf16_f32 v96, v88, v89
v_cvt_pk_bf16_f32 v97, v90, v91
v_cvt_pk_bf16_f32 v98, v92, v93
v_cvt_pk_bf16_f32 v99, v94, v95
ds_write_b128 v31, v[96:99] offset:2048
v_accvgpr_read_b32 v100, a12
v_accvgpr_read_b32 v101, a13
v_accvgpr_read_b32 v102, a14
v_accvgpr_read_b32 v103, a15
v_accvgpr_read_b32 v104, a28
v_accvgpr_read_b32 v105, a29
v_accvgpr_read_b32 v106, a30
v_accvgpr_read_b32 v107, a31
v_pk_mul_f32 v[100:101], v[100:101], v[126:127] op_sel:[0,1]
v_pk_mul_f32 v[102:103], v[102:103], v[126:127] op_sel:[0,1]
v_pk_mul_f32 v[104:105], v[104:105], v[126:127] op_sel:[0,1]
v_pk_mul_f32 v[106:107], v[106:107], v[126:127] op_sel:[0,1]
v_cvt_pk_bf16_f32 v108, v100, v101
v_cvt_pk_bf16_f32 v109, v102, v103
v_cvt_pk_bf16_f32 v110, v104, v105
v_cvt_pk_bf16_f32 v111, v106, v107
ds_write_b128 v31, v[108:111] offset:3072
v_accvgpr_read_b32 v64, a32
v_accvgpr_read_b32 v65, a33
v_accvgpr_read_b32 v66, a34
v_accvgpr_read_b32 v67, a35
v_accvgpr_read_b32 v68, a48
v_accvgpr_read_b32 v69, a49
v_accvgpr_read_b32 v70, a50
v_accvgpr_read_b32 v71, a51
v_pk_mul_f32 v[64:65], v[64:65], v[124:125] op_sel_hi:[1,0]
v_pk_mul_f32 v[66:67], v[66:67], v[124:125] op_sel_hi:[1,0]
v_pk_mul_f32 v[68:69], v[68:69], v[124:125] op_sel_hi:[1,0]
v_pk_mul_f32 v[70:71], v[70:71], v[124:125] op_sel_hi:[1,0]
v_cvt_pk_bf16_f32 v72, v64, v65
v_cvt_pk_bf16_f32 v73, v66, v67
v_cvt_pk_bf16_f32 v74, v68, v69
v_cvt_pk_bf16_f32 v75, v70, v71
ds_write_b128 v31, v[72:75] offset:4096
v_accvgpr_read_b32 v76, a36
v_accvgpr_read_b32 v77, a37
v_accvgpr_read_b32 v78, a38
v_accvgpr_read_b32 v79, a39
v_accvgpr_read_b32 v80, a52
v_accvgpr_read_b32 v81, a53
v_accvgpr_read_b32 v82, a54
v_accvgpr_read_b32 v83, a55
v_pk_mul_f32 v[76:77], v[76:77], v[124:125] op_sel:[0,1]
v_pk_mul_f32 v[78:79], v[78:79], v[124:125] op_sel:[0,1]
v_pk_mul_f32 v[80:81], v[80:81], v[124:125] op_sel:[0,1]
v_pk_mul_f32 v[82:83], v[82:83], v[124:125] op_sel:[0,1]
v_cvt_pk_bf16_f32 v84, v76, v77
v_cvt_pk_bf16_f32 v85, v78, v79
v_cvt_pk_bf16_f32 v86, v80, v81
v_cvt_pk_bf16_f32 v87, v82, v83
ds_write_b128 v31, v[84:87] offset:5120
v_accvgpr_read_b32 v88, a40
v_accvgpr_read_b32 v89, a41
v_accvgpr_read_b32 v90, a42
v_accvgpr_read_b32 v91, a43
v_accvgpr_read_b32 v92, a56
v_accvgpr_read_b32 v93, a57
v_accvgpr_read_b32 v94, a58
v_accvgpr_read_b32 v95, a59
v_pk_mul_f32 v[88:89], v[88:89], v[126:127] op_sel_hi:[1,0]
v_pk_mul_f32 v[90:91], v[90:91], v[126:127] op_sel_hi:[1,0]
v_pk_mul_f32 v[92:93], v[92:93], v[126:127] op_sel_hi:[1,0]
v_pk_mul_f32 v[94:95], v[94:95], v[126:127] op_sel_hi:[1,0]
v_cvt_pk_bf16_f32 v96, v88, v89
v_cvt_pk_bf16_f32 v97, v90, v91
v_cvt_pk_bf16_f32 v98, v92, v93
v_cvt_pk_bf16_f32 v99, v94, v95
ds_write_b128 v31, v[96:99] offset:6144
v_accvgpr_read_b32 v100, a44
v_accvgpr_read_b32 v101, a45
v_accvgpr_read_b32 v102, a46
v_accvgpr_read_b32 v103, a47
v_accvgpr_read_b32 v104, a60
v_accvgpr_read_b32 v105, a61
v_accvgpr_read_b32 v106, a62
v_accvgpr_read_b32 v107, a63
v_pk_mul_f32 v[100:101], v[100:101], v[126:127] op_sel:[0,1]
v_pk_mul_f32 v[102:103], v[102:103], v[126:127] op_sel:[0,1]
v_pk_mul_f32 v[104:105], v[104:105], v[126:127] op_sel:[0,1]
v_pk_mul_f32 v[106:107], v[106:107], v[126:127] op_sel:[0,1]
v_cvt_pk_bf16_f32 v108, v100, v101
v_cvt_pk_bf16_f32 v109, v102, v103
v_cvt_pk_bf16_f32 v110, v104, v105
v_cvt_pk_bf16_f32 v111, v106, v107
ds_write_b128 v31, v[108:111] offset:7168
v_accvgpr_read_b32 v64, a64
v_accvgpr_read_b32 v65, a65
v_accvgpr_read_b32 v66, a66
v_accvgpr_read_b32 v67, a67
v_accvgpr_read_b32 v68, a80
v_accvgpr_read_b32 v69, a81
v_accvgpr_read_b32 v70, a82
v_accvgpr_read_b32 v71, a83
v_pk_mul_f32 v[64:65], v[64:65], v[124:125] op_sel_hi:[1,0]
v_pk_mul_f32 v[66:67], v[66:67], v[124:125] op_sel_hi:[1,0]
v_pk_mul_f32 v[68:69], v[68:69], v[124:125] op_sel_hi:[1,0]
v_pk_mul_f32 v[70:71], v[70:71], v[124:125] op_sel_hi:[1,0]
v_cvt_pk_bf16_f32 v72, v64, v65
v_cvt_pk_bf16_f32 v73, v66, v67
v_cvt_pk_bf16_f32 v74, v68, v69
v_cvt_pk_bf16_f32 v75, v70, v71
ds_write_b128 v31, v[72:75] offset:8192
v_accvgpr_read_b32 v76, a68
v_accvgpr_read_b32 v77, a69
v_accvgpr_read_b32 v78, a70
v_accvgpr_read_b32 v79, a71
v_accvgpr_read_b32 v80, a84
v_accvgpr_read_b32 v81, a85
v_accvgpr_read_b32 v82, a86
v_accvgpr_read_b32 v83, a87
v_pk_mul_f32 v[76:77], v[76:77], v[124:125] op_sel:[0,1]
v_pk_mul_f32 v[78:79], v[78:79], v[124:125] op_sel:[0,1]
v_pk_mul_f32 v[80:81], v[80:81], v[124:125] op_sel:[0,1]
v_pk_mul_f32 v[82:83], v[82:83], v[124:125] op_sel:[0,1]
v_cvt_pk_bf16_f32 v84, v76, v77
v_cvt_pk_bf16_f32 v85, v78, v79
v_cvt_pk_bf16_f32 v86, v80, v81
v_cvt_pk_bf16_f32 v87, v82, v83
ds_write_b128 v31, v[84:87] offset:9216
v_accvgpr_read_b32 v88, a72
v_accvgpr_read_b32 v89, a73
v_accvgpr_read_b32 v90, a74
v_accvgpr_read_b32 v91, a75
v_accvgpr_read_b32 v92, a88
v_accvgpr_read_b32 v93, a89
v_accvgpr_read_b32 v94, a90
v_accvgpr_read_b32 v95, a91
v_pk_mul_f32 v[88:89], v[88:89], v[126:127] op_sel_hi:[1,0]
v_pk_mul_f32 v[90:91], v[90:91], v[126:127] op_sel_hi:[1,0]
v_pk_mul_f32 v[92:93], v[92:93], v[126:127] op_sel_hi:[1,0]
v_pk_mul_f32 v[94:95], v[94:95], v[126:127] op_sel_hi:[1,0]
v_cvt_pk_bf16_f32 v96, v88, v89
v_cvt_pk_bf16_f32 v97, v90, v91
v_cvt_pk_bf16_f32 v98, v92, v93
v_cvt_pk_bf16_f32 v99, v94, v95
ds_write_b128 v31, v[96:99] offset:10240
v_accvgpr_read_b32 v100, a76
v_accvgpr_read_b32 v101, a77
v_accvgpr_read_b32 v102, a78
v_accvgpr_read_b32 v103, a79
v_accvgpr_read_b32 v104, a92
v_accvgpr_read_b32 v105, a93
v_accvgpr_read_b32 v106, a94
v_accvgpr_read_b32 v107, a95
v_pk_mul_f32 v[100:101], v[100:101], v[126:127] op_sel:[0,1]
v_pk_mul_f32 v[102:103], v[102:103], v[126:127] op_sel:[0,1]
v_pk_mul_f32 v[104:105], v[104:105], v[126:127] op_sel:[0,1]
v_pk_mul_f32 v[106:107], v[106:107], v[126:127] op_sel:[0,1]
v_cvt_pk_bf16_f32 v108, v100, v101
v_cvt_pk_bf16_f32 v109, v102, v103
v_cvt_pk_bf16_f32 v110, v104, v105
v_cvt_pk_bf16_f32 v111, v106, v107
ds_write_b128 v31, v[108:111] offset:11264
v_accvgpr_read_b32 v64, a96
v_accvgpr_read_b32 v65, a97
v_accvgpr_read_b32 v66, a98
v_accvgpr_read_b32 v67, a99
v_accvgpr_read_b32 v68, a112
v_accvgpr_read_b32 v69, a113
v_accvgpr_read_b32 v70, a114
v_accvgpr_read_b32 v71, a115
v_pk_mul_f32 v[64:65], v[64:65], v[124:125] op_sel_hi:[1,0]
v_pk_mul_f32 v[66:67], v[66:67], v[124:125] op_sel_hi:[1,0]
v_pk_mul_f32 v[68:69], v[68:69], v[124:125] op_sel_hi:[1,0]
v_pk_mul_f32 v[70:71], v[70:71], v[124:125] op_sel_hi:[1,0]
v_cvt_pk_bf16_f32 v72, v64, v65
v_cvt_pk_bf16_f32 v73, v66, v67
v_cvt_pk_bf16_f32 v74, v68, v69
v_cvt_pk_bf16_f32 v75, v70, v71
ds_write_b128 v31, v[72:75] offset:12288
v_accvgpr_read_b32 v76, a100
v_accvgpr_read_b32 v77, a101
v_accvgpr_read_b32 v78, a102
v_accvgpr_read_b32 v79, a103
v_accvgpr_read_b32 v80, a116
v_accvgpr_read_b32 v81, a117
v_accvgpr_read_b32 v82, a118
v_accvgpr_read_b32 v83, a119
v_pk_mul_f32 v[76:77], v[76:77], v[124:125] op_sel:[0,1]
v_pk_mul_f32 v[78:79], v[78:79], v[124:125] op_sel:[0,1]
v_pk_mul_f32 v[80:81], v[80:81], v[124:125] op_sel:[0,1]
v_pk_mul_f32 v[82:83], v[82:83], v[124:125] op_sel:[0,1]
v_cvt_pk_bf16_f32 v84, v76, v77
v_cvt_pk_bf16_f32 v85, v78, v79
v_cvt_pk_bf16_f32 v86, v80, v81
v_cvt_pk_bf16_f32 v87, v82, v83
ds_write_b128 v31, v[84:87] offset:13312
v_accvgpr_read_b32 v88, a104
v_accvgpr_read_b32 v89, a105
v_accvgpr_read_b32 v90, a106
v_accvgpr_read_b32 v91, a107
v_accvgpr_read_b32 v92, a120
v_accvgpr_read_b32 v93, a121
v_accvgpr_read_b32 v94, a122
v_accvgpr_read_b32 v95, a123
v_pk_mul_f32 v[88:89], v[88:89], v[126:127] op_sel_hi:[1,0]
v_pk_mul_f32 v[90:91], v[90:91], v[126:127] op_sel_hi:[1,0]
v_pk_mul_f32 v[92:93], v[92:93], v[126:127] op_sel_hi:[1,0]
v_pk_mul_f32 v[94:95], v[94:95], v[126:127] op_sel_hi:[1,0]
v_cvt_pk_bf16_f32 v96, v88, v89
v_cvt_pk_bf16_f32 v97, v90, v91
v_cvt_pk_bf16_f32 v98, v92, v93
v_cvt_pk_bf16_f32 v99, v94, v95
ds_write_b128 v31, v[96:99] offset:14336
v_accvgpr_read_b32 v100, a108
v_accvgpr_read_b32 v101, a109
v_accvgpr_read_b32 v102, a110
v_accvgpr_read_b32 v103, a111
v_accvgpr_read_b32 v104, a124
v_accvgpr_read_b32 v105, a125
v_accvgpr_read_b32 v106, a126
v_accvgpr_read_b32 v107, a127
v_pk_mul_f32 v[100:101], v[100:101], v[126:127] op_sel:[0,1]
v_pk_mul_f32 v[102:103], v[102:103], v[126:127] op_sel:[0,1]
v_pk_mul_f32 v[104:105], v[104:105], v[126:127] op_sel:[0,1]
v_pk_mul_f32 v[106:107], v[106:107], v[126:127] op_sel:[0,1]
v_cvt_pk_bf16_f32 v108, v100, v101
v_cvt_pk_bf16_f32 v109, v102, v103
v_cvt_pk_bf16_f32 v110, v104, v105
v_cvt_pk_bf16_f32 v111, v106, v107
ds_write_b128 v31, v[108:111] offset:15360
ds_read_b64_tr_b16 v[32:33], v6 offset:8192
ds_read_b64_tr_b16 v[34:35], v6 offset:10240
ds_read_b64_tr_b16 v[36:37], v6 offset:12288
ds_read_b64_tr_b16 v[38:39], v6 offset:14336
ds_read_b128 a[0:3], v120 offset:0
ds_read_b128 a[4:7], v120 offset:1024
ds_read_b128 a[8:11], v120 offset:2048
ds_read_b128 a[12:15], v120 offset:3072
ds_read_b128 a[16:19], v120 offset:4096
ds_read_b128 a[20:23], v120 offset:5120
ds_read_b128 a[24:27], v120 offset:6144
ds_read_b128 a[28:31], v120 offset:7168
ds_read_b64_tr_b16 v[40:41], v7 offset:8192
ds_read_b64_tr_b16 v[42:43], v7 offset:10240
ds_read_b64_tr_b16 v[44:45], v7 offset:12288
ds_read_b64_tr_b16 v[46:47], v7 offset:14336
ds_read_b64_tr_b16 v[48:49], v8 offset:8192
ds_read_b64_tr_b16 v[50:51], v8 offset:10240
ds_read_b64_tr_b16 v[52:53], v8 offset:12288
ds_read_b64_tr_b16 v[54:55], v8 offset:14336
s_waitcnt lgkmcnt(8)
v_mfma_f32_16x16x32_bf16 v[128:131], v[32:35], a[0:3], 0
ds_read_b64_tr_b16 v[56:57], v9 offset:8192
ds_read_b64_tr_b16 v[58:59], v9 offset:10240
v_mfma_f32_16x16x32_bf16 v[128:131], v[36:39], a[16:19], v[128:131]
ds_read_b64_tr_b16 v[60:61], v9 offset:12288
ds_read_b64_tr_b16 v[62:63], v9 offset:14336
v_mfma_f32_16x16x32_bf16 v[132:135], v[32:35], a[4:7], 0
v_accvgpr_read_b32 v224, a160
v_accvgpr_read_b32 v225, a161
v_mfma_f32_16x16x32_bf16 v[132:135], v[36:39], a[20:23], v[132:135]
v_accvgpr_read_b32 v226, a162
v_accvgpr_read_b32 v227, a163
v_mfma_f32_16x16x32_bf16 v[136:139], v[32:35], a[8:11], 0
v_accvgpr_read_b32 v228, a164
v_accvgpr_read_b32 v229, a165
v_mfma_f32_16x16x32_bf16 v[136:139], v[36:39], a[24:27], v[136:139]
s_add_u32 s52, s47, 0
v_accvgpr_read_b32 v230, a166
v_accvgpr_read_b32 v231, a167
v_mfma_f32_16x16x32_bf16 v[140:143], v[32:35], a[12:15], 0
s_add_u32 m0, s50, 8192
v_accvgpr_read_b32 v232, a168
v_accvgpr_read_b32 v233, a169
v_mfma_f32_16x16x32_bf16 v[140:143], v[36:39], a[28:31], v[140:143]
s_waitcnt lgkmcnt(0)
v_accvgpr_read_b32 v234, a170
v_accvgpr_read_b32 v235, a171
v_mfma_f32_16x16x32_bf16 v[144:147], v[40:43], a[0:3], 0
ds_read_b64_tr_b16 v[32:33], v6 offset:16384
ds_read_b64_tr_b16 v[34:35], v6 offset:18432
v_mfma_f32_16x16x32_bf16 v[144:147], v[44:47], a[16:19], v[144:147]
buffer_load_dwordx4 v18, s[32:35], s52 offen lds
v_mfma_f32_16x16x32_bf16 v[148:151], v[40:43], a[4:7], 0
s_barrier
ds_read_b64_tr_b16 v[36:37], v6 offset:20480
ds_read_b64_tr_b16 v[38:39], v6 offset:22528
v_mfma_f32_16x16x32_bf16 v[148:151], v[44:47], a[20:23], v[148:151]
buffer_load_dwordx4 v19, s[32:35], s52 offen offset:1024 lds
v_mfma_f32_16x16x32_bf16 v[152:155], v[40:43], a[8:11], 0
ds_read_b128 a[32:35], v121 offset:0
v_accvgpr_read_b32 v236, a172
v_mfma_f32_16x16x32_bf16 v[152:155], v[44:47], a[24:27], v[152:155]
buffer_load_dwordx4 v20, s[32:35], s52 offen offset:2048 lds
v_mfma_f32_16x16x32_bf16 v[156:159], v[40:43], a[12:15], 0
ds_read_b128 a[48:51], v121 offset:4096
v_accvgpr_read_b32 v237, a173
v_mfma_f32_16x16x32_bf16 v[156:159], v[44:47], a[28:31], v[156:159]
ds_read_b128 a[36:39], v121 offset:1024
v_accvgpr_read_b32 v238, a174
v_mfma_f32_16x16x32_bf16 v[160:163], v[48:51], a[0:3], 0
s_add_u32 s53, s52, 32768
ds_read_b64_tr_b16 v[40:41], v7 offset:16384
ds_read_b64_tr_b16 v[42:43], v7 offset:18432
v_mfma_f32_16x16x32_bf16 v[160:163], v[52:55], a[16:19], v[160:163]
buffer_load_dwordx4 v21, s[32:35], s52 offen offset:3072 lds
v_mfma_f32_16x16x32_bf16 v[164:167], v[48:51], a[4:7], 0
s_add_u32 m0, s50, 12288
ds_read_b64_tr_b16 v[44:45], v7 offset:20480
ds_read_b64_tr_b16 v[46:47], v7 offset:22528
v_mfma_f32_16x16x32_bf16 v[164:167], v[52:55], a[20:23], v[164:167]
buffer_load_dwordx4 v18, s[32:35], s53 offen lds
v_mfma_f32_16x16x32_bf16 v[168:171], v[48:51], a[8:11], 0
ds_read_b128 a[52:55], v121 offset:5120
v_accvgpr_read_b32 v239, a175
v_mfma_f32_16x16x32_bf16 v[168:171], v[52:55], a[24:27], v[168:171]
buffer_load_dwordx4 v19, s[32:35], s53 offen offset:1024 lds
v_mfma_f32_16x16x32_bf16 v[172:175], v[48:51], a[12:15], 0
ds_read_b128 a[40:43], v121 offset:2048
v_accvgpr_read_b32 v240, a176
v_mfma_f32_16x16x32_bf16 v[172:175], v[52:55], a[28:31], v[172:175]
ds_read_b128 a[56:59], v121 offset:6144
v_accvgpr_read_b32 v241, a177
v_mfma_f32_16x16x32_bf16 v[176:179], v[56:59], a[0:3], 0
ds_read_b64_tr_b16 v[48:49], v8 offset:16384
ds_read_b64_tr_b16 v[50:51], v8 offset:18432
v_mfma_f32_16x16x32_bf16 v[176:179], v[60:63], a[16:19], v[176:179]
buffer_load_dwordx4 v20, s[32:35], s53 offen offset:2048 lds
v_mfma_f32_16x16x32_bf16 v[180:183], v[56:59], a[4:7], 0
ds_read_b64_tr_b16 v[52:53], v8 offset:20480
ds_read_b64_tr_b16 v[54:55], v8 offset:22528
v_mfma_f32_16x16x32_bf16 v[180:183], v[60:63], a[20:23], v[180:183]
buffer_load_dwordx4 v21, s[32:35], s53 offen offset:3072 lds
v_mfma_f32_16x16x32_bf16 v[184:187], v[56:59], a[8:11], 0
ds_read_b128 a[44:47], v121 offset:3072
v_accvgpr_read_b32 v242, a178
v_mfma_f32_16x16x32_bf16 v[184:187], v[60:63], a[24:27], v[184:187]
ds_read_b128 a[60:63], v121 offset:7168
v_accvgpr_read_b32 v243, a179
v_mfma_f32_16x16x32_bf16 v[188:191], v[56:59], a[12:15], 0
v_accvgpr_read_b32 v244, a180
v_accvgpr_read_b32 v245, a181
v_mfma_f32_16x16x32_bf16 v[188:191], v[60:63], a[28:31], v[188:191]
s_waitcnt lgkmcnt(0)
v_accvgpr_read_b32 v246, a182
v_accvgpr_read_b32 v247, a183
v_mfma_f32_16x16x32_bf16 v[128:131], v[32:35], a[32:35], v[128:131]
ds_read_b64_tr_b16 v[56:57], v9 offset:16384
ds_read_b64_tr_b16 v[58:59], v9 offset:18432
v_mfma_f32_16x16x32_bf16 v[128:131], v[36:39], a[48:51], v[128:131]
ds_read_b64_tr_b16 v[60:61], v9 offset:20480
ds_read_b64_tr_b16 v[62:63], v9 offset:22528
v_mfma_f32_16x16x32_bf16 v[132:135], v[32:35], a[36:39], v[132:135]
ds_read_b128 a[64:67], v122 offset:0
v_accvgpr_read_b32 v248, a184
v_mfma_f32_16x16x32_bf16 v[132:135], v[36:39], a[52:55], v[132:135]
ds_read_b128 a[80:83], v122 offset:4096
v_accvgpr_read_b32 v249, a185
v_mfma_f32_16x16x32_bf16 v[136:139], v[32:35], a[40:43], v[136:139]
ds_read_b128 a[68:71], v122 offset:1024
v_accvgpr_read_b32 v250, a186
v_mfma_f32_16x16x32_bf16 v[136:139], v[36:39], a[56:59], v[136:139]
s_add_u32 s52, s44, 65536
ds_read_b128 a[84:87], v122 offset:5120
v_accvgpr_read_b32 v251, a187
v_mfma_f32_16x16x32_bf16 v[140:143], v[32:35], a[44:47], v[140:143]
s_add_u32 m0, s50, 16384
ds_read_b128 a[72:75], v122 offset:2048
v_accvgpr_read_b32 v252, a188
v_mfma_f32_16x16x32_bf16 v[140:143], v[36:39], a[60:63], v[140:143]
s_waitcnt vmcnt(20) lgkmcnt(5)
v_accvgpr_read_b32 v253, a189
v_accvgpr_read_b32 v254, a190
v_mfma_f32_16x16x32_bf16 v[144:147], v[40:43], a[32:35], v[144:147]
ds_read_b64_tr_b16 v[32:33], v6 offset:0
ds_read_b64_tr_b16 v[34:35], v6 offset:2048
v_mfma_f32_16x16x32_bf16 v[144:147], v[44:47], a[48:51], v[144:147]
buffer_load_dwordx4 v18, s[32:35], s52 offen lds
v_mfma_f32_16x16x32_bf16 v[148:151], v[40:43], a[36:39], v[148:151]
ds_read_b64_tr_b16 v[36:37], v6 offset:4096
ds_read_b64_tr_b16 v[38:39], v6 offset:6144
v_mfma_f32_16x16x32_bf16 v[148:151], v[44:47], a[52:55], v[148:151]
buffer_load_dwordx4 v19, s[32:35], s52 offen offset:1024 lds
v_mfma_f32_16x16x32_bf16 v[152:155], v[40:43], a[40:43], v[152:155]
ds_read_b128 a[88:91], v122 offset:6144
v_accvgpr_read_b32 v255, a191
v_mfma_f32_16x16x32_bf16 v[152:155], v[44:47], a[56:59], v[152:155]
buffer_load_dwordx4 v20, s[32:35], s52 offen offset:2048 lds
v_mfma_f32_16x16x32_bf16 v[156:159], v[40:43], a[44:47], v[156:159]
ds_read_b128 a[76:79], v122 offset:3072
v_mfma_f32_16x16x32_bf16 v[156:159], v[44:47], a[60:63], v[156:159]
v_mfma_f32_16x16x32_bf16 v[160:163], v[48:51], a[32:35], v[160:163]
s_add_u32 s53, s52, 32768
ds_read_b64_tr_b16 v[40:41], v7 offset:0
ds_read_b64_tr_b16 v[42:43], v7 offset:2048
v_mfma_f32_16x16x32_bf16 v[160:163], v[52:55], a[48:51], v[160:163]
buffer_load_dwordx4 v21, s[32:35], s52 offen offset:3072 lds
v_mfma_f32_16x16x32_bf16 v[164:167], v[48:51], a[36:39], v[164:167]
s_add_u32 m0, s50, 20480
ds_read_b64_tr_b16 v[44:45], v7 offset:4096
ds_read_b64_tr_b16 v[46:47], v7 offset:6144
v_mfma_f32_16x16x32_bf16 v[164:167], v[52:55], a[52:55], v[164:167]
buffer_load_dwordx4 v18, s[32:35], s53 offen lds
v_mfma_f32_16x16x32_bf16 v[168:171], v[48:51], a[40:43], v[168:171]
ds_read_b128 a[92:95], v122 offset:7168
v_mfma_f32_16x16x32_bf16 v[168:171], v[52:55], a[56:59], v[168:171]
buffer_load_dwordx4 v19, s[32:35], s53 offen offset:1024 lds
v_mfma_f32_16x16x32_bf16 v[172:175], v[48:51], a[44:47], v[172:175]
v_mfma_f32_16x16x32_bf16 v[172:175], v[52:55], a[60:63], v[172:175]
v_mfma_f32_16x16x32_bf16 v[176:179], v[56:59], a[32:35], v[176:179]
ds_read_b64_tr_b16 v[48:49], v8 offset:0
ds_read_b64_tr_b16 v[50:51], v8 offset:2048
v_mfma_f32_16x16x32_bf16 v[176:179], v[60:63], a[48:51], v[176:179]
buffer_load_dwordx4 v20, s[32:35], s53 offen offset:2048 lds
v_mfma_f32_16x16x32_bf16 v[180:183], v[56:59], a[36:39], v[180:183]
ds_read_b64_tr_b16 v[52:53], v8 offset:4096
ds_read_b64_tr_b16 v[54:55], v8 offset:6144
v_mfma_f32_16x16x32_bf16 v[180:183], v[60:63], a[52:55], v[180:183]
buffer_load_dwordx4 v21, s[32:35], s53 offen offset:3072 lds
v_mfma_f32_16x16x32_bf16 v[184:187], v[56:59], a[40:43], v[184:187]
v_mfma_f32_16x16x32_bf16 v[184:187], v[60:63], a[56:59], v[184:187]
v_mfma_f32_16x16x32_bf16 v[188:191], v[56:59], a[44:47], v[188:191]
v_mfma_f32_16x16x32_bf16 v[188:191], v[60:63], a[60:63], v[188:191]
s_waitcnt lgkmcnt(4)
v_mfma_f32_16x16x32_bf16 v[128:131], v[32:35], a[64:67], v[128:131]
ds_read_b64_tr_b16 v[56:57], v9 offset:0
ds_read_b64_tr_b16 v[58:59], v9 offset:2048
v_mfma_f32_16x16x32_bf16 v[128:131], v[36:39], a[80:83], v[128:131]
ds_read_b64_tr_b16 v[60:61], v9 offset:4096
ds_read_b64_tr_b16 v[62:63], v9 offset:6144
v_mfma_f32_16x16x32_bf16 v[132:135], v[32:35], a[68:71], v[132:135]
ds_read_b128 a[96:99], v123 offset:0
v_mfma_f32_16x16x32_bf16 v[132:135], v[36:39], a[84:87], v[132:135]
ds_read_b128 a[112:115], v123 offset:4096
v_mfma_f32_16x16x32_bf16 v[136:139], v[32:35], a[72:75], v[136:139]
ds_read_b128 a[100:103], v123 offset:1024
v_mfma_f32_16x16x32_bf16 v[136:139], v[36:39], a[88:91], v[136:139]
s_add_u32 s52, s45, 65536
ds_read_b128 a[116:119], v123 offset:5120
v_mfma_f32_16x16x32_bf16 v[140:143], v[32:35], a[76:79], v[140:143]
s_add_u32 m0, s50, 0
ds_read_b128 a[104:107], v123 offset:2048
v_mfma_f32_16x16x32_bf16 v[140:143], v[36:39], a[92:95], v[140:143]
s_waitcnt vmcnt(8) lgkmcnt(5)
v_mfma_f32_16x16x32_bf16 v[144:147], v[40:43], a[64:67], v[144:147]
ds_read_b64_tr_b16 v[32:33], v6 offset:8192
ds_read_b64_tr_b16 v[34:35], v6 offset:10240
v_mfma_f32_16x16x32_bf16 v[144:147], v[44:47], a[80:83], v[144:147]
buffer_load_dwordx4 v18, s[32:35], s52 offen lds
v_mfma_f32_16x16x32_bf16 v[148:151], v[40:43], a[68:71], v[148:151]
ds_read_b64_tr_b16 v[36:37], v6 offset:12288
ds_read_b64_tr_b16 v[38:39], v6 offset:14336
v_mfma_f32_16x16x32_bf16 v[148:151], v[44:47], a[84:87], v[148:151]
buffer_load_dwordx4 v19, s[32:35], s52 offen offset:1024 lds
v_mfma_f32_16x16x32_bf16 v[152:155], v[40:43], a[72:75], v[152:155]
ds_read_b128 a[120:123], v123 offset:6144
v_mfma_f32_16x16x32_bf16 v[152:155], v[44:47], a[88:91], v[152:155]
buffer_load_dwordx4 v20, s[32:35], s52 offen offset:2048 lds
v_mfma_f32_16x16x32_bf16 v[156:159], v[40:43], a[76:79], v[156:159]
ds_read_b128 a[108:111], v123 offset:3072
v_mfma_f32_16x16x32_bf16 v[156:159], v[44:47], a[92:95], v[156:159]
v_mfma_f32_16x16x32_bf16 v[160:163], v[48:51], a[64:67], v[160:163]
s_add_u32 s53, s52, 32768
ds_read_b64_tr_b16 v[40:41], v7 offset:8192
ds_read_b64_tr_b16 v[42:43], v7 offset:10240
v_mfma_f32_16x16x32_bf16 v[160:163], v[52:55], a[80:83], v[160:163]
buffer_load_dwordx4 v21, s[32:35], s52 offen offset:3072 lds
v_mfma_f32_16x16x32_bf16 v[164:167], v[48:51], a[68:71], v[164:167]
s_add_u32 m0, s50, 4096
ds_read_b64_tr_b16 v[44:45], v7 offset:12288
ds_read_b64_tr_b16 v[46:47], v7 offset:14336
v_mfma_f32_16x16x32_bf16 v[164:167], v[52:55], a[84:87], v[164:167]
buffer_load_dwordx4 v18, s[32:35], s53 offen lds
v_mfma_f32_16x16x32_bf16 v[168:171], v[48:51], a[72:75], v[168:171]
ds_read_b128 a[124:127], v123 offset:7168
v_mfma_f32_16x16x32_bf16 v[168:171], v[52:55], a[88:91], v[168:171]
buffer_load_dwordx4 v19, s[32:35], s53 offen offset:1024 lds
v_mfma_f32_16x16x32_bf16 v[172:175], v[48:51], a[76:79], v[172:175]
v_mfma_f32_16x16x32_bf16 v[172:175], v[52:55], a[92:95], v[172:175]
v_mfma_f32_16x16x32_bf16 v[176:179], v[56:59], a[64:67], v[176:179]
ds_read_b64_tr_b16 v[48:49], v8 offset:8192
ds_read_b64_tr_b16 v[50:51], v8 offset:10240
v_mfma_f32_16x16x32_bf16 v[176:179], v[60:63], a[80:83], v[176:179]
buffer_load_dwordx4 v20, s[32:35], s53 offen offset:2048 lds
v_mfma_f32_16x16x32_bf16 v[180:183], v[56:59], a[68:71], v[180:183]
ds_read_b64_tr_b16 v[52:53], v8 offset:12288
ds_read_b64_tr_b16 v[54:55], v8 offset:14336
v_mfma_f32_16x16x32_bf16 v[180:183], v[60:63], a[84:87], v[180:183]
buffer_load_dwordx4 v21, s[32:35], s53 offen offset:3072 lds
v_mfma_f32_16x16x32_bf16 v[184:187], v[56:59], a[72:75], v[184:187]
v_mfma_f32_16x16x32_bf16 v[184:187], v[60:63], a[88:91], v[184:187]
v_mfma_f32_16x16x32_bf16 v[188:191], v[56:59], a[76:79], v[188:191]
v_mfma_f32_16x16x32_bf16 v[188:191], v[60:63], a[92:95], v[188:191]
s_waitcnt lgkmcnt(4)
v_mfma_f32_16x16x32_bf16 v[128:131], v[32:35], a[96:99], v[128:131]
ds_read_b64_tr_b16 v[56:57], v9 offset:8192
ds_read_b64_tr_b16 v[58:59], v9 offset:10240
v_mfma_f32_16x16x32_bf16 v[128:131], v[36:39], a[112:115], v[128:131]
ds_read_b64_tr_b16 v[60:61], v9 offset:12288
ds_read_b64_tr_b16 v[62:63], v9 offset:14336
v_mfma_f32_16x16x32_bf16 v[132:135], v[32:35], a[100:103], v[132:135]
ds_read_b128 a[128:131], v120 offset:8192
v_mfma_f32_16x16x32_bf16 v[132:135], v[36:39], a[116:119], v[132:135]
ds_read_b128 a[144:147], v120 offset:12288
v_mfma_f32_16x16x32_bf16 v[136:139], v[32:35], a[104:107], v[136:139]
ds_read_b128 a[132:135], v120 offset:9216
v_mfma_f32_16x16x32_bf16 v[136:139], v[36:39], a[120:123], v[136:139]
s_add_u32 s52, s46, 65536
ds_read_b128 a[148:151], v120 offset:13312
v_mfma_f32_16x16x32_bf16 v[140:143], v[32:35], a[108:111], v[140:143]
s_add_u32 m0, s50, 8192
ds_read_b128 a[136:139], v120 offset:10240
v_mfma_f32_16x16x32_bf16 v[140:143], v[36:39], a[124:127], v[140:143]
s_waitcnt vmcnt(8) lgkmcnt(5)
v_mfma_f32_16x16x32_bf16 v[144:147], v[40:43], a[96:99], v[144:147]
ds_read_b64_tr_b16 v[32:33], v6 offset:16384
ds_read_b64_tr_b16 v[34:35], v6 offset:18432
v_mfma_f32_16x16x32_bf16 v[144:147], v[44:47], a[112:115], v[144:147]
buffer_load_dwordx4 v18, s[32:35], s52 offen lds
v_mfma_f32_16x16x32_bf16 v[148:151], v[40:43], a[100:103], v[148:151]
ds_read_b64_tr_b16 v[36:37], v6 offset:20480
ds_read_b64_tr_b16 v[38:39], v6 offset:22528
v_mfma_f32_16x16x32_bf16 v[148:151], v[44:47], a[116:119], v[148:151]
buffer_load_dwordx4 v19, s[32:35], s52 offen offset:1024 lds
v_mfma_f32_16x16x32_bf16 v[152:155], v[40:43], a[104:107], v[152:155]
ds_read_b128 a[152:155], v120 offset:14336
v_mfma_f32_16x16x32_bf16 v[152:155], v[44:47], a[120:123], v[152:155]
buffer_load_dwordx4 v20, s[32:35], s52 offen offset:2048 lds
v_mfma_f32_16x16x32_bf16 v[156:159], v[40:43], a[108:111], v[156:159]
ds_read_b128 a[140:143], v120 offset:11264
v_mfma_f32_16x16x32_bf16 v[156:159], v[44:47], a[124:127], v[156:159]
v_mfma_f32_16x16x32_bf16 v[160:163], v[48:51], a[96:99], v[160:163]
s_add_u32 s53, s52, 32768
ds_read_b64_tr_b16 v[40:41], v7 offset:16384
ds_read_b64_tr_b16 v[42:43], v7 offset:18432
v_mfma_f32_16x16x32_bf16 v[160:163], v[52:55], a[112:115], v[160:163]
buffer_load_dwordx4 v21, s[32:35], s52 offen offset:3072 lds
v_mfma_f32_16x16x32_bf16 v[164:167], v[48:51], a[100:103], v[164:167]
s_add_u32 m0, s50, 12288
ds_read_b64_tr_b16 v[44:45], v7 offset:20480
ds_read_b64_tr_b16 v[46:47], v7 offset:22528
v_mfma_f32_16x16x32_bf16 v[164:167], v[52:55], a[116:119], v[164:167]
buffer_load_dwordx4 v18, s[32:35], s53 offen lds
v_mfma_f32_16x16x32_bf16 v[168:171], v[48:51], a[104:107], v[168:171]
ds_read_b128 a[156:159], v120 offset:15360
v_mfma_f32_16x16x32_bf16 v[168:171], v[52:55], a[120:123], v[168:171]
buffer_load_dwordx4 v19, s[32:35], s53 offen offset:1024 lds
v_mfma_f32_16x16x32_bf16 v[172:175], v[48:51], a[108:111], v[172:175]
v_mfma_f32_16x16x32_bf16 v[172:175], v[52:55], a[124:127], v[172:175]
v_mfma_f32_16x16x32_bf16 v[176:179], v[56:59], a[96:99], v[176:179]
ds_read_b64_tr_b16 v[48:49], v8 offset:16384
ds_read_b64_tr_b16 v[50:51], v8 offset:18432
v_mfma_f32_16x16x32_bf16 v[176:179], v[60:63], a[112:115], v[176:179]
buffer_load_dwordx4 v20, s[32:35], s53 offen offset:2048 lds
v_mfma_f32_16x16x32_bf16 v[180:183], v[56:59], a[100:103], v[180:183]
ds_read_b64_tr_b16 v[52:53], v8 offset:20480
ds_read_b64_tr_b16 v[54:55], v8 offset:22528
v_mfma_f32_16x16x32_bf16 v[180:183], v[60:63], a[116:119], v[180:183]
buffer_load_dwordx4 v21, s[32:35], s53 offen offset:3072 lds
v_mfma_f32_16x16x32_bf16 v[184:187], v[56:59], a[104:107], v[184:187]
v_mfma_f32_16x16x32_bf16 v[184:187], v[60:63], a[120:123], v[184:187]
v_mfma_f32_16x16x32_bf16 v[188:191], v[56:59], a[108:111], v[188:191]
v_mfma_f32_16x16x32_bf16 v[188:191], v[60:63], a[124:127], v[188:191]
s_waitcnt lgkmcnt(4)
v_mfma_f32_16x16x32_bf16 v[128:131], v[32:35], a[128:131], v[128:131]
ds_read_b64_tr_b16 v[56:57], v9 offset:16384
ds_read_b64_tr_b16 v[58:59], v9 offset:18432
v_mfma_f32_16x16x32_bf16 v[128:131], v[36:39], a[144:147], v[128:131]
ds_read_b64_tr_b16 v[60:61], v9 offset:20480
ds_read_b64_tr_b16 v[62:63], v9 offset:22528
v_mfma_f32_16x16x32_bf16 v[132:135], v[32:35], a[132:135], v[132:135]
ds_read_b128 a[160:163], v121 offset:8192
v_mfma_f32_16x16x32_bf16 v[132:135], v[36:39], a[148:151], v[132:135]
ds_read_b128 a[176:179], v121 offset:12288
v_mfma_f32_16x16x32_bf16 v[136:139], v[32:35], a[136:139], v[136:139]
ds_read_b128 a[164:167], v121 offset:9216
v_mfma_f32_16x16x32_bf16 v[136:139], v[36:39], a[152:155], v[136:139]
s_add_u32 s52, s47, 65536
ds_read_b128 a[180:183], v121 offset:13312
v_mfma_f32_16x16x32_bf16 v[140:143], v[32:35], a[140:143], v[140:143]
s_add_u32 m0, s50, 16384
ds_read_b128 a[168:171], v121 offset:10240
v_mfma_f32_16x16x32_bf16 v[140:143], v[36:39], a[156:159], v[140:143]
s_waitcnt vmcnt(8) lgkmcnt(5)
v_mfma_f32_16x16x32_bf16 v[144:147], v[40:43], a[128:131], v[144:147]
ds_read_b64_tr_b16 v[32:33], v6 offset:0
ds_read_b64_tr_b16 v[34:35], v6 offset:2048
v_mfma_f32_16x16x32_bf16 v[144:147], v[44:47], a[144:147], v[144:147]
buffer_load_dwordx4 v18, s[32:35], s52 offen lds
v_mfma_f32_16x16x32_bf16 v[148:151], v[40:43], a[132:135], v[148:151]
ds_read_b64_tr_b16 v[36:37], v6 offset:4096
ds_read_b64_tr_b16 v[38:39], v6 offset:6144
v_mfma_f32_16x16x32_bf16 v[148:151], v[44:47], a[148:151], v[148:151]
buffer_load_dwordx4 v19, s[32:35], s52 offen offset:1024 lds
v_mfma_f32_16x16x32_bf16 v[152:155], v[40:43], a[136:139], v[152:155]
ds_read_b128 a[184:187], v121 offset:14336
v_mfma_f32_16x16x32_bf16 v[152:155], v[44:47], a[152:155], v[152:155]
buffer_load_dwordx4 v20, s[32:35], s52 offen offset:2048 lds
v_mfma_f32_16x16x32_bf16 v[156:159], v[40:43], a[140:143], v[156:159]
ds_read_b128 a[172:175], v121 offset:11264
v_mfma_f32_16x16x32_bf16 v[156:159], v[44:47], a[156:159], v[156:159]
v_mfma_f32_16x16x32_bf16 v[160:163], v[48:51], a[128:131], v[160:163]
s_add_u32 s53, s52, 32768
ds_read_b64_tr_b16 v[40:41], v7 offset:0
ds_read_b64_tr_b16 v[42:43], v7 offset:2048
v_mfma_f32_16x16x32_bf16 v[160:163], v[52:55], a[144:147], v[160:163]
buffer_load_dwordx4 v21, s[32:35], s52 offen offset:3072 lds
v_mfma_f32_16x16x32_bf16 v[164:167], v[48:51], a[132:135], v[164:167]
s_add_u32 m0, s50, 20480
ds_read_b64_tr_b16 v[44:45], v7 offset:4096
ds_read_b64_tr_b16 v[46:47], v7 offset:6144
v_mfma_f32_16x16x32_bf16 v[164:167], v[52:55], a[148:151], v[164:167]
buffer_load_dwordx4 v18, s[32:35], s53 offen lds
v_mfma_f32_16x16x32_bf16 v[168:171], v[48:51], a[136:139], v[168:171]
ds_read_b128 a[188:191], v121 offset:15360
v_mfma_f32_16x16x32_bf16 v[168:171], v[52:55], a[152:155], v[168:171]
buffer_load_dwordx4 v19, s[32:35], s53 offen offset:1024 lds
v_mfma_f32_16x16x32_bf16 v[172:175], v[48:51], a[140:143], v[172:175]
v_mfma_f32_16x16x32_bf16 v[172:175], v[52:55], a[156:159], v[172:175]
v_mfma_f32_16x16x32_bf16 v[176:179], v[56:59], a[128:131], v[176:179]
ds_read_b64_tr_b16 v[48:49], v8 offset:0
ds_read_b64_tr_b16 v[50:51], v8 offset:2048
v_mfma_f32_16x16x32_bf16 v[176:179], v[60:63], a[144:147], v[176:179]
buffer_load_dwordx4 v20, s[32:35], s53 offen offset:2048 lds
v_mfma_f32_16x16x32_bf16 v[180:183], v[56:59], a[132:135], v[180:183]
ds_read_b64_tr_b16 v[52:53], v8 offset:4096
ds_read_b64_tr_b16 v[54:55], v8 offset:6144
v_mfma_f32_16x16x32_bf16 v[180:183], v[60:63], a[148:151], v[180:183]
buffer_load_dwordx4 v21, s[32:35], s53 offen offset:3072 lds
v_mfma_f32_16x16x32_bf16 v[184:187], v[56:59], a[136:139], v[184:187]
v_mfma_f32_16x16x32_bf16 v[184:187], v[60:63], a[152:155], v[184:187]
v_mfma_f32_16x16x32_bf16 v[188:191], v[56:59], a[140:143], v[188:191]
v_mfma_f32_16x16x32_bf16 v[188:191], v[60:63], a[156:159], v[188:191]
s_waitcnt lgkmcnt(4)
v_mfma_f32_16x16x32_bf16 v[128:131], v[32:35], a[160:163], v[128:131]
ds_read_b64_tr_b16 v[56:57], v9 offset:0
ds_read_b64_tr_b16 v[58:59], v9 offset:2048
v_mfma_f32_16x16x32_bf16 v[128:131], v[36:39], a[176:179], v[128:131]
ds_read_b64_tr_b16 v[60:61], v9 offset:4096
ds_read_b64_tr_b16 v[62:63], v9 offset:6144
v_mfma_f32_16x16x32_bf16 v[132:135], v[32:35], a[164:167], v[132:135]
ds_read_b128 a[192:195], v122 offset:8192
v_mfma_f32_16x16x32_bf16 v[132:135], v[36:39], a[180:183], v[132:135]
ds_read_b128 a[208:211], v122 offset:12288
v_mfma_f32_16x16x32_bf16 v[136:139], v[32:35], a[168:171], v[136:139]
ds_read_b128 a[196:199], v122 offset:9216
v_mfma_f32_16x16x32_bf16 v[136:139], v[36:39], a[184:187], v[136:139]
s_add_u32 s52, s44, 128
ds_read_b128 a[212:215], v122 offset:13312
v_mfma_f32_16x16x32_bf16 v[140:143], v[32:35], a[172:175], v[140:143]
s_add_u32 m0, s50, 0
ds_read_b128 a[200:203], v122 offset:10240
v_mfma_f32_16x16x32_bf16 v[140:143], v[36:39], a[188:191], v[140:143]
s_waitcnt vmcnt(8) lgkmcnt(5)
v_mfma_f32_16x16x32_bf16 v[144:147], v[40:43], a[160:163], v[144:147]
ds_read_b64_tr_b16 v[32:33], v6 offset:8192
ds_read_b64_tr_b16 v[34:35], v6 offset:10240
v_mfma_f32_16x16x32_bf16 v[144:147], v[44:47], a[176:179], v[144:147]
buffer_load_dwordx4 v18, s[32:35], s52 offen lds
v_mfma_f32_16x16x32_bf16 v[148:151], v[40:43], a[164:167], v[148:151]
ds_read_b64_tr_b16 v[36:37], v6 offset:12288
ds_read_b64_tr_b16 v[38:39], v6 offset:14336
v_mfma_f32_16x16x32_bf16 v[148:151], v[44:47], a[180:183], v[148:151]
buffer_load_dwordx4 v19, s[32:35], s52 offen offset:1024 lds
v_mfma_f32_16x16x32_bf16 v[152:155], v[40:43], a[168:171], v[152:155]
ds_read_b128 a[216:219], v122 offset:14336
v_mfma_f32_16x16x32_bf16 v[152:155], v[44:47], a[184:187], v[152:155]
buffer_load_dwordx4 v20, s[32:35], s52 offen offset:2048 lds
v_mfma_f32_16x16x32_bf16 v[156:159], v[40:43], a[172:175], v[156:159]
ds_read_b128 a[204:207], v122 offset:11264
v_mfma_f32_16x16x32_bf16 v[156:159], v[44:47], a[188:191], v[156:159]
v_mfma_f32_16x16x32_bf16 v[160:163], v[48:51], a[160:163], v[160:163]
s_add_u32 s53, s52, 32768
ds_read_b64_tr_b16 v[40:41], v7 offset:8192
ds_read_b64_tr_b16 v[42:43], v7 offset:10240
v_mfma_f32_16x16x32_bf16 v[160:163], v[52:55], a[176:179], v[160:163]
buffer_load_dwordx4 v21, s[32:35], s52 offen offset:3072 lds
v_mfma_f32_16x16x32_bf16 v[164:167], v[48:51], a[164:167], v[164:167]
s_add_u32 m0, s50, 4096
ds_read_b64_tr_b16 v[44:45], v7 offset:12288
ds_read_b64_tr_b16 v[46:47], v7 offset:14336
v_mfma_f32_16x16x32_bf16 v[164:167], v[52:55], a[180:183], v[164:167]
buffer_load_dwordx4 v18, s[32:35], s53 offen lds
v_mfma_f32_16x16x32_bf16 v[168:171], v[48:51], a[168:171], v[168:171]
ds_read_b128 a[220:223], v122 offset:15360
v_mfma_f32_16x16x32_bf16 v[168:171], v[52:55], a[184:187], v[168:171]
buffer_load_dwordx4 v19, s[32:35], s53 offen offset:1024 lds
v_mfma_f32_16x16x32_bf16 v[172:175], v[48:51], a[172:175], v[172:175]
v_mfma_f32_16x16x32_bf16 v[172:175], v[52:55], a[188:191], v[172:175]
v_mfma_f32_16x16x32_bf16 v[176:179], v[56:59], a[160:163], v[176:179]
ds_read_b64_tr_b16 v[48:49], v8 offset:8192
ds_read_b64_tr_b16 v[50:51], v8 offset:10240
v_mfma_f32_16x16x32_bf16 v[176:179], v[60:63], a[176:179], v[176:179]
buffer_load_dwordx4 v20, s[32:35], s53 offen offset:2048 lds
v_mfma_f32_16x16x32_bf16 v[180:183], v[56:59], a[164:167], v[180:183]
ds_read_b64_tr_b16 v[52:53], v8 offset:12288
ds_read_b64_tr_b16 v[54:55], v8 offset:14336
v_mfma_f32_16x16x32_bf16 v[180:183], v[60:63], a[180:183], v[180:183]
buffer_load_dwordx4 v21, s[32:35], s53 offen offset:3072 lds
v_mfma_f32_16x16x32_bf16 v[184:187], v[56:59], a[168:171], v[184:187]
v_mfma_f32_16x16x32_bf16 v[184:187], v[60:63], a[184:187], v[184:187]
v_mfma_f32_16x16x32_bf16 v[188:191], v[56:59], a[172:175], v[188:191]
v_mfma_f32_16x16x32_bf16 v[188:191], v[60:63], a[188:191], v[188:191]
s_waitcnt lgkmcnt(4)
v_mfma_f32_16x16x32_bf16 v[128:131], v[32:35], a[192:195], v[128:131]
ds_read_b64_tr_b16 v[56:57], v9 offset:8192
ds_read_b64_tr_b16 v[58:59], v9 offset:10240
v_mfma_f32_16x16x32_bf16 v[128:131], v[36:39], a[208:211], v[128:131]
ds_read_b64_tr_b16 v[60:61], v9 offset:12288
ds_read_b64_tr_b16 v[62:63], v9 offset:14336
v_mfma_f32_16x16x32_bf16 v[132:135], v[32:35], a[196:199], v[132:135]
ds_read_b128 a[224:227], v123 offset:8192
v_mfma_f32_16x16x32_bf16 v[132:135], v[36:39], a[212:215], v[132:135]
ds_read_b128 a[240:243], v123 offset:12288
v_mfma_f32_16x16x32_bf16 v[136:139], v[32:35], a[200:203], v[136:139]
ds_read_b128 a[228:231], v123 offset:9216
v_mfma_f32_16x16x32_bf16 v[136:139], v[36:39], a[216:219], v[136:139]
s_add_u32 s52, s45, 128
ds_read_b128 a[244:247], v123 offset:13312
v_mfma_f32_16x16x32_bf16 v[140:143], v[32:35], a[204:207], v[140:143]
s_add_u32 m0, s50, 8192
ds_read_b128 a[232:235], v123 offset:10240
v_mfma_f32_16x16x32_bf16 v[140:143], v[36:39], a[220:223], v[140:143]
s_waitcnt vmcnt(8) lgkmcnt(5)
v_mfma_f32_16x16x32_bf16 v[144:147], v[40:43], a[192:195], v[144:147]
ds_read_b64_tr_b16 v[32:33], v6 offset:16384
ds_read_b64_tr_b16 v[34:35], v6 offset:18432
v_mfma_f32_16x16x32_bf16 v[144:147], v[44:47], a[208:211], v[144:147]
buffer_load_dwordx4 v18, s[32:35], s52 offen lds
v_mfma_f32_16x16x32_bf16 v[148:151], v[40:43], a[196:199], v[148:151]
ds_read_b64_tr_b16 v[36:37], v6 offset:20480
ds_read_b64_tr_b16 v[38:39], v6 offset:22528
v_mfma_f32_16x16x32_bf16 v[148:151], v[44:47], a[212:215], v[148:151]
buffer_load_dwordx4 v19, s[32:35], s52 offen offset:1024 lds
v_mfma_f32_16x16x32_bf16 v[152:155], v[40:43], a[200:203], v[152:155]
ds_read_b128 a[248:251], v123 offset:14336
v_mfma_f32_16x16x32_bf16 v[152:155], v[44:47], a[216:219], v[152:155]
buffer_load_dwordx4 v20, s[32:35], s52 offen offset:2048 lds
v_mfma_f32_16x16x32_bf16 v[156:159], v[40:43], a[204:207], v[156:159]
ds_read_b128 a[236:239], v123 offset:11264
v_mfma_f32_16x16x32_bf16 v[156:159], v[44:47], a[220:223], v[156:159]
v_mfma_f32_16x16x32_bf16 v[160:163], v[48:51], a[192:195], v[160:163]
s_add_u32 s53, s52, 32768
ds_read_b64_tr_b16 v[40:41], v7 offset:16384
ds_read_b64_tr_b16 v[42:43], v7 offset:18432
v_mfma_f32_16x16x32_bf16 v[160:163], v[52:55], a[208:211], v[160:163]
buffer_load_dwordx4 v21, s[32:35], s52 offen offset:3072 lds
v_mfma_f32_16x16x32_bf16 v[164:167], v[48:51], a[196:199], v[164:167]
s_add_u32 m0, s50, 12288
ds_read_b64_tr_b16 v[44:45], v7 offset:20480
ds_read_b64_tr_b16 v[46:47], v7 offset:22528
v_mfma_f32_16x16x32_bf16 v[164:167], v[52:55], a[212:215], v[164:167]
buffer_load_dwordx4 v18, s[32:35], s53 offen lds
v_mfma_f32_16x16x32_bf16 v[168:171], v[48:51], a[200:203], v[168:171]
ds_read_b128 a[252:255], v123 offset:15360
v_mfma_f32_16x16x32_bf16 v[168:171], v[52:55], a[216:219], v[168:171]
buffer_load_dwordx4 v19, s[32:35], s53 offen offset:1024 lds
v_mfma_f32_16x16x32_bf16 v[172:175], v[48:51], a[204:207], v[172:175]
v_mfma_f32_16x16x32_bf16 v[172:175], v[52:55], a[220:223], v[172:175]
v_mfma_f32_16x16x32_bf16 v[176:179], v[56:59], a[192:195], v[176:179]
ds_read_b64_tr_b16 v[48:49], v8 offset:16384
ds_read_b64_tr_b16 v[50:51], v8 offset:18432
v_mfma_f32_16x16x32_bf16 v[176:179], v[60:63], a[208:211], v[176:179]
buffer_load_dwordx4 v20, s[32:35], s53 offen offset:2048 lds
v_mfma_f32_16x16x32_bf16 v[180:183], v[56:59], a[196:199], v[180:183]
ds_read_b64_tr_b16 v[52:53], v8 offset:20480
ds_read_b64_tr_b16 v[54:55], v8 offset:22528
v_mfma_f32_16x16x32_bf16 v[180:183], v[60:63], a[212:215], v[180:183]
buffer_load_dwordx4 v21, s[32:35], s53 offen offset:3072 lds
v_mfma_f32_16x16x32_bf16 v[184:187], v[56:59], a[200:203], v[184:187]
v_mfma_f32_16x16x32_bf16 v[184:187], v[60:63], a[216:219], v[184:187]
v_mfma_f32_16x16x32_bf16 v[188:191], v[56:59], a[204:207], v[188:191]
v_mfma_f32_16x16x32_bf16 v[188:191], v[60:63], a[220:223], v[188:191]
s_waitcnt lgkmcnt(4)
v_mfma_f32_16x16x32_bf16 v[128:131], v[32:35], a[224:227], v[128:131]
ds_read_b64_tr_b16 v[56:57], v9 offset:16384
ds_read_b64_tr_b16 v[58:59], v9 offset:18432
v_mfma_f32_16x16x32_bf16 v[128:131], v[36:39], a[240:243], v[128:131]
ds_read_b64_tr_b16 v[60:61], v9 offset:20480
ds_read_b64_tr_b16 v[62:63], v9 offset:22528
v_mfma_f32_16x16x32_bf16 v[132:135], v[32:35], a[228:231], v[132:135]
v_mfma_f32_16x16x32_bf16 v[132:135], v[36:39], a[244:247], v[132:135]
v_mfma_f32_16x16x32_bf16 v[136:139], v[32:35], a[232:235], v[136:139]
v_mfma_f32_16x16x32_bf16 v[136:139], v[36:39], a[248:251], v[136:139]
s_add_u32 s52, s46, 128
v_mfma_f32_16x16x32_bf16 v[140:143], v[32:35], a[236:239], v[140:143]
s_add_u32 m0, s50, 16384
v_mfma_f32_16x16x32_bf16 v[140:143], v[36:39], a[252:255], v[140:143]
s_waitcnt vmcnt(8) lgkmcnt(0)
v_mfma_f32_16x16x32_bf16 v[144:147], v[40:43], a[224:227], v[144:147]
ds_read_b64_tr_b16 v[32:33], v6 offset:0
ds_read_b64_tr_b16 v[34:35], v6 offset:2048
v_mfma_f32_16x16x32_bf16 v[144:147], v[44:47], a[240:243], v[144:147]
buffer_load_dwordx4 v18, s[32:35], s52 offen lds
v_mfma_f32_16x16x32_bf16 v[148:151], v[40:43], a[228:231], v[148:151]
ds_read_b64_tr_b16 v[36:37], v6 offset:4096
ds_read_b64_tr_b16 v[38:39], v6 offset:6144
v_mfma_f32_16x16x32_bf16 v[148:151], v[44:47], a[244:247], v[148:151]
buffer_load_dwordx4 v19, s[32:35], s52 offen offset:1024 lds
v_mfma_f32_16x16x32_bf16 v[152:155], v[40:43], a[232:235], v[152:155]
v_mfma_f32_16x16x32_bf16 v[152:155], v[44:47], a[248:251], v[152:155]
buffer_load_dwordx4 v20, s[32:35], s52 offen offset:2048 lds
v_mfma_f32_16x16x32_bf16 v[156:159], v[40:43], a[236:239], v[156:159]
v_mfma_f32_16x16x32_bf16 v[156:159], v[44:47], a[252:255], v[156:159]
v_mfma_f32_16x16x32_bf16 v[160:163], v[48:51], a[224:227], v[160:163]
s_add_u32 s53, s52, 32768
ds_read_b64_tr_b16 v[40:41], v7 offset:0
ds_read_b64_tr_b16 v[42:43], v7 offset:2048
v_mfma_f32_16x16x32_bf16 v[160:163], v[52:55], a[240:243], v[160:163]
buffer_load_dwordx4 v21, s[32:35], s52 offen offset:3072 lds
v_mfma_f32_16x16x32_bf16 v[164:167], v[48:51], a[228:231], v[164:167]
s_add_u32 m0, s50, 20480
ds_read_b64_tr_b16 v[44:45], v7 offset:4096
ds_read_b64_tr_b16 v[46:47], v7 offset:6144
v_mfma_f32_16x16x32_bf16 v[164:167], v[52:55], a[244:247], v[164:167]
buffer_load_dwordx4 v18, s[32:35], s53 offen lds
v_mfma_f32_16x16x32_bf16 v[168:171], v[48:51], a[232:235], v[168:171]
v_mfma_f32_16x16x32_bf16 v[168:171], v[52:55], a[248:251], v[168:171]
buffer_load_dwordx4 v19, s[32:35], s53 offen offset:1024 lds
v_mfma_f32_16x16x32_bf16 v[172:175], v[48:51], a[236:239], v[172:175]
v_mfma_f32_16x16x32_bf16 v[172:175], v[52:55], a[252:255], v[172:175]
v_mfma_f32_16x16x32_bf16 v[176:179], v[56:59], a[224:227], v[176:179]
ds_read_b64_tr_b16 v[48:49], v8 offset:0
ds_read_b64_tr_b16 v[50:51], v8 offset:2048
v_mfma_f32_16x16x32_bf16 v[176:179], v[60:63], a[240:243], v[176:179]
buffer_load_dwordx4 v20, s[32:35], s53 offen offset:2048 lds
v_mfma_f32_16x16x32_bf16 v[180:183], v[56:59], a[228:231], v[180:183]
ds_read_b64_tr_b16 v[52:53], v8 offset:4096
ds_read_b64_tr_b16 v[54:55], v8 offset:6144
v_mfma_f32_16x16x32_bf16 v[180:183], v[60:63], a[244:247], v[180:183]
buffer_load_dwordx4 v21, s[32:35], s53 offen offset:3072 lds
v_mfma_f32_16x16x32_bf16 v[184:187], v[56:59], a[232:235], v[184:187]
v_mfma_f32_16x16x32_bf16 v[184:187], v[60:63], a[248:251], v[184:187]
v_mfma_f32_16x16x32_bf16 v[188:191], v[56:59], a[236:239], v[188:191]
v_mfma_f32_16x16x32_bf16 v[188:191], v[60:63], a[252:255], v[188:191]
s_waitcnt lgkmcnt(8)
v_mfma_f32_16x16x32_bf16 v[64:67], v[32:35], a[0:3], 0
ds_read_b64_tr_b16 v[56:57], v9 offset:0
ds_read_b64_tr_b16 v[58:59], v9 offset:2048
v_mfma_f32_16x16x32_bf16 v[64:67], v[36:39], a[16:19], v[64:67]
ds_read_b64_tr_b16 v[60:61], v9 offset:4096
ds_read_b64_tr_b16 v[62:63], v9 offset:6144
v_mfma_f32_16x16x32_bf16 v[68:71], v[32:35], a[4:7], 0
v_mfma_f32_16x16x32_bf16 v[68:71], v[36:39], a[20:23], v[68:71]
v_mfma_f32_16x16x32_bf16 v[72:75], v[32:35], a[8:11], 0
v_mfma_f32_16x16x32_bf16 v[72:75], v[36:39], a[24:27], v[72:75]
s_add_u32 s52, s47, 128
v_mfma_f32_16x16x32_bf16 v[76:79], v[32:35], a[12:15], 0
s_add_u32 m0, s50, 0
v_mfma_f32_16x16x32_bf16 v[76:79], v[36:39], a[28:31], v[76:79]
s_waitcnt vmcnt(8) lgkmcnt(0)
v_mfma_f32_16x16x32_bf16 v[80:83], v[40:43], a[0:3], 0
ds_read_b64_tr_b16 v[32:33], v6 offset:8192
ds_read_b64_tr_b16 v[34:35], v6 offset:10240
v_mfma_f32_16x16x32_bf16 v[80:83], v[44:47], a[16:19], v[80:83]
buffer_load_dwordx4 v18, s[32:35], s52 offen lds
v_mfma_f32_16x16x32_bf16 v[84:87], v[40:43], a[4:7], 0
ds_read_b64_tr_b16 v[36:37], v6 offset:12288
ds_read_b64_tr_b16 v[38:39], v6 offset:14336
v_mfma_f32_16x16x32_bf16 v[84:87], v[44:47], a[20:23], v[84:87]
buffer_load_dwordx4 v19, s[32:35], s52 offen offset:1024 lds
v_mfma_f32_16x16x32_bf16 v[88:91], v[40:43], a[8:11], 0
v_mfma_f32_16x16x32_bf16 v[88:91], v[44:47], a[24:27], v[88:91]
buffer_load_dwordx4 v20, s[32:35], s52 offen offset:2048 lds
v_mfma_f32_16x16x32_bf16 v[92:95], v[40:43], a[12:15], 0
v_mfma_f32_16x16x32_bf16 v[92:95], v[44:47], a[28:31], v[92:95]
v_mfma_f32_16x16x32_bf16 v[96:99], v[48:51], a[0:3], 0
s_add_u32 s53, s52, 32768
ds_read_b64_tr_b16 v[40:41], v7 offset:8192
ds_read_b64_tr_b16 v[42:43], v7 offset:10240
v_mfma_f32_16x16x32_bf16 v[96:99], v[52:55], a[16:19], v[96:99]
buffer_load_dwordx4 v21, s[32:35], s52 offen offset:3072 lds
v_mfma_f32_16x16x32_bf16 v[100:103], v[48:51], a[4:7], 0
s_add_u32 m0, s50, 4096
ds_read_b64_tr_b16 v[44:45], v7 offset:12288
ds_read_b64_tr_b16 v[46:47], v7 offset:14336
v_mfma_f32_16x16x32_bf16 v[100:103], v[52:55], a[20:23], v[100:103]
buffer_load_dwordx4 v18, s[32:35], s53 offen lds
v_mfma_f32_16x16x32_bf16 v[104:107], v[48:51], a[8:11], 0
v_mfma_f32_16x16x32_bf16 v[104:107], v[52:55], a[24:27], v[104:107]
buffer_load_dwordx4 v19, s[32:35], s53 offen offset:1024 lds
v_mfma_f32_16x16x32_bf16 v[108:111], v[48:51], a[12:15], 0
v_mfma_f32_16x16x32_bf16 v[108:111], v[52:55], a[28:31], v[108:111]
v_mfma_f32_16x16x32_bf16 v[112:115], v[56:59], a[0:3], 0
ds_read_b64_tr_b16 v[48:49], v8 offset:8192
ds_read_b64_tr_b16 v[50:51], v8 offset:10240
v_mfma_f32_16x16x32_bf16 v[112:115], v[60:63], a[16:19], v[112:115]
buffer_load_dwordx4 v20, s[32:35], s53 offen offset:2048 lds
v_mfma_f32_16x16x32_bf16 v[116:119], v[56:59], a[4:7], 0
ds_read_b64_tr_b16 v[52:53], v8 offset:12288
ds_read_b64_tr_b16 v[54:55], v8 offset:14336
v_mfma_f32_16x16x32_bf16 v[116:119], v[60:63], a[20:23], v[116:119]
buffer_load_dwordx4 v21, s[32:35], s53 offen offset:3072 lds
v_mfma_f32_16x16x32_bf16 v[120:123], v[56:59], a[8:11], 0
v_mfma_f32_16x16x32_bf16 v[120:123], v[60:63], a[24:27], v[120:123]
v_mfma_f32_16x16x32_bf16 v[124:127], v[56:59], a[12:15], 0
v_mfma_f32_16x16x32_bf16 v[124:127], v[60:63], a[28:31], v[124:127]
s_waitcnt lgkmcnt(8)
v_mfma_f32_16x16x32_bf16 v[64:67], v[32:35], a[32:35], v[64:67]
ds_read_b64_tr_b16 v[56:57], v9 offset:8192
ds_read_b64_tr_b16 v[58:59], v9 offset:10240
v_mfma_f32_16x16x32_bf16 v[64:67], v[36:39], a[48:51], v[64:67]
ds_read_b64_tr_b16 v[60:61], v9 offset:12288
ds_read_b64_tr_b16 v[62:63], v9 offset:14336
v_mfma_f32_16x16x32_bf16 v[68:71], v[32:35], a[36:39], v[68:71]
v_mfma_f32_16x16x32_bf16 v[68:71], v[36:39], a[52:55], v[68:71]
v_mfma_f32_16x16x32_bf16 v[72:75], v[32:35], a[40:43], v[72:75]
v_mfma_f32_16x16x32_bf16 v[72:75], v[36:39], a[56:59], v[72:75]
s_add_u32 s52, s44, 65664
v_mfma_f32_16x16x32_bf16 v[76:79], v[32:35], a[44:47], v[76:79]
s_add_u32 m0, s50, 8192
v_mfma_f32_16x16x32_bf16 v[76:79], v[36:39], a[60:63], v[76:79]
s_waitcnt vmcnt(8) lgkmcnt(0)
v_mfma_f32_16x16x32_bf16 v[80:83], v[40:43], a[32:35], v[80:83]
ds_read_b64_tr_b16 v[32:33], v6 offset:16384
ds_read_b64_tr_b16 v[34:35], v6 offset:18432
v_mfma_f32_16x16x32_bf16 v[80:83], v[44:47], a[48:51], v[80:83]
buffer_load_dwordx4 v18, s[32:35], s52 offen lds
v_mfma_f32_16x16x32_bf16 v[84:87], v[40:43], a[36:39], v[84:87]
ds_read_b64_tr_b16 v[36:37], v6 offset:20480
ds_read_b64_tr_b16 v[38:39], v6 offset:22528
v_mfma_f32_16x16x32_bf16 v[84:87], v[44:47], a[52:55], v[84:87]
buffer_load_dwordx4 v19, s[32:35], s52 offen offset:1024 lds
v_mfma_f32_16x16x32_bf16 v[88:91], v[40:43], a[40:43], v[88:91]
v_mfma_f32_16x16x32_bf16 v[88:91], v[44:47], a[56:59], v[88:91]
buffer_load_dwordx4 v20, s[32:35], s52 offen offset:2048 lds
v_mfma_f32_16x16x32_bf16 v[92:95], v[40:43], a[44:47], v[92:95]
v_mfma_f32_16x16x32_bf16 v[92:95], v[44:47], a[60:63], v[92:95]
v_mfma_f32_16x16x32_bf16 v[96:99], v[48:51], a[32:35], v[96:99]
s_add_u32 s53, s52, 32768
ds_read_b64_tr_b16 v[40:41], v7 offset:16384
ds_read_b64_tr_b16 v[42:43], v7 offset:18432
v_mfma_f32_16x16x32_bf16 v[96:99], v[52:55], a[48:51], v[96:99]
buffer_load_dwordx4 v21, s[32:35], s52 offen offset:3072 lds
v_mfma_f32_16x16x32_bf16 v[100:103], v[48:51], a[36:39], v[100:103]
s_add_u32 m0, s50, 12288
ds_read_b64_tr_b16 v[44:45], v7 offset:20480
ds_read_b64_tr_b16 v[46:47], v7 offset:22528
v_mfma_f32_16x16x32_bf16 v[100:103], v[52:55], a[52:55], v[100:103]
buffer_load_dwordx4 v18, s[32:35], s53 offen lds
v_mfma_f32_16x16x32_bf16 v[104:107], v[48:51], a[40:43], v[104:107]
v_mfma_f32_16x16x32_bf16 v[104:107], v[52:55], a[56:59], v[104:107]
buffer_load_dwordx4 v19, s[32:35], s53 offen offset:1024 lds
v_mfma_f32_16x16x32_bf16 v[108:111], v[48:51], a[44:47], v[108:111]
v_mfma_f32_16x16x32_bf16 v[108:111], v[52:55], a[60:63], v[108:111]
v_mfma_f32_16x16x32_bf16 v[112:115], v[56:59], a[32:35], v[112:115]
ds_read_b64_tr_b16 v[48:49], v8 offset:16384
ds_read_b64_tr_b16 v[50:51], v8 offset:18432
v_mfma_f32_16x16x32_bf16 v[112:115], v[60:63], a[48:51], v[112:115]
buffer_load_dwordx4 v20, s[32:35], s53 offen offset:2048 lds
v_mfma_f32_16x16x32_bf16 v[116:119], v[56:59], a[36:39], v[116:119]
ds_read_b64_tr_b16 v[52:53], v8 offset:20480
ds_read_b64_tr_b16 v[54:55], v8 offset:22528
v_mfma_f32_16x16x32_bf16 v[116:119], v[60:63], a[52:55], v[116:119]
buffer_load_dwordx4 v21, s[32:35], s53 offen offset:3072 lds
v_mfma_f32_16x16x32_bf16 v[120:123], v[56:59], a[40:43], v[120:123]
v_mfma_f32_16x16x32_bf16 v[120:123], v[60:63], a[56:59], v[120:123]
v_mfma_f32_16x16x32_bf16 v[124:127], v[56:59], a[44:47], v[124:127]
v_mfma_f32_16x16x32_bf16 v[124:127], v[60:63], a[60:63], v[124:127]
s_waitcnt lgkmcnt(8)
v_mfma_f32_16x16x32_bf16 v[64:67], v[32:35], a[64:67], v[64:67]
ds_read_b64_tr_b16 v[56:57], v9 offset:16384
ds_read_b64_tr_b16 v[58:59], v9 offset:18432
v_mfma_f32_16x16x32_bf16 v[64:67], v[36:39], a[80:83], v[64:67]
ds_read_b64_tr_b16 v[60:61], v9 offset:20480
ds_read_b64_tr_b16 v[62:63], v9 offset:22528
v_mfma_f32_16x16x32_bf16 v[68:71], v[32:35], a[68:71], v[68:71]
v_mfma_f32_16x16x32_bf16 v[68:71], v[36:39], a[84:87], v[68:71]
v_mfma_f32_16x16x32_bf16 v[72:75], v[32:35], a[72:75], v[72:75]
v_mfma_f32_16x16x32_bf16 v[72:75], v[36:39], a[88:91], v[72:75]
s_add_u32 s52, s45, 65664
v_mfma_f32_16x16x32_bf16 v[76:79], v[32:35], a[76:79], v[76:79]
s_add_u32 m0, s50, 16384
v_mfma_f32_16x16x32_bf16 v[76:79], v[36:39], a[92:95], v[76:79]
s_waitcnt vmcnt(8) lgkmcnt(0)
v_mfma_f32_16x16x32_bf16 v[80:83], v[40:43], a[64:67], v[80:83]
ds_read_b64_tr_b16 v[32:33], v6 offset:0
ds_read_b64_tr_b16 v[34:35], v6 offset:2048
v_mfma_f32_16x16x32_bf16 v[80:83], v[44:47], a[80:83], v[80:83]
buffer_load_dwordx4 v18, s[32:35], s52 offen lds
v_mfma_f32_16x16x32_bf16 v[84:87], v[40:43], a[68:71], v[84:87]
ds_read_b64_tr_b16 v[36:37], v6 offset:4096
ds_read_b64_tr_b16 v[38:39], v6 offset:6144
v_mfma_f32_16x16x32_bf16 v[84:87], v[44:47], a[84:87], v[84:87]
buffer_load_dwordx4 v19, s[32:35], s52 offen offset:1024 lds
v_mfma_f32_16x16x32_bf16 v[88:91], v[40:43], a[72:75], v[88:91]
v_mfma_f32_16x16x32_bf16 v[88:91], v[44:47], a[88:91], v[88:91]
buffer_load_dwordx4 v20, s[32:35], s52 offen offset:2048 lds
v_mfma_f32_16x16x32_bf16 v[92:95], v[40:43], a[76:79], v[92:95]
v_mfma_f32_16x16x32_bf16 v[92:95], v[44:47], a[92:95], v[92:95]
v_mfma_f32_16x16x32_bf16 v[96:99], v[48:51], a[64:67], v[96:99]
s_add_u32 s53, s52, 32768
ds_read_b64_tr_b16 v[40:41], v7 offset:0
ds_read_b64_tr_b16 v[42:43], v7 offset:2048
v_mfma_f32_16x16x32_bf16 v[96:99], v[52:55], a[80:83], v[96:99]
buffer_load_dwordx4 v21, s[32:35], s52 offen offset:3072 lds
v_mfma_f32_16x16x32_bf16 v[100:103], v[48:51], a[68:71], v[100:103]
s_add_u32 m0, s50, 20480
ds_read_b64_tr_b16 v[44:45], v7 offset:4096
ds_read_b64_tr_b16 v[46:47], v7 offset:6144
v_mfma_f32_16x16x32_bf16 v[100:103], v[52:55], a[84:87], v[100:103]
buffer_load_dwordx4 v18, s[32:35], s53 offen lds
v_mfma_f32_16x16x32_bf16 v[104:107], v[48:51], a[72:75], v[104:107]
v_mfma_f32_16x16x32_bf16 v[104:107], v[52:55], a[88:91], v[104:107]
buffer_load_dwordx4 v19, s[32:35], s53 offen offset:1024 lds
v_mfma_f32_16x16x32_bf16 v[108:111], v[48:51], a[76:79], v[108:111]
v_mfma_f32_16x16x32_bf16 v[108:111], v[52:55], a[92:95], v[108:111]
v_mfma_f32_16x16x32_bf16 v[112:115], v[56:59], a[64:67], v[112:115]
ds_read_b64_tr_b16 v[48:49], v8 offset:0
ds_read_b64_tr_b16 v[50:51], v8 offset:2048
v_mfma_f32_16x16x32_bf16 v[112:115], v[60:63], a[80:83], v[112:115]
buffer_load_dwordx4 v20, s[32:35], s53 offen offset:2048 lds
v_mfma_f32_16x16x32_bf16 v[116:119], v[56:59], a[68:71], v[116:119]
ds_read_b64_tr_b16 v[52:53], v8 offset:4096
ds_read_b64_tr_b16 v[54:55], v8 offset:6144
v_mfma_f32_16x16x32_bf16 v[116:119], v[60:63], a[84:87], v[116:119]
buffer_load_dwordx4 v21, s[32:35], s53 offen offset:3072 lds
v_mfma_f32_16x16x32_bf16 v[120:123], v[56:59], a[72:75], v[120:123]
v_mfma_f32_16x16x32_bf16 v[120:123], v[60:63], a[88:91], v[120:123]
v_mfma_f32_16x16x32_bf16 v[124:127], v[56:59], a[76:79], v[124:127]
v_mfma_f32_16x16x32_bf16 v[124:127], v[60:63], a[92:95], v[124:127]
s_waitcnt lgkmcnt(8)
v_mfma_f32_16x16x32_bf16 v[64:67], v[32:35], a[96:99], v[64:67]
ds_read_b64_tr_b16 v[56:57], v9 offset:0
ds_read_b64_tr_b16 v[58:59], v9 offset:2048
v_mfma_f32_16x16x32_bf16 v[64:67], v[36:39], a[112:115], v[64:67]
ds_read_b64_tr_b16 v[60:61], v9 offset:4096
ds_read_b64_tr_b16 v[62:63], v9 offset:6144
v_mfma_f32_16x16x32_bf16 v[68:71], v[32:35], a[100:103], v[68:71]
v_mfma_f32_16x16x32_bf16 v[68:71], v[36:39], a[116:119], v[68:71]
v_mfma_f32_16x16x32_bf16 v[72:75], v[32:35], a[104:107], v[72:75]
v_mfma_f32_16x16x32_bf16 v[72:75], v[36:39], a[120:123], v[72:75]
s_add_u32 s52, s46, 65664
v_mfma_f32_16x16x32_bf16 v[76:79], v[32:35], a[108:111], v[76:79]
s_add_u32 m0, s50, 0
v_mfma_f32_16x16x32_bf16 v[76:79], v[36:39], a[124:127], v[76:79]
s_waitcnt vmcnt(8) lgkmcnt(0)
v_mfma_f32_16x16x32_bf16 v[80:83], v[40:43], a[96:99], v[80:83]
ds_read_b64_tr_b16 v[32:33], v6 offset:8192
ds_read_b64_tr_b16 v[34:35], v6 offset:10240
v_mfma_f32_16x16x32_bf16 v[80:83], v[44:47], a[112:115], v[80:83]
buffer_load_dwordx4 v18, s[32:35], s52 offen lds
v_mfma_f32_16x16x32_bf16 v[84:87], v[40:43], a[100:103], v[84:87]
ds_read_b64_tr_b16 v[36:37], v6 offset:12288
ds_read_b64_tr_b16 v[38:39], v6 offset:14336
v_mfma_f32_16x16x32_bf16 v[84:87], v[44:47], a[116:119], v[84:87]
buffer_load_dwordx4 v19, s[32:35], s52 offen offset:1024 lds
v_mfma_f32_16x16x32_bf16 v[88:91], v[40:43], a[104:107], v[88:91]
v_mfma_f32_16x16x32_bf16 v[88:91], v[44:47], a[120:123], v[88:91]
buffer_load_dwordx4 v20, s[32:35], s52 offen offset:2048 lds
v_mfma_f32_16x16x32_bf16 v[92:95], v[40:43], a[108:111], v[92:95]
v_mfma_f32_16x16x32_bf16 v[92:95], v[44:47], a[124:127], v[92:95]
v_mfma_f32_16x16x32_bf16 v[96:99], v[48:51], a[96:99], v[96:99]
s_add_u32 s53, s52, 32768
ds_read_b64_tr_b16 v[40:41], v7 offset:8192
ds_read_b64_tr_b16 v[42:43], v7 offset:10240
v_mfma_f32_16x16x32_bf16 v[96:99], v[52:55], a[112:115], v[96:99]
buffer_load_dwordx4 v21, s[32:35], s52 offen offset:3072 lds
v_mfma_f32_16x16x32_bf16 v[100:103], v[48:51], a[100:103], v[100:103]
s_add_u32 m0, s50, 4096
ds_read_b64_tr_b16 v[44:45], v7 offset:12288
ds_read_b64_tr_b16 v[46:47], v7 offset:14336
v_mfma_f32_16x16x32_bf16 v[100:103], v[52:55], a[116:119], v[100:103]
buffer_load_dwordx4 v18, s[32:35], s53 offen lds
v_mfma_f32_16x16x32_bf16 v[104:107], v[48:51], a[104:107], v[104:107]
v_mfma_f32_16x16x32_bf16 v[104:107], v[52:55], a[120:123], v[104:107]
buffer_load_dwordx4 v19, s[32:35], s53 offen offset:1024 lds
v_mfma_f32_16x16x32_bf16 v[108:111], v[48:51], a[108:111], v[108:111]
v_mfma_f32_16x16x32_bf16 v[108:111], v[52:55], a[124:127], v[108:111]
v_mfma_f32_16x16x32_bf16 v[112:115], v[56:59], a[96:99], v[112:115]
ds_read_b64_tr_b16 v[48:49], v8 offset:8192
ds_read_b64_tr_b16 v[50:51], v8 offset:10240
v_mfma_f32_16x16x32_bf16 v[112:115], v[60:63], a[112:115], v[112:115]
buffer_load_dwordx4 v20, s[32:35], s53 offen offset:2048 lds
v_mfma_f32_16x16x32_bf16 v[116:119], v[56:59], a[100:103], v[116:119]
ds_read_b64_tr_b16 v[52:53], v8 offset:12288
ds_read_b64_tr_b16 v[54:55], v8 offset:14336
v_mfma_f32_16x16x32_bf16 v[116:119], v[60:63], a[116:119], v[116:119]
buffer_load_dwordx4 v21, s[32:35], s53 offen offset:3072 lds
v_mfma_f32_16x16x32_bf16 v[120:123], v[56:59], a[104:107], v[120:123]
v_mfma_f32_16x16x32_bf16 v[120:123], v[60:63], a[120:123], v[120:123]
v_mfma_f32_16x16x32_bf16 v[124:127], v[56:59], a[108:111], v[124:127]
v_mfma_f32_16x16x32_bf16 v[124:127], v[60:63], a[124:127], v[124:127]
s_waitcnt lgkmcnt(8)
v_mfma_f32_16x16x32_bf16 v[64:67], v[32:35], a[128:131], v[64:67]
ds_read_b64_tr_b16 v[56:57], v9 offset:8192
ds_read_b64_tr_b16 v[58:59], v9 offset:10240
v_mfma_f32_16x16x32_bf16 v[64:67], v[36:39], a[144:147], v[64:67]
ds_read_b64_tr_b16 v[60:61], v9 offset:12288
ds_read_b64_tr_b16 v[62:63], v9 offset:14336
v_mfma_f32_16x16x32_bf16 v[68:71], v[32:35], a[132:135], v[68:71]
v_mfma_f32_16x16x32_bf16 v[68:71], v[36:39], a[148:151], v[68:71]
v_mfma_f32_16x16x32_bf16 v[72:75], v[32:35], a[136:139], v[72:75]
v_mfma_f32_16x16x32_bf16 v[72:75], v[36:39], a[152:155], v[72:75]
s_add_u32 s52, s47, 65664
v_mfma_f32_16x16x32_bf16 v[76:79], v[32:35], a[140:143], v[76:79]
s_add_u32 m0, s50, 8192
v_mfma_f32_16x16x32_bf16 v[76:79], v[36:39], a[156:159], v[76:79]
s_waitcnt vmcnt(8) lgkmcnt(0)
v_mfma_f32_16x16x32_bf16 v[80:83], v[40:43], a[128:131], v[80:83]
ds_read_b64_tr_b16 v[32:33], v6 offset:16384
ds_read_b64_tr_b16 v[34:35], v6 offset:18432
v_mfma_f32_16x16x32_bf16 v[80:83], v[44:47], a[144:147], v[80:83]
buffer_load_dwordx4 v18, s[32:35], s52 offen lds
v_mfma_f32_16x16x32_bf16 v[84:87], v[40:43], a[132:135], v[84:87]
ds_read_b64_tr_b16 v[36:37], v6 offset:20480
ds_read_b64_tr_b16 v[38:39], v6 offset:22528
v_mfma_f32_16x16x32_bf16 v[84:87], v[44:47], a[148:151], v[84:87]
buffer_load_dwordx4 v19, s[32:35], s52 offen offset:1024 lds
v_mfma_f32_16x16x32_bf16 v[88:91], v[40:43], a[136:139], v[88:91]
v_mfma_f32_16x16x32_bf16 v[88:91], v[44:47], a[152:155], v[88:91]
buffer_load_dwordx4 v20, s[32:35], s52 offen offset:2048 lds
v_mfma_f32_16x16x32_bf16 v[92:95], v[40:43], a[140:143], v[92:95]
v_mfma_f32_16x16x32_bf16 v[92:95], v[44:47], a[156:159], v[92:95]
v_mfma_f32_16x16x32_bf16 v[96:99], v[48:51], a[128:131], v[96:99]
s_add_u32 s53, s52, 32768
ds_read_b64_tr_b16 v[40:41], v7 offset:16384
ds_read_b64_tr_b16 v[42:43], v7 offset:18432
v_mfma_f32_16x16x32_bf16 v[96:99], v[52:55], a[144:147], v[96:99]
buffer_load_dwordx4 v21, s[32:35], s52 offen offset:3072 lds
v_mfma_f32_16x16x32_bf16 v[100:103], v[48:51], a[132:135], v[100:103]
s_add_u32 m0, s50, 12288
ds_read_b64_tr_b16 v[44:45], v7 offset:20480
ds_read_b64_tr_b16 v[46:47], v7 offset:22528
v_mfma_f32_16x16x32_bf16 v[100:103], v[52:55], a[148:151], v[100:103]
buffer_load_dwordx4 v18, s[32:35], s53 offen lds
v_mfma_f32_16x16x32_bf16 v[104:107], v[48:51], a[136:139], v[104:107]
v_mfma_f32_16x16x32_bf16 v[104:107], v[52:55], a[152:155], v[104:107]
buffer_load_dwordx4 v19, s[32:35], s53 offen offset:1024 lds
v_mfma_f32_16x16x32_bf16 v[108:111], v[48:51], a[140:143], v[108:111]
v_mfma_f32_16x16x32_bf16 v[108:111], v[52:55], a[156:159], v[108:111]
v_mfma_f32_16x16x32_bf16 v[112:115], v[56:59], a[128:131], v[112:115]
ds_read_b64_tr_b16 v[48:49], v8 offset:16384
ds_read_b64_tr_b16 v[50:51], v8 offset:18432
v_mfma_f32_16x16x32_bf16 v[112:115], v[60:63], a[144:147], v[112:115]
buffer_load_dwordx4 v20, s[32:35], s53 offen offset:2048 lds
v_mfma_f32_16x16x32_bf16 v[116:119], v[56:59], a[132:135], v[116:119]
ds_read_b64_tr_b16 v[52:53], v8 offset:20480
ds_read_b64_tr_b16 v[54:55], v8 offset:22528
v_mfma_f32_16x16x32_bf16 v[116:119], v[60:63], a[148:151], v[116:119]
buffer_load_dwordx4 v21, s[32:35], s53 offen offset:3072 lds
v_mfma_f32_16x16x32_bf16 v[120:123], v[56:59], a[136:139], v[120:123]
v_mfma_f32_16x16x32_bf16 v[120:123], v[60:63], a[152:155], v[120:123]
v_mfma_f32_16x16x32_bf16 v[124:127], v[56:59], a[140:143], v[124:127]
v_mfma_f32_16x16x32_bf16 v[124:127], v[60:63], a[156:159], v[124:127]
s_waitcnt lgkmcnt(8)
v_mfma_f32_16x16x32_bf16 v[64:67], v[32:35], a[160:163], v[64:67]
ds_read_b64_tr_b16 v[56:57], v9 offset:16384
ds_read_b64_tr_b16 v[58:59], v9 offset:18432
v_mfma_f32_16x16x32_bf16 v[64:67], v[36:39], a[176:179], v[64:67]
ds_read_b64_tr_b16 v[60:61], v9 offset:20480
ds_read_b64_tr_b16 v[62:63], v9 offset:22528
v_mfma_f32_16x16x32_bf16 v[68:71], v[32:35], a[164:167], v[68:71]
v_cvt_pk_bf16_f32 v128, v128, v129
v_cvt_pk_bf16_f32 v129, v130, v131
v_mfma_f32_16x16x32_bf16 v[68:71], v[36:39], a[180:183], v[68:71]
v_cvt_pk_bf16_f32 v130, v144, v145
v_cvt_pk_bf16_f32 v131, v146, v147
v_mfma_f32_16x16x32_bf16 v[72:75], v[32:35], a[168:171], v[72:75]
buffer_store_dwordx4 v[128:131], v1, s[40:43], s72 offen offset:0 sc1
v_mfma_f32_16x16x32_bf16 v[72:75], v[36:39], a[184:187], v[72:75]
v_cvt_pk_bf16_f32 v132, v132, v133
v_cvt_pk_bf16_f32 v133, v134, v135
v_mfma_f32_16x16x32_bf16 v[76:79], v[32:35], a[172:175], v[76:79]
v_cvt_pk_bf16_f32 v134, v148, v149
v_cvt_pk_bf16_f32 v135, v150, v151
v_mfma_f32_16x16x32_bf16 v[76:79], v[36:39], a[188:191], v[76:79]
s_waitcnt vmcnt(9) lgkmcnt(0)
v_cvt_pk_bf16_f32 v136, v136, v137
v_cvt_pk_bf16_f32 v137, v138, v139
v_mfma_f32_16x16x32_bf16 v[80:83], v[40:43], a[160:163], v[80:83]
ds_read_b64_tr_b16 v[32:33], v6 offset:0
ds_read_b64_tr_b16 v[34:35], v6 offset:2048
v_mfma_f32_16x16x32_bf16 v[80:83], v[44:47], a[176:179], v[80:83]
buffer_store_dwordx4 v[132:135], v1, s[40:43], s72 offen offset:1024 sc1
v_mfma_f32_16x16x32_bf16 v[84:87], v[40:43], a[164:167], v[84:87]
ds_read_b64_tr_b16 v[36:37], v6 offset:4096
ds_read_b64_tr_b16 v[38:39], v6 offset:6144
v_mfma_f32_16x16x32_bf16 v[84:87], v[44:47], a[180:183], v[84:87]
v_cvt_pk_bf16_f32 v138, v152, v153
v_cvt_pk_bf16_f32 v139, v154, v155
v_mfma_f32_16x16x32_bf16 v[88:91], v[40:43], a[168:171], v[88:91]
v_cvt_pk_bf16_f32 v140, v140, v141
v_cvt_pk_bf16_f32 v141, v142, v143
v_mfma_f32_16x16x32_bf16 v[88:91], v[44:47], a[184:187], v[88:91]
buffer_store_dwordx4 v[136:139], v1, s[40:43], s72 offen offset:2048 sc1
v_mfma_f32_16x16x32_bf16 v[92:95], v[40:43], a[172:175], v[92:95]
v_cvt_pk_bf16_f32 v142, v156, v157
v_cvt_pk_bf16_f32 v143, v158, v159
v_mfma_f32_16x16x32_bf16 v[92:95], v[44:47], a[188:191], v[92:95]
v_cvt_pk_bf16_f32 v160, v160, v161
v_cvt_pk_bf16_f32 v161, v162, v163
v_mfma_f32_16x16x32_bf16 v[96:99], v[48:51], a[160:163], v[96:99]
ds_read_b64_tr_b16 v[40:41], v7 offset:0
ds_read_b64_tr_b16 v[42:43], v7 offset:2048
v_mfma_f32_16x16x32_bf16 v[96:99], v[52:55], a[176:179], v[96:99]
buffer_store_dwordx4 v[140:143], v1, s[40:43], s72 offen offset:3072 sc1
v_mfma_f32_16x16x32_bf16 v[100:103], v[48:51], a[164:167], v[100:103]
ds_read_b64_tr_b16 v[44:45], v7 offset:4096
ds_read_b64_tr_b16 v[46:47], v7 offset:6144
v_mfma_f32_16x16x32_bf16 v[100:103], v[52:55], a[180:183], v[100:103]
v_cvt_pk_bf16_f32 v162, v176, v177
v_cvt_pk_bf16_f32 v163, v178, v179
v_mfma_f32_16x16x32_bf16 v[104:107], v[48:51], a[168:171], v[104:107]
v_cvt_pk_bf16_f32 v164, v164, v165
v_cvt_pk_bf16_f32 v165, v166, v167
v_mfma_f32_16x16x32_bf16 v[104:107], v[52:55], a[184:187], v[104:107]
buffer_store_dwordx4 v[160:163], v1, s[40:43], s73 offen offset:0 sc1
v_mfma_f32_16x16x32_bf16 v[108:111], v[48:51], a[172:175], v[108:111]
v_cvt_pk_bf16_f32 v166, v180, v181
v_cvt_pk_bf16_f32 v167, v182, v183
v_mfma_f32_16x16x32_bf16 v[108:111], v[52:55], a[188:191], v[108:111]
v_cvt_pk_bf16_f32 v168, v168, v169
v_cvt_pk_bf16_f32 v169, v170, v171
v_mfma_f32_16x16x32_bf16 v[112:115], v[56:59], a[160:163], v[112:115]
ds_read_b64_tr_b16 v[48:49], v8 offset:0
ds_read_b64_tr_b16 v[50:51], v8 offset:2048
v_mfma_f32_16x16x32_bf16 v[112:115], v[60:63], a[176:179], v[112:115]
buffer_store_dwordx4 v[164:167], v1, s[40:43], s73 offen offset:1024 sc1
v_mfma_f32_16x16x32_bf16 v[116:119], v[56:59], a[164:167], v[116:119]
ds_read_b64_tr_b16 v[52:53], v8 offset:4096
ds_read_b64_tr_b16 v[54:55], v8 offset:6144
v_mfma_f32_16x16x32_bf16 v[116:119], v[60:63], a[180:183], v[116:119]
v_cvt_pk_bf16_f32 v170, v184, v185
v_cvt_pk_bf16_f32 v171, v186, v187
v_mfma_f32_16x16x32_bf16 v[120:123], v[56:59], a[168:171], v[120:123]
v_cvt_pk_bf16_f32 v172, v172, v173
v_cvt_pk_bf16_f32 v173, v174, v175
v_mfma_f32_16x16x32_bf16 v[120:123], v[60:63], a[184:187], v[120:123]
buffer_store_dwordx4 v[168:171], v1, s[40:43], s73 offen offset:2048 sc1
v_mfma_f32_16x16x32_bf16 v[124:127], v[56:59], a[172:175], v[124:127]
v_cvt_pk_bf16_f32 v174, v188, v189
v_cvt_pk_bf16_f32 v175, v190, v191
v_mfma_f32_16x16x32_bf16 v[124:127], v[60:63], a[188:191], v[124:127]
s_waitcnt lgkmcnt(8)
v_mfma_f32_16x16x32_bf16 v[64:67], v[32:35], a[192:195], v[64:67]
ds_read_b64_tr_b16 v[56:57], v9 offset:0
ds_read_b64_tr_b16 v[58:59], v9 offset:2048
v_mfma_f32_16x16x32_bf16 v[64:67], v[36:39], a[208:211], v[64:67]
ds_read_b64_tr_b16 v[60:61], v9 offset:4096
ds_read_b64_tr_b16 v[62:63], v9 offset:6144
v_mfma_f32_16x16x32_bf16 v[68:71], v[32:35], a[196:199], v[68:71]
buffer_store_dwordx4 v[172:175], v1, s[40:43], s73 offen offset:3072 sc1
v_mfma_f32_16x16x32_bf16 v[68:71], v[36:39], a[212:215], v[68:71]
v_mfma_f32_16x16x32_bf16 v[72:75], v[32:35], a[200:203], v[72:75]
v_mfma_f32_16x16x32_bf16 v[72:75], v[36:39], a[216:219], v[72:75]
v_mfma_f32_16x16x32_bf16 v[76:79], v[32:35], a[204:207], v[76:79]
v_mfma_f32_16x16x32_bf16 v[76:79], v[36:39], a[220:223], v[76:79]
s_waitcnt vmcnt(8) lgkmcnt(0)
v_mfma_f32_16x16x32_bf16 v[80:83], v[40:43], a[192:195], v[80:83]
ds_read_b64_tr_b16 v[32:33], v6 offset:8192
ds_read_b64_tr_b16 v[34:35], v6 offset:10240
v_mfma_f32_16x16x32_bf16 v[80:83], v[44:47], a[208:211], v[80:83]
v_mfma_f32_16x16x32_bf16 v[84:87], v[40:43], a[196:199], v[84:87]
ds_read_b64_tr_b16 v[36:37], v6 offset:12288
ds_read_b64_tr_b16 v[38:39], v6 offset:14336
v_mfma_f32_16x16x32_bf16 v[84:87], v[44:47], a[212:215], v[84:87]
v_mfma_f32_16x16x32_bf16 v[88:91], v[40:43], a[200:203], v[88:91]
v_mfma_f32_16x16x32_bf16 v[88:91], v[44:47], a[216:219], v[88:91]
v_mfma_f32_16x16x32_bf16 v[92:95], v[40:43], a[204:207], v[92:95]
v_mfma_f32_16x16x32_bf16 v[92:95], v[44:47], a[220:223], v[92:95]
v_mfma_f32_16x16x32_bf16 v[96:99], v[48:51], a[192:195], v[96:99]
ds_read_b64_tr_b16 v[40:41], v7 offset:8192
ds_read_b64_tr_b16 v[42:43], v7 offset:10240
v_mfma_f32_16x16x32_bf16 v[96:99], v[52:55], a[208:211], v[96:99]
v_mfma_f32_16x16x32_bf16 v[100:103], v[48:51], a[196:199], v[100:103]
ds_read_b64_tr_b16 v[44:45], v7 offset:12288
ds_read_b64_tr_b16 v[46:47], v7 offset:14336
v_mfma_f32_16x16x32_bf16 v[100:103], v[52:55], a[212:215], v[100:103]
v_mfma_f32_16x16x32_bf16 v[104:107], v[48:51], a[200:203], v[104:107]
v_mfma_f32_16x16x32_bf16 v[104:107], v[52:55], a[216:219], v[104:107]
v_mfma_f32_16x16x32_bf16 v[108:111], v[48:51], a[204:207], v[108:111]
v_mfma_f32_16x16x32_bf16 v[108:111], v[52:55], a[220:223], v[108:111]
v_mfma_f32_16x16x32_bf16 v[112:115], v[56:59], a[192:195], v[112:115]
ds_read_b64_tr_b16 v[48:49], v8 offset:8192
ds_read_b64_tr_b16 v[50:51], v8 offset:10240
v_mfma_f32_16x16x32_bf16 v[112:115], v[60:63], a[208:211], v[112:115]
v_mfma_f32_16x16x32_bf16 v[116:119], v[56:59], a[196:199], v[116:119]
ds_read_b64_tr_b16 v[52:53], v8 offset:12288
ds_read_b64_tr_b16 v[54:55], v8 offset:14336
v_mfma_f32_16x16x32_bf16 v[116:119], v[60:63], a[212:215], v[116:119]
v_mfma_f32_16x16x32_bf16 v[120:123], v[56:59], a[200:203], v[120:123]
v_mfma_f32_16x16x32_bf16 v[120:123], v[60:63], a[216:219], v[120:123]
v_mfma_f32_16x16x32_bf16 v[124:127], v[56:59], a[204:207], v[124:127]
v_mfma_f32_16x16x32_bf16 v[124:127], v[60:63], a[220:223], v[124:127]
s_waitcnt lgkmcnt(8)
v_mfma_f32_16x16x32_bf16 v[64:67], v[32:35], a[224:227], v[64:67]
ds_read_b64_tr_b16 v[56:57], v9 offset:8192
ds_read_b64_tr_b16 v[58:59], v9 offset:10240
v_mfma_f32_16x16x32_bf16 v[64:67], v[36:39], a[240:243], v[64:67]
ds_read_b64_tr_b16 v[60:61], v9 offset:12288
ds_read_b64_tr_b16 v[62:63], v9 offset:14336
v_mfma_f32_16x16x32_bf16 v[68:71], v[32:35], a[228:231], v[68:71]
v_mfma_f32_16x16x32_bf16 v[68:71], v[36:39], a[244:247], v[68:71]
v_mfma_f32_16x16x32_bf16 v[72:75], v[32:35], a[232:235], v[72:75]
v_mfma_f32_16x16x32_bf16 v[72:75], v[36:39], a[248:251], v[72:75]
v_mfma_f32_16x16x32_bf16 v[76:79], v[32:35], a[236:239], v[76:79]
v_mfma_f32_16x16x32_bf16 v[76:79], v[36:39], a[252:255], v[76:79]
s_waitcnt lgkmcnt(8)
v_mfma_f32_16x16x32_bf16 v[80:83], v[40:43], a[224:227], v[80:83]
v_mfma_f32_16x16x32_bf16 v[80:83], v[44:47], a[240:243], v[80:83]
v_mfma_f32_16x16x32_bf16 v[84:87], v[40:43], a[228:231], v[84:87]
v_mfma_f32_16x16x32_bf16 v[84:87], v[44:47], a[244:247], v[84:87]
v_mfma_f32_16x16x32_bf16 v[88:91], v[40:43], a[232:235], v[88:91]
v_mfma_f32_16x16x32_bf16 v[88:91], v[44:47], a[248:251], v[88:91]
v_mfma_f32_16x16x32_bf16 v[92:95], v[40:43], a[236:239], v[92:95]
v_mfma_f32_16x16x32_bf16 v[92:95], v[44:47], a[252:255], v[92:95]
s_waitcnt lgkmcnt(4)
v_mfma_f32_16x16x32_bf16 v[96:99], v[48:51], a[224:227], v[96:99]
v_mfma_f32_16x16x32_bf16 v[96:99], v[52:55], a[240:243], v[96:99]
v_mfma_f32_16x16x32_bf16 v[100:103], v[48:51], a[228:231], v[100:103]
v_cvt_pk_bf16_f32 v64, v64, v65
v_cvt_pk_bf16_f32 v65, v66, v67
v_mfma_f32_16x16x32_bf16 v[100:103], v[52:55], a[244:247], v[100:103]
v_cvt_pk_bf16_f32 v66, v80, v81
v_cvt_pk_bf16_f32 v67, v82, v83
v_mfma_f32_16x16x32_bf16 v[104:107], v[48:51], a[232:235], v[104:107]
buffer_store_dwordx4 v[64:67], v1, s[40:43], s74 offen offset:0 sc1
v_mfma_f32_16x16x32_bf16 v[104:107], v[52:55], a[248:251], v[104:107]
v_cvt_pk_bf16_f32 v68, v68, v69
v_cvt_pk_bf16_f32 v69, v70, v71
v_mfma_f32_16x16x32_bf16 v[108:111], v[48:51], a[236:239], v[108:111]
v_cvt_pk_bf16_f32 v70, v84, v85
v_cvt_pk_bf16_f32 v71, v86, v87
v_mfma_f32_16x16x32_bf16 v[108:111], v[52:55], a[252:255], v[108:111]
s_waitcnt lgkmcnt(0)
v_cvt_pk_bf16_f32 v72, v72, v73
v_cvt_pk_bf16_f32 v73, v74, v75
v_mfma_f32_16x16x32_bf16 v[112:115], v[56:59], a[224:227], v[112:115]
buffer_store_dwordx4 v[68:71], v1, s[40:43], s74 offen offset:1024 sc1
v_mfma_f32_16x16x32_bf16 v[112:115], v[60:63], a[240:243], v[112:115]
v_cvt_pk_bf16_f32 v74, v88, v89
v_cvt_pk_bf16_f32 v75, v90, v91
v_mfma_f32_16x16x32_bf16 v[116:119], v[56:59], a[228:231], v[116:119]
v_cvt_pk_bf16_f32 v76, v76, v77
v_cvt_pk_bf16_f32 v77, v78, v79
v_mfma_f32_16x16x32_bf16 v[116:119], v[60:63], a[244:247], v[116:119]
v_cvt_pk_bf16_f32 v78, v92, v93
v_cvt_pk_bf16_f32 v79, v94, v95
v_mfma_f32_16x16x32_bf16 v[120:123], v[56:59], a[232:235], v[120:123]
buffer_store_dwordx4 v[72:75], v1, s[40:43], s74 offen offset:2048 sc1
v_mfma_f32_16x16x32_bf16 v[120:123], v[60:63], a[248:251], v[120:123]
v_mfma_f32_16x16x32_bf16 v[124:127], v[56:59], a[236:239], v[124:127]
v_mfma_f32_16x16x32_bf16 v[124:127], v[60:63], a[252:255], v[124:127]
buffer_store_dwordx4 v[76:79], v1, s[40:43], s74 offen offset:3072 sc1
s_nop 5
v_cvt_pk_bf16_f32 v96, v96, v97
v_cvt_pk_bf16_f32 v97, v98, v99
v_cvt_pk_bf16_f32 v98, v112, v113
v_cvt_pk_bf16_f32 v99, v114, v115
buffer_store_dwordx4 v[96:99], v1, s[40:43], s75 offen offset:0 sc1
v_cvt_pk_bf16_f32 v100, v100, v101
v_cvt_pk_bf16_f32 v101, v102, v103
v_cvt_pk_bf16_f32 v102, v116, v117
v_cvt_pk_bf16_f32 v103, v118, v119
buffer_store_dwordx4 v[100:103], v1, s[40:43], s75 offen offset:1024 sc1
v_cvt_pk_bf16_f32 v104, v104, v105
v_cvt_pk_bf16_f32 v105, v106, v107
v_cvt_pk_bf16_f32 v106, v120, v121
v_cvt_pk_bf16_f32 v107, v122, v123
buffer_store_dwordx4 v[104:107], v1, s[40:43], s75 offen offset:2048 sc1
v_cvt_pk_bf16_f32 v108, v108, v109
v_cvt_pk_bf16_f32 v109, v110, v111
v_cvt_pk_bf16_f32 v110, v124, v125
v_cvt_pk_bf16_f32 v111, v126, v127
buffer_store_dwordx4 v[108:111], v1, s[40:43], s75 offen offset:3072 sc1
s_mov_b32 s44, 0xffff0000
s_mov_b32 s45, 0xbfb8aa3b
v_lshlrev_b32 v40, 16, v192
v_and_b32 v41, s44, v192
v_lshlrev_b32 v42, 16, v193
v_and_b32 v43, s44, v193
v_lshlrev_b32 v44, 16, v194
v_and_b32 v45, s44, v194
v_lshlrev_b32 v46, 16, v195
v_and_b32 v47, s44, v195
v_lshlrev_b32 v56, 16, v196
v_and_b32 v57, s44, v196
v_lshlrev_b32 v58, 16, v197
v_and_b32 v59, s44, v197
v_lshlrev_b32 v60, 16, v198
v_and_b32 v61, s44, v198
v_lshlrev_b32 v62, 16, v199
v_and_b32 v63, s44, v199
v_pk_add_f32 v[40:41], v[40:41], v[56:57]
v_pk_add_f32 v[42:43], v[42:43], v[58:59]
v_pk_add_f32 v[44:45], v[44:45], v[60:61]
v_pk_add_f32 v[46:47], v[46:47], v[62:63]
v_lshlrev_b32 v56, 16, v200
v_and_b32 v57, s44, v200
v_lshlrev_b32 v58, 16, v201
v_and_b32 v59, s44, v201
v_lshlrev_b32 v60, 16, v202
v_and_b32 v61, s44, v202
v_lshlrev_b32 v62, 16, v203
v_and_b32 v63, s44, v203
v_pk_add_f32 v[40:41], v[40:41], v[56:57]
v_pk_add_f32 v[42:43], v[42:43], v[58:59]
v_pk_add_f32 v[44:45], v[44:45], v[60:61]
v_pk_add_f32 v[46:47], v[46:47], v[62:63]
v_lshlrev_b32 v56, 16, v204
v_and_b32 v57, s44, v204
v_lshlrev_b32 v58, 16, v205
v_and_b32 v59, s44, v205
v_lshlrev_b32 v60, 16, v206
v_and_b32 v61, s44, v206
v_lshlrev_b32 v62, 16, v207
v_and_b32 v63, s44, v207
v_pk_add_f32 v[40:41], v[40:41], v[56:57]
v_pk_add_f32 v[42:43], v[42:43], v[58:59]
v_pk_add_f32 v[44:45], v[44:45], v[60:61]
v_pk_add_f32 v[46:47], v[46:47], v[62:63]
v_lshlrev_b32 v56, 16, v208
v_and_b32 v57, s44, v208
v_lshlrev_b32 v58, 16, v209
v_and_b32 v59, s44, v209
v_lshlrev_b32 v60, 16, v210
v_and_b32 v61, s44, v210
v_lshlrev_b32 v62, 16, v211
v_and_b32 v63, s44, v211
v_pk_add_f32 v[40:41], v[40:41], v[56:57]
v_pk_add_f32 v[42:43], v[42:43], v[58:59]
v_pk_add_f32 v[44:45], v[44:45], v[60:61]
v_pk_add_f32 v[46:47], v[46:47], v[62:63]
v_lshlrev_b32 v56, 16, v212
v_and_b32 v57, s44, v212
v_lshlrev_b32 v58, 16, v213
v_and_b32 v59, s44, v213
v_lshlrev_b32 v60, 16, v214
v_and_b32 v61, s44, v214
v_lshlrev_b32 v62, 16, v215
v_and_b32 v63, s44, v215
v_pk_add_f32 v[40:41], v[40:41], v[56:57]
v_pk_add_f32 v[42:43], v[42:43], v[58:59]
v_pk_add_f32 v[44:45], v[44:45], v[60:61]
v_pk_add_f32 v[46:47], v[46:47], v[62:63]
v_lshlrev_b32 v56, 16, v216
v_and_b32 v57, s44, v216
v_lshlrev_b32 v58, 16, v217
v_and_b32 v59, s44, v217
v_lshlrev_b32 v60, 16, v218
v_and_b32 v61, s44, v218
v_lshlrev_b32 v62, 16, v219
v_and_b32 v63, s44, v219
v_pk_add_f32 v[40:41], v[40:41], v[56:57]
v_pk_add_f32 v[42:43], v[42:43], v[58:59]
v_pk_add_f32 v[44:45], v[44:45], v[60:61]
v_pk_add_f32 v[46:47], v[46:47], v[62:63]
v_lshlrev_b32 v56, 16, v220
v_and_b32 v57, s44, v220
v_lshlrev_b32 v58, 16, v221
v_and_b32 v59, s44, v221
v_lshlrev_b32 v60, 16, v222
v_and_b32 v61, s44, v222
v_lshlrev_b32 v62, 16, v223
v_and_b32 v63, s44, v223
v_pk_add_f32 v[40:41], v[40:41], v[56:57]
v_pk_add_f32 v[42:43], v[42:43], v[58:59]
v_pk_add_f32 v[44:45], v[44:45], v[60:61]
v_pk_add_f32 v[46:47], v[46:47], v[62:63]
v_lshlrev_b32 v48, 16, v224
v_and_b32 v49, s44, v224
v_lshlrev_b32 v50, 16, v225
v_and_b32 v51, s44, v225
v_lshlrev_b32 v52, 16, v226
v_and_b32 v53, s44, v226
v_lshlrev_b32 v54, 16, v227
v_and_b32 v55, s44, v227
v_lshlrev_b32 v56, 16, v228
v_and_b32 v57, s44, v228
v_lshlrev_b32 v58, 16, v229
v_and_b32 v59, s44, v229
v_lshlrev_b32 v60, 16, v230
v_and_b32 v61, s44, v230
v_lshlrev_b32 v62, 16, v231
v_and_b32 v63, s44, v231
v_pk_add_f32 v[48:49], v[48:49], v[56:57]
v_pk_add_f32 v[50:51], v[50:51], v[58:59]
v_pk_add_f32 v[52:53], v[52:53], v[60:61]
v_pk_add_f32 v[54:55], v[54:55], v[62:63]
v_lshlrev_b32 v56, 16, v232
v_and_b32 v57, s44, v232
v_lshlrev_b32 v58, 16, v233
v_and_b32 v59, s44, v233
v_lshlrev_b32 v60, 16, v234
v_and_b32 v61, s44, v234
v_lshlrev_b32 v62, 16, v235
v_and_b32 v63, s44, v235
v_pk_add_f32 v[48:49], v[48:49], v[56:57]
v_pk_add_f32 v[50:51], v[50:51], v[58:59]
v_pk_add_f32 v[52:53], v[52:53], v[60:61]
v_pk_add_f32 v[54:55], v[54:55], v[62:63]
v_lshlrev_b32 v56, 16, v236
v_and_b32 v57, s44, v236
v_lshlrev_b32 v58, 16, v237
v_and_b32 v59, s44, v237
v_lshlrev_b32 v60, 16, v238
v_and_b32 v61, s44, v238
v_lshlrev_b32 v62, 16, v239
v_and_b32 v63, s44, v239
v_pk_add_f32 v[48:49], v[48:49], v[56:57]
v_pk_add_f32 v[50:51], v[50:51], v[58:59]
v_pk_add_f32 v[52:53], v[52:53], v[60:61]
v_pk_add_f32 v[54:55], v[54:55], v[62:63]
v_lshlrev_b32 v56, 16, v240
v_and_b32 v57, s44, v240
v_lshlrev_b32 v58, 16, v241
v_and_b32 v59, s44, v241
v_lshlrev_b32 v60, 16, v242
v_and_b32 v61, s44, v242
v_lshlrev_b32 v62, 16, v243
v_and_b32 v63, s44, v243
v_pk_add_f32 v[48:49], v[48:49], v[56:57]
v_pk_add_f32 v[50:51], v[50:51], v[58:59]
v_pk_add_f32 v[52:53], v[52:53], v[60:61]
v_pk_add_f32 v[54:55], v[54:55], v[62:63]
v_lshlrev_b32 v56, 16, v244
v_and_b32 v57, s44, v244
v_lshlrev_b32 v58, 16, v245
v_and_b32 v59, s44, v245
v_lshlrev_b32 v60, 16, v246
v_and_b32 v61, s44, v246
v_lshlrev_b32 v62, 16, v247
v_and_b32 v63, s44, v247
v_pk_add_f32 v[48:49], v[48:49], v[56:57]
v_pk_add_f32 v[50:51], v[50:51], v[58:59]
v_pk_add_f32 v[52:53], v[52:53], v[60:61]
v_pk_add_f32 v[54:55], v[54:55], v[62:63]
v_lshlrev_b32 v56, 16, v248
v_and_b32 v57, s44, v248
v_lshlrev_b32 v58, 16, v249
v_and_b32 v59, s44, v249
v_lshlrev_b32 v60, 16, v250
v_and_b32 v61, s44, v250
v_lshlrev_b32 v62, 16, v251
v_and_b32 v63, s44, v251
v_pk_add_f32 v[48:49], v[48:49], v[56:57]
v_pk_add_f32 v[50:51], v[50:51], v[58:59]
v_pk_add_f32 v[52:53], v[52:53], v[60:61]
v_pk_add_f32 v[54:55], v[54:55], v[62:63]
v_lshlrev_b32 v56, 16, v252
v_and_b32 v57, s44, v252
v_lshlrev_b32 v58, 16, v253
v_and_b32 v59, s44, v253
v_lshlrev_b32 v60, 16, v254
v_and_b32 v61, s44, v254
v_lshlrev_b32 v62, 16, v255
v_and_b32 v63, s44, v255
v_pk_add_f32 v[48:49], v[48:49], v[56:57]
v_pk_add_f32 v[50:51], v[50:51], v[58:59]
v_pk_add_f32 v[52:53], v[52:53], v[60:61]
v_pk_add_f32 v[54:55], v[54:55], v[62:63]
v_mul_f32 v56, s45, v40
v_mul_f32 v57, s45, v41
v_mul_f32 v58, s45, v42
v_mul_f32 v59, s45, v43
v_mul_f32 v60, s45, v44
v_mul_f32 v61, s45, v45
v_mul_f32 v62, s45, v46
v_mul_f32 v63, s45, v47
v_exp_f32 v56, v56
v_exp_f32 v57, v57
v_exp_f32 v58, v58
v_exp_f32 v59, v59
v_exp_f32 v60, v60
v_exp_f32 v61, v61
v_exp_f32 v62, v62
v_exp_f32 v63, v63
v_add_f32 v56, 1.0, v56
v_add_f32 v57, 1.0, v57
v_add_f32 v58, 1.0, v58
v_add_f32 v59, 1.0, v59
v_add_f32 v60, 1.0, v60
v_add_f32 v61, 1.0, v61
v_add_f32 v62, 1.0, v62
v_add_f32 v63, 1.0, v63
v_rcp_f32 v56, v56
v_rcp_f32 v57, v57
v_rcp_f32 v58, v58
v_rcp_f32 v59, v59
v_rcp_f32 v60, v60
v_rcp_f32 v61, v61
v_rcp_f32 v62, v62
v_rcp_f32 v63, v63
v_mul_f32 v192, v40, v56
v_mul_f32 v193, v41, v57
v_mul_f32 v194, v42, v58
v_mul_f32 v195, v43, v59
v_mul_f32 v196, v44, v60
v_mul_f32 v197, v45, v61
v_mul_f32 v198, v46, v62
v_mul_f32 v199, v47, v63
v_mul_f32 v56, s45, v48
v_mul_f32 v57, s45, v49
v_mul_f32 v58, s45, v50
v_mul_f32 v59, s45, v51
v_mul_f32 v60, s45, v52
v_mul_f32 v61, s45, v53
v_mul_f32 v62, s45, v54
v_mul_f32 v63, s45, v55
v_exp_f32 v56, v56
v_exp_f32 v57, v57
v_exp_f32 v58, v58
v_exp_f32 v59, v59
v_exp_f32 v60, v60
v_exp_f32 v61, v61
v_exp_f32 v62, v62
v_exp_f32 v63, v63
v_add_f32 v56, 1.0, v56
v_add_f32 v57, 1.0, v57
v_add_f32 v58, 1.0, v58
v_add_f32 v59, 1.0, v59
v_add_f32 v60, 1.0, v60
v_add_f32 v61, 1.0, v61
v_add_f32 v62, 1.0, v62
v_add_f32 v63, 1.0, v63
v_rcp_f32 v56, v56
v_rcp_f32 v57, v57
v_rcp_f32 v58, v58
v_rcp_f32 v59, v59
v_rcp_f32 v60, v60
v_rcp_f32 v61, v61
v_rcp_f32 v62, v62
v_rcp_f32 v63, v63
v_mul_f32 v224, v48, v56
v_mul_f32 v225, v49, v57
v_mul_f32 v226, v50, v58
v_mul_f32 v227, v51, v59
v_mul_f32 v228, v52, v60
v_mul_f32 v229, v53, v61
v_mul_f32 v230, v54, v62
v_mul_f32 v231, v55, v63
v_mov_b32 v32, 0
v_mov_b32 v33, 0
s_cmp_lg_u32 s3, 0
s_cbranch_scc1 L_e_nz
ds_write_b32 v32, v33
L_e_nz:
s_waitcnt vmcnt(0) lgkmcnt(0)
s_barrier
s_mov_b32 s84, 0
s_mov_b32 s85, 0
s_mov_b32 s49, 0
s_lshl_b32 s46, s5, 3
s_lshl_b32 s47, 1, s4
v_mov_b32 v34, s47
s_cmp_lg_u32 s3, 0
s_cbranch_scc1 L_e_nosig
s_mov_b64 exec, 1
buffer_atomic_or v34, v11, s[68:71], 0 offen sc0
s_mov_b64 exec, -1
L_e_nosig:
s_mov_b32 s83, 0
s_waitcnt vmcnt(0)
s_cmp_lg_u32 s3, 0
s_cbranch_scc1 L_e_other
v_readfirstlane_b32 s1, v34
s_nop 0
s_or_b32 s1, s1, s47
s_and_b32 s47, s1, 0xff
s_cmp_eq_u32 s47, 0xff
s_cbranch_scc1 L_e_pub
L_e_w0:
s_nop 0
s_or_b32 s1, s1, s84
s_and_b32 s1, s1, 0xff
L_e_pub:
s_and_b32 s1, s1, 0xff00ff
v_mov_b32 v33, s1
ds_write_b32 v32, v33
s_branch L_e_have
L_e_other:
ds_read_b32 v33, v32
s_waitcnt lgkmcnt(0)
v_readfirstlane_b32 s1, v33
s_nop 0
s_bitcmp1_b32 s1, 31
s_cbranch_scc1 L_e_exit
L_e_have:
s_andn2_b32 s47, s1, s84
s_bitcmp1_b32 s47, 0
s_cbranch_scc0 L_e_s0
s_add_u32 s0, s62, 0
buffer_load_dwordx4 v[128:131], v1, s[40:43], s0 offen sc1
buffer_load_dwordx4 v[160:163], v1, s[40:43], s0 offen offset:1024 sc1
L_e_s0:
s_bitcmp1_b32 s47, 1
s_cbranch_scc0 L_e_s1
s_add_u32 s0, s62, 2097152
buffer_load_dwordx4 v[132:135], v1, s[40:43], s0 offen sc1
buffer_load_dwordx4 v[164:167], v1, s[40:43], s0 offen offset:1024 sc1
L_e_s1:
s_bitcmp1_b32 s47, 2
s_cbranch_scc0 L_e_s2
s_add_u32 s0, s62, 4194304
buffer_load_dwordx4 v[136:139], v1, s[40:43], s0 offen sc1
buffer_load_dwordx4 v[168:171], v1, s[40:43], s0 offen offset:1024 sc1
L_e_s2:
s_bitcmp1_b32 s47, 3
s_cbranch_scc0 L_e_s3
s_add_u32 s0, s62, 6291456
buffer_load_dwordx4 v[140:143], v1, s[40:43], s0 offen sc1
buffer_load_dwordx4 v[172:175], v1, s[40:43], s0 offen offset:1024 sc1
L_e_s3:
s_bitcmp1_b32 s47, 4
s_cbranch_scc0 L_e_s4
s_add_u32 s0, s62, 8388608
buffer_load_dwordx4 v[144:147], v1, s[40:43], s0 offen sc1
buffer_load_dwordx4 v[176:179], v1, s[40:43], s0 offen offset:1024 sc1
L_e_s4:
s_bitcmp1_b32 s47, 5
s_cbranch_scc0 L_e_s5
s_add_u32 s0, s62, 10485760
buffer_load_dwordx4 v[148:151], v1, s[40:43], s0 offen sc1
buffer_load_dwordx4 v[180:183], v1, s[40:43], s0 offen offset:1024 sc1
L_e_s5:
s_bitcmp1_b32 s47, 6
s_cbranch_scc0 L_e_s6
s_add_u32 s0, s62, 12582912
buffer_load_dwordx4 v[152:155], v1, s[40:43], s0 offen sc1
buffer_load_dwordx4 v[184:187], v1, s[40:43], s0 offen offset:1024 sc1
L_e_s6:
s_bitcmp1_b32 s47, 7
s_cbranch_scc0 L_e_s7
s_add_u32 s0, s62, 14680064
buffer_load_dwordx4 v[156:159], v1, s[40:43], s0 offen sc1
buffer_load_dwordx4 v[188:191], v1, s[40:43], s0 offen offset:1024 sc1
L_e_s7:
s_or_b32 s84, s84, s1
s_and_b32 s47, s84, 0xff
s_cmp_eq_u32 s47, 0xff
s_cbranch_scc1 L_e_all
s_cmp_lg_u32 s3, 0
s_cbranch_scc0 L_e_poll
s_sleep 1
s_branch L_e_other
L_e_poll:
s_add_u32 s49, s49, 1
s_cmp_gt_u32 s49, 30000
s_cbranch_scc1 L_e_abandon
s_sleep 8
buffer_load_dword v34, off, s[68:71], s46 sc1
s_waitcnt vmcnt(0)
v_readfirstlane_b32 s1, v34
s_branch L_e_w0
L_e_abandon:
s_lshl_b32 s47, 0x10000, s4
v_mov_b32 v34, s47
s_mov_b64 exec, 1
buffer_atomic_or v34, v11, s[68:71], 0 offen sc0
s_waitcnt vmcnt(0)
v_readfirstlane_b32 s1, v34
s_mov_b64 exec, -1
s_nop 0
s_and_b32 s47, s1, 0xff
s_cmp_eq_u32 s47, 0xff
s_cbranch_scc1 L_e_w0
v_mov_b32 v33, 0x80000000
ds_write_b32 v32, v33
s_waitcnt lgkmcnt(0)
s_branch L_e_exit
L_e_all:
s_lshr_b32 s85, s1, 16
L_e_fin:
s_cmp_eq_u32 s61, 0
s_cbranch_scc1 L_e_nolate
s_add_u32 s0, s62, 16777216
buffer_load_dwordx4 v[192:195], v1, s[40:43], s0 offen sc1
buffer_load_dwordx4 v[224:227], v1, s[40:43], s0 offen offset:1024 sc1
s_add_u32 s0, s62, 18874368
buffer_load_dwordx4 v[196:199], v1, s[40:43], s0 offen sc1
buffer_load_dwordx4 v[228:231], v1, s[40:43], s0 offen offset:1024 sc1
s_add_u32 s0, s62, 20971520
buffer_load_dwordx4 v[200:203], v1, s[40:43], s0 offen sc1
buffer_load_dwordx4 v[232:235], v1, s[40:43], s0 offen offset:1024 sc1
s_add_u32 s0, s62, 23068672
buffer_load_dwordx4 v[204:207], v1, s[40:43], s0 offen sc1
buffer_load_dwordx4 v[236:239], v1, s[40:43], s0 offen offset:1024 sc1
s_add_u32 s0, s62, 25165824
buffer_load_dwordx4 v[208:211], v1, s[40:43], s0 offen sc1
buffer_load_dwordx4 v[240:243], v1, s[40:43], s0 offen offset:1024 sc1
s_add_u32 s0, s62, 27262976
buffer_load_dwordx4 v[212:215], v1, s[40:43], s0 offen sc1
buffer_load_dwordx4 v[244:247], v1, s[40:43], s0 offen offset:1024 sc1
s_add_u32 s0, s62, 29360128
buffer_load_dwordx4 v[216:219], v1, s[40:43], s0 offen sc1
buffer_load_dwordx4 v[248:251], v1, s[40:43], s0 offen offset:1024 sc1
s_add_u32 s0, s62, 31457280
buffer_load_dwordx4 v[220:223], v1, s[40:43], s0 offen sc1
buffer_load_dwordx4 v[252:255], v1, s[40:43], s0 offen offset:1024 sc1
s_add_u32 s0, s63, 0
buffer_load_dwordx2 v[2:3], v10, s[36:39], s0 offen offset:0
buffer_load_dwordx2 v[4:5], v10, s[36:39], s0 offen offset:32
s_add_u32 s0, s63, 16384
buffer_load_dwordx2 v[12:13], v10, s[36:39], s0 offen offset:0
buffer_load_dwordx2 v[14:15], v10, s[36:39], s0 offen offset:32
s_waitcnt vmcnt(0)
s_mov_b32 s44, 0xffff0000
s_mov_b32 s45, 0xbfb8aa3b
v_lshlrev_b32 v40, 16, v192
v_and_b32 v41, s44, v192
v_lshlrev_b32 v42, 16, v193
v_and_b32 v43, s44, v193
v_lshlrev_b32 v44, 16, v194
v_and_b32 v45, s44, v194
v_lshlrev_b32 v46, 16, v195
v_and_b32 v47, s44, v195
v_lshlrev_b32 v56, 16, v196
v_and_b32 v57, s44, v196
v_lshlrev_b32 v58, 16, v197
v_and_b32 v59, s44, v197
v_lshlrev_b32 v60, 16, v198
v_and_b32 v61, s44, v198
v_lshlrev_b32 v62, 16, v199
v_and_b32 v63, s44, v199
v_pk_add_f32 v[40:41], v[40:41], v[56:57]
v_pk_add_f32 v[42:43], v[42:43], v[58:59]
v_pk_add_f32 v[44:45], v[44:45], v[60:61]
v_pk_add_f32 v[46:47], v[46:47], v[62:63]
v_lshlrev_b32 v56, 16, v200
v_and_b32 v57, s44, v200
v_lshlrev_b32 v58, 16, v201
v_and_b32 v59, s44, v201
v_lshlrev_b32 v60, 16, v202
v_and_b32 v61, s44, v202
v_lshlrev_b32 v62, 16, v203
v_and_b32 v63, s44, v203
v_pk_add_f32 v[40:41], v[40:41], v[56:57]
v_pk_add_f32 v[42:43], v[42:43], v[58:59]
v_pk_add_f32 v[44:45], v[44:45], v[60:61]
v_pk_add_f32 v[46:47], v[46:47], v[62:63]
v_lshlrev_b32 v56, 16, v204
v_and_b32 v57, s44, v204
v_lshlrev_b32 v58, 16, v205
v_and_b32 v59, s44, v205
v_lshlrev_b32 v60, 16, v206
v_and_b32 v61, s44, v206
v_lshlrev_b32 v62, 16, v207
v_and_b32 v63, s44, v207
v_pk_add_f32 v[40:41], v[40:41], v[56:57]
v_pk_add_f32 v[42:43], v[42:43], v[58:59]
v_pk_add_f32 v[44:45], v[44:45], v[60:61]
v_pk_add_f32 v[46:47], v[46:47], v[62:63]
v_lshlrev_b32 v56, 16, v208
v_and_b32 v57, s44, v208
v_lshlrev_b32 v58, 16, v209
v_and_b32 v59, s44, v209
v_lshlrev_b32 v60, 16, v210
v_and_b32 v61, s44, v210
v_lshlrev_b32 v62, 16, v211
v_and_b32 v63, s44, v211
v_pk_add_f32 v[40:41], v[40:41], v[56:57]
v_pk_add_f32 v[42:43], v[42:43], v[58:59]
v_pk_add_f32 v[44:45], v[44:45], v[60:61]
v_pk_add_f32 v[46:47], v[46:47], v[62:63]
v_lshlrev_b32 v56, 16, v212
v_and_b32 v57, s44, v212
v_lshlrev_b32 v58, 16, v213
v_and_b32 v59, s44, v213
v_lshlrev_b32 v60, 16, v214
v_and_b32 v61, s44, v214
v_lshlrev_b32 v62, 16, v215
v_and_b32 v63, s44, v215
v_pk_add_f32 v[40:41], v[40:41], v[56:57]
v_pk_add_f32 v[42:43], v[42:43], v[58:59]
v_pk_add_f32 v[44:45], v[44:45], v[60:61]
v_pk_add_f32 v[46:47], v[46:47], v[62:63]
v_lshlrev_b32 v56, 16, v216
v_and_b32 v57, s44, v216
v_lshlrev_b32 v58, 16, v217
v_and_b32 v59, s44, v217
v_lshlrev_b32 v60, 16, v218
v_and_b32 v61, s44, v218
v_lshlrev_b32 v62, 16, v219
v_and_b32 v63, s44, v219
v_pk_add_f32 v[40:41], v[40:41], v[56:57]
v_pk_add_f32 v[42:43], v[42:43], v[58:59]
v_pk_add_f32 v[44:45], v[44:45], v[60:61]
v_pk_add_f32 v[46:47], v[46:47], v[62:63]
v_lshlrev_b32 v56, 16, v220
v_and_b32 v57, s44, v220
v_lshlrev_b32 v58, 16, v221
v_and_b32 v59, s44, v221
v_lshlrev_b32 v60, 16, v222
v_and_b32 v61, s44, v222
v_lshlrev_b32 v62, 16, v223
v_and_b32 v63, s44, v223
v_pk_add_f32 v[40:41], v[40:41], v[56:57]
v_pk_add_f32 v[42:43], v[42:43], v[58:59]
v_pk_add_f32 v[44:45], v[44:45], v[60:61]
v_pk_add_f32 v[46:47], v[46:47], v[62:63]
v_lshlrev_b32 v48, 16, v224
v_and_b32 v49, s44, v224
v_lshlrev_b32 v50, 16, v225
v_and_b32 v51, s44, v225
v_lshlrev_b32 v52, 16, v226
v_and_b32 v53, s44, v226
v_lshlrev_b32 v54, 16, v227
v_and_b32 v55, s44, v227
v_lshlrev_b32 v56, 16, v228
v_and_b32 v57, s44, v228
v_lshlrev_b32 v58, 16, v229
v_and_b32 v59, s44, v229
v_lshlrev_b32 v60, 16, v230
v_and_b32 v61, s44, v230
v_lshlrev_b32 v62, 16, v231
v_and_b32 v63, s44, v231
v_pk_add_f32 v[48:49], v[48:49], v[56:57]
v_pk_add_f32 v[50:51], v[50:51], v[58:59]
v_pk_add_f32 v[52:53], v[52:53], v[60:61]
v_pk_add_f32 v[54:55], v[54:55], v[62:63]
v_lshlrev_b32 v56, 16, v232
v_and_b32 v57, s44, v232
v_lshlrev_b32 v58, 16, v233
v_and_b32 v59, s44, v233
v_lshlrev_b32 v60, 16, v234
v_and_b32 v61, s44, v234
v_lshlrev_b32 v62, 16, v235
v_and_b32 v63, s44, v235
v_pk_add_f32 v[48:49], v[48:49], v[56:57]
v_pk_add_f32 v[50:51], v[50:51], v[58:59]
v_pk_add_f32 v[52:53], v[52:53], v[60:61]
v_pk_add_f32 v[54:55], v[54:55], v[62:63]
v_lshlrev_b32 v56, 16, v236
v_and_b32 v57, s44, v236
v_lshlrev_b32 v58, 16, v237
v_and_b32 v59, s44, v237
v_lshlrev_b32 v60, 16, v238
v_and_b32 v61, s44, v238
v_lshlrev_b32 v62, 16, v239
v_and_b32 v63, s44, v239
v_pk_add_f32 v[48:49], v[48:49], v[56:57]
v_pk_add_f32 v[50:51], v[50:51], v[58:59]
v_pk_add_f32 v[52:53], v[52:53], v[60:61]
v_pk_add_f32 v[54:55], v[54:55], v[62:63]
v_lshlrev_b32 v56, 16, v240
v_and_b32 v57, s44, v240
v_lshlrev_b32 v58, 16, v241
v_and_b32 v59, s44, v241
v_lshlrev_b32 v60, 16, v242
v_and_b32 v61, s44, v242
v_lshlrev_b32 v62, 16, v243
v_and_b32 v63, s44, v243
v_pk_add_f32 v[48:49], v[48:49], v[56:57]
v_pk_add_f32 v[50:51], v[50:51], v[58:59]
v_pk_add_f32 v[52:53], v[52:53], v[60:61]
v_pk_add_f32 v[54:55], v[54:55], v[62:63]
v_lshlrev_b32 v56, 16, v244
v_and_b32 v57, s44, v244
v_lshlrev_b32 v58, 16, v245
v_and_b32 v59, s44, v245
v_lshlrev_b32 v60, 16, v246
v_and_b32 v61, s44, v246
v_lshlrev_b32 v62, 16, v247
v_and_b32 v63, s44, v247
v_pk_add_f32 v[48:49], v[48:49], v[56:57]
v_pk_add_f32 v[50:51], v[50:51], v[58:59]
v_pk_add_f32 v[52:53], v[52:53], v[60:61]
v_pk_add_f32 v[54:55], v[54:55], v[62:63]
v_lshlrev_b32 v56, 16, v248
v_and_b32 v57, s44, v248
v_lshlrev_b32 v58, 16, v249
v_and_b32 v59, s44, v249
v_lshlrev_b32 v60, 16, v250
v_and_b32 v61, s44, v250
v_lshlrev_b32 v62, 16, v251
v_and_b32 v63, s44, v251
v_pk_add_f32 v[48:49], v[48:49], v[56:57]
v_pk_add_f32 v[50:51], v[50:51], v[58:59]
v_pk_add_f32 v[52:53], v[52:53], v[60:61]
v_pk_add_f32 v[54:55], v[54:55], v[62:63]
v_lshlrev_b32 v56, 16, v252
v_and_b32 v57, s44, v252
v_lshlrev_b32 v58, 16, v253
v_and_b32 v59, s44, v253
v_lshlrev_b32 v60, 16, v254
v_and_b32 v61, s44, v254
v_lshlrev_b32 v62, 16, v255
v_and_b32 v63, s44, v255
v_pk_add_f32 v[48:49], v[48:49], v[56:57]
v_pk_add_f32 v[50:51], v[50:51], v[58:59]
v_pk_add_f32 v[52:53], v[52:53], v[60:61]
v_pk_add_f32 v[54:55], v[54:55], v[62:63]
v_mul_f32 v56, s45, v40
v_mul_f32 v57, s45, v41
v_mul_f32 v58, s45, v42
v_mul_f32 v59, s45, v43
v_mul_f32 v60, s45, v44
v_mul_f32 v61, s45, v45
v_mul_f32 v62, s45, v46
v_mul_f32 v63, s45, v47
v_exp_f32 v56, v56
v_exp_f32 v57, v57
v_exp_f32 v58, v58
v_exp_f32 v59, v59
v_exp_f32 v60, v60
v_exp_f32 v61, v61
v_exp_f32 v62, v62
v_exp_f32 v63, v63
v_add_f32 v56, 1.0, v56
v_add_f32 v57, 1.0, v57
v_add_f32 v58, 1.0, v58
v_add_f32 v59, 1.0, v59
v_add_f32 v60, 1.0, v60
v_add_f32 v61, 1.0, v61
v_add_f32 v62, 1.0, v62
v_add_f32 v63, 1.0, v63
v_rcp_f32 v56, v56
v_rcp_f32 v57, v57
v_rcp_f32 v58, v58
v_rcp_f32 v59, v59
v_rcp_f32 v60, v60
v_rcp_f32 v61, v61
v_rcp_f32 v62, v62
v_rcp_f32 v63, v63
v_mul_f32 v192, v40, v56
v_mul_f32 v193, v41, v57
v_mul_f32 v194, v42, v58
v_mul_f32 v195, v43, v59
v_mul_f32 v196, v44, v60
v_mul_f32 v197, v45, v61
v_mul_f32 v198, v46, v62
v_mul_f32 v199, v47, v63
v_mul_f32 v56, s45, v48
v_mul_f32 v57, s45, v49
v_mul_f32 v58, s45, v50
v_mul_f32 v59, s45, v51
v_mul_f32 v60, s45, v52
v_mul_f32 v61, s45, v53
v_mul_f32 v62, s45, v54
v_mul_f32 v63, s45, v55
v_exp_f32 v56, v56
v_exp_f32 v57, v57
v_exp_f32 v58, v58
v_exp_f32 v59, v59
v_exp_f32 v60, v60
v_exp_f32 v61, v61
v_exp_f32 v62, v62
v_exp_f32 v63, v63
v_add_f32 v56, 1.0, v56
v_add_f32 v57, 1.0, v57
v_add_f32 v58, 1.0, v58
v_add_f32 v59, 1.0, v59
v_add_f32 v60, 1.0, v60
v_add_f32 v61, 1.0, v61
v_add_f32 v62, 1.0, v62
v_add_f32 v63, 1.0, v63
v_rcp_f32 v56, v56
v_rcp_f32 v57, v57
v_rcp_f32 v58, v58
v_rcp_f32 v59, v59
v_rcp_f32 v60, v60
v_rcp_f32 v61, v61
v_rcp_f32 v62, v62
v_rcp_f32 v63, v63
v_mul_f32 v224, v48, v56
v_mul_f32 v225, v49, v57
v_mul_f32 v226, v50, v58
v_mul_f32 v227, v51, v59
v_mul_f32 v228, v52, v60
v_mul_f32 v229, v53, v61
v_mul_f32 v230, v54, v62
v_mul_f32 v231, v55, v63
L_e_nolate:
s_mov_b32 s44, 0xffff0000
s_waitcnt vmcnt(0)
v_lshlrev_b32 v64, 16, v128
v_and_b32 v65, s44, v128
v_lshlrev_b32 v66, 16, v129
v_and_b32 v67, s44, v129
v_lshlrev_b32 v68, 16, v130
v_and_b32 v69, s44, v130
v_lshlrev_b32 v70, 16, v131
v_and_b32 v71, s44, v131
v_lshlrev_b32 v80, 16, v132
v_and_b32 v81, s44, v132
v_lshlrev_b32 v82, 16, v133
v_and_b32 v83, s44, v133
v_lshlrev_b32 v84, 16, v134
v_and_b32 v85, s44, v134
v_lshlrev_b32 v86, 16, v135
v_and_b32 v87, s44, v135
v_pk_add_f32 v[64:65], v[64:65], v[80:81]
v_pk_add_f32 v[66:67], v[66:67], v[82:83]
v_pk_add_f32 v[68:69], v[68:69], v[84:85]
v_pk_add_f32 v[70:71], v[70:71], v[86:87]
v_lshlrev_b32 v80, 16, v136
v_and_b32 v81, s44, v136
v_lshlrev_b32 v82, 16, v137
v_and_b32 v83, s44, v137
v_lshlrev_b32 v84, 16, v138
v_and_b32 v85, s44, v138
v_lshlrev_b32 v86, 16, v139
v_and_b32 v87, s44, v139
v_pk_add_f32 v[64:65], v[64:65], v[80:81]
v_pk_add_f32 v[66:67], v[66:67], v[82:83]
v_pk_add_f32 v[68:69], v[68:69], v[84:85]
v_pk_add_f32 v[70:71], v[70:71], v[86:87]
v_lshlrev_b32 v80, 16, v140
v_and_b32 v81, s44, v140
v_lshlrev_b32 v82, 16, v141
v_and_b32 v83, s44, v141
v_lshlrev_b32 v84, 16, v142
v_and_b32 v85, s44, v142
v_lshlrev_b32 v86, 16, v143
v_and_b32 v87, s44, v143
v_pk_add_f32 v[64:65], v[64:65], v[80:81]
v_pk_add_f32 v[66:67], v[66:67], v[82:83]
v_pk_add_f32 v[68:69], v[68:69], v[84:85]
v_pk_add_f32 v[70:71], v[70:71], v[86:87]
v_lshlrev_b32 v80, 16, v144
v_and_b32 v81, s44, v144
v_lshlrev_b32 v82, 16, v145
v_and_b32 v83, s44, v145
v_lshlrev_b32 v84, 16, v146
v_and_b32 v85, s44, v146
v_lshlrev_b32 v86, 16, v147
v_and_b32 v87, s44, v147
v_pk_add_f32 v[64:65], v[64:65], v[80:81]
v_pk_add_f32 v[66:67], v[66:67], v[82:83]
v_pk_add_f32 v[68:69], v[68:69], v[84:85]
v_pk_add_f32 v[70:71], v[70:71], v[86:87]
v_lshlrev_b32 v80, 16, v148
v_and_b32 v81, s44, v148
v_lshlrev_b32 v82, 16, v149
v_and_b32 v83, s44, v149
v_lshlrev_b32 v84, 16, v150
v_and_b32 v85, s44, v150
v_lshlrev_b32 v86, 16, v151
v_and_b32 v87, s44, v151
v_pk_add_f32 v[64:65], v[64:65], v[80:81]
v_pk_add_f32 v[66:67], v[66:67], v[82:83]
v_pk_add_f32 v[68:69], v[68:69], v[84:85]
v_pk_add_f32 v[70:71], v[70:71], v[86:87]
v_lshlrev_b32 v80, 16, v152
v_and_b32 v81, s44, v152
v_lshlrev_b32 v82, 16, v153
v_and_b32 v83, s44, v153
v_lshlrev_b32 v84, 16, v154
v_and_b32 v85, s44, v154
v_lshlrev_b32 v86, 16, v155
v_and_b32 v87, s44, v155
v_pk_add_f32 v[64:65], v[64:65], v[80:81]
v_pk_add_f32 v[66:67], v[66:67], v[82:83]
v_pk_add_f32 v[68:69], v[68:69], v[84:85]
v_pk_add_f32 v[70:71], v[70:71], v[86:87]
v_lshlrev_b32 v80, 16, v156
v_and_b32 v81, s44, v156
v_lshlrev_b32 v82, 16, v157
v_and_b32 v83, s44, v157
v_lshlrev_b32 v84, 16, v158
v_and_b32 v85, s44, v158
v_lshlrev_b32 v86, 16, v159
v_and_b32 v87, s44, v159
v_pk_add_f32 v[64:65], v[64:65], v[80:81]
v_pk_add_f32 v[66:67], v[66:67], v[82:83]
v_pk_add_f32 v[68:69], v[68:69], v[84:85]
v_pk_add_f32 v[70:71], v[70:71], v[86:87]
s_add_u32 s0, s63, 0
v_lshlrev_b32 v80, 16, v2
v_and_b32 v81, 0xffff0000, v2
v_lshlrev_b32 v82, 16, v3
v_and_b32 v83, 0xffff0000, v3
v_fmac_f32 v80, v64, v192
v_fmac_f32 v81, v65, v193
v_fmac_f32 v82, v66, v194
v_fmac_f32 v83, v67, v195
v_cvt_pk_bf16_f32 v88, v80, v81
v_cvt_pk_bf16_f32 v89, v82, v83
buffer_store_dwordx2 v[88:89], v10, s[64:67], s0 offen offset:0
v_lshlrev_b32 v80, 16, v4
v_and_b32 v81, 0xffff0000, v4
v_lshlrev_b32 v82, 16, v5
v_and_b32 v83, 0xffff0000, v5
v_fmac_f32 v80, v68, v196
v_fmac_f32 v81, v69, v197
v_fmac_f32 v82, v70, v198
v_fmac_f32 v83, v71, v199
v_cvt_pk_bf16_f32 v90, v80, v81
v_cvt_pk_bf16_f32 v91, v82, v83
buffer_store_dwordx2 v[90:91], v10, s[64:67], s0 offen offset:32
v_lshlrev_b32 v72, 16, v160
v_and_b32 v73, s44, v160
v_lshlrev_b32 v74, 16, v161
v_and_b32 v75, s44, v161
v_lshlrev_b32 v76, 16, v162
v_and_b32 v77, s44, v162
v_lshlrev_b32 v78, 16, v163
v_and_b32 v79, s44, v163
v_lshlrev_b32 v80, 16, v164
v_and_b32 v81, s44, v164
v_lshlrev_b32 v82, 16, v165
v_and_b32 v83, s44, v165
v_lshlrev_b32 v84, 16, v166
v_and_b32 v85, s44, v166
v_lshlrev_b32 v86, 16, v167
v_and_b32 v87, s44, v167
v_pk_add_f32 v[72:73], v[72:73], v[80:81]
v_pk_add_f32 v[74:75], v[74:75], v[82:83]
v_pk_add_f32 v[76:77], v[76:77], v[84:85]
v_pk_add_f32 v[78:79], v[78:79], v[86:87]
v_lshlrev_b32 v80, 16, v168
v_and_b32 v81, s44, v168
v_lshlrev_b32 v82, 16, v169
v_and_b32 v83, s44, v169
v_lshlrev_b32 v84, 16, v170
v_and_b32 v85, s44, v170
v_lshlrev_b32 v86, 16, v171
v_and_b32 v87, s44, v171
v_pk_add_f32 v[72:73], v[72:73], v[80:81]
v_pk_add_f32 v[74:75], v[74:75], v[82:83]
v_pk_add_f32 v[76:77], v[76:77], v[84:85]
v_pk_add_f32 v[78:79], v[78:79], v[86:87]
v_lshlrev_b32 v80, 16, v172
v_and_b32 v81, s44, v172
v_lshlrev_b32 v82, 16, v173
v_and_b32 v83, s44, v173
v_lshlrev_b32 v84, 16, v174
v_and_b32 v85, s44, v174
v_lshlrev_b32 v86, 16, v175
v_and_b32 v87, s44, v175
v_pk_add_f32 v[72:73], v[72:73], v[80:81]
v_pk_add_f32 v[74:75], v[74:75], v[82:83]
v_pk_add_f32 v[76:77], v[76:77], v[84:85]
v_pk_add_f32 v[78:79], v[78:79], v[86:87]
v_lshlrev_b32 v80, 16, v176
v_and_b32 v81, s44, v176
v_lshlrev_b32 v82, 16, v177
v_and_b32 v83, s44, v177
v_lshlrev_b32 v84, 16, v178
v_and_b32 v85, s44, v178
v_lshlrev_b32 v86, 16, v179
v_and_b32 v87, s44, v179
v_pk_add_f32 v[72:73], v[72:73], v[80:81]
v_pk_add_f32 v[74:75], v[74:75], v[82:83]
v_pk_add_f32 v[76:77], v[76:77], v[84:85]
v_pk_add_f32 v[78:79], v[78:79], v[86:87]
v_lshlrev_b32 v80, 16, v180
v_and_b32 v81, s44, v180
v_lshlrev_b32 v82, 16, v181
v_and_b32 v83, s44, v181
v_lshlrev_b32 v84, 16, v182
v_and_b32 v85, s44, v182
v_lshlrev_b32 v86, 16, v183
v_and_b32 v87, s44, v183
v_pk_add_f32 v[72:73], v[72:73], v[80:81]
v_pk_add_f32 v[74:75], v[74:75], v[82:83]
v_pk_add_f32 v[76:77], v[76:77], v[84:85]
v_pk_add_f32 v[78:79], v[78:79], v[86:87]
v_lshlrev_b32 v80, 16, v184
v_and_b32 v81, s44, v184
v_lshlrev_b32 v82, 16, v185
v_and_b32 v83, s44, v185
v_lshlrev_b32 v84, 16, v186
v_and_b32 v85, s44, v186
v_lshlrev_b32 v86, 16, v187
v_and_b32 v87, s44, v187
v_pk_add_f32 v[72:73], v[72:73], v[80:81]
v_pk_add_f32 v[74:75], v[74:75], v[82:83]
v_pk_add_f32 v[76:77], v[76:77], v[84:85]
v_pk_add_f32 v[78:79], v[78:79], v[86:87]
v_lshlrev_b32 v80, 16, v188
v_and_b32 v81, s44, v188
v_lshlrev_b32 v82, 16, v189
v_and_b32 v83, s44, v189
v_lshlrev_b32 v84, 16, v190
v_and_b32 v85, s44, v190
v_lshlrev_b32 v86, 16, v191
v_and_b32 v87, s44, v191
v_pk_add_f32 v[72:73], v[72:73], v[80:81]
v_pk_add_f32 v[74:75], v[74:75], v[82:83]
v_pk_add_f32 v[76:77], v[76:77], v[84:85]
v_pk_add_f32 v[78:79], v[78:79], v[86:87]
s_add_u32 s0, s63, 16384
v_lshlrev_b32 v80, 16, v12
v_and_b32 v81, 0xffff0000, v12
v_lshlrev_b32 v82, 16, v13
v_and_b32 v83, 0xffff0000, v13
v_fmac_f32 v80, v72, v224
v_fmac_f32 v81, v73, v225
v_fmac_f32 v82, v74, v226
v_fmac_f32 v83, v75, v227
v_cvt_pk_bf16_f32 v92, v80, v81
v_cvt_pk_bf16_f32 v93, v82, v83
buffer_store_dwordx2 v[92:93], v10, s[64:67], s0 offen offset:0
v_lshlrev_b32 v80, 16, v14
v_and_b32 v81, 0xffff0000, v14
v_lshlrev_b32 v82, 16, v15
v_and_b32 v83, 0xffff0000, v15
v_fmac_f32 v80, v76, v228
v_fmac_f32 v81, v77, v229
v_fmac_f32 v82, v78, v230
v_fmac_f32 v83, v79, v231
v_cvt_pk_bf16_f32 v94, v80, v81
v_cvt_pk_bf16_f32 v95, v82, v83
buffer_store_dwordx2 v[94:95], v10, s[64:67], s0 offen offset:32
s_cmp_eq_u32 s85, 0
s_cbranch_scc1 L_e_exit
s_ff1_i32_b32 s47, s85
s_bitset0_b32 s85, s47
s_mov_b32 s61, 1
s_lshl_b32 s62, s5, 3
s_add_u32 s62, s62, s47
s_lshl_b32 s62, s62, 2
s_add_u32 s62, s62, s3
s_lshl_b32 s62, s62, 11
s_lshl_b32 s63, s47, 1
s_lshr_b32 s0, s3, 1
s_add_u32 s63, s63, s0
s_lshl_b32 s63, s63, 6
s_and_b32 s0, s3, 1
s_lshl_b32 s0, s0, 15
s_add_u32 s63, s63, s0
s_lshl_b32 s0, s5, 16
s_add_u32 s63, s63, s0
s_add_u32 s0, s62, 0
buffer_load_dwordx4 v[128:131], v1, s[40:43], s0 offen sc1
buffer_load_dwordx4 v[160:163], v1, s[40:43], s0 offen offset:1024 sc1
s_add_u32 s0, s62, 2097152
buffer_load_dwordx4 v[132:135], v1, s[40:43], s0 offen sc1
buffer_load_dwordx4 v[164:167], v1, s[40:43], s0 offen offset:1024 sc1
s_add_u32 s0, s62, 4194304
buffer_load_dwordx4 v[136:139], v1, s[40:43], s0 offen sc1
buffer_load_dwordx4 v[168:171], v1, s[40:43], s0 offen offset:1024 sc1
s_add_u32 s0, s62, 6291456
buffer_load_dwordx4 v[140:143], v1, s[40:43], s0 offen sc1
buffer_load_dwordx4 v[172:175], v1, s[40:43], s0 offen offset:1024 sc1
s_add_u32 s0, s62, 8388608
buffer_load_dwordx4 v[144:147], v1, s[40:43], s0 offen sc1
buffer_load_dwordx4 v[176:179], v1, s[40:43], s0 offen offset:1024 sc1
s_add_u32 s0, s62, 10485760
buffer_load_dwordx4 v[148:151], v1, s[40:43], s0 offen sc1
buffer_load_dwordx4 v[180:183], v1, s[40:43], s0 offen offset:1024 sc1
s_add_u32 s0, s62, 12582912
buffer_load_dwordx4 v[152:155], v1, s[40:43], s0 offen sc1
buffer_load_dwordx4 v[184:187], v1, s[40:43], s0 offen offset:1024 sc1
s_add_u32 s0, s62, 14680064
buffer_load_dwordx4 v[156:159], v1, s[40:43], s0 offen sc1
buffer_load_dwordx4 v[188:191], v1, s[40:43], s0 offen offset:1024 sc1
s_branch L_e_fin
L_e_exit:
L_main_end:
s_endpgm

L_code_end:
L_fallback:
s_waitcnt vmcnt(0) lgkmcnt(0)
s_mov_b32 s61, 1
v_bfe_u32 v26, v1, 4, 4
v_lshrrev_b32 v27, 8, v1
v_lshrrev_b32 v28, 3, v26
v_lshlrev_b32 v28, 12, v28
v_and_b32 v29, 7, v26
v_lshlrev_b32 v29, 8, v29
v_add_u32 v28, v28, v29
v_add_u32 v28, 98304, v28
v_add_u32 v29, 0, v27
v_xor_b32 v29, v29, v26
v_lshl_add_u32 v96, v29, 4, v28
v_add_u32 v29, 4, v27
v_xor_b32 v29, v29, v26
v_lshl_add_u32 v97, v29, 4, v28
v_add_u32 v29, 8, v27
v_xor_b32 v29, v29, v26
v_lshl_add_u32 v98, v29, 4, v28
v_add_u32 v29, 12, v27
v_xor_b32 v29, v29, v26
v_lshl_add_u32 v99, v29, 4, v28
v_bfe_u32 v26, v1, 6, 3
v_lshrrev_b32 v28, 9, v1
v_lshlrev_b32 v28, 12, v28
v_lshl_add_u32 v28, v26, 8, v28
v_add_u32 v28, 100352, v28
v_bfe_u32 v29, v1, 4, 2
v_lshl_add_u32 v28, v29, 3, v28
v_xor_b32 v29, 0, v26
v_lshl_add_u32 v100, v29, 5, v28
v_xor_b32 v29, 1, v26
v_lshl_add_u32 v101, v29, 5, v28
v_xor_b32 v29, 2, v26
v_lshl_add_u32 v102, v29, 5, v28
v_xor_b32 v29, 3, v26
v_lshl_add_u32 v103, v29, 5, v28
v_xor_b32 v29, 4, v26
v_lshl_add_u32 v104, v29, 5, v28
v_xor_b32 v29, 5, v26
v_lshl_add_u32 v105, v29, 5, v28
v_xor_b32 v29, 6, v26
v_lshl_add_u32 v106, v29, 5, v28
v_xor_b32 v29, 7, v26
v_lshl_add_u32 v107, v29, 5, v28
v_add_u32 v96, s83, v96
v_add_u32 v97, s83, v97
v_add_u32 v98, s83, v98
v_add_u32 v99, s83, v99
v_add_u32 v100, s83, v100
v_add_u32 v101, s83, v101
v_add_u32 v102, s83, v102
v_add_u32 v103, s83, v103
v_add_u32 v104, s83, v104
v_add_u32 v105, s83, v105
v_add_u32 v106, s83, v106
v_add_u32 v107, s83, v107
v_lshrrev_b32 v26, 8, v1
v_bfe_u32 v27, v1, 4, 4
v_add_u32 v28, 0, v26
v_and_b32 v28, 15, v28
v_xor_b32 v28, v28, v27
v_lshlrev_b32 v28, 4, v28
v_add_u32 v29, 0, v26
v_lshl_add_u32 v80, v29, 8, v28
v_add_u32 v28, 0, v26
v_lshlrev_b32 v28, 1, v28
v_xor_b32 v28, v28, v27
v_lshlrev_b32 v28, 4, v28
v_lshl_add_u32 v88, v29, 8, v28
v_add_u32 v28, 4, v26
v_and_b32 v28, 15, v28
v_xor_b32 v28, v28, v27
v_lshlrev_b32 v28, 4, v28
v_add_u32 v29, 0, v26
v_lshl_add_u32 v81, v29, 8, v28
v_add_u32 v28, 4, v26
v_lshlrev_b32 v28, 1, v28
v_xor_b32 v28, v28, v27
v_lshlrev_b32 v28, 4, v28
v_lshl_add_u32 v89, v29, 8, v28
v_add_u32 v28, 8, v26
v_and_b32 v28, 15, v28
v_xor_b32 v28, v28, v27
v_lshlrev_b32 v28, 4, v28
v_add_u32 v29, 8, v26
v_lshl_add_u32 v82, v29, 8, v28
v_add_u32 v28, 0, v26
v_lshlrev_b32 v28, 1, v28
v_xor_b32 v28, v28, v27
v_lshlrev_b32 v28, 4, v28
v_lshl_add_u32 v90, v29, 8, v28
v_add_u32 v28, 12, v26
v_and_b32 v28, 15, v28
v_xor_b32 v28, v28, v27
v_lshlrev_b32 v28, 4, v28
v_add_u32 v29, 8, v26
v_lshl_add_u32 v83, v29, 8, v28
v_add_u32 v28, 4, v26
v_lshlrev_b32 v28, 1, v28
v_xor_b32 v28, v28, v27
v_lshlrev_b32 v28, 4, v28
v_lshl_add_u32 v91, v29, 8, v28
v_add_u32 v28, 16, v26
v_and_b32 v28, 15, v28
v_xor_b32 v28, v28, v27
v_lshlrev_b32 v28, 4, v28
v_add_u32 v29, 16, v26
v_lshl_add_u32 v84, v29, 8, v28
v_add_u32 v28, 0, v26
v_lshlrev_b32 v28, 1, v28
v_xor_b32 v28, v28, v27
v_lshlrev_b32 v28, 4, v28
v_lshl_add_u32 v92, v29, 8, v28
v_add_u32 v28, 20, v26
v_and_b32 v28, 15, v28
v_xor_b32 v28, v28, v27
v_lshlrev_b32 v28, 4, v28
v_add_u32 v29, 16, v26
v_lshl_add_u32 v85, v29, 8, v28
v_add_u32 v28, 4, v26
v_lshlrev_b32 v28, 1, v28
v_xor_b32 v28, v28, v27
v_lshlrev_b32 v28, 4, v28
v_lshl_add_u32 v93, v29, 8, v28
v_add_u32 v28, 24, v26
v_and_b32 v28, 15, v28
v_xor_b32 v28, v28, v27
v_lshlrev_b32 v28, 4, v28
v_add_u32 v29, 24, v26
v_lshl_add_u32 v86, v29, 8, v28
v_add_u32 v28, 0, v26
v_lshlrev_b32 v28, 1, v28
v_xor_b32 v28, v28, v27
v_lshlrev_b32 v28, 4, v28
v_lshl_add_u32 v94, v29, 8, v28
v_add_u32 v28, 28, v26
v_and_b32 v28, 15, v28
v_xor_b32 v28, v28, v27
v_lshlrev_b32 v28, 4, v28
v_add_u32 v29, 24, v26
v_lshl_add_u32 v87, v29, 8, v28
v_add_u32 v28, 4, v26
v_lshlrev_b32 v28, 1, v28
v_xor_b32 v28, v28, v27
v_lshlrev_b32 v28, 4, v28
v_lshl_add_u32 v95, v29, 8, v28
v_mov_b32 v64, 0xff7fffff
v_mov_b32 v124, 0
v_mov_b32 v65, 0xff7fffff
v_mov_b32 v125, 0
v_mov_b32 v66, 0xff7fffff
v_mov_b32 v126, 0
v_mov_b32 v67, 0xff7fffff
v_mov_b32 v127, 0
v_accvgpr_write_b32 a0, 0
v_accvgpr_write_b32 a1, 0
v_accvgpr_write_b32 a2, 0
v_accvgpr_write_b32 a3, 0
v_accvgpr_write_b32 a4, 0
v_accvgpr_write_b32 a5, 0
v_accvgpr_write_b32 a6, 0
v_accvgpr_write_b32 a7, 0
v_accvgpr_write_b32 a8, 0
v_accvgpr_write_b32 a9, 0
v_accvgpr_write_b32 a10, 0
v_accvgpr_write_b32 a11, 0
v_accvgpr_write_b32 a12, 0
v_accvgpr_write_b32 a13, 0
v_accvgpr_write_b32 a14, 0
v_accvgpr_write_b32 a15, 0
v_accvgpr_write_b32 a16, 0
v_accvgpr_write_b32 a17, 0
v_accvgpr_write_b32 a18, 0
v_accvgpr_write_b32 a19, 0
v_accvgpr_write_b32 a20, 0
v_accvgpr_write_b32 a21, 0
v_accvgpr_write_b32 a22, 0
v_accvgpr_write_b32 a23, 0
v_accvgpr_write_b32 a24, 0
v_accvgpr_write_b32 a25, 0
v_accvgpr_write_b32 a26, 0
v_accvgpr_write_b32 a27, 0
v_accvgpr_write_b32 a28, 0
v_accvgpr_write_b32 a29, 0
v_accvgpr_write_b32 a30, 0
v_accvgpr_write_b32 a31, 0
v_accvgpr_write_b32 a32, 0
v_accvgpr_write_b32 a33, 0
v_accvgpr_write_b32 a34, 0
v_accvgpr_write_b32 a35, 0
v_accvgpr_write_b32 a36, 0
v_accvgpr_write_b32 a37, 0
v_accvgpr_write_b32 a38, 0
v_accvgpr_write_b32 a39, 0
v_accvgpr_write_b32 a40, 0
v_accvgpr_write_b32 a41, 0
v_accvgpr_write_b32 a42, 0
v_accvgpr_write_b32 a43, 0
v_accvgpr_write_b32 a44, 0
v_accvgpr_write_b32 a45, 0
v_accvgpr_write_b32 a46, 0
v_accvgpr_write_b32 a47, 0
v_accvgpr_write_b32 a48, 0
v_accvgpr_write_b32 a49, 0
v_accvgpr_write_b32 a50, 0
v_accvgpr_write_b32 a51, 0
v_accvgpr_write_b32 a52, 0
v_accvgpr_write_b32 a53, 0
v_accvgpr_write_b32 a54, 0
v_accvgpr_write_b32 a55, 0
v_accvgpr_write_b32 a56, 0
v_accvgpr_write_b32 a57, 0
v_accvgpr_write_b32 a58, 0
v_accvgpr_write_b32 a59, 0
v_accvgpr_write_b32 a60, 0
v_accvgpr_write_b32 a61, 0
v_accvgpr_write_b32 a62, 0
v_accvgpr_write_b32 a63, 0
v_accvgpr_write_b32 a64, 0
v_accvgpr_write_b32 a65, 0
v_accvgpr_write_b32 a66, 0
v_accvgpr_write_b32 a67, 0
v_accvgpr_write_b32 a68, 0
v_accvgpr_write_b32 a69, 0
v_accvgpr_write_b32 a70, 0
v_accvgpr_write_b32 a71, 0
v_accvgpr_write_b32 a72, 0
v_accvgpr_write_b32 a73, 0
v_accvgpr_write_b32 a74, 0
v_accvgpr_write_b32 a75, 0
v_accvgpr_write_b32 a76, 0
v_accvgpr_write_b32 a77, 0
v_accvgpr_write_b32 a78, 0
v_accvgpr_write_b32 a79, 0
v_accvgpr_write_b32 a80, 0
v_accvgpr_write_b32 a81, 0
v_accvgpr_write_b32 a82, 0
v_accvgpr_write_b32 a83, 0
v_accvgpr_write_b32 a84, 0
v_accvgpr_write_b32 a85, 0
v_accvgpr_write_b32 a86, 0
v_accvgpr_write_b32 a87, 0
v_accvgpr_write_b32 a88, 0
v_accvgpr_write_b32 a89, 0
v_accvgpr_write_b32 a90, 0
v_accvgpr_write_b32 a91, 0
v_accvgpr_write_b32 a92, 0
v_accvgpr_write_b32 a93, 0
v_accvgpr_write_b32 a94, 0
v_accvgpr_write_b32 a95, 0
v_accvgpr_write_b32 a96, 0
v_accvgpr_write_b32 a97, 0
v_accvgpr_write_b32 a98, 0
v_accvgpr_write_b32 a99, 0
v_accvgpr_write_b32 a100, 0
v_accvgpr_write_b32 a101, 0
v_accvgpr_write_b32 a102, 0
v_accvgpr_write_b32 a103, 0
v_accvgpr_write_b32 a104, 0
v_accvgpr_write_b32 a105, 0
v_accvgpr_write_b32 a106, 0
v_accvgpr_write_b32 a107, 0
v_accvgpr_write_b32 a108, 0
v_accvgpr_write_b32 a109, 0
v_accvgpr_write_b32 a110, 0
v_accvgpr_write_b32 a111, 0
v_accvgpr_write_b32 a112, 0
v_accvgpr_write_b32 a113, 0
v_accvgpr_write_b32 a114, 0
v_accvgpr_write_b32 a115, 0
v_accvgpr_write_b32 a116, 0
v_accvgpr_write_b32 a117, 0
v_accvgpr_write_b32 a118, 0
v_accvgpr_write_b32 a119, 0
v_accvgpr_write_b32 a120, 0
v_accvgpr_write_b32 a121, 0
v_accvgpr_write_b32 a122, 0
v_accvgpr_write_b32 a123, 0
v_accvgpr_write_b32 a124, 0
v_accvgpr_write_b32 a125, 0
v_accvgpr_write_b32 a126, 0
v_accvgpr_write_b32 a127, 0
s_mov_b32 s80, 0
s_add_u32 s81, s83, 98304
L_fb_loop:
s_add_u32 m0, s81, 0
s_nop 0
buffer_load_dwordx4 v80, s[8:11], s80 offen lds
buffer_load_dwordx4 v81, s[8:11], s80 offen offset:1024 lds
buffer_load_dwordx4 v88, s[12:15], s80 offen offset:2048 lds
buffer_load_dwordx4 v89, s[12:15], s80 offen offset:3072 lds
s_add_u32 m0, s81, 4096
s_nop 0
buffer_load_dwordx4 v82, s[8:11], s80 offen lds
buffer_load_dwordx4 v83, s[8:11], s80 offen offset:1024 lds
buffer_load_dwordx4 v90, s[12:15], s80 offen offset:2048 lds
buffer_load_dwordx4 v91, s[12:15], s80 offen offset:3072 lds
s_add_u32 m0, s81, 8192
s_nop 0
buffer_load_dwordx4 v84, s[8:11], s80 offen lds
buffer_load_dwordx4 v85, s[8:11], s80 offen offset:1024 lds
buffer_load_dwordx4 v92, s[12:15], s80 offen offset:2048 lds
buffer_load_dwordx4 v93, s[12:15], s80 offen offset:3072 lds
s_add_u32 m0, s81, 12288
s_nop 0
buffer_load_dwordx4 v86, s[8:11], s80 offen lds
buffer_load_dwordx4 v87, s[8:11], s80 offen offset:1024 lds
buffer_load_dwordx4 v94, s[12:15], s80 offen offset:2048 lds
buffer_load_dwordx4 v95, s[12:15], s80 offen offset:3072 lds
s_waitcnt vmcnt(0)
ds_read_b128 a[192:195], v96 offset:0
ds_read_b128 a[196:199], v97 offset:0
ds_read_b128 a[200:203], v98 offset:0
ds_read_b128 a[204:207], v99 offset:0
ds_read_b128 a[208:211], v96 offset:8192
ds_read_b128 a[212:215], v97 offset:8192
ds_read_b128 a[216:219], v98 offset:8192
ds_read_b128 a[220:223], v99 offset:8192
s_waitcnt lgkmcnt(0)
ds_read_b64_tr_b16 a[224:225], v100 offset:0
ds_read_b64_tr_b16 a[226:227], v100 offset:8192
ds_read_b64_tr_b16 a[228:229], v101 offset:0
ds_read_b64_tr_b16 a[230:231], v101 offset:8192
ds_read_b64_tr_b16 a[232:233], v102 offset:0
ds_read_b64_tr_b16 a[234:235], v102 offset:8192
ds_read_b64_tr_b16 a[236:237], v103 offset:0
ds_read_b64_tr_b16 a[238:239], v103 offset:8192
ds_read_b64_tr_b16 a[240:241], v104 offset:0
ds_read_b64_tr_b16 a[242:243], v104 offset:8192
ds_read_b64_tr_b16 a[244:245], v105 offset:0
ds_read_b64_tr_b16 a[246:247], v105 offset:8192
ds_read_b64_tr_b16 a[248:249], v106 offset:0
ds_read_b64_tr_b16 a[250:251], v106 offset:8192
ds_read_b64_tr_b16 a[252:253], v107 offset:0
ds_read_b64_tr_b16 a[254:255], v107 offset:8192
v_mfma_f32_16x16x32_bf16 v[192:195], a[192:195], v[128:131], 0
v_mfma_f32_16x16x32_bf16 v[192:195], a[196:199], v[132:135], v[192:195]
v_mfma_f32_16x16x32_bf16 v[192:195], a[200:203], v[136:139], v[192:195]
v_mfma_f32_16x16x32_bf16 v[192:195], a[204:207], v[140:143], v[192:195]
v_mfma_f32_16x16x32_bf16 v[196:199], a[208:211], v[128:131], 0
v_mfma_f32_16x16x32_bf16 v[196:199], a[212:215], v[132:135], v[196:199]
v_mfma_f32_16x16x32_bf16 v[196:199], a[216:219], v[136:139], v[196:199]
v_mfma_f32_16x16x32_bf16 v[196:199], a[220:223], v[140:143], v[196:199]
v_mfma_f32_16x16x32_bf16 v[200:203], a[192:195], v[144:147], 0
v_mfma_f32_16x16x32_bf16 v[200:203], a[196:199], v[148:151], v[200:203]
v_mfma_f32_16x16x32_bf16 v[200:203], a[200:203], v[152:155], v[200:203]
v_mfma_f32_16x16x32_bf16 v[200:203], a[204:207], v[156:159], v[200:203]
v_mfma_f32_16x16x32_bf16 v[204:207], a[208:211], v[144:147], 0
v_mfma_f32_16x16x32_bf16 v[204:207], a[212:215], v[148:151], v[204:207]
v_mfma_f32_16x16x32_bf16 v[204:207], a[216:219], v[152:155], v[204:207]
v_mfma_f32_16x16x32_bf16 v[204:207], a[220:223], v[156:159], v[204:207]
v_mfma_f32_16x16x32_bf16 v[208:211], a[192:195], v[160:163], 0
v_mfma_f32_16x16x32_bf16 v[208:211], a[196:199], v[164:167], v[208:211]
v_mfma_f32_16x16x32_bf16 v[208:211], a[200:203], v[168:171], v[208:211]
v_mfma_f32_16x16x32_bf16 v[208:211], a[204:207], v[172:175], v[208:211]
v_mfma_f32_16x16x32_bf16 v[212:215], a[208:211], v[160:163], 0
v_mfma_f32_16x16x32_bf16 v[212:215], a[212:215], v[164:167], v[212:215]
v_mfma_f32_16x16x32_bf16 v[212:215], a[216:219], v[168:171], v[212:215]
v_mfma_f32_16x16x32_bf16 v[212:215], a[220:223], v[172:175], v[212:215]
v_mfma_f32_16x16x32_bf16 v[216:219], a[192:195], v[176:179], 0
v_mfma_f32_16x16x32_bf16 v[216:219], a[196:199], v[180:183], v[216:219]
v_mfma_f32_16x16x32_bf16 v[216:219], a[200:203], v[184:187], v[216:219]
v_mfma_f32_16x16x32_bf16 v[216:219], a[204:207], v[188:191], v[216:219]
v_mfma_f32_16x16x32_bf16 v[220:223], a[208:211], v[176:179], 0
v_mfma_f32_16x16x32_bf16 v[220:223], a[212:215], v[180:183], v[220:223]
v_mfma_f32_16x16x32_bf16 v[220:223], a[216:219], v[184:187], v[220:223]
v_mfma_f32_16x16x32_bf16 v[220:223], a[220:223], v[188:191], v[220:223]
s_nop 7
s_waitcnt lgkmcnt(0)
v_max3_f32 v72, v192, v193, v194
v_max3_f32 v72, v72, v195, v196
v_max3_f32 v72, v72, v197, v198
v_max3_f32 v72, v72, v199, v64
v_mov_b32 v73, v72
s_nop 1
v_permlane16_swap_b32 v72, v73
s_nop 1
v_max_f32 v72, v72, v73
v_mov_b32 v73, v72
s_nop 1
v_permlane32_swap_b32 v72, v73
s_nop 1
v_max_f32 v72, v72, v73
v_sub_f32 v68, v64, v72
v_mov_b32 v64, v72
v_exp_f32 v68, v68
v_sub_f32 v192, v192, v72
v_sub_f32 v193, v193, v72
v_sub_f32 v194, v194, v72
v_sub_f32 v195, v195, v72
v_sub_f32 v196, v196, v72
v_sub_f32 v197, v197, v72
v_sub_f32 v198, v198, v72
v_sub_f32 v199, v199, v72
v_exp_f32 v192, v192
v_exp_f32 v193, v193
v_exp_f32 v194, v194
v_exp_f32 v195, v195
v_exp_f32 v196, v196
v_exp_f32 v197, v197
v_exp_f32 v198, v198
v_exp_f32 v199, v199
v_mul_f32 v124, v124, v68
v_add_f32 v124, v124, v192
v_add_f32 v124, v124, v193
v_add_f32 v124, v124, v194
v_add_f32 v124, v124, v195
v_add_f32 v124, v124, v196
v_add_f32 v124, v124, v197
v_add_f32 v124, v124, v198
v_add_f32 v124, v124, v199
v_cvt_pk_bf16_f32 v32, v192, v193
v_cvt_pk_bf16_f32 v33, v194, v195
v_cvt_pk_bf16_f32 v34, v196, v197
v_cvt_pk_bf16_f32 v35, v198, v199
v_accvgpr_read_b32 v26, a0
v_accvgpr_read_b32 v27, a1
v_accvgpr_read_b32 v28, a2
v_accvgpr_read_b32 v29, a3
v_mul_f32 v26, v26, v68
v_mul_f32 v27, v27, v68
v_mul_f32 v28, v28, v68
v_mul_f32 v29, v29, v68
v_accvgpr_write_b32 a0, v26
v_accvgpr_write_b32 a1, v27
v_accvgpr_write_b32 a2, v28
v_accvgpr_write_b32 a3, v29
v_accvgpr_read_b32 v26, a16
v_accvgpr_read_b32 v27, a17
v_accvgpr_read_b32 v28, a18
v_accvgpr_read_b32 v29, a19
v_mul_f32 v26, v26, v68
v_mul_f32 v27, v27, v68
v_mul_f32 v28, v28, v68
v_mul_f32 v29, v29, v68
v_accvgpr_write_b32 a16, v26
v_accvgpr_write_b32 a17, v27
v_accvgpr_write_b32 a18, v28
v_accvgpr_write_b32 a19, v29
v_accvgpr_read_b32 v26, a32
v_accvgpr_read_b32 v27, a33
v_accvgpr_read_b32 v28, a34
v_accvgpr_read_b32 v29, a35
v_mul_f32 v26, v26, v68
v_mul_f32 v27, v27, v68
v_mul_f32 v28, v28, v68
v_mul_f32 v29, v29, v68
v_accvgpr_write_b32 a32, v26
v_accvgpr_write_b32 a33, v27
v_accvgpr_write_b32 a34, v28
v_accvgpr_write_b32 a35, v29
v_accvgpr_read_b32 v26, a48
v_accvgpr_read_b32 v27, a49
v_accvgpr_read_b32 v28, a50
v_accvgpr_read_b32 v29, a51
v_mul_f32 v26, v26, v68
v_mul_f32 v27, v27, v68
v_mul_f32 v28, v28, v68
v_mul_f32 v29, v29, v68
v_accvgpr_write_b32 a48, v26
v_accvgpr_write_b32 a49, v27
v_accvgpr_write_b32 a50, v28
v_accvgpr_write_b32 a51, v29
v_accvgpr_read_b32 v26, a64
v_accvgpr_read_b32 v27, a65
v_accvgpr_read_b32 v28, a66
v_accvgpr_read_b32 v29, a67
v_mul_f32 v26, v26, v68
v_mul_f32 v27, v27, v68
v_mul_f32 v28, v28, v68
v_mul_f32 v29, v29, v68
v_accvgpr_write_b32 a64, v26
v_accvgpr_write_b32 a65, v27
v_accvgpr_write_b32 a66, v28
v_accvgpr_write_b32 a67, v29
v_accvgpr_read_b32 v26, a80
v_accvgpr_read_b32 v27, a81
v_accvgpr_read_b32 v28, a82
v_accvgpr_read_b32 v29, a83
v_mul_f32 v26, v26, v68
v_mul_f32 v27, v27, v68
v_mul_f32 v28, v28, v68
v_mul_f32 v29, v29, v68
v_accvgpr_write_b32 a80, v26
v_accvgpr_write_b32 a81, v27
v_accvgpr_write_b32 a82, v28
v_accvgpr_write_b32 a83, v29
v_accvgpr_read_b32 v26, a96
v_accvgpr_read_b32 v27, a97
v_accvgpr_read_b32 v28, a98
v_accvgpr_read_b32 v29, a99
v_mul_f32 v26, v26, v68
v_mul_f32 v27, v27, v68
v_mul_f32 v28, v28, v68
v_mul_f32 v29, v29, v68
v_accvgpr_write_b32 a96, v26
v_accvgpr_write_b32 a97, v27
v_accvgpr_write_b32 a98, v28
v_accvgpr_write_b32 a99, v29
v_accvgpr_read_b32 v26, a112
v_accvgpr_read_b32 v27, a113
v_accvgpr_read_b32 v28, a114
v_accvgpr_read_b32 v29, a115
v_mul_f32 v26, v26, v68
v_mul_f32 v27, v27, v68
v_mul_f32 v28, v28, v68
v_mul_f32 v29, v29, v68
v_accvgpr_write_b32 a112, v26
v_accvgpr_write_b32 a113, v27
v_accvgpr_write_b32 a114, v28
v_accvgpr_write_b32 a115, v29
v_max3_f32 v74, v200, v201, v202
v_max3_f32 v74, v74, v203, v204
v_max3_f32 v74, v74, v205, v206
v_max3_f32 v74, v74, v207, v65
v_mov_b32 v75, v74
s_nop 1
v_permlane16_swap_b32 v74, v75
s_nop 1
v_max_f32 v74, v74, v75
v_mov_b32 v75, v74
s_nop 1
v_permlane32_swap_b32 v74, v75
s_nop 1
v_max_f32 v74, v74, v75
v_sub_f32 v69, v65, v74
v_mov_b32 v65, v74
v_exp_f32 v69, v69
v_sub_f32 v200, v200, v74
v_sub_f32 v201, v201, v74
v_sub_f32 v202, v202, v74
v_sub_f32 v203, v203, v74
v_sub_f32 v204, v204, v74
v_sub_f32 v205, v205, v74
v_sub_f32 v206, v206, v74
v_sub_f32 v207, v207, v74
v_exp_f32 v200, v200
v_exp_f32 v201, v201
v_exp_f32 v202, v202
v_exp_f32 v203, v203
v_exp_f32 v204, v204
v_exp_f32 v205, v205
v_exp_f32 v206, v206
v_exp_f32 v207, v207
v_mul_f32 v125, v125, v69
v_add_f32 v125, v125, v200
v_add_f32 v125, v125, v201
v_add_f32 v125, v125, v202
v_add_f32 v125, v125, v203
v_add_f32 v125, v125, v204
v_add_f32 v125, v125, v205
v_add_f32 v125, v125, v206
v_add_f32 v125, v125, v207
v_cvt_pk_bf16_f32 v36, v200, v201
v_cvt_pk_bf16_f32 v37, v202, v203
v_cvt_pk_bf16_f32 v38, v204, v205
v_cvt_pk_bf16_f32 v39, v206, v207
v_accvgpr_read_b32 v26, a4
v_accvgpr_read_b32 v27, a5
v_accvgpr_read_b32 v28, a6
v_accvgpr_read_b32 v29, a7
v_mul_f32 v26, v26, v69
v_mul_f32 v27, v27, v69
v_mul_f32 v28, v28, v69
v_mul_f32 v29, v29, v69
v_accvgpr_write_b32 a4, v26
v_accvgpr_write_b32 a5, v27
v_accvgpr_write_b32 a6, v28
v_accvgpr_write_b32 a7, v29
v_accvgpr_read_b32 v26, a20
v_accvgpr_read_b32 v27, a21
v_accvgpr_read_b32 v28, a22
v_accvgpr_read_b32 v29, a23
v_mul_f32 v26, v26, v69
v_mul_f32 v27, v27, v69
v_mul_f32 v28, v28, v69
v_mul_f32 v29, v29, v69
v_accvgpr_write_b32 a20, v26
v_accvgpr_write_b32 a21, v27
v_accvgpr_write_b32 a22, v28
v_accvgpr_write_b32 a23, v29
v_accvgpr_read_b32 v26, a36
v_accvgpr_read_b32 v27, a37
v_accvgpr_read_b32 v28, a38
v_accvgpr_read_b32 v29, a39
v_mul_f32 v26, v26, v69
v_mul_f32 v27, v27, v69
v_mul_f32 v28, v28, v69
v_mul_f32 v29, v29, v69
v_accvgpr_write_b32 a36, v26
v_accvgpr_write_b32 a37, v27
v_accvgpr_write_b32 a38, v28
v_accvgpr_write_b32 a39, v29
v_accvgpr_read_b32 v26, a52
v_accvgpr_read_b32 v27, a53
v_accvgpr_read_b32 v28, a54
v_accvgpr_read_b32 v29, a55
v_mul_f32 v26, v26, v69
v_mul_f32 v27, v27, v69
v_mul_f32 v28, v28, v69
v_mul_f32 v29, v29, v69
v_accvgpr_write_b32 a52, v26
v_accvgpr_write_b32 a53, v27
v_accvgpr_write_b32 a54, v28
v_accvgpr_write_b32 a55, v29
v_accvgpr_read_b32 v26, a68
v_accvgpr_read_b32 v27, a69
v_accvgpr_read_b32 v28, a70
v_accvgpr_read_b32 v29, a71
v_mul_f32 v26, v26, v69
v_mul_f32 v27, v27, v69
v_mul_f32 v28, v28, v69
v_mul_f32 v29, v29, v69
v_accvgpr_write_b32 a68, v26
v_accvgpr_write_b32 a69, v27
v_accvgpr_write_b32 a70, v28
v_accvgpr_write_b32 a71, v29
v_accvgpr_read_b32 v26, a84
v_accvgpr_read_b32 v27, a85
v_accvgpr_read_b32 v28, a86
v_accvgpr_read_b32 v29, a87
v_mul_f32 v26, v26, v69
v_mul_f32 v27, v27, v69
v_mul_f32 v28, v28, v69
v_mul_f32 v29, v29, v69
v_accvgpr_write_b32 a84, v26
v_accvgpr_write_b32 a85, v27
v_accvgpr_write_b32 a86, v28
v_accvgpr_write_b32 a87, v29
v_accvgpr_read_b32 v26, a100
v_accvgpr_read_b32 v27, a101
v_accvgpr_read_b32 v28, a102
v_accvgpr_read_b32 v29, a103
v_mul_f32 v26, v26, v69
v_mul_f32 v27, v27, v69
v_mul_f32 v28, v28, v69
v_mul_f32 v29, v29, v69
v_accvgpr_write_b32 a100, v26
v_accvgpr_write_b32 a101, v27
v_accvgpr_write_b32 a102, v28
v_accvgpr_write_b32 a103, v29
v_accvgpr_read_b32 v26, a116
v_accvgpr_read_b32 v27, a117
v_accvgpr_read_b32 v28, a118
v_accvgpr_read_b32 v29, a119
v_mul_f32 v26, v26, v69
v_mul_f32 v27, v27, v69
v_mul_f32 v28, v28, v69
v_mul_f32 v29, v29, v69
v_accvgpr_write_b32 a116, v26
v_accvgpr_write_b32 a117, v27
v_accvgpr_write_b32 a118, v28
v_accvgpr_write_b32 a119, v29
v_max3_f32 v76, v208, v209, v210
v_max3_f32 v76, v76, v211, v212
v_max3_f32 v76, v76, v213, v214
v_max3_f32 v76, v76, v215, v66
v_mov_b32 v77, v76
s_nop 1
v_permlane16_swap_b32 v76, v77
s_nop 1
v_max_f32 v76, v76, v77
v_mov_b32 v77, v76
s_nop 1
v_permlane32_swap_b32 v76, v77
s_nop 1
v_max_f32 v76, v76, v77
v_sub_f32 v70, v66, v76
v_mov_b32 v66, v76
v_exp_f32 v70, v70
v_sub_f32 v208, v208, v76
v_sub_f32 v209, v209, v76
v_sub_f32 v210, v210, v76
v_sub_f32 v211, v211, v76
v_sub_f32 v212, v212, v76
v_sub_f32 v213, v213, v76
v_sub_f32 v214, v214, v76
v_sub_f32 v215, v215, v76
v_exp_f32 v208, v208
v_exp_f32 v209, v209
v_exp_f32 v210, v210
v_exp_f32 v211, v211
v_exp_f32 v212, v212
v_exp_f32 v213, v213
v_exp_f32 v214, v214
v_exp_f32 v215, v215
v_mul_f32 v126, v126, v70
v_add_f32 v126, v126, v208
v_add_f32 v126, v126, v209
v_add_f32 v126, v126, v210
v_add_f32 v126, v126, v211
v_add_f32 v126, v126, v212
v_add_f32 v126, v126, v213
v_add_f32 v126, v126, v214
v_add_f32 v126, v126, v215
v_cvt_pk_bf16_f32 v40, v208, v209
v_cvt_pk_bf16_f32 v41, v210, v211
v_cvt_pk_bf16_f32 v42, v212, v213
v_cvt_pk_bf16_f32 v43, v214, v215
v_accvgpr_read_b32 v26, a8
v_accvgpr_read_b32 v27, a9
v_accvgpr_read_b32 v28, a10
v_accvgpr_read_b32 v29, a11
v_mul_f32 v26, v26, v70
v_mul_f32 v27, v27, v70
v_mul_f32 v28, v28, v70
v_mul_f32 v29, v29, v70
v_accvgpr_write_b32 a8, v26
v_accvgpr_write_b32 a9, v27
v_accvgpr_write_b32 a10, v28
v_accvgpr_write_b32 a11, v29
v_accvgpr_read_b32 v26, a24
v_accvgpr_read_b32 v27, a25
v_accvgpr_read_b32 v28, a26
v_accvgpr_read_b32 v29, a27
v_mul_f32 v26, v26, v70
v_mul_f32 v27, v27, v70
v_mul_f32 v28, v28, v70
v_mul_f32 v29, v29, v70
v_accvgpr_write_b32 a24, v26
v_accvgpr_write_b32 a25, v27
v_accvgpr_write_b32 a26, v28
v_accvgpr_write_b32 a27, v29
v_accvgpr_read_b32 v26, a40
v_accvgpr_read_b32 v27, a41
v_accvgpr_read_b32 v28, a42
v_accvgpr_read_b32 v29, a43
v_mul_f32 v26, v26, v70
v_mul_f32 v27, v27, v70
v_mul_f32 v28, v28, v70
v_mul_f32 v29, v29, v70
v_accvgpr_write_b32 a40, v26
v_accvgpr_write_b32 a41, v27
v_accvgpr_write_b32 a42, v28
v_accvgpr_write_b32 a43, v29
v_accvgpr_read_b32 v26, a56
v_accvgpr_read_b32 v27, a57
v_accvgpr_read_b32 v28, a58
v_accvgpr_read_b32 v29, a59
v_mul_f32 v26, v26, v70
v_mul_f32 v27, v27, v70
v_mul_f32 v28, v28, v70
v_mul_f32 v29, v29, v70
v_accvgpr_write_b32 a56, v26
v_accvgpr_write_b32 a57, v27
v_accvgpr_write_b32 a58, v28
v_accvgpr_write_b32 a59, v29
v_accvgpr_read_b32 v26, a72
v_accvgpr_read_b32 v27, a73
v_accvgpr_read_b32 v28, a74
v_accvgpr_read_b32 v29, a75
v_mul_f32 v26, v26, v70
v_mul_f32 v27, v27, v70
v_mul_f32 v28, v28, v70
v_mul_f32 v29, v29, v70
v_accvgpr_write_b32 a72, v26
v_accvgpr_write_b32 a73, v27
v_accvgpr_write_b32 a74, v28
v_accvgpr_write_b32 a75, v29
v_accvgpr_read_b32 v26, a88
v_accvgpr_read_b32 v27, a89
v_accvgpr_read_b32 v28, a90
v_accvgpr_read_b32 v29, a91
v_mul_f32 v26, v26, v70
v_mul_f32 v27, v27, v70
v_mul_f32 v28, v28, v70
v_mul_f32 v29, v29, v70
v_accvgpr_write_b32 a88, v26
v_accvgpr_write_b32 a89, v27
v_accvgpr_write_b32 a90, v28
v_accvgpr_write_b32 a91, v29
v_accvgpr_read_b32 v26, a104
v_accvgpr_read_b32 v27, a105
v_accvgpr_read_b32 v28, a106
v_accvgpr_read_b32 v29, a107
v_mul_f32 v26, v26, v70
v_mul_f32 v27, v27, v70
v_mul_f32 v28, v28, v70
v_mul_f32 v29, v29, v70
v_accvgpr_write_b32 a104, v26
v_accvgpr_write_b32 a105, v27
v_accvgpr_write_b32 a106, v28
v_accvgpr_write_b32 a107, v29
v_accvgpr_read_b32 v26, a120
v_accvgpr_read_b32 v27, a121
v_accvgpr_read_b32 v28, a122
v_accvgpr_read_b32 v29, a123
v_mul_f32 v26, v26, v70
v_mul_f32 v27, v27, v70
v_mul_f32 v28, v28, v70
v_mul_f32 v29, v29, v70
v_accvgpr_write_b32 a120, v26
v_accvgpr_write_b32 a121, v27
v_accvgpr_write_b32 a122, v28
v_accvgpr_write_b32 a123, v29
v_max3_f32 v78, v216, v217, v218
v_max3_f32 v78, v78, v219, v220
v_max3_f32 v78, v78, v221, v222
v_max3_f32 v78, v78, v223, v67
v_mov_b32 v79, v78
s_nop 1
v_permlane16_swap_b32 v78, v79
s_nop 1
v_max_f32 v78, v78, v79
v_mov_b32 v79, v78
s_nop 1
v_permlane32_swap_b32 v78, v79
s_nop 1
v_max_f32 v78, v78, v79
v_sub_f32 v71, v67, v78
v_mov_b32 v67, v78
v_exp_f32 v71, v71
v_sub_f32 v216, v216, v78
v_sub_f32 v217, v217, v78
v_sub_f32 v218, v218, v78
v_sub_f32 v219, v219, v78
v_sub_f32 v220, v220, v78
v_sub_f32 v221, v221, v78
v_sub_f32 v222, v222, v78
v_sub_f32 v223, v223, v78
v_exp_f32 v216, v216
v_exp_f32 v217, v217
v_exp_f32 v218, v218
v_exp_f32 v219, v219
v_exp_f32 v220, v220
v_exp_f32 v221, v221
v_exp_f32 v222, v222
v_exp_f32 v223, v223
v_mul_f32 v127, v127, v71
v_add_f32 v127, v127, v216
v_add_f32 v127, v127, v217
v_add_f32 v127, v127, v218
v_add_f32 v127, v127, v219
v_add_f32 v127, v127, v220
v_add_f32 v127, v127, v221
v_add_f32 v127, v127, v222
v_add_f32 v127, v127, v223
v_cvt_pk_bf16_f32 v44, v216, v217
v_cvt_pk_bf16_f32 v45, v218, v219
v_cvt_pk_bf16_f32 v46, v220, v221
v_cvt_pk_bf16_f32 v47, v222, v223
v_accvgpr_read_b32 v26, a12
v_accvgpr_read_b32 v27, a13
v_accvgpr_read_b32 v28, a14
v_accvgpr_read_b32 v29, a15
v_mul_f32 v26, v26, v71
v_mul_f32 v27, v27, v71
v_mul_f32 v28, v28, v71
v_mul_f32 v29, v29, v71
v_accvgpr_write_b32 a12, v26
v_accvgpr_write_b32 a13, v27
v_accvgpr_write_b32 a14, v28
v_accvgpr_write_b32 a15, v29
v_accvgpr_read_b32 v26, a28
v_accvgpr_read_b32 v27, a29
v_accvgpr_read_b32 v28, a30
v_accvgpr_read_b32 v29, a31
v_mul_f32 v26, v26, v71
v_mul_f32 v27, v27, v71
v_mul_f32 v28, v28, v71
v_mul_f32 v29, v29, v71
v_accvgpr_write_b32 a28, v26
v_accvgpr_write_b32 a29, v27
v_accvgpr_write_b32 a30, v28
v_accvgpr_write_b32 a31, v29
v_accvgpr_read_b32 v26, a44
v_accvgpr_read_b32 v27, a45
v_accvgpr_read_b32 v28, a46
v_accvgpr_read_b32 v29, a47
v_mul_f32 v26, v26, v71
v_mul_f32 v27, v27, v71
v_mul_f32 v28, v28, v71
v_mul_f32 v29, v29, v71
v_accvgpr_write_b32 a44, v26
v_accvgpr_write_b32 a45, v27
v_accvgpr_write_b32 a46, v28
v_accvgpr_write_b32 a47, v29
v_accvgpr_read_b32 v26, a60
v_accvgpr_read_b32 v27, a61
v_accvgpr_read_b32 v28, a62
v_accvgpr_read_b32 v29, a63
v_mul_f32 v26, v26, v71
v_mul_f32 v27, v27, v71
v_mul_f32 v28, v28, v71
v_mul_f32 v29, v29, v71
v_accvgpr_write_b32 a60, v26
v_accvgpr_write_b32 a61, v27
v_accvgpr_write_b32 a62, v28
v_accvgpr_write_b32 a63, v29
v_accvgpr_read_b32 v26, a76
v_accvgpr_read_b32 v27, a77
v_accvgpr_read_b32 v28, a78
v_accvgpr_read_b32 v29, a79
v_mul_f32 v26, v26, v71
v_mul_f32 v27, v27, v71
v_mul_f32 v28, v28, v71
v_mul_f32 v29, v29, v71
v_accvgpr_write_b32 a76, v26
v_accvgpr_write_b32 a77, v27
v_accvgpr_write_b32 a78, v28
v_accvgpr_write_b32 a79, v29
v_accvgpr_read_b32 v26, a92
v_accvgpr_read_b32 v27, a93
v_accvgpr_read_b32 v28, a94
v_accvgpr_read_b32 v29, a95
v_mul_f32 v26, v26, v71
v_mul_f32 v27, v27, v71
v_mul_f32 v28, v28, v71
v_mul_f32 v29, v29, v71
v_accvgpr_write_b32 a92, v26
v_accvgpr_write_b32 a93, v27
v_accvgpr_write_b32 a94, v28
v_accvgpr_write_b32 a95, v29
v_accvgpr_read_b32 v26, a108
v_accvgpr_read_b32 v27, a109
v_accvgpr_read_b32 v28, a110
v_accvgpr_read_b32 v29, a111
v_mul_f32 v26, v26, v71
v_mul_f32 v27, v27, v71
v_mul_f32 v28, v28, v71
v_mul_f32 v29, v29, v71
v_accvgpr_write_b32 a108, v26
v_accvgpr_write_b32 a109, v27
v_accvgpr_write_b32 a110, v28
v_accvgpr_write_b32 a111, v29
v_accvgpr_read_b32 v26, a124
v_accvgpr_read_b32 v27, a125
v_accvgpr_read_b32 v28, a126
v_accvgpr_read_b32 v29, a127
v_mul_f32 v26, v26, v71
v_mul_f32 v27, v27, v71
v_mul_f32 v28, v28, v71
v_mul_f32 v29, v29, v71
v_accvgpr_write_b32 a124, v26
v_accvgpr_write_b32 a125, v27
v_accvgpr_write_b32 a126, v28
v_accvgpr_write_b32 a127, v29
s_nop 1
v_mfma_f32_16x16x32_bf16 a[0:3], a[224:227], v[32:35], a[0:3]
v_mfma_f32_16x16x32_bf16 a[16:19], a[228:231], v[32:35], a[16:19]
v_mfma_f32_16x16x32_bf16 a[32:35], a[232:235], v[32:35], a[32:35]
v_mfma_f32_16x16x32_bf16 a[48:51], a[236:239], v[32:35], a[48:51]
v_mfma_f32_16x16x32_bf16 a[64:67], a[240:243], v[32:35], a[64:67]
v_mfma_f32_16x16x32_bf16 a[80:83], a[244:247], v[32:35], a[80:83]
v_mfma_f32_16x16x32_bf16 a[96:99], a[248:251], v[32:35], a[96:99]
v_mfma_f32_16x16x32_bf16 a[112:115], a[252:255], v[32:35], a[112:115]
v_mfma_f32_16x16x32_bf16 a[4:7], a[224:227], v[36:39], a[4:7]
v_mfma_f32_16x16x32_bf16 a[20:23], a[228:231], v[36:39], a[20:23]
v_mfma_f32_16x16x32_bf16 a[36:39], a[232:235], v[36:39], a[36:39]
v_mfma_f32_16x16x32_bf16 a[52:55], a[236:239], v[36:39], a[52:55]
v_mfma_f32_16x16x32_bf16 a[68:71], a[240:243], v[36:39], a[68:71]
v_mfma_f32_16x16x32_bf16 a[84:87], a[244:247], v[36:39], a[84:87]
v_mfma_f32_16x16x32_bf16 a[100:103], a[248:251], v[36:39], a[100:103]
v_mfma_f32_16x16x32_bf16 a[116:119], a[252:255], v[36:39], a[116:119]
v_mfma_f32_16x16x32_bf16 a[8:11], a[224:227], v[40:43], a[8:11]
v_mfma_f32_16x16x32_bf16 a[24:27], a[228:231], v[40:43], a[24:27]
v_mfma_f32_16x16x32_bf16 a[40:43], a[232:235], v[40:43], a[40:43]
v_mfma_f32_16x16x32_bf16 a[56:59], a[236:239], v[40:43], a[56:59]
v_mfma_f32_16x16x32_bf16 a[72:75], a[240:243], v[40:43], a[72:75]
v_mfma_f32_16x16x32_bf16 a[88:91], a[244:247], v[40:43], a[88:91]
v_mfma_f32_16x16x32_bf16 a[104:107], a[248:251], v[40:43], a[104:107]
v_mfma_f32_16x16x32_bf16 a[120:123], a[252:255], v[40:43], a[120:123]
v_mfma_f32_16x16x32_bf16 a[12:15], a[224:227], v[44:47], a[12:15]
v_mfma_f32_16x16x32_bf16 a[28:31], a[228:231], v[44:47], a[28:31]
v_mfma_f32_16x16x32_bf16 a[44:47], a[232:235], v[44:47], a[44:47]
v_mfma_f32_16x16x32_bf16 a[60:63], a[236:239], v[44:47], a[60:63]
v_mfma_f32_16x16x32_bf16 a[76:79], a[240:243], v[44:47], a[76:79]
v_mfma_f32_16x16x32_bf16 a[92:95], a[244:247], v[44:47], a[92:95]
v_mfma_f32_16x16x32_bf16 a[108:111], a[248:251], v[44:47], a[108:111]
v_mfma_f32_16x16x32_bf16 a[124:127], a[252:255], v[44:47], a[124:127]
s_nop 7
s_add_u32 s80, s80, 8192
s_cmp_lt_u32 s80, 0x80000
s_cbranch_scc1 L_fb_loop
v_mov_b32 v26, v124
s_nop 1
v_permlane16_swap_b32 v124, v26
s_nop 1
v_add_f32 v124, v124, v26
v_mov_b32 v26, v124
s_nop 1
v_permlane32_swap_b32 v124, v26
s_nop 1
v_add_f32 v124, v124, v26
v_mov_b32 v26, v125
s_nop 1
v_permlane16_swap_b32 v125, v26
s_nop 1
v_add_f32 v125, v125, v26
v_mov_b32 v26, v125
s_nop 1
v_permlane32_swap_b32 v125, v26
s_nop 1
v_add_f32 v125, v125, v26
v_mov_b32 v26, v126
s_nop 1
v_permlane16_swap_b32 v126, v26
s_nop 1
v_add_f32 v126, v126, v26
v_mov_b32 v26, v126
s_nop 1
v_permlane32_swap_b32 v126, v26
s_nop 1
v_add_f32 v126, v126, v26
v_mov_b32 v26, v127
s_nop 1
v_permlane16_swap_b32 v127, v26
s_nop 1
v_add_f32 v127, v127, v26
v_mov_b32 v26, v127
s_nop 1
v_permlane32_swap_b32 v127, v26
s_nop 1
v_add_f32 v127, v127, v26
s_branch L_fb_ret
.section .rodata,"a"
.p2align 6
.amdhsa_kernel recurrent_scan__gqa_block_cached__geglu_ffn__prompt_kernel
  .amdhsa_next_free_vgpr 512
  .amdhsa_next_free_sgpr 102
  .amdhsa_accum_offset 256
  .amdhsa_group_segment_fixed_size 0
  .amdhsa_kernarg_size 96
  .amdhsa_user_sgpr_count 2
  .amdhsa_user_sgpr_kernarg_segment_ptr 1
  .amdhsa_system_sgpr_workgroup_id_x 1
.end_amdhsa_kernel
```
